```python
import torch

def _softmax(x, axis=-1):
    return torch.softmax(x, dim=axis)
def _gelu(x):
    return torch.nn.functional.gelu(x, approximate="tanh")
def _silu(x):
    return torch.nn.functional.silu(x)
def _sigmoid(x):
    return torch.sigmoid(x)
def _layernorm(x, axis=-1, eps=1e-5):
    m = x.mean(dim=axis, keepdim=True)
    v = x.var(dim=axis, keepdim=True, unbiased=False)
    return (x - m) / torch.sqrt(v + eps)
def _scatter_add(tgt, idx, src, axis=0):
    return tgt.clone().index_add_(axis, idx, src)
def _segment_sum(src, seg, n):
    out = torch.zeros((n,) + src.shape[1:], dtype=src.dtype)
    return out.index_add_(0, seg, src)
def _pad(x, pw):
    flat = tuple(v for pair in reversed(pw) for v in pair)
    return torch.nn.functional.pad(x, flat)

kernel_name = 'interleave_layers__linear_kernel_hedgehog__mixer_s_mlp__prompt'

def setup_inputs():

    _w = (lambda a: (lambda t: t.to(torch.bfloat16) if t.is_floating_point() else t)(torch.as_tensor(a)))
    def _A_setup():
        B, S, D, H = 1, 2048, 1024, 32
        Dh = D // H
        return {
            "x": _w((lambda *s: torch.randn(*s, dtype=torch.bfloat16) * 0.05)(B, S, D)),
            "wqkv": _w((lambda *s: torch.randn(*s, dtype=torch.bfloat16) * 0.2)(D, 3 * D)),
            "w_phi": _w((lambda *s: torch.randn(*s, dtype=torch.bfloat16) * 0.2)(H, Dh, Dh) * (Dh ** -0.5)),
            "wo": _w((lambda *s: torch.randn(*s, dtype=torch.bfloat16) * 0.05)(D, D)),
        }
    _A_in = _A_setup()

    def _B_setup():
        B, S, D, F = 1, 2048, 1024, 3584
        return {
            "x":  _w((lambda *s: torch.randn(*s, dtype=torch.bfloat16) * 0.05)(B, S, D)),
            "w1": _w((lambda *s: torch.randn(*s, dtype=torch.bfloat16) * 3.2)(D, D) * (D ** -0.5)),
            "w2": _w((lambda *s: torch.randn(*s, dtype=torch.bfloat16) * 3.2)(D, D) * (D ** -0.5)),
            "w3": _w((lambda *s: torch.randn(*s, dtype=torch.bfloat16) * 3.2)(D, F) * (D ** -0.5)),
            "w4": _w((lambda *s: torch.randn(*s, dtype=torch.bfloat16) * 1.6)(F, D) * (F ** -0.5)),
        }
    _B_in = _B_setup()

    return {
        "A_x": _A_in["x"],
        "A_wqkv": _A_in["wqkv"],
        "A_w_phi": _A_in["w_phi"],
        "A_wo": _A_in["wo"],
        "B_x": _B_in["x"],
        "B_w1": _B_in["w1"],
        "B_w2": _B_in["w2"],
        "B_w3": _B_in["w3"],
        "B_w4": _B_in["w4"],
    }

def reference(A_x, A_wqkv, A_w_phi, A_wo, B_x, B_w1, B_w2, B_w3, B_w4):
    def _A_ref(x, wqkv, w_phi, wo):
        B, S, D = x.shape
        H = 32; Dh = D // H
        qkv = (lambda x, *d: x.permute(*d))((x @ wqkv).reshape(B, S, 3, H, Dh), 2, 0, 3, 1, 4)
        q, k, v = qkv[0], qkv[1], qkv[2]
        pq = torch.einsum("bhsd,hdf->bhsf", q, w_phi)
        pk = torch.einsum("bhsd,hdf->bhsf", k, w_phi)
        phi_q = torch.concatenate([_softmax(pq, axis=-1), _softmax(-pq, axis=-1)], axis=-1)
        phi_k = torch.concatenate([_softmax(pk, axis=-1), _softmax(-pk, axis=-1)], axis=-1)
        kv = torch.einsum("bhsf,bhsd->bhfd", phi_k, v)
        z  = torch.einsum("bhsf->bhf", phi_k)
        num = torch.einsum("bhqf,bhfd->bhqd", phi_q, kv)
        den = torch.einsum("bhqf,bhf->bhq", phi_q, z)[..., None] + 1e-6
        o = num / den
        return (lambda x, *d: x.permute(*d))(o, 0, 2, 1, 3).reshape(B, S, D) @ wo

    def _B_ref(x, w1, w2, w3, w4):
        B, S, D = x.shape
        h = _gelu(_layernorm(x, axis=-1) @ w1)
        c = D // 4
        g0 = _pad(h[:, :, 0*c:1*c], ((0, 0), (1, 0), (0, 0)))[:, :S, :]
        g1 = _pad(h[:, :, 1*c:2*c], ((0, 0), (0, 1), (0, 0)))[:, 1:, :]
        g2 = _pad(h[:, :, 2*c:3*c], ((0, 0), (2, 0), (0, 0)))[:, :S, :]
        g3 = _pad(h[:, :, 3*c:   ], ((0, 0), (0, 2), (0, 0)))[:, 2:, :]
        hs = torch.concatenate([g0, g1, g2, g3], axis=-1) @ w2
        x1 = x + hs
        h2 = _gelu(_layernorm(x1, axis=-1) @ w3) @ w4
        return x1 + h2

    x = A_x
    x = x + _A_ref(_layernorm(x, axis=-1), A_wqkv, A_w_phi, A_wo)
    x = x + _B_ref(_layernorm(x, axis=-1), B_w1, B_w2, B_w3, B_w4)
    x = x + _A_ref(_layernorm(x, axis=-1), A_wqkv, A_w_phi, A_wo)
    x = x + _B_ref(_layernorm(x, axis=-1), B_w1, B_w2, B_w3, B_w4)
    return x
```

```asm
; @launch kernel=lna_0_kernel grid=(512,1,1) block=(256,1,1) lds=0
; @launch kernel=gqkv_0_kernel grid=(256,1,1) block=(512,1,1) lds=163840
; @launch kernel=akv_0_kernel grid=(256,1,1) block=(256,1,1) lds=58368
; @launch kernel=ao_0_kernel grid=(256,1,1) block=(256,1,1) lds=8448
; @launch kernel=gwo_0_kernel grid=(256,1,1) block=(512,1,1) lds=147456
; @launch kernel=lnb_0_kernel grid=(512,1,1) block=(256,1,1) lds=0
; @launch kernel=gw1_0_kernel grid=(256,1,1) block=(512,1,1) lds=147456
; @launch kernel=gw2_0_kernel grid=(256,1,1) block=(512,1,1) lds=147456
; @launch kernel=lnc_0_kernel grid=(512,1,1) block=(256,1,1) lds=0
; @launch kernel=gw3_0_kernel grid=(224,1,1) block=(512,1,1) lds=147456
; @launch kernel=gw4_0_kernel grid=(256,1,1) block=(512,1,1) lds=147456
; @launch kernel=lna_1_kernel grid=(512,1,1) block=(256,1,1) lds=0
; @launch kernel=gqkv_1_kernel grid=(256,1,1) block=(512,1,1) lds=163840
; @launch kernel=akv_1_kernel grid=(256,1,1) block=(256,1,1) lds=58368
; @launch kernel=ao_1_kernel grid=(256,1,1) block=(256,1,1) lds=8448
; @launch kernel=gwo_1_kernel grid=(256,1,1) block=(512,1,1) lds=147456
; @launch kernel=lnb_1_kernel grid=(512,1,1) block=(256,1,1) lds=0
; @launch kernel=gw1_1_kernel grid=(256,1,1) block=(512,1,1) lds=147456
; @launch kernel=gw2_1_kernel grid=(256,1,1) block=(512,1,1) lds=147456
; @launch kernel=lnc_1_kernel grid=(512,1,1) block=(256,1,1) lds=0
; @launch kernel=gw3_1_kernel grid=(224,1,1) block=(512,1,1) lds=147456
; @launch kernel=gw4_1_kernel grid=(256,1,1) block=(512,1,1) lds=147456
.amdgcn_target "amdgcn-amd-amdhsa--gfx950"
.text
.globl lna_0_kernel
.p2align 8
.type lna_0_kernel,@function
lna_0_kernel:
    s_cmp_ge_u32 s2, 512
    s_cbranch_scc1 L_done_lna_0_kernel
    s_load_dwordx2 s[40:41], s[0:1], 0
    s_load_dwordx2 s[42:43], s[0:1], 88
    s_waitcnt lgkmcnt(0)
    s_mov_b32 s8, s40
    s_mov_b32 s9, s41
    s_mov_b32 s10, 4194304
    s_mov_b32 s11, 0x00020000
    s_mov_b32 s12, s42
    s_mov_b32 s13, s43
    s_mov_b32 s14, 4194304
    s_mov_b32 s15, 0x00020000
    s_lshl_b32 s3, s2, 2
    v_lshrrev_b32 v1, 6, v0
    v_add_u32 v1, s3, v1
    v_lshlrev_b32 v1, 11, v1
    v_and_b32 v2, 63, v0
    v_lshlrev_b32 v2, 4, v2
    v_add_u32 v1, v1, v2
    buffer_load_dwordx4 v[8:11], v1, s[8:11], 0 offen
    buffer_load_dwordx4 v[12:15], v1, s[8:11], 0 offen offset:1024
    s_waitcnt vmcnt(0)
    v_lshlrev_b32 v16, 16, v8
    v_and_b32 v17, 0xffff0000, v8
    v_lshlrev_b32 v18, 16, v9
    v_and_b32 v19, 0xffff0000, v9
    v_lshlrev_b32 v20, 16, v10
    v_and_b32 v21, 0xffff0000, v10
    v_lshlrev_b32 v22, 16, v11
    v_and_b32 v23, 0xffff0000, v11
    v_lshlrev_b32 v24, 16, v12
    v_and_b32 v25, 0xffff0000, v12
    v_lshlrev_b32 v26, 16, v13
    v_and_b32 v27, 0xffff0000, v13
    v_lshlrev_b32 v28, 16, v14
    v_and_b32 v29, 0xffff0000, v14
    v_lshlrev_b32 v30, 16, v15
    v_and_b32 v31, 0xffff0000, v15
    v_mov_b32 v4, 0
    v_add_f32 v4, v4, v16
    v_add_f32 v4, v4, v17
    v_add_f32 v4, v4, v18
    v_add_f32 v4, v4, v19
    v_add_f32 v4, v4, v20
    v_add_f32 v4, v4, v21
    v_add_f32 v4, v4, v22
    v_add_f32 v4, v4, v23
    v_add_f32 v4, v4, v24
    v_add_f32 v4, v4, v25
    v_add_f32 v4, v4, v26
    v_add_f32 v4, v4, v27
    v_add_f32 v4, v4, v28
    v_add_f32 v4, v4, v29
    v_add_f32 v4, v4, v30
    v_add_f32 v4, v4, v31
    ds_swizzle_b32 v5, v4 offset:0x041F
    s_waitcnt lgkmcnt(0)
    v_add_f32 v4, v4, v5
    ds_swizzle_b32 v5, v4 offset:0x081F
    s_waitcnt lgkmcnt(0)
    v_add_f32 v4, v4, v5
    ds_swizzle_b32 v5, v4 offset:0x101F
    s_waitcnt lgkmcnt(0)
    v_add_f32 v4, v4, v5
    ds_swizzle_b32 v5, v4 offset:0x201F
    s_waitcnt lgkmcnt(0)
    v_add_f32 v4, v4, v5
    ds_swizzle_b32 v5, v4 offset:0x401F
    s_waitcnt lgkmcnt(0)
    v_add_f32 v4, v4, v5
    s_nop 0
    v_readlane_b32 s30, v4, 32
    v_readlane_b32 s31, v4, 0
    s_nop 1
    v_mov_b32 v4, s30
    v_add_f32 v4, s31, v4
    v_mul_f32 v4, 0x3a800000, v4
    v_mov_b32 v6, 0
    v_sub_f32 v16, v16, v4
    v_fmac_f32 v6, v16, v16
    v_sub_f32 v17, v17, v4
    v_fmac_f32 v6, v17, v17
    v_sub_f32 v18, v18, v4
    v_fmac_f32 v6, v18, v18
    v_sub_f32 v19, v19, v4
    v_fmac_f32 v6, v19, v19
    v_sub_f32 v20, v20, v4
    v_fmac_f32 v6, v20, v20
    v_sub_f32 v21, v21, v4
    v_fmac_f32 v6, v21, v21
    v_sub_f32 v22, v22, v4
    v_fmac_f32 v6, v22, v22
    v_sub_f32 v23, v23, v4
    v_fmac_f32 v6, v23, v23
    v_sub_f32 v24, v24, v4
    v_fmac_f32 v6, v24, v24
    v_sub_f32 v25, v25, v4
    v_fmac_f32 v6, v25, v25
    v_sub_f32 v26, v26, v4
    v_fmac_f32 v6, v26, v26
    v_sub_f32 v27, v27, v4
    v_fmac_f32 v6, v27, v27
    v_sub_f32 v28, v28, v4
    v_fmac_f32 v6, v28, v28
    v_sub_f32 v29, v29, v4
    v_fmac_f32 v6, v29, v29
    v_sub_f32 v30, v30, v4
    v_fmac_f32 v6, v30, v30
    v_sub_f32 v31, v31, v4
    v_fmac_f32 v6, v31, v31
    ds_swizzle_b32 v5, v6 offset:0x041F
    s_waitcnt lgkmcnt(0)
    v_add_f32 v6, v6, v5
    ds_swizzle_b32 v5, v6 offset:0x081F
    s_waitcnt lgkmcnt(0)
    v_add_f32 v6, v6, v5
    ds_swizzle_b32 v5, v6 offset:0x101F
    s_waitcnt lgkmcnt(0)
    v_add_f32 v6, v6, v5
    ds_swizzle_b32 v5, v6 offset:0x201F
    s_waitcnt lgkmcnt(0)
    v_add_f32 v6, v6, v5
    ds_swizzle_b32 v5, v6 offset:0x401F
    s_waitcnt lgkmcnt(0)
    v_add_f32 v6, v6, v5
    s_nop 0
    v_readlane_b32 s30, v6, 32
    v_readlane_b32 s31, v6, 0
    s_nop 1
    v_mov_b32 v6, s30
    v_add_f32 v6, s31, v6
    v_mov_b32 v5, 0x3727c5ac
    v_fmac_f32 v5, 0x3a800000, v6
    v_rsq_f32 v5, v5
    s_nop 0
    v_mul_f32 v16, v16, v5
    v_mul_f32 v17, v17, v5
    v_mul_f32 v18, v18, v5
    v_mul_f32 v19, v19, v5
    v_mul_f32 v20, v20, v5
    v_mul_f32 v21, v21, v5
    v_mul_f32 v22, v22, v5
    v_mul_f32 v23, v23, v5
    v_mul_f32 v24, v24, v5
    v_mul_f32 v25, v25, v5
    v_mul_f32 v26, v26, v5
    v_mul_f32 v27, v27, v5
    v_mul_f32 v28, v28, v5
    v_mul_f32 v29, v29, v5
    v_mul_f32 v30, v30, v5
    v_mul_f32 v31, v31, v5
    v_cvt_pk_bf16_f32 v32, v16, v17
    v_cvt_pk_bf16_f32 v33, v18, v19
    v_cvt_pk_bf16_f32 v34, v20, v21
    v_cvt_pk_bf16_f32 v35, v22, v23
    v_cvt_pk_bf16_f32 v36, v24, v25
    v_cvt_pk_bf16_f32 v37, v26, v27
    v_cvt_pk_bf16_f32 v38, v28, v29
    v_cvt_pk_bf16_f32 v39, v30, v31
    buffer_store_dwordx4 v[32:35], v1, s[12:15], 0 offen
    buffer_store_dwordx4 v[36:39], v1, s[12:15], 0 offen offset:1024
L_done_lna_0_kernel:
    s_endpgm
.globl gqkv_0_kernel
.p2align 8
.type gqkv_0_kernel,@function
gqkv_0_kernel:
    s_cmp_ge_u32 s2, 256
    s_cbranch_scc1 L_done_gqkv_0_kernel
    s_load_dwordx2 s[40:41], s[0:1], 8
    s_load_dwordx2 s[42:43], s[0:1], 88
    s_waitcnt lgkmcnt(0)
    s_mov_b32 s8, s42
    s_mov_b32 s9, s43
    s_mov_b32 s10, 4194304
    s_mov_b32 s11, 0x00020000
    s_mov_b32 s12, s40
    s_mov_b32 s13, s41
    s_mov_b32 s14, 6291456
    s_mov_b32 s15, 0x00020000
    s_add_u32 s16, s42, 4194304
    s_addc_u32 s17, s43, 0
    s_mov_b32 s18, 12582912
    s_mov_b32 s19, 0x00020000
    s_mov_b32 s36, 0x3d372713
    s_mov_b32 s37, 0xc0135761
    s_and_b32 s3, s2, 7
    s_lshr_b32 s4, s2, 3
    s_mul_i32 s5, s4, 16384
    s_lshr_b32 s5, s5, 16
    s_mul_i32 s6, s5, 4
    s_sub_u32 s6, s4, s6
    s_lshr_b32 s7, s3, 2
    s_mul_i32 s7, s7, 8
    s_add_u32 s28, s7, s5
    s_and_b32 s7, s3, 3
    s_mul_i32 s7, s7, 4
    s_add_u32 s29, s7, s6
    v_lshrrev_b32 v1, 6, v0
    s_nop 0
    v_readfirstlane_b32 s30, v1
    v_and_b32 v0, 63, v0
    v_lshrrev_b32 v1, 3, v0
    s_lshl_b32 s31, s30, 4
    s_lshl_b32 s34, s28, 7
    s_add_u32 s31, s31, s34
    v_add_u32 v1, s31, v1
    v_add_u32 v6, 0, v1
    v_lshrrev_b32 v7, 1, v6
    v_and_b32 v7, 7, v7
    v_and_b32 v8, 7, v0
    v_xor_b32 v7, v7, v8
    v_lshlrev_b32 v7, 4, v7
    s_mov_b32 s35, 2048
    v_mul_lo_u32 v6, v6, s35
    v_add_u32 v2, v6, v7
    v_add_u32 v6, 8, v1
    v_lshrrev_b32 v7, 1, v6
    v_and_b32 v7, 7, v7
    v_and_b32 v8, 7, v0
    v_xor_b32 v7, v7, v8
    v_lshlrev_b32 v7, 4, v7
    s_mov_b32 s35, 2048
    v_mul_lo_u32 v6, v6, s35
    v_add_u32 v3, v6, v7
    s_mul_i32 s31, s30, 192
    s_mul_i32 s34, s29, 384
    v_add_u32 v6, s31, v0
    v_add_u32 v6, 0, v6
    v_mul_u32_u24 v7, 2731, v6
    v_lshrrev_b32 v7, 16, v7
    v_mul_u32_u24 v8, 24, v7
    v_sub_u32 v8, v6, v8
    v_lshlrev_b32 v9, 1, v7
    v_and_b32 v9, 4, v9
    v_xor_b32 v8, v8, v9
    v_lshlrev_b32 v8, 4, v8
    s_mov_b32 s35, 6144
    v_mul_lo_u32 v7, v7, s35
    v_add_u32 v7, v7, v8
    v_add_u32 v10, s34, v7
    v_add_u32 v6, s31, v0
    v_add_u32 v6, 64, v6
    v_mul_u32_u24 v7, 2731, v6
    v_lshrrev_b32 v7, 16, v7
    v_mul_u32_u24 v8, 24, v7
    v_sub_u32 v8, v6, v8
    v_lshlrev_b32 v9, 1, v7
    v_and_b32 v9, 4, v9
    v_xor_b32 v8, v8, v9
    v_lshlrev_b32 v8, 4, v8
    s_mov_b32 s35, 6144
    v_mul_lo_u32 v7, v7, s35
    v_add_u32 v7, v7, v8
    v_add_u32 v11, s34, v7
    v_add_u32 v6, s31, v0
    v_add_u32 v6, 128, v6
    v_mul_u32_u24 v7, 2731, v6
    v_lshrrev_b32 v7, 16, v7
    v_mul_u32_u24 v8, 24, v7
    v_sub_u32 v8, v6, v8
    v_lshlrev_b32 v9, 1, v7
    v_and_b32 v9, 4, v9
    v_xor_b32 v8, v8, v9
    v_lshlrev_b32 v8, 4, v8
    s_mov_b32 s35, 6144
    v_mul_lo_u32 v7, v7, s35
    v_add_u32 v7, v7, v8
    v_add_u32 v12, s34, v7
    s_lshr_b32 s31, s30, 1
    s_and_b32 s34, s30, 1
    s_mul_i32 s38, s31, 32
    s_mul_i32 s39, s34, 96
    v_and_b32 v6, 31, v0
    v_add_u32 v6, s38, v6
    v_lshrrev_b32 v7, 1, v6
    v_and_b32 v7, 7, v7
    v_lshrrev_b32 v8, 5, v0
    v_xor_b32 v7, v7, v8
    v_lshlrev_b32 v7, 4, v7
    v_lshlrev_b32 v6, 7, v6
    v_add_u32 v6, v6, v7
    v_xor_b32 v20, 0, v6
    v_add_u32 v36, 65536, v20
    v_xor_b32 v21, 32, v6
    v_add_u32 v37, 65536, v21
    v_xor_b32 v22, 64, v6
    v_add_u32 v38, 65536, v22
    v_xor_b32 v23, 96, v6
    v_add_u32 v39, 65536, v23
    v_lshrrev_b32 v6, 5, v0
    v_lshlrev_b32 v6, 3, v6
    v_bfe_u32 v7, v0, 2, 2
    v_add_u32 v6, v6, v7
    v_bfe_u32 v8, v0, 4, 1
    v_lshlrev_b32 v8, 4, v8
    v_and_b32 v9, 3, v0
    v_lshlrev_b32 v9, 2, v9
    v_add_u32 v8, v8, v9
    v_add_u32 v8, s39, v8
    v_add_u32 v9, 0, v8
    v_lshlrev_b32 v9, 1, v9
    v_lshlrev_b32 v18, 5, v7
    v_and_b32 v18, 64, v18
    v_xor_b32 v9, v9, v18
    v_mul_u32_u24 v19, 384, v6
    v_add_u32 v24, v19, v9
    v_add_u32 v24, 65536, v24
    v_add_u32 v28, 49152, v24
    v_add_u32 v9, 32, v8
    v_lshlrev_b32 v9, 1, v9
    v_lshlrev_b32 v18, 5, v7
    v_and_b32 v18, 64, v18
    v_xor_b32 v9, v9, v18
    v_mul_u32_u24 v19, 384, v6
    v_add_u32 v25, v19, v9
    v_add_u32 v25, 65536, v25
    v_add_u32 v29, 49152, v25
    v_add_u32 v9, 64, v8
    v_lshlrev_b32 v9, 1, v9
    v_lshlrev_b32 v18, 5, v7
    v_and_b32 v18, 64, v18
    v_xor_b32 v9, v9, v18
    v_mul_u32_u24 v19, 384, v6
    v_add_u32 v26, v19, v9
    v_add_u32 v26, 65536, v26
    v_add_u32 v30, 49152, v26
    v_mov_b32 v40, 0
    v_mov_b32 v41, 0
    v_mov_b32 v42, 0
    v_mov_b32 v43, 0
    v_mov_b32 v44, 0
    v_mov_b32 v45, 0
    v_mov_b32 v46, 0
    v_mov_b32 v47, 0
    v_mov_b32 v48, 0
    v_mov_b32 v49, 0
    v_mov_b32 v50, 0
    v_mov_b32 v51, 0
    v_mov_b32 v52, 0
    v_mov_b32 v53, 0
    v_mov_b32 v54, 0
    v_mov_b32 v55, 0
    v_mov_b32 v56, 0
    v_mov_b32 v57, 0
    v_mov_b32 v58, 0
    v_mov_b32 v59, 0
    v_mov_b32 v60, 0
    v_mov_b32 v61, 0
    v_mov_b32 v62, 0
    v_mov_b32 v63, 0
    v_mov_b32 v64, 0
    v_mov_b32 v65, 0
    v_mov_b32 v66, 0
    v_mov_b32 v67, 0
    v_mov_b32 v68, 0
    v_mov_b32 v69, 0
    v_mov_b32 v70, 0
    v_mov_b32 v71, 0
    v_mov_b32 v72, 0
    v_mov_b32 v73, 0
    v_mov_b32 v74, 0
    v_mov_b32 v75, 0
    v_mov_b32 v76, 0
    v_mov_b32 v77, 0
    v_mov_b32 v78, 0
    v_mov_b32 v79, 0
    v_mov_b32 v80, 0
    v_mov_b32 v81, 0
    v_mov_b32 v82, 0
    v_mov_b32 v83, 0
    v_mov_b32 v84, 0
    v_mov_b32 v85, 0
    v_mov_b32 v86, 0
    v_mov_b32 v87, 0
    s_lshl_b32 s40, s30, 11
    s_mul_i32 s41, s30, 3072
    s_add_u32 s41, s41, 65536
    s_mov_b32 s32, 0
    s_mov_b32 s33, 0
    s_and_b32 s42, s4, 15
    s_mov_b32 s42, 0
    s_mov_b32 s35, 0
    s_add_u32 s35, s35, s42
    s_sub_u32 s34, s35, 16
    s_cmp_ge_u32 s35, 16
    s_cselect_b32 s35, s34, s35
    s_mul_i32 s33, s35, 393216
    s_lshl_b32 s32, s35, 7
    s_add_u32 m0, s40, 0
    s_nop 0
    buffer_load_dwordx4 v2, s[8:11], s32 offen lds
    s_add_u32 m0, s40, 1024
    s_nop 0
    buffer_load_dwordx4 v3, s[8:11], s32 offen lds
    s_add_u32 m0, s41, 0
    s_nop 0
    buffer_load_dwordx4 v10, s[12:15], s33 offen lds
    s_add_u32 m0, s41, 1024
    s_nop 0
    buffer_load_dwordx4 v11, s[12:15], s33 offen lds
    s_add_u32 m0, s41, 2048
    s_nop 0
    buffer_load_dwordx4 v12, s[12:15], s33 offen lds
    s_mov_b32 s35, 1
    s_add_u32 s35, s35, s42
    s_sub_u32 s34, s35, 16
    s_cmp_ge_u32 s35, 16
    s_cselect_b32 s35, s34, s35
    s_mul_i32 s33, s35, 393216
    s_lshl_b32 s32, s35, 7
    s_add_u32 m0, s40, 16384
    s_nop 0
    buffer_load_dwordx4 v2, s[8:11], s32 offen lds
    s_add_u32 m0, s40, 17408
    s_nop 0
    buffer_load_dwordx4 v3, s[8:11], s32 offen lds
    s_add_u32 m0, s41, 24576
    s_nop 0
    buffer_load_dwordx4 v10, s[12:15], s33 offen lds
    s_add_u32 m0, s41, 25600
    s_nop 0
    buffer_load_dwordx4 v11, s[12:15], s33 offen lds
    s_add_u32 m0, s41, 26624
    s_nop 0
    buffer_load_dwordx4 v12, s[12:15], s33 offen lds
    s_mov_b32 s35, 2
    s_add_u32 s35, s35, s42
    s_sub_u32 s34, s35, 16
    s_cmp_ge_u32 s35, 16
    s_cselect_b32 s35, s34, s35
    s_mul_i32 s33, s35, 393216
    s_lshl_b32 s32, s35, 7
    s_add_u32 m0, s40, 32768
    s_nop 0
    buffer_load_dwordx4 v2, s[8:11], s32 offen lds
    s_add_u32 m0, s40, 33792
    s_nop 0
    buffer_load_dwordx4 v3, s[8:11], s32 offen lds
    s_add_u32 m0, s41, 49152
    s_nop 0
    buffer_load_dwordx4 v10, s[12:15], s33 offen lds
    s_add_u32 m0, s41, 50176
    s_nop 0
    buffer_load_dwordx4 v11, s[12:15], s33 offen lds
    s_add_u32 m0, s41, 51200
    s_nop 0
    buffer_load_dwordx4 v12, s[12:15], s33 offen lds
    s_mov_b32 s31, 0
    s_waitcnt vmcnt(10)
    s_barrier
    ds_read_b128 v[88:91], v20 offset:0
    ds_read_b64_tr_b16 v[92:93], v24 offset:0
    ds_read_b64_tr_b16 v[94:95], v24 offset:1536
    ds_read_b64_tr_b16 v[96:97], v25 offset:0
    ds_read_b64_tr_b16 v[98:99], v25 offset:1536
    ds_read_b64_tr_b16 v[100:101], v26 offset:0
    ds_read_b64_tr_b16 v[102:103], v26 offset:1536
L_loop_gqkv_0_kernel:
    s_cmp_ge_u32 s31, 13
    s_cbranch_scc1 L_gqkv_0_kernel_tail1
    s_waitcnt vmcnt(5)
    s_barrier
    s_add_u32 s35, s31, 3
    s_add_u32 s35, s35, s42
    s_sub_u32 s34, s35, 16
    s_cmp_ge_u32 s35, 16
    s_cselect_b32 s35, s34, s35
    s_mul_i32 s33, s35, 393216
    s_lshl_b32 s32, s35, 7
    s_add_u32 m0, s40, 49152
    s_nop 0
    buffer_load_dwordx4 v2, s[8:11], s32 offen lds
    s_add_u32 m0, s40, 50176
    s_nop 0
    buffer_load_dwordx4 v3, s[8:11], s32 offen lds
    s_add_u32 m0, s41, 73728
    s_nop 0
    buffer_load_dwordx4 v10, s[12:15], s33 offen lds
    s_add_u32 m0, s41, 74752
    s_nop 0
    buffer_load_dwordx4 v11, s[12:15], s33 offen lds
    s_add_u32 m0, s41, 75776
    s_nop 0
    buffer_load_dwordx4 v12, s[12:15], s33 offen lds
    s_branch L_gqkv_0_kernel_join2
L_gqkv_0_kernel_tail1:
    s_waitcnt vmcnt(0)
    s_barrier
L_gqkv_0_kernel_join2:
    ds_read_b128 v[104:107], v21 offset:0
    ds_read_b64_tr_b16 v[108:109], v24 offset:6144
    ds_read_b64_tr_b16 v[110:111], v24 offset:7680
    ds_read_b64_tr_b16 v[112:113], v25 offset:6144
    ds_read_b64_tr_b16 v[114:115], v25 offset:7680
    ds_read_b64_tr_b16 v[116:117], v26 offset:6144
    ds_read_b64_tr_b16 v[118:119], v26 offset:7680
    s_waitcnt lgkmcnt(7)
    v_mfma_f32_32x32x16_bf16 v[40:55], v[92:95], v[88:91], v[40:55]
    v_mfma_f32_32x32x16_bf16 v[56:71], v[96:99], v[88:91], v[56:71]
    v_mfma_f32_32x32x16_bf16 v[72:87], v[100:103], v[88:91], v[72:87]
    ds_read_b128 v[88:91], v22 offset:0
    ds_read_b64_tr_b16 v[92:93], v24 offset:12288
    ds_read_b64_tr_b16 v[94:95], v24 offset:13824
    ds_read_b64_tr_b16 v[96:97], v25 offset:12288
    ds_read_b64_tr_b16 v[98:99], v25 offset:13824
    ds_read_b64_tr_b16 v[100:101], v26 offset:12288
    ds_read_b64_tr_b16 v[102:103], v26 offset:13824
    s_waitcnt lgkmcnt(7)
    v_mfma_f32_32x32x16_bf16 v[40:55], v[108:111], v[104:107], v[40:55]
    v_mfma_f32_32x32x16_bf16 v[56:71], v[112:115], v[104:107], v[56:71]
    v_mfma_f32_32x32x16_bf16 v[72:87], v[116:119], v[104:107], v[72:87]
    ds_read_b128 v[104:107], v23 offset:0
    ds_read_b64_tr_b16 v[108:109], v24 offset:18432
    ds_read_b64_tr_b16 v[110:111], v24 offset:19968
    ds_read_b64_tr_b16 v[112:113], v25 offset:18432
    ds_read_b64_tr_b16 v[114:115], v25 offset:19968
    ds_read_b64_tr_b16 v[116:117], v26 offset:18432
    ds_read_b64_tr_b16 v[118:119], v26 offset:19968
    s_waitcnt lgkmcnt(7)
    v_mfma_f32_32x32x16_bf16 v[40:55], v[92:95], v[88:91], v[40:55]
    v_mfma_f32_32x32x16_bf16 v[56:71], v[96:99], v[88:91], v[56:71]
    v_mfma_f32_32x32x16_bf16 v[72:87], v[100:103], v[88:91], v[72:87]
    ds_read_b128 v[88:91], v20 offset:16384
    ds_read_b64_tr_b16 v[92:93], v24 offset:24576
    ds_read_b64_tr_b16 v[94:95], v24 offset:26112
    ds_read_b64_tr_b16 v[96:97], v25 offset:24576
    ds_read_b64_tr_b16 v[98:99], v25 offset:26112
    ds_read_b64_tr_b16 v[100:101], v26 offset:24576
    ds_read_b64_tr_b16 v[102:103], v26 offset:26112
    s_waitcnt lgkmcnt(7)
    v_mfma_f32_32x32x16_bf16 v[40:55], v[108:111], v[104:107], v[40:55]
    v_mfma_f32_32x32x16_bf16 v[56:71], v[112:115], v[104:107], v[56:71]
    v_mfma_f32_32x32x16_bf16 v[72:87], v[116:119], v[104:107], v[72:87]
    s_cmp_ge_u32 s31, 12
    s_cbranch_scc1 L_gqkv_0_kernel_tail3
    s_waitcnt vmcnt(5)
    s_barrier
    s_add_u32 s35, s31, 4
    s_add_u32 s35, s35, s42
    s_sub_u32 s34, s35, 16
    s_cmp_ge_u32 s35, 16
    s_cselect_b32 s35, s34, s35
    s_mul_i32 s33, s35, 393216
    s_lshl_b32 s32, s35, 7
    s_add_u32 m0, s40, 0
    s_nop 0
    buffer_load_dwordx4 v2, s[8:11], s32 offen lds
    s_add_u32 m0, s40, 1024
    s_nop 0
    buffer_load_dwordx4 v3, s[8:11], s32 offen lds
    s_add_u32 m0, s41, 0
    s_nop 0
    buffer_load_dwordx4 v10, s[12:15], s33 offen lds
    s_add_u32 m0, s41, 1024
    s_nop 0
    buffer_load_dwordx4 v11, s[12:15], s33 offen lds
    s_add_u32 m0, s41, 2048
    s_nop 0
    buffer_load_dwordx4 v12, s[12:15], s33 offen lds
    s_branch L_gqkv_0_kernel_join4
L_gqkv_0_kernel_tail3:
    s_waitcnt vmcnt(0)
    s_barrier
L_gqkv_0_kernel_join4:
    ds_read_b128 v[104:107], v21 offset:16384
    ds_read_b64_tr_b16 v[108:109], v24 offset:30720
    ds_read_b64_tr_b16 v[110:111], v24 offset:32256
    ds_read_b64_tr_b16 v[112:113], v25 offset:30720
    ds_read_b64_tr_b16 v[114:115], v25 offset:32256
    ds_read_b64_tr_b16 v[116:117], v26 offset:30720
    ds_read_b64_tr_b16 v[118:119], v26 offset:32256
    s_waitcnt lgkmcnt(7)
    v_mfma_f32_32x32x16_bf16 v[40:55], v[92:95], v[88:91], v[40:55]
    v_mfma_f32_32x32x16_bf16 v[56:71], v[96:99], v[88:91], v[56:71]
    v_mfma_f32_32x32x16_bf16 v[72:87], v[100:103], v[88:91], v[72:87]
    ds_read_b128 v[88:91], v22 offset:16384
    ds_read_b64_tr_b16 v[92:93], v24 offset:36864
    ds_read_b64_tr_b16 v[94:95], v24 offset:38400
    ds_read_b64_tr_b16 v[96:97], v25 offset:36864
    ds_read_b64_tr_b16 v[98:99], v25 offset:38400
    ds_read_b64_tr_b16 v[100:101], v26 offset:36864
    ds_read_b64_tr_b16 v[102:103], v26 offset:38400
    s_waitcnt lgkmcnt(7)
    v_mfma_f32_32x32x16_bf16 v[40:55], v[108:111], v[104:107], v[40:55]
    v_mfma_f32_32x32x16_bf16 v[56:71], v[112:115], v[104:107], v[56:71]
    v_mfma_f32_32x32x16_bf16 v[72:87], v[116:119], v[104:107], v[72:87]
    ds_read_b128 v[104:107], v23 offset:16384
    ds_read_b64_tr_b16 v[108:109], v24 offset:43008
    ds_read_b64_tr_b16 v[110:111], v24 offset:44544
    ds_read_b64_tr_b16 v[112:113], v25 offset:43008
    ds_read_b64_tr_b16 v[114:115], v25 offset:44544
    ds_read_b64_tr_b16 v[116:117], v26 offset:43008
    ds_read_b64_tr_b16 v[118:119], v26 offset:44544
    s_waitcnt lgkmcnt(7)
    v_mfma_f32_32x32x16_bf16 v[40:55], v[92:95], v[88:91], v[40:55]
    v_mfma_f32_32x32x16_bf16 v[56:71], v[96:99], v[88:91], v[56:71]
    v_mfma_f32_32x32x16_bf16 v[72:87], v[100:103], v[88:91], v[72:87]
    ds_read_b128 v[88:91], v20 offset:32768
    ds_read_b64_tr_b16 v[92:93], v28 offset:0
    ds_read_b64_tr_b16 v[94:95], v28 offset:1536
    ds_read_b64_tr_b16 v[96:97], v29 offset:0
    ds_read_b64_tr_b16 v[98:99], v29 offset:1536
    ds_read_b64_tr_b16 v[100:101], v30 offset:0
    ds_read_b64_tr_b16 v[102:103], v30 offset:1536
    s_waitcnt lgkmcnt(7)
    v_mfma_f32_32x32x16_bf16 v[40:55], v[108:111], v[104:107], v[40:55]
    v_mfma_f32_32x32x16_bf16 v[56:71], v[112:115], v[104:107], v[56:71]
    v_mfma_f32_32x32x16_bf16 v[72:87], v[116:119], v[104:107], v[72:87]
    s_cmp_ge_u32 s31, 11
    s_cbranch_scc1 L_gqkv_0_kernel_tail5
    s_waitcnt vmcnt(5)
    s_barrier
    s_add_u32 s35, s31, 5
    s_add_u32 s35, s35, s42
    s_sub_u32 s34, s35, 16
    s_cmp_ge_u32 s35, 16
    s_cselect_b32 s35, s34, s35
    s_mul_i32 s33, s35, 393216
    s_lshl_b32 s32, s35, 7
    s_add_u32 m0, s40, 16384
    s_nop 0
    buffer_load_dwordx4 v2, s[8:11], s32 offen lds
    s_add_u32 m0, s40, 17408
    s_nop 0
    buffer_load_dwordx4 v3, s[8:11], s32 offen lds
    s_add_u32 m0, s41, 24576
    s_nop 0
    buffer_load_dwordx4 v10, s[12:15], s33 offen lds
    s_add_u32 m0, s41, 25600
    s_nop 0
    buffer_load_dwordx4 v11, s[12:15], s33 offen lds
    s_add_u32 m0, s41, 26624
    s_nop 0
    buffer_load_dwordx4 v12, s[12:15], s33 offen lds
    s_branch L_gqkv_0_kernel_join6
L_gqkv_0_kernel_tail5:
    s_waitcnt vmcnt(0)
    s_barrier
L_gqkv_0_kernel_join6:
    ds_read_b128 v[104:107], v21 offset:32768
    ds_read_b64_tr_b16 v[108:109], v28 offset:6144
    ds_read_b64_tr_b16 v[110:111], v28 offset:7680
    ds_read_b64_tr_b16 v[112:113], v29 offset:6144
    ds_read_b64_tr_b16 v[114:115], v29 offset:7680
    ds_read_b64_tr_b16 v[116:117], v30 offset:6144
    ds_read_b64_tr_b16 v[118:119], v30 offset:7680
    s_waitcnt lgkmcnt(7)
    v_mfma_f32_32x32x16_bf16 v[40:55], v[92:95], v[88:91], v[40:55]
    v_mfma_f32_32x32x16_bf16 v[56:71], v[96:99], v[88:91], v[56:71]
    v_mfma_f32_32x32x16_bf16 v[72:87], v[100:103], v[88:91], v[72:87]
    ds_read_b128 v[88:91], v22 offset:32768
    ds_read_b64_tr_b16 v[92:93], v28 offset:12288
    ds_read_b64_tr_b16 v[94:95], v28 offset:13824
    ds_read_b64_tr_b16 v[96:97], v29 offset:12288
    ds_read_b64_tr_b16 v[98:99], v29 offset:13824
    ds_read_b64_tr_b16 v[100:101], v30 offset:12288
    ds_read_b64_tr_b16 v[102:103], v30 offset:13824
    s_waitcnt lgkmcnt(7)
    v_mfma_f32_32x32x16_bf16 v[40:55], v[108:111], v[104:107], v[40:55]
    v_mfma_f32_32x32x16_bf16 v[56:71], v[112:115], v[104:107], v[56:71]
    v_mfma_f32_32x32x16_bf16 v[72:87], v[116:119], v[104:107], v[72:87]
    ds_read_b128 v[104:107], v23 offset:32768
    ds_read_b64_tr_b16 v[108:109], v28 offset:18432
    ds_read_b64_tr_b16 v[110:111], v28 offset:19968
    ds_read_b64_tr_b16 v[112:113], v29 offset:18432
    ds_read_b64_tr_b16 v[114:115], v29 offset:19968
    ds_read_b64_tr_b16 v[116:117], v30 offset:18432
    ds_read_b64_tr_b16 v[118:119], v30 offset:19968
    s_waitcnt lgkmcnt(7)
    v_mfma_f32_32x32x16_bf16 v[40:55], v[92:95], v[88:91], v[40:55]
    v_mfma_f32_32x32x16_bf16 v[56:71], v[96:99], v[88:91], v[56:71]
    v_mfma_f32_32x32x16_bf16 v[72:87], v[100:103], v[88:91], v[72:87]
    ds_read_b128 v[88:91], v20 offset:49152
    ds_read_b64_tr_b16 v[92:93], v28 offset:24576
    ds_read_b64_tr_b16 v[94:95], v28 offset:26112
    ds_read_b64_tr_b16 v[96:97], v29 offset:24576
    ds_read_b64_tr_b16 v[98:99], v29 offset:26112
    ds_read_b64_tr_b16 v[100:101], v30 offset:24576
    ds_read_b64_tr_b16 v[102:103], v30 offset:26112
    s_waitcnt lgkmcnt(7)
    v_mfma_f32_32x32x16_bf16 v[40:55], v[108:111], v[104:107], v[40:55]
    v_mfma_f32_32x32x16_bf16 v[56:71], v[112:115], v[104:107], v[56:71]
    v_mfma_f32_32x32x16_bf16 v[72:87], v[116:119], v[104:107], v[72:87]
    s_cmp_ge_u32 s31, 10
    s_cbranch_scc1 L_gqkv_0_kernel_tail7
    s_waitcnt vmcnt(5)
    s_barrier
    s_add_u32 s35, s31, 6
    s_add_u32 s35, s35, s42
    s_sub_u32 s34, s35, 16
    s_cmp_ge_u32 s35, 16
    s_cselect_b32 s35, s34, s35
    s_mul_i32 s33, s35, 393216
    s_lshl_b32 s32, s35, 7
    s_add_u32 m0, s40, 32768
    s_nop 0
    buffer_load_dwordx4 v2, s[8:11], s32 offen lds
    s_add_u32 m0, s40, 33792
    s_nop 0
    buffer_load_dwordx4 v3, s[8:11], s32 offen lds
    s_add_u32 m0, s41, 49152
    s_nop 0
    buffer_load_dwordx4 v10, s[12:15], s33 offen lds
    s_add_u32 m0, s41, 50176
    s_nop 0
    buffer_load_dwordx4 v11, s[12:15], s33 offen lds
    s_add_u32 m0, s41, 51200
    s_nop 0
    buffer_load_dwordx4 v12, s[12:15], s33 offen lds
    s_branch L_gqkv_0_kernel_join8
L_gqkv_0_kernel_tail7:
    s_waitcnt vmcnt(0)
    s_barrier
L_gqkv_0_kernel_join8:
    ds_read_b128 v[104:107], v21 offset:49152
    ds_read_b64_tr_b16 v[108:109], v28 offset:30720
    ds_read_b64_tr_b16 v[110:111], v28 offset:32256
    ds_read_b64_tr_b16 v[112:113], v29 offset:30720
    ds_read_b64_tr_b16 v[114:115], v29 offset:32256
    ds_read_b64_tr_b16 v[116:117], v30 offset:30720
    ds_read_b64_tr_b16 v[118:119], v30 offset:32256
    s_waitcnt lgkmcnt(7)
    v_mfma_f32_32x32x16_bf16 v[40:55], v[92:95], v[88:91], v[40:55]
    v_mfma_f32_32x32x16_bf16 v[56:71], v[96:99], v[88:91], v[56:71]
    v_mfma_f32_32x32x16_bf16 v[72:87], v[100:103], v[88:91], v[72:87]
    ds_read_b128 v[88:91], v22 offset:49152
    ds_read_b64_tr_b16 v[92:93], v28 offset:36864
    ds_read_b64_tr_b16 v[94:95], v28 offset:38400
    ds_read_b64_tr_b16 v[96:97], v29 offset:36864
    ds_read_b64_tr_b16 v[98:99], v29 offset:38400
    ds_read_b64_tr_b16 v[100:101], v30 offset:36864
    ds_read_b64_tr_b16 v[102:103], v30 offset:38400
    s_waitcnt lgkmcnt(7)
    v_mfma_f32_32x32x16_bf16 v[40:55], v[108:111], v[104:107], v[40:55]
    v_mfma_f32_32x32x16_bf16 v[56:71], v[112:115], v[104:107], v[56:71]
    v_mfma_f32_32x32x16_bf16 v[72:87], v[116:119], v[104:107], v[72:87]
    ds_read_b128 v[104:107], v23 offset:49152
    ds_read_b64_tr_b16 v[108:109], v28 offset:43008
    ds_read_b64_tr_b16 v[110:111], v28 offset:44544
    ds_read_b64_tr_b16 v[112:113], v29 offset:43008
    ds_read_b64_tr_b16 v[114:115], v29 offset:44544
    ds_read_b64_tr_b16 v[116:117], v30 offset:43008
    ds_read_b64_tr_b16 v[118:119], v30 offset:44544
    s_waitcnt lgkmcnt(7)
    v_mfma_f32_32x32x16_bf16 v[40:55], v[92:95], v[88:91], v[40:55]
    v_mfma_f32_32x32x16_bf16 v[56:71], v[96:99], v[88:91], v[56:71]
    v_mfma_f32_32x32x16_bf16 v[72:87], v[100:103], v[88:91], v[72:87]
    ds_read_b128 v[88:91], v20 offset:0
    ds_read_b64_tr_b16 v[92:93], v24 offset:0
    ds_read_b64_tr_b16 v[94:95], v24 offset:1536
    ds_read_b64_tr_b16 v[96:97], v25 offset:0
    ds_read_b64_tr_b16 v[98:99], v25 offset:1536
    ds_read_b64_tr_b16 v[100:101], v26 offset:0
    ds_read_b64_tr_b16 v[102:103], v26 offset:1536
    s_waitcnt lgkmcnt(7)
    v_mfma_f32_32x32x16_bf16 v[40:55], v[108:111], v[104:107], v[40:55]
    v_mfma_f32_32x32x16_bf16 v[56:71], v[112:115], v[104:107], v[56:71]
    v_mfma_f32_32x32x16_bf16 v[72:87], v[116:119], v[104:107], v[72:87]
    s_add_u32 s31, s31, 4
    s_cmp_lt_u32 s31, 16
    s_cbranch_scc1 L_loop_gqkv_0_kernel
L_lend_gqkv_0_kernel:
    s_nop 15
    s_nop 7
    s_lshr_b32 s31, s30, 1
    s_and_b32 s34, s30, 1
    s_mul_i32 s38, s31, 32
    s_mul_i32 s39, s34, 96
    s_lshl_b32 s31, s28, 7
    s_add_u32 s38, s38, s31
    s_mul_i32 s31, s29, 192
    s_add_u32 s39, s39, s31
    s_barrier
    s_mul_i32 s32, s30, 6656
    v_and_b32 v1, 31, v0
    v_mul_u32_u24 v1, 208, v1
    v_lshrrev_b32 v2, 5, v0
    v_lshlrev_b32 v2, 3, v2
    v_add_u32 v1, v1, v2
    v_add_u32 v1, s32, v1
    v_cvt_pk_bf16_f32 v40, v40, v41
    v_cvt_pk_bf16_f32 v41, v42, v43
    ds_write_b64 v1, v[40:41] offset:0
    v_cvt_pk_bf16_f32 v44, v44, v45
    v_cvt_pk_bf16_f32 v45, v46, v47
    ds_write_b64 v1, v[44:45] offset:16
    v_cvt_pk_bf16_f32 v48, v48, v49
    v_cvt_pk_bf16_f32 v49, v50, v51
    ds_write_b64 v1, v[48:49] offset:32
    v_cvt_pk_bf16_f32 v52, v52, v53
    v_cvt_pk_bf16_f32 v53, v54, v55
    ds_write_b64 v1, v[52:53] offset:48
    v_cvt_pk_bf16_f32 v56, v56, v57
    v_cvt_pk_bf16_f32 v57, v58, v59
    ds_write_b64 v1, v[56:57] offset:64
    v_cvt_pk_bf16_f32 v60, v60, v61
    v_cvt_pk_bf16_f32 v61, v62, v63
    ds_write_b64 v1, v[60:61] offset:80
    v_cvt_pk_bf16_f32 v64, v64, v65
    v_cvt_pk_bf16_f32 v65, v66, v67
    ds_write_b64 v1, v[64:65] offset:96
    v_cvt_pk_bf16_f32 v68, v68, v69
    v_cvt_pk_bf16_f32 v69, v70, v71
    ds_write_b64 v1, v[68:69] offset:112
    v_cvt_pk_bf16_f32 v72, v72, v73
    v_cvt_pk_bf16_f32 v73, v74, v75
    ds_write_b64 v1, v[72:73] offset:128
    v_cvt_pk_bf16_f32 v76, v76, v77
    v_cvt_pk_bf16_f32 v77, v78, v79
    ds_write_b64 v1, v[76:77] offset:144
    v_cvt_pk_bf16_f32 v80, v80, v81
    v_cvt_pk_bf16_f32 v81, v82, v83
    ds_write_b64 v1, v[80:81] offset:160
    v_cvt_pk_bf16_f32 v84, v84, v85
    v_cvt_pk_bf16_f32 v85, v86, v87
    ds_write_b64 v1, v[84:85] offset:176
    s_mov_b32 s35, 6144
    s_lshl_b32 s39, s39, 1
    v_add_u32 v2, 0, v0
    v_mul_u32_u24 v3, 5462, v2
    v_lshrrev_b32 v3, 16, v3
    v_mul_u32_u24 v4, 12, v3
    v_sub_u32 v4, v2, v4
    v_lshlrev_b32 v4, 4, v4
    v_mul_u32_u24 v5, 208, v3
    v_add_u32 v5, v5, v4
    v_add_u32 v8, s32, v5
    v_add_u32 v3, s38, v3
    v_mul_lo_u32 v3, v3, s35
    v_add_u32 v3, v3, v4
    v_add_u32 v16, s39, v3
    v_add_u32 v2, 64, v0
    v_mul_u32_u24 v3, 5462, v2
    v_lshrrev_b32 v3, 16, v3
    v_mul_u32_u24 v4, 12, v3
    v_sub_u32 v4, v2, v4
    v_lshlrev_b32 v4, 4, v4
    v_mul_u32_u24 v5, 208, v3
    v_add_u32 v5, v5, v4
    v_add_u32 v9, s32, v5
    v_add_u32 v3, s38, v3
    v_mul_lo_u32 v3, v3, s35
    v_add_u32 v3, v3, v4
    v_add_u32 v17, s39, v3
    v_add_u32 v2, 128, v0
    v_mul_u32_u24 v3, 5462, v2
    v_lshrrev_b32 v3, 16, v3
    v_mul_u32_u24 v4, 12, v3
    v_sub_u32 v4, v2, v4
    v_lshlrev_b32 v4, 4, v4
    v_mul_u32_u24 v5, 208, v3
    v_add_u32 v5, v5, v4
    v_add_u32 v10, s32, v5
    v_add_u32 v3, s38, v3
    v_mul_lo_u32 v3, v3, s35
    v_add_u32 v3, v3, v4
    v_add_u32 v18, s39, v3
    v_add_u32 v2, 192, v0
    v_mul_u32_u24 v3, 5462, v2
    v_lshrrev_b32 v3, 16, v3
    v_mul_u32_u24 v4, 12, v3
    v_sub_u32 v4, v2, v4
    v_lshlrev_b32 v4, 4, v4
    v_mul_u32_u24 v5, 208, v3
    v_add_u32 v5, v5, v4
    v_add_u32 v11, s32, v5
    v_add_u32 v3, s38, v3
    v_mul_lo_u32 v3, v3, s35
    v_add_u32 v3, v3, v4
    v_add_u32 v19, s39, v3
    v_add_u32 v2, 256, v0
    v_mul_u32_u24 v3, 5462, v2
    v_lshrrev_b32 v3, 16, v3
    v_mul_u32_u24 v4, 12, v3
    v_sub_u32 v4, v2, v4
    v_lshlrev_b32 v4, 4, v4
    v_mul_u32_u24 v5, 208, v3
    v_add_u32 v5, v5, v4
    v_add_u32 v12, s32, v5
    v_add_u32 v3, s38, v3
    v_mul_lo_u32 v3, v3, s35
    v_add_u32 v3, v3, v4
    v_add_u32 v20, s39, v3
    v_add_u32 v2, 320, v0
    v_mul_u32_u24 v3, 5462, v2
    v_lshrrev_b32 v3, 16, v3
    v_mul_u32_u24 v4, 12, v3
    v_sub_u32 v4, v2, v4
    v_lshlrev_b32 v4, 4, v4
    v_mul_u32_u24 v5, 208, v3
    v_add_u32 v5, v5, v4
    v_add_u32 v13, s32, v5
    v_add_u32 v3, s38, v3
    v_mul_lo_u32 v3, v3, s35
    v_add_u32 v3, v3, v4
    v_add_u32 v21, s39, v3
    s_waitcnt lgkmcnt(0)
    ds_read_b128 v[40:43], v8
    ds_read_b128 v[44:47], v9
    ds_read_b128 v[48:51], v10
    ds_read_b128 v[52:55], v11
    ds_read_b128 v[56:59], v12
    ds_read_b128 v[60:63], v13
    s_waitcnt lgkmcnt(0)
    buffer_store_dwordx4 v[40:43], v16, s[16:19], 0 offen
    buffer_store_dwordx4 v[44:47], v17, s[16:19], 0 offen
    buffer_store_dwordx4 v[48:51], v18, s[16:19], 0 offen
    buffer_store_dwordx4 v[52:55], v19, s[16:19], 0 offen
    buffer_store_dwordx4 v[56:59], v20, s[16:19], 0 offen
    buffer_store_dwordx4 v[60:63], v21, s[16:19], 0 offen
L_done_gqkv_0_kernel:
    s_endpgm
.globl akv_0_kernel
.p2align 8
.type akv_0_kernel,@function
akv_0_kernel:
    s_cmp_ge_u32 s2, 256
    s_cbranch_scc1 L_done_akv_0_kernel
    s_load_dwordx2 s[40:41], s[0:1], 16
    s_load_dwordx2 s[42:43], s[0:1], 88
    s_waitcnt lgkmcnt(0)
    s_add_u32 s8, s42, 4194304
    s_addc_u32 s9, s43, 0
    s_mov_b32 s10, 12582912
    s_mov_b32 s11, 0x00020000
    s_mov_b32 s12, s40
    s_mov_b32 s13, s41
    s_mov_b32 s14, 65536
    s_mov_b32 s15, 0x00020000
    s_add_u32 s16, s42, 16777216
    s_addc_u32 s17, s43, 0
    s_mov_b32 s18, 2162688
    s_mov_b32 s19, 0x00020000
    s_and_b32 s28, s2, 31
    s_lshr_b32 s29, s2, 5
    v_lshrrev_b32 v1, 6, v0
    s_nop 0
    v_readfirstlane_b32 s30, v1
    v_mov_b32 v60, v0
    v_and_b32 v0, 63, v0
    v_and_b32 v2, 31, v0
    v_lshrrev_b32 v3, 5, v0
    v_xor_b32 v4, 32, v0
    v_lshlrev_b32 v4, 2, v4
    s_lshl_b32 s31, s28, 11
    v_lshlrev_b32 v5, 9, v3
    v_lshlrev_b32 v6, 1, v2
    v_add_u32 v5, v5, v6
    v_add_u32 v5, s31, v5
    buffer_load_ushort v16, v5, s[12:15], 0 offen offset:0
    buffer_load_ushort v17, v5, s[12:15], 0 offen offset:64
    buffer_load_ushort v18, v5, s[12:15], 0 offen offset:128
    buffer_load_ushort v19, v5, s[12:15], 0 offen offset:192
    buffer_load_ushort v20, v5, s[12:15], 0 offen offset:256
    buffer_load_ushort v21, v5, s[12:15], 0 offen offset:320
    buffer_load_ushort v22, v5, s[12:15], 0 offen offset:384
    buffer_load_ushort v23, v5, s[12:15], 0 offen offset:448
    buffer_load_ushort v24, v5, s[12:15], 0 offen offset:1024
    buffer_load_ushort v25, v5, s[12:15], 0 offen offset:1088
    buffer_load_ushort v26, v5, s[12:15], 0 offen offset:1152
    buffer_load_ushort v27, v5, s[12:15], 0 offen offset:1216
    buffer_load_ushort v28, v5, s[12:15], 0 offen offset:1280
    buffer_load_ushort v29, v5, s[12:15], 0 offen offset:1344
    buffer_load_ushort v30, v5, s[12:15], 0 offen offset:1408
    buffer_load_ushort v31, v5, s[12:15], 0 offen offset:1472
    s_waitcnt vmcnt(0)
    v_lshl_or_b32 v8, v17, 16, v16
    v_lshl_or_b32 v9, v19, 16, v18
    v_lshl_or_b32 v10, v21, 16, v20
    v_lshl_or_b32 v11, v23, 16, v22
    v_lshl_or_b32 v12, v25, 16, v24
    v_lshl_or_b32 v13, v27, 16, v26
    v_lshl_or_b32 v14, v29, 16, v28
    v_lshl_or_b32 v15, v31, 16, v30
    v_mov_b32 v64, 0
    v_mov_b32 v65, 0
    v_mov_b32 v66, 0
    v_mov_b32 v67, 0
    v_mov_b32 v68, 0
    v_mov_b32 v69, 0
    v_mov_b32 v70, 0
    v_mov_b32 v71, 0
    v_mov_b32 v72, 0
    v_mov_b32 v73, 0
    v_mov_b32 v74, 0
    v_mov_b32 v75, 0
    v_mov_b32 v76, 0
    v_mov_b32 v77, 0
    v_mov_b32 v78, 0
    v_mov_b32 v79, 0
    v_mov_b32 v80, 0
    v_mov_b32 v81, 0
    v_mov_b32 v82, 0
    v_mov_b32 v83, 0
    v_mov_b32 v84, 0
    v_mov_b32 v85, 0
    v_mov_b32 v86, 0
    v_mov_b32 v87, 0
    v_mov_b32 v88, 0
    v_mov_b32 v89, 0
    v_mov_b32 v90, 0
    v_mov_b32 v91, 0
    v_mov_b32 v92, 0
    v_mov_b32 v93, 0
    v_mov_b32 v94, 0
    v_mov_b32 v95, 0
    v_mov_b32 v96, 0
    v_mov_b32 v97, 0
    v_mov_b32 v98, 0
    v_mov_b32 v99, 0
    v_mov_b32 v100, 0
    v_mov_b32 v101, 0
    v_mov_b32 v102, 0
    v_mov_b32 v103, 0
    v_mov_b32 v104, 0
    v_mov_b32 v105, 0
    v_mov_b32 v106, 0
    v_mov_b32 v107, 0
    v_mov_b32 v108, 0
    v_mov_b32 v109, 0
    v_mov_b32 v110, 0
    v_mov_b32 v111, 0
    v_mov_b32 v112, 0
    v_mov_b32 v113, 0
    v_mov_b32 v114, 0
    v_mov_b32 v115, 0
    v_mov_b32 v116, 0
    v_mov_b32 v117, 0
    v_mov_b32 v118, 0
    v_mov_b32 v119, 0
    v_mov_b32 v120, 0
    v_mov_b32 v121, 0
    v_mov_b32 v122, 0
    v_mov_b32 v123, 0
    v_mov_b32 v124, 0
    v_mov_b32 v125, 0
    v_mov_b32 v126, 0
    v_mov_b32 v127, 0
    v_mov_b32 v128, 0x3f803f80
    v_mov_b32 v129, 0x3f803f80
    v_mov_b32 v130, 0x3f803f80
    v_mov_b32 v131, 0x3f803f80
    s_mul_i32 s32, s30, 6144
    s_add_u32 s32, s32, 33792
    s_lshl_b32 s31, s29, 8
    s_lshl_b32 s33, s30, 6
    s_add_u32 s31, s31, s33
    s_add_u32 s31, s31, 0
    s_mul_i32 s33, s31, 6144
    v_mul_u32_u24 v7, 6144, v2
    v_add_u32 v7, s33, v7
    s_lshl_b32 s34, s28, 6
    s_add_u32 s34, s34, 2048
    v_lshrrev_b32 v61, 2, v0
    v_mul_u32_u24 v61, 6144, v61
    v_and_b32 v62, 3, v0
    v_lshlrev_b32 v62, 4, v62
    v_add_u32 v61, v61, v62
    v_add_u32 v61, s33, v61
    s_lshl_b32 s35, s28, 6
    s_add_u32 s35, s35, 4096
    v_add_u32 v61, s35, v61
    buffer_load_dwordx4 v[132:135], v61, s[8:11], 0 offen
    v_add_u32 v61, 98304, v61
    buffer_load_dwordx4 v[136:139], v61, s[8:11], 0 offen
    v_lshlrev_b32 v6, 4, v3
    v_add_u32 v6, v7, v6
    v_add_u32 v6, s34, v6
    buffer_load_dwordx4 v[48:51], v6, s[8:11], 0 offen
    buffer_load_dwordx4 v[52:55], v6, s[8:11], 0 offen offset:32
    v_mov_b32 v16, 0
    v_mov_b32 v17, 0
    v_mov_b32 v18, 0
    v_mov_b32 v19, 0
    v_mov_b32 v20, 0
    v_mov_b32 v21, 0
    v_mov_b32 v22, 0
    v_mov_b32 v23, 0
    v_mov_b32 v24, 0
    v_mov_b32 v25, 0
    v_mov_b32 v26, 0
    v_mov_b32 v27, 0
    v_mov_b32 v28, 0
    v_mov_b32 v29, 0
    v_mov_b32 v30, 0
    v_mov_b32 v31, 0
    s_waitcnt vmcnt(0)
    v_mfma_f32_32x32x16_bf16 v[16:31], v[8:11], v[48:51], v[16:31]
    v_mfma_f32_32x32x16_bf16 v[16:31], v[12:15], v[52:55], v[16:31]
    s_nop 15
    s_nop 3
    v_cvt_pk_bf16_f32 v16, v16, v16
    v_lshlrev_b32 v16, 16, v16
    v_cvt_pk_bf16_f32 v17, v17, v17
    v_lshlrev_b32 v17, 16, v17
    v_cvt_pk_bf16_f32 v18, v18, v18
    v_lshlrev_b32 v18, 16, v18
    v_cvt_pk_bf16_f32 v19, v19, v19
    v_lshlrev_b32 v19, 16, v19
    v_cvt_pk_bf16_f32 v20, v20, v20
    v_lshlrev_b32 v20, 16, v20
    v_cvt_pk_bf16_f32 v21, v21, v21
    v_lshlrev_b32 v21, 16, v21
    v_cvt_pk_bf16_f32 v22, v22, v22
    v_lshlrev_b32 v22, 16, v22
    v_cvt_pk_bf16_f32 v23, v23, v23
    v_lshlrev_b32 v23, 16, v23
    v_cvt_pk_bf16_f32 v24, v24, v24
    v_lshlrev_b32 v24, 16, v24
    v_cvt_pk_bf16_f32 v25, v25, v25
    v_lshlrev_b32 v25, 16, v25
    v_cvt_pk_bf16_f32 v26, v26, v26
    v_lshlrev_b32 v26, 16, v26
    v_cvt_pk_bf16_f32 v27, v27, v27
    v_lshlrev_b32 v27, 16, v27
    v_cvt_pk_bf16_f32 v28, v28, v28
    v_lshlrev_b32 v28, 16, v28
    v_cvt_pk_bf16_f32 v29, v29, v29
    v_lshlrev_b32 v29, 16, v29
    v_cvt_pk_bf16_f32 v30, v30, v30
    v_lshlrev_b32 v30, 16, v30
    v_cvt_pk_bf16_f32 v31, v31, v31
    v_lshlrev_b32 v31, 16, v31
    v_mov_b32 v56, v16
    v_mov_b32 v57, v16
    v_max_f32 v56, v56, v17
    v_min_f32 v57, v57, v17
    v_max_f32 v56, v56, v18
    v_min_f32 v57, v57, v18
    v_max_f32 v56, v56, v19
    v_min_f32 v57, v57, v19
    v_max_f32 v56, v56, v20
    v_min_f32 v57, v57, v20
    v_max_f32 v56, v56, v21
    v_min_f32 v57, v57, v21
    v_max_f32 v56, v56, v22
    v_min_f32 v57, v57, v22
    v_max_f32 v56, v56, v23
    v_min_f32 v57, v57, v23
    v_max_f32 v56, v56, v24
    v_min_f32 v57, v57, v24
    v_max_f32 v56, v56, v25
    v_min_f32 v57, v57, v25
    v_max_f32 v56, v56, v26
    v_min_f32 v57, v57, v26
    v_max_f32 v56, v56, v27
    v_min_f32 v57, v57, v27
    v_max_f32 v56, v56, v28
    v_min_f32 v57, v57, v28
    v_max_f32 v56, v56, v29
    v_min_f32 v57, v57, v29
    v_max_f32 v56, v56, v30
    v_min_f32 v57, v57, v30
    v_max_f32 v56, v56, v31
    v_min_f32 v57, v57, v31
    ds_bpermute_b32 v58, v4, v56
    ds_bpermute_b32 v59, v4, v57
    s_waitcnt lgkmcnt(0)
    v_max_f32 v56, v56, v58
    v_min_f32 v57, v57, v59
    v_mov_b32 v58, 0
    v_mov_b32 v59, 0
    s_mov_b32 s35, 0x3fb8aa3b
    v_sub_f32 v32, v57, v16
    v_sub_f32 v16, v16, v56
    v_mul_f32 v32, s35, v32
    v_mul_f32 v16, s35, v16
    v_exp_f32 v32, v32
    v_exp_f32 v16, v16
    s_nop 0
    v_add_f32 v58, v58, v16
    v_add_f32 v59, v59, v32
    v_sub_f32 v33, v57, v17
    v_sub_f32 v17, v17, v56
    v_mul_f32 v33, s35, v33
    v_mul_f32 v17, s35, v17
    v_exp_f32 v33, v33
    v_exp_f32 v17, v17
    s_nop 0
    v_add_f32 v58, v58, v17
    v_add_f32 v59, v59, v33
    v_sub_f32 v34, v57, v18
    v_sub_f32 v18, v18, v56
    v_mul_f32 v34, s35, v34
    v_mul_f32 v18, s35, v18
    v_exp_f32 v34, v34
    v_exp_f32 v18, v18
    s_nop 0
    v_add_f32 v58, v58, v18
    v_add_f32 v59, v59, v34
    v_sub_f32 v35, v57, v19
    v_sub_f32 v19, v19, v56
    v_mul_f32 v35, s35, v35
    v_mul_f32 v19, s35, v19
    v_exp_f32 v35, v35
    v_exp_f32 v19, v19
    s_nop 0
    v_add_f32 v58, v58, v19
    v_add_f32 v59, v59, v35
    v_sub_f32 v36, v57, v20
    v_sub_f32 v20, v20, v56
    v_mul_f32 v36, s35, v36
    v_mul_f32 v20, s35, v20
    v_exp_f32 v36, v36
    v_exp_f32 v20, v20
    s_nop 0
    v_add_f32 v58, v58, v20
    v_add_f32 v59, v59, v36
    v_sub_f32 v37, v57, v21
    v_sub_f32 v21, v21, v56
    v_mul_f32 v37, s35, v37
    v_mul_f32 v21, s35, v21
    v_exp_f32 v37, v37
    v_exp_f32 v21, v21
    s_nop 0
    v_add_f32 v58, v58, v21
    v_add_f32 v59, v59, v37
    v_sub_f32 v38, v57, v22
    v_sub_f32 v22, v22, v56
    v_mul_f32 v38, s35, v38
    v_mul_f32 v22, s35, v22
    v_exp_f32 v38, v38
    v_exp_f32 v22, v22
    s_nop 0
    v_add_f32 v58, v58, v22
    v_add_f32 v59, v59, v38
    v_sub_f32 v39, v57, v23
    v_sub_f32 v23, v23, v56
    v_mul_f32 v39, s35, v39
    v_mul_f32 v23, s35, v23
    v_exp_f32 v39, v39
    v_exp_f32 v23, v23
    s_nop 0
    v_add_f32 v58, v58, v23
    v_add_f32 v59, v59, v39
    v_sub_f32 v40, v57, v24
    v_sub_f32 v24, v24, v56
    v_mul_f32 v40, s35, v40
    v_mul_f32 v24, s35, v24
    v_exp_f32 v40, v40
    v_exp_f32 v24, v24
    s_nop 0
    v_add_f32 v58, v58, v24
    v_add_f32 v59, v59, v40
    v_sub_f32 v41, v57, v25
    v_sub_f32 v25, v25, v56
    v_mul_f32 v41, s35, v41
    v_mul_f32 v25, s35, v25
    v_exp_f32 v41, v41
    v_exp_f32 v25, v25
    s_nop 0
    v_add_f32 v58, v58, v25
    v_add_f32 v59, v59, v41
    v_sub_f32 v42, v57, v26
    v_sub_f32 v26, v26, v56
    v_mul_f32 v42, s35, v42
    v_mul_f32 v26, s35, v26
    v_exp_f32 v42, v42
    v_exp_f32 v26, v26
    s_nop 0
    v_add_f32 v58, v58, v26
    v_add_f32 v59, v59, v42
    v_sub_f32 v43, v57, v27
    v_sub_f32 v27, v27, v56
    v_mul_f32 v43, s35, v43
    v_mul_f32 v27, s35, v27
    v_exp_f32 v43, v43
    v_exp_f32 v27, v27
    s_nop 0
    v_add_f32 v58, v58, v27
    v_add_f32 v59, v59, v43
    v_sub_f32 v44, v57, v28
    v_sub_f32 v28, v28, v56
    v_mul_f32 v44, s35, v44
    v_mul_f32 v28, s35, v28
    v_exp_f32 v44, v44
    v_exp_f32 v28, v28
    s_nop 0
    v_add_f32 v58, v58, v28
    v_add_f32 v59, v59, v44
    v_sub_f32 v45, v57, v29
    v_sub_f32 v29, v29, v56
    v_mul_f32 v45, s35, v45
    v_mul_f32 v29, s35, v29
    v_exp_f32 v45, v45
    v_exp_f32 v29, v29
    s_nop 0
    v_add_f32 v58, v58, v29
    v_add_f32 v59, v59, v45
    v_sub_f32 v46, v57, v30
    v_sub_f32 v30, v30, v56
    v_mul_f32 v46, s35, v46
    v_mul_f32 v30, s35, v30
    v_exp_f32 v46, v46
    v_exp_f32 v30, v30
    s_nop 0
    v_add_f32 v58, v58, v30
    v_add_f32 v59, v59, v46
    v_sub_f32 v47, v57, v31
    v_sub_f32 v31, v31, v56
    v_mul_f32 v47, s35, v47
    v_mul_f32 v31, s35, v31
    v_exp_f32 v47, v47
    v_exp_f32 v31, v31
    s_nop 0
    v_add_f32 v58, v58, v31
    v_add_f32 v59, v59, v47
    ds_bpermute_b32 v56, v4, v58
    ds_bpermute_b32 v57, v4, v59
    s_waitcnt lgkmcnt(0)
    v_add_f32 v58, v58, v56
    v_add_f32 v59, v59, v57
    v_rcp_f32 v58, v58
    v_rcp_f32 v59, v59
    s_nop 0
    v_mul_f32 v16, v16, v58
    v_mul_f32 v32, v32, v59
    v_cvt_pk_bf16_f32 v16, v16, v16
    v_lshlrev_b32 v16, 16, v16
    v_cvt_pk_bf16_f32 v32, v32, v32
    v_lshlrev_b32 v32, 16, v32
    v_mul_f32 v17, v17, v58
    v_mul_f32 v33, v33, v59
    v_cvt_pk_bf16_f32 v17, v17, v17
    v_lshlrev_b32 v17, 16, v17
    v_cvt_pk_bf16_f32 v33, v33, v33
    v_lshlrev_b32 v33, 16, v33
    v_mul_f32 v18, v18, v58
    v_mul_f32 v34, v34, v59
    v_cvt_pk_bf16_f32 v18, v18, v18
    v_lshlrev_b32 v18, 16, v18
    v_cvt_pk_bf16_f32 v34, v34, v34
    v_lshlrev_b32 v34, 16, v34
    v_mul_f32 v19, v19, v58
    v_mul_f32 v35, v35, v59
    v_cvt_pk_bf16_f32 v19, v19, v19
    v_lshlrev_b32 v19, 16, v19
    v_cvt_pk_bf16_f32 v35, v35, v35
    v_lshlrev_b32 v35, 16, v35
    v_mul_f32 v20, v20, v58
    v_mul_f32 v36, v36, v59
    v_cvt_pk_bf16_f32 v20, v20, v20
    v_lshlrev_b32 v20, 16, v20
    v_cvt_pk_bf16_f32 v36, v36, v36
    v_lshlrev_b32 v36, 16, v36
    v_mul_f32 v21, v21, v58
    v_mul_f32 v37, v37, v59
    v_cvt_pk_bf16_f32 v21, v21, v21
    v_lshlrev_b32 v21, 16, v21
    v_cvt_pk_bf16_f32 v37, v37, v37
    v_lshlrev_b32 v37, 16, v37
    v_mul_f32 v22, v22, v58
    v_mul_f32 v38, v38, v59
    v_cvt_pk_bf16_f32 v22, v22, v22
    v_lshlrev_b32 v22, 16, v22
    v_cvt_pk_bf16_f32 v38, v38, v38
    v_lshlrev_b32 v38, 16, v38
    v_mul_f32 v23, v23, v58
    v_mul_f32 v39, v39, v59
    v_cvt_pk_bf16_f32 v23, v23, v23
    v_lshlrev_b32 v23, 16, v23
    v_cvt_pk_bf16_f32 v39, v39, v39
    v_lshlrev_b32 v39, 16, v39
    v_mul_f32 v24, v24, v58
    v_mul_f32 v40, v40, v59
    v_cvt_pk_bf16_f32 v24, v24, v24
    v_lshlrev_b32 v24, 16, v24
    v_cvt_pk_bf16_f32 v40, v40, v40
    v_lshlrev_b32 v40, 16, v40
    v_mul_f32 v25, v25, v58
    v_mul_f32 v41, v41, v59
    v_cvt_pk_bf16_f32 v25, v25, v25
    v_lshlrev_b32 v25, 16, v25
    v_cvt_pk_bf16_f32 v41, v41, v41
    v_lshlrev_b32 v41, 16, v41
    v_mul_f32 v26, v26, v58
    v_mul_f32 v42, v42, v59
    v_cvt_pk_bf16_f32 v26, v26, v26
    v_lshlrev_b32 v26, 16, v26
    v_cvt_pk_bf16_f32 v42, v42, v42
    v_lshlrev_b32 v42, 16, v42
    v_mul_f32 v27, v27, v58
    v_mul_f32 v43, v43, v59
    v_cvt_pk_bf16_f32 v27, v27, v27
    v_lshlrev_b32 v27, 16, v27
    v_cvt_pk_bf16_f32 v43, v43, v43
    v_lshlrev_b32 v43, 16, v43
    v_mul_f32 v28, v28, v58
    v_mul_f32 v44, v44, v59
    v_cvt_pk_bf16_f32 v28, v28, v28
    v_lshlrev_b32 v28, 16, v28
    v_cvt_pk_bf16_f32 v44, v44, v44
    v_lshlrev_b32 v44, 16, v44
    v_mul_f32 v29, v29, v58
    v_mul_f32 v45, v45, v59
    v_cvt_pk_bf16_f32 v29, v29, v29
    v_lshlrev_b32 v29, 16, v29
    v_cvt_pk_bf16_f32 v45, v45, v45
    v_lshlrev_b32 v45, 16, v45
    v_mul_f32 v30, v30, v58
    v_mul_f32 v46, v46, v59
    v_cvt_pk_bf16_f32 v30, v30, v30
    v_lshlrev_b32 v30, 16, v30
    v_cvt_pk_bf16_f32 v46, v46, v46
    v_lshlrev_b32 v46, 16, v46
    v_mul_f32 v31, v31, v58
    v_mul_f32 v47, v47, v59
    v_cvt_pk_bf16_f32 v31, v31, v31
    v_lshlrev_b32 v31, 16, v31
    v_cvt_pk_bf16_f32 v47, v47, v47
    v_lshlrev_b32 v47, 16, v47
    v_lshlrev_b32 v6, 7, v2
    v_lshlrev_b32 v62, 3, v3
    v_add_u32 v6, v6, v62
    v_add_u32 v6, s32, v6
    v_cvt_pk_bf16_f32 v16, v16, v17
    v_cvt_pk_bf16_f32 v17, v18, v19
    ds_write_b64 v6, v[16:17] offset:0
    v_cvt_pk_bf16_f32 v20, v20, v21
    v_cvt_pk_bf16_f32 v21, v22, v23
    ds_write_b64 v6, v[20:21] offset:16
    v_cvt_pk_bf16_f32 v24, v24, v25
    v_cvt_pk_bf16_f32 v25, v26, v27
    ds_write_b64 v6, v[24:25] offset:32
    v_cvt_pk_bf16_f32 v28, v28, v29
    v_cvt_pk_bf16_f32 v29, v30, v31
    ds_write_b64 v6, v[28:29] offset:48
    v_cvt_pk_bf16_f32 v32, v32, v33
    v_cvt_pk_bf16_f32 v33, v34, v35
    ds_write_b64 v6, v[32:33] offset:64
    v_cvt_pk_bf16_f32 v36, v36, v37
    v_cvt_pk_bf16_f32 v37, v38, v39
    ds_write_b64 v6, v[36:37] offset:80
    v_cvt_pk_bf16_f32 v40, v40, v41
    v_cvt_pk_bf16_f32 v41, v42, v43
    ds_write_b64 v6, v[40:41] offset:96
    v_cvt_pk_bf16_f32 v44, v44, v45
    v_cvt_pk_bf16_f32 v45, v46, v47
    ds_write_b64 v6, v[44:45] offset:112
    v_lshlrev_b32 v6, 4, v0
    v_add_u32 v6, s32, v6
    s_waitcnt vmcnt(0)
    ds_write_b128 v6, v[132:135] offset:4096
    ds_write_b128 v6, v[136:139] offset:5120
    s_waitcnt lgkmcnt(0)
    v_lshlrev_b32 v6, 3, v3
    v_bfe_u32 v61, v0, 2, 2
    v_add_u32 v6, v6, v61
    v_bfe_u32 v61, v0, 4, 1
    v_lshlrev_b32 v61, 4, v61
    v_and_b32 v62, 3, v0
    v_lshlrev_b32 v62, 2, v62
    v_add_u32 v61, v61, v62
    v_lshlrev_b32 v61, 1, v61
    v_lshlrev_b32 v62, 7, v6
    v_add_u32 v62, v62, v61
    v_add_u32 v62, s32, v62
    v_lshlrev_b32 v63, 6, v6
    v_add_u32 v63, v63, v61
    v_add_u32 v63, s32, v63
    ds_read_b64_tr_b16 v[16:17], v62 offset:0
    ds_read_b64_tr_b16 v[18:19], v62 offset:512
    ds_read_b64_tr_b16 v[20:21], v62 offset:64
    ds_read_b64_tr_b16 v[22:23], v62 offset:576
    ds_read_b64_tr_b16 v[24:25], v63 offset:4096
    ds_read_b64_tr_b16 v[26:27], v63 offset:4352
    s_waitcnt lgkmcnt(0)
    v_mfma_f32_32x32x16_bf16 v[64:79], v[16:19], v[24:27], v[64:79]
    v_mfma_f32_32x32x16_bf16 v[96:111], v[16:19], v[128:131], v[96:111]
    v_mfma_f32_32x32x16_bf16 v[80:95], v[20:23], v[24:27], v[80:95]
    v_mfma_f32_32x32x16_bf16 v[112:127], v[20:23], v[128:131], v[112:127]
    s_nop 7
    s_nop 7
    ds_read_b64_tr_b16 v[16:17], v62 offset:2048
    ds_read_b64_tr_b16 v[18:19], v62 offset:2560
    ds_read_b64_tr_b16 v[20:21], v62 offset:2112
    ds_read_b64_tr_b16 v[22:23], v62 offset:2624
    ds_read_b64_tr_b16 v[24:25], v63 offset:5120
    ds_read_b64_tr_b16 v[26:27], v63 offset:5376
    s_waitcnt lgkmcnt(0)
    v_mfma_f32_32x32x16_bf16 v[64:79], v[16:19], v[24:27], v[64:79]
    v_mfma_f32_32x32x16_bf16 v[96:111], v[16:19], v[128:131], v[96:111]
    v_mfma_f32_32x32x16_bf16 v[80:95], v[20:23], v[24:27], v[80:95]
    v_mfma_f32_32x32x16_bf16 v[112:127], v[20:23], v[128:131], v[112:127]
    s_nop 7
    s_nop 7
    s_lshl_b32 s31, s29, 8
    s_lshl_b32 s33, s30, 6
    s_add_u32 s31, s31, s33
    s_add_u32 s31, s31, 32
    s_mul_i32 s33, s31, 6144
    v_mul_u32_u24 v7, 6144, v2
    v_add_u32 v7, s33, v7
    s_lshl_b32 s34, s28, 6
    s_add_u32 s34, s34, 2048
    v_lshrrev_b32 v61, 2, v0
    v_mul_u32_u24 v61, 6144, v61
    v_and_b32 v62, 3, v0
    v_lshlrev_b32 v62, 4, v62
    v_add_u32 v61, v61, v62
    v_add_u32 v61, s33, v61
    s_lshl_b32 s35, s28, 6
    s_add_u32 s35, s35, 4096
    v_add_u32 v61, s35, v61
    buffer_load_dwordx4 v[132:135], v61, s[8:11], 0 offen
    v_add_u32 v61, 98304, v61
    buffer_load_dwordx4 v[136:139], v61, s[8:11], 0 offen
    v_lshlrev_b32 v6, 4, v3
    v_add_u32 v6, v7, v6
    v_add_u32 v6, s34, v6
    buffer_load_dwordx4 v[48:51], v6, s[8:11], 0 offen
    buffer_load_dwordx4 v[52:55], v6, s[8:11], 0 offen offset:32
    v_mov_b32 v16, 0
    v_mov_b32 v17, 0
    v_mov_b32 v18, 0
    v_mov_b32 v19, 0
    v_mov_b32 v20, 0
    v_mov_b32 v21, 0
    v_mov_b32 v22, 0
    v_mov_b32 v23, 0
    v_mov_b32 v24, 0
    v_mov_b32 v25, 0
    v_mov_b32 v26, 0
    v_mov_b32 v27, 0
    v_mov_b32 v28, 0
    v_mov_b32 v29, 0
    v_mov_b32 v30, 0
    v_mov_b32 v31, 0
    s_waitcnt vmcnt(0)
    v_mfma_f32_32x32x16_bf16 v[16:31], v[8:11], v[48:51], v[16:31]
    v_mfma_f32_32x32x16_bf16 v[16:31], v[12:15], v[52:55], v[16:31]
    s_nop 15
    s_nop 3
    v_cvt_pk_bf16_f32 v16, v16, v16
    v_lshlrev_b32 v16, 16, v16
    v_cvt_pk_bf16_f32 v17, v17, v17
    v_lshlrev_b32 v17, 16, v17
    v_cvt_pk_bf16_f32 v18, v18, v18
    v_lshlrev_b32 v18, 16, v18
    v_cvt_pk_bf16_f32 v19, v19, v19
    v_lshlrev_b32 v19, 16, v19
    v_cvt_pk_bf16_f32 v20, v20, v20
    v_lshlrev_b32 v20, 16, v20
    v_cvt_pk_bf16_f32 v21, v21, v21
    v_lshlrev_b32 v21, 16, v21
    v_cvt_pk_bf16_f32 v22, v22, v22
    v_lshlrev_b32 v22, 16, v22
    v_cvt_pk_bf16_f32 v23, v23, v23
    v_lshlrev_b32 v23, 16, v23
    v_cvt_pk_bf16_f32 v24, v24, v24
    v_lshlrev_b32 v24, 16, v24
    v_cvt_pk_bf16_f32 v25, v25, v25
    v_lshlrev_b32 v25, 16, v25
    v_cvt_pk_bf16_f32 v26, v26, v26
    v_lshlrev_b32 v26, 16, v26
    v_cvt_pk_bf16_f32 v27, v27, v27
    v_lshlrev_b32 v27, 16, v27
    v_cvt_pk_bf16_f32 v28, v28, v28
    v_lshlrev_b32 v28, 16, v28
    v_cvt_pk_bf16_f32 v29, v29, v29
    v_lshlrev_b32 v29, 16, v29
    v_cvt_pk_bf16_f32 v30, v30, v30
    v_lshlrev_b32 v30, 16, v30
    v_cvt_pk_bf16_f32 v31, v31, v31
    v_lshlrev_b32 v31, 16, v31
    v_mov_b32 v56, v16
    v_mov_b32 v57, v16
    v_max_f32 v56, v56, v17
    v_min_f32 v57, v57, v17
    v_max_f32 v56, v56, v18
    v_min_f32 v57, v57, v18
    v_max_f32 v56, v56, v19
    v_min_f32 v57, v57, v19
    v_max_f32 v56, v56, v20
    v_min_f32 v57, v57, v20
    v_max_f32 v56, v56, v21
    v_min_f32 v57, v57, v21
    v_max_f32 v56, v56, v22
    v_min_f32 v57, v57, v22
    v_max_f32 v56, v56, v23
    v_min_f32 v57, v57, v23
    v_max_f32 v56, v56, v24
    v_min_f32 v57, v57, v24
    v_max_f32 v56, v56, v25
    v_min_f32 v57, v57, v25
    v_max_f32 v56, v56, v26
    v_min_f32 v57, v57, v26
    v_max_f32 v56, v56, v27
    v_min_f32 v57, v57, v27
    v_max_f32 v56, v56, v28
    v_min_f32 v57, v57, v28
    v_max_f32 v56, v56, v29
    v_min_f32 v57, v57, v29
    v_max_f32 v56, v56, v30
    v_min_f32 v57, v57, v30
    v_max_f32 v56, v56, v31
    v_min_f32 v57, v57, v31
    ds_bpermute_b32 v58, v4, v56
    ds_bpermute_b32 v59, v4, v57
    s_waitcnt lgkmcnt(0)
    v_max_f32 v56, v56, v58
    v_min_f32 v57, v57, v59
    v_mov_b32 v58, 0
    v_mov_b32 v59, 0
    s_mov_b32 s35, 0x3fb8aa3b
    v_sub_f32 v32, v57, v16
    v_sub_f32 v16, v16, v56
    v_mul_f32 v32, s35, v32
    v_mul_f32 v16, s35, v16
    v_exp_f32 v32, v32
    v_exp_f32 v16, v16
    s_nop 0
    v_add_f32 v58, v58, v16
    v_add_f32 v59, v59, v32
    v_sub_f32 v33, v57, v17
    v_sub_f32 v17, v17, v56
    v_mul_f32 v33, s35, v33
    v_mul_f32 v17, s35, v17
    v_exp_f32 v33, v33
    v_exp_f32 v17, v17
    s_nop 0
    v_add_f32 v58, v58, v17
    v_add_f32 v59, v59, v33
    v_sub_f32 v34, v57, v18
    v_sub_f32 v18, v18, v56
    v_mul_f32 v34, s35, v34
    v_mul_f32 v18, s35, v18
    v_exp_f32 v34, v34
    v_exp_f32 v18, v18
    s_nop 0
    v_add_f32 v58, v58, v18
    v_add_f32 v59, v59, v34
    v_sub_f32 v35, v57, v19
    v_sub_f32 v19, v19, v56
    v_mul_f32 v35, s35, v35
    v_mul_f32 v19, s35, v19
    v_exp_f32 v35, v35
    v_exp_f32 v19, v19
    s_nop 0
    v_add_f32 v58, v58, v19
    v_add_f32 v59, v59, v35
    v_sub_f32 v36, v57, v20
    v_sub_f32 v20, v20, v56
    v_mul_f32 v36, s35, v36
    v_mul_f32 v20, s35, v20
    v_exp_f32 v36, v36
    v_exp_f32 v20, v20
    s_nop 0
    v_add_f32 v58, v58, v20
    v_add_f32 v59, v59, v36
    v_sub_f32 v37, v57, v21
    v_sub_f32 v21, v21, v56
    v_mul_f32 v37, s35, v37
    v_mul_f32 v21, s35, v21
    v_exp_f32 v37, v37
    v_exp_f32 v21, v21
    s_nop 0
    v_add_f32 v58, v58, v21
    v_add_f32 v59, v59, v37
    v_sub_f32 v38, v57, v22
    v_sub_f32 v22, v22, v56
    v_mul_f32 v38, s35, v38
    v_mul_f32 v22, s35, v22
    v_exp_f32 v38, v38
    v_exp_f32 v22, v22
    s_nop 0
    v_add_f32 v58, v58, v22
    v_add_f32 v59, v59, v38
    v_sub_f32 v39, v57, v23
    v_sub_f32 v23, v23, v56
    v_mul_f32 v39, s35, v39
    v_mul_f32 v23, s35, v23
    v_exp_f32 v39, v39
    v_exp_f32 v23, v23
    s_nop 0
    v_add_f32 v58, v58, v23
    v_add_f32 v59, v59, v39
    v_sub_f32 v40, v57, v24
    v_sub_f32 v24, v24, v56
    v_mul_f32 v40, s35, v40
    v_mul_f32 v24, s35, v24
    v_exp_f32 v40, v40
    v_exp_f32 v24, v24
    s_nop 0
    v_add_f32 v58, v58, v24
    v_add_f32 v59, v59, v40
    v_sub_f32 v41, v57, v25
    v_sub_f32 v25, v25, v56
    v_mul_f32 v41, s35, v41
    v_mul_f32 v25, s35, v25
    v_exp_f32 v41, v41
    v_exp_f32 v25, v25
    s_nop 0
    v_add_f32 v58, v58, v25
    v_add_f32 v59, v59, v41
    v_sub_f32 v42, v57, v26
    v_sub_f32 v26, v26, v56
    v_mul_f32 v42, s35, v42
    v_mul_f32 v26, s35, v26
    v_exp_f32 v42, v42
    v_exp_f32 v26, v26
    s_nop 0
    v_add_f32 v58, v58, v26
    v_add_f32 v59, v59, v42
    v_sub_f32 v43, v57, v27
    v_sub_f32 v27, v27, v56
    v_mul_f32 v43, s35, v43
    v_mul_f32 v27, s35, v27
    v_exp_f32 v43, v43
    v_exp_f32 v27, v27
    s_nop 0
    v_add_f32 v58, v58, v27
    v_add_f32 v59, v59, v43
    v_sub_f32 v44, v57, v28
    v_sub_f32 v28, v28, v56
    v_mul_f32 v44, s35, v44
    v_mul_f32 v28, s35, v28
    v_exp_f32 v44, v44
    v_exp_f32 v28, v28
    s_nop 0
    v_add_f32 v58, v58, v28
    v_add_f32 v59, v59, v44
    v_sub_f32 v45, v57, v29
    v_sub_f32 v29, v29, v56
    v_mul_f32 v45, s35, v45
    v_mul_f32 v29, s35, v29
    v_exp_f32 v45, v45
    v_exp_f32 v29, v29
    s_nop 0
    v_add_f32 v58, v58, v29
    v_add_f32 v59, v59, v45
    v_sub_f32 v46, v57, v30
    v_sub_f32 v30, v30, v56
    v_mul_f32 v46, s35, v46
    v_mul_f32 v30, s35, v30
    v_exp_f32 v46, v46
    v_exp_f32 v30, v30
    s_nop 0
    v_add_f32 v58, v58, v30
    v_add_f32 v59, v59, v46
    v_sub_f32 v47, v57, v31
    v_sub_f32 v31, v31, v56
    v_mul_f32 v47, s35, v47
    v_mul_f32 v31, s35, v31
    v_exp_f32 v47, v47
    v_exp_f32 v31, v31
    s_nop 0
    v_add_f32 v58, v58, v31
    v_add_f32 v59, v59, v47
    ds_bpermute_b32 v56, v4, v58
    ds_bpermute_b32 v57, v4, v59
    s_waitcnt lgkmcnt(0)
    v_add_f32 v58, v58, v56
    v_add_f32 v59, v59, v57
    v_rcp_f32 v58, v58
    v_rcp_f32 v59, v59
    s_nop 0
    v_mul_f32 v16, v16, v58
    v_mul_f32 v32, v32, v59
    v_cvt_pk_bf16_f32 v16, v16, v16
    v_lshlrev_b32 v16, 16, v16
    v_cvt_pk_bf16_f32 v32, v32, v32
    v_lshlrev_b32 v32, 16, v32
    v_mul_f32 v17, v17, v58
    v_mul_f32 v33, v33, v59
    v_cvt_pk_bf16_f32 v17, v17, v17
    v_lshlrev_b32 v17, 16, v17
    v_cvt_pk_bf16_f32 v33, v33, v33
    v_lshlrev_b32 v33, 16, v33
    v_mul_f32 v18, v18, v58
    v_mul_f32 v34, v34, v59
    v_cvt_pk_bf16_f32 v18, v18, v18
    v_lshlrev_b32 v18, 16, v18
    v_cvt_pk_bf16_f32 v34, v34, v34
    v_lshlrev_b32 v34, 16, v34
    v_mul_f32 v19, v19, v58
    v_mul_f32 v35, v35, v59
    v_cvt_pk_bf16_f32 v19, v19, v19
    v_lshlrev_b32 v19, 16, v19
    v_cvt_pk_bf16_f32 v35, v35, v35
    v_lshlrev_b32 v35, 16, v35
    v_mul_f32 v20, v20, v58
    v_mul_f32 v36, v36, v59
    v_cvt_pk_bf16_f32 v20, v20, v20
    v_lshlrev_b32 v20, 16, v20
    v_cvt_pk_bf16_f32 v36, v36, v36
    v_lshlrev_b32 v36, 16, v36
    v_mul_f32 v21, v21, v58
    v_mul_f32 v37, v37, v59
    v_cvt_pk_bf16_f32 v21, v21, v21
    v_lshlrev_b32 v21, 16, v21
    v_cvt_pk_bf16_f32 v37, v37, v37
    v_lshlrev_b32 v37, 16, v37
    v_mul_f32 v22, v22, v58
    v_mul_f32 v38, v38, v59
    v_cvt_pk_bf16_f32 v22, v22, v22
    v_lshlrev_b32 v22, 16, v22
    v_cvt_pk_bf16_f32 v38, v38, v38
    v_lshlrev_b32 v38, 16, v38
    v_mul_f32 v23, v23, v58
    v_mul_f32 v39, v39, v59
    v_cvt_pk_bf16_f32 v23, v23, v23
    v_lshlrev_b32 v23, 16, v23
    v_cvt_pk_bf16_f32 v39, v39, v39
    v_lshlrev_b32 v39, 16, v39
    v_mul_f32 v24, v24, v58
    v_mul_f32 v40, v40, v59
    v_cvt_pk_bf16_f32 v24, v24, v24
    v_lshlrev_b32 v24, 16, v24
    v_cvt_pk_bf16_f32 v40, v40, v40
    v_lshlrev_b32 v40, 16, v40
    v_mul_f32 v25, v25, v58
    v_mul_f32 v41, v41, v59
    v_cvt_pk_bf16_f32 v25, v25, v25
    v_lshlrev_b32 v25, 16, v25
    v_cvt_pk_bf16_f32 v41, v41, v41
    v_lshlrev_b32 v41, 16, v41
    v_mul_f32 v26, v26, v58
    v_mul_f32 v42, v42, v59
    v_cvt_pk_bf16_f32 v26, v26, v26
    v_lshlrev_b32 v26, 16, v26
    v_cvt_pk_bf16_f32 v42, v42, v42
    v_lshlrev_b32 v42, 16, v42
    v_mul_f32 v27, v27, v58
    v_mul_f32 v43, v43, v59
    v_cvt_pk_bf16_f32 v27, v27, v27
    v_lshlrev_b32 v27, 16, v27
    v_cvt_pk_bf16_f32 v43, v43, v43
    v_lshlrev_b32 v43, 16, v43
    v_mul_f32 v28, v28, v58
    v_mul_f32 v44, v44, v59
    v_cvt_pk_bf16_f32 v28, v28, v28
    v_lshlrev_b32 v28, 16, v28
    v_cvt_pk_bf16_f32 v44, v44, v44
    v_lshlrev_b32 v44, 16, v44
    v_mul_f32 v29, v29, v58
    v_mul_f32 v45, v45, v59
    v_cvt_pk_bf16_f32 v29, v29, v29
    v_lshlrev_b32 v29, 16, v29
    v_cvt_pk_bf16_f32 v45, v45, v45
    v_lshlrev_b32 v45, 16, v45
    v_mul_f32 v30, v30, v58
    v_mul_f32 v46, v46, v59
    v_cvt_pk_bf16_f32 v30, v30, v30
    v_lshlrev_b32 v30, 16, v30
    v_cvt_pk_bf16_f32 v46, v46, v46
    v_lshlrev_b32 v46, 16, v46
    v_mul_f32 v31, v31, v58
    v_mul_f32 v47, v47, v59
    v_cvt_pk_bf16_f32 v31, v31, v31
    v_lshlrev_b32 v31, 16, v31
    v_cvt_pk_bf16_f32 v47, v47, v47
    v_lshlrev_b32 v47, 16, v47
    v_lshlrev_b32 v6, 7, v2
    v_lshlrev_b32 v62, 3, v3
    v_add_u32 v6, v6, v62
    v_add_u32 v6, s32, v6
    v_cvt_pk_bf16_f32 v16, v16, v17
    v_cvt_pk_bf16_f32 v17, v18, v19
    ds_write_b64 v6, v[16:17] offset:0
    v_cvt_pk_bf16_f32 v20, v20, v21
    v_cvt_pk_bf16_f32 v21, v22, v23
    ds_write_b64 v6, v[20:21] offset:16
    v_cvt_pk_bf16_f32 v24, v24, v25
    v_cvt_pk_bf16_f32 v25, v26, v27
    ds_write_b64 v6, v[24:25] offset:32
    v_cvt_pk_bf16_f32 v28, v28, v29
    v_cvt_pk_bf16_f32 v29, v30, v31
    ds_write_b64 v6, v[28:29] offset:48
    v_cvt_pk_bf16_f32 v32, v32, v33
    v_cvt_pk_bf16_f32 v33, v34, v35
    ds_write_b64 v6, v[32:33] offset:64
    v_cvt_pk_bf16_f32 v36, v36, v37
    v_cvt_pk_bf16_f32 v37, v38, v39
    ds_write_b64 v6, v[36:37] offset:80
    v_cvt_pk_bf16_f32 v40, v40, v41
    v_cvt_pk_bf16_f32 v41, v42, v43
    ds_write_b64 v6, v[40:41] offset:96
    v_cvt_pk_bf16_f32 v44, v44, v45
    v_cvt_pk_bf16_f32 v45, v46, v47
    ds_write_b64 v6, v[44:45] offset:112
    v_lshlrev_b32 v6, 4, v0
    v_add_u32 v6, s32, v6
    s_waitcnt vmcnt(0)
    ds_write_b128 v6, v[132:135] offset:4096
    ds_write_b128 v6, v[136:139] offset:5120
    s_waitcnt lgkmcnt(0)
    v_lshlrev_b32 v6, 3, v3
    v_bfe_u32 v61, v0, 2, 2
    v_add_u32 v6, v6, v61
    v_bfe_u32 v61, v0, 4, 1
    v_lshlrev_b32 v61, 4, v61
    v_and_b32 v62, 3, v0
    v_lshlrev_b32 v62, 2, v62
    v_add_u32 v61, v61, v62
    v_lshlrev_b32 v61, 1, v61
    v_lshlrev_b32 v62, 7, v6
    v_add_u32 v62, v62, v61
    v_add_u32 v62, s32, v62
    v_lshlrev_b32 v63, 6, v6
    v_add_u32 v63, v63, v61
    v_add_u32 v63, s32, v63
    ds_read_b64_tr_b16 v[16:17], v62 offset:0
    ds_read_b64_tr_b16 v[18:19], v62 offset:512
    ds_read_b64_tr_b16 v[20:21], v62 offset:64
    ds_read_b64_tr_b16 v[22:23], v62 offset:576
    ds_read_b64_tr_b16 v[24:25], v63 offset:4096
    ds_read_b64_tr_b16 v[26:27], v63 offset:4352
    s_waitcnt lgkmcnt(0)
    v_mfma_f32_32x32x16_bf16 v[64:79], v[16:19], v[24:27], v[64:79]
    v_mfma_f32_32x32x16_bf16 v[96:111], v[16:19], v[128:131], v[96:111]
    v_mfma_f32_32x32x16_bf16 v[80:95], v[20:23], v[24:27], v[80:95]
    v_mfma_f32_32x32x16_bf16 v[112:127], v[20:23], v[128:131], v[112:127]
    s_nop 7
    s_nop 7
    ds_read_b64_tr_b16 v[16:17], v62 offset:2048
    ds_read_b64_tr_b16 v[18:19], v62 offset:2560
    ds_read_b64_tr_b16 v[20:21], v62 offset:2112
    ds_read_b64_tr_b16 v[22:23], v62 offset:2624
    ds_read_b64_tr_b16 v[24:25], v63 offset:5120
    ds_read_b64_tr_b16 v[26:27], v63 offset:5376
    s_waitcnt lgkmcnt(0)
    v_mfma_f32_32x32x16_bf16 v[64:79], v[16:19], v[24:27], v[64:79]
    v_mfma_f32_32x32x16_bf16 v[96:111], v[16:19], v[128:131], v[96:111]
    v_mfma_f32_32x32x16_bf16 v[80:95], v[20:23], v[24:27], v[80:95]
    v_mfma_f32_32x32x16_bf16 v[112:127], v[20:23], v[128:131], v[112:127]
    s_nop 7
    s_nop 7
    s_nop 15
    s_mul_i32 s32, s30, 8448
    v_lshlrev_b32 v6, 2, v2
    v_lshlrev_b32 v7, 9, v3
    v_add_u32 v6, v6, v7
    v_add_u32 v6, s32, v6
    v_lshlrev_b32 v7, 4, v3
    v_add_u32 v7, s32, v7
    ds_write_b32 v6, v64 offset:0
    ds_write_b32 v7, v96 offset:8192
    ds_write_b32 v6, v65 offset:128
    ds_write_b32 v7, v97 offset:8196
    ds_write_b32 v6, v66 offset:256
    ds_write_b32 v7, v98 offset:8200
    ds_write_b32 v6, v67 offset:384
    ds_write_b32 v7, v99 offset:8204
    ds_write_b32 v6, v68 offset:1024
    ds_write_b32 v7, v100 offset:8224
    ds_write_b32 v6, v69 offset:1152
    ds_write_b32 v7, v101 offset:8228
    ds_write_b32 v6, v70 offset:1280
    ds_write_b32 v7, v102 offset:8232
    ds_write_b32 v6, v71 offset:1408
    ds_write_b32 v7, v103 offset:8236
    ds_write_b32 v6, v72 offset:2048
    ds_write_b32 v7, v104 offset:8256
    ds_write_b32 v6, v73 offset:2176
    ds_write_b32 v7, v105 offset:8260
    ds_write_b32 v6, v74 offset:2304
    ds_write_b32 v7, v106 offset:8264
    ds_write_b32 v6, v75 offset:2432
    ds_write_b32 v7, v107 offset:8268
    ds_write_b32 v6, v76 offset:3072
    ds_write_b32 v7, v108 offset:8288
    ds_write_b32 v6, v77 offset:3200
    ds_write_b32 v7, v109 offset:8292
    ds_write_b32 v6, v78 offset:3328
    ds_write_b32 v7, v110 offset:8296
    ds_write_b32 v6, v79 offset:3456
    ds_write_b32 v7, v111 offset:8300
    ds_write_b32 v6, v80 offset:4096
    ds_write_b32 v7, v112 offset:8320
    ds_write_b32 v6, v81 offset:4224
    ds_write_b32 v7, v113 offset:8324
    ds_write_b32 v6, v82 offset:4352
    ds_write_b32 v7, v114 offset:8328
    ds_write_b32 v6, v83 offset:4480
    ds_write_b32 v7, v115 offset:8332
    ds_write_b32 v6, v84 offset:5120
    ds_write_b32 v7, v116 offset:8352
    ds_write_b32 v6, v85 offset:5248
    ds_write_b32 v7, v117 offset:8356
    ds_write_b32 v6, v86 offset:5376
    ds_write_b32 v7, v118 offset:8360
    ds_write_b32 v6, v87 offset:5504
    ds_write_b32 v7, v119 offset:8364
    ds_write_b32 v6, v88 offset:6144
    ds_write_b32 v7, v120 offset:8384
    ds_write_b32 v6, v89 offset:6272
    ds_write_b32 v7, v121 offset:8388
    ds_write_b32 v6, v90 offset:6400
    ds_write_b32 v7, v122 offset:8392
    ds_write_b32 v6, v91 offset:6528
    ds_write_b32 v7, v123 offset:8396
    ds_write_b32 v6, v92 offset:7168
    ds_write_b32 v7, v124 offset:8416
    ds_write_b32 v6, v93 offset:7296
    ds_write_b32 v7, v125 offset:8420
    ds_write_b32 v6, v94 offset:7424
    ds_write_b32 v7, v126 offset:8424
    ds_write_b32 v6, v95 offset:7552
    ds_write_b32 v7, v127 offset:8428
    s_waitcnt lgkmcnt(0)
    s_barrier
    v_lshlrev_b32 v6, 2, v60
    s_lshl_b32 s31, s28, 3
    s_add_u32 s31, s31, s29
    s_mul_i32 s31, s31, 8448
    v_add_u32 v7, s31, v6
    ds_read_b32 v16, v6 offset:0
    ds_read_b32 v17, v6 offset:8448
    ds_read_b32 v18, v6 offset:16896
    ds_read_b32 v19, v6 offset:25344
    s_waitcnt lgkmcnt(0)
    v_add_f32 v16, v16, v17
    v_add_f32 v18, v18, v19
    v_add_f32 v16, v16, v18
    s_mov_b32 s33, 0
    buffer_store_dword v16, v7, s[16:19], s33 offen
    ds_read_b32 v16, v6 offset:1024
    ds_read_b32 v17, v6 offset:9472
    ds_read_b32 v18, v6 offset:17920
    ds_read_b32 v19, v6 offset:26368
    s_waitcnt lgkmcnt(0)
    v_add_f32 v16, v16, v17
    v_add_f32 v18, v18, v19
    v_add_f32 v16, v16, v18
    s_mov_b32 s33, 1024
    buffer_store_dword v16, v7, s[16:19], s33 offen
    ds_read_b32 v16, v6 offset:2048
    ds_read_b32 v17, v6 offset:10496
    ds_read_b32 v18, v6 offset:18944
    ds_read_b32 v19, v6 offset:27392
    s_waitcnt lgkmcnt(0)
    v_add_f32 v16, v16, v17
    v_add_f32 v18, v18, v19
    v_add_f32 v16, v16, v18
    s_mov_b32 s33, 2048
    buffer_store_dword v16, v7, s[16:19], s33 offen
    ds_read_b32 v16, v6 offset:3072
    ds_read_b32 v17, v6 offset:11520
    ds_read_b32 v18, v6 offset:19968
    ds_read_b32 v19, v6 offset:28416
    s_waitcnt lgkmcnt(0)
    v_add_f32 v16, v16, v17
    v_add_f32 v18, v18, v19
    v_add_f32 v16, v16, v18
    s_mov_b32 s33, 3072
    buffer_store_dword v16, v7, s[16:19], s33 offen
    ds_read_b32 v16, v6 offset:4096
    ds_read_b32 v17, v6 offset:12544
    ds_read_b32 v18, v6 offset:20992
    ds_read_b32 v19, v6 offset:29440
    s_waitcnt lgkmcnt(0)
    v_add_f32 v16, v16, v17
    v_add_f32 v18, v18, v19
    v_add_f32 v16, v16, v18
    s_mov_b32 s33, 4096
    buffer_store_dword v16, v7, s[16:19], s33 offen
    ds_read_b32 v16, v6 offset:5120
    ds_read_b32 v17, v6 offset:13568
    ds_read_b32 v18, v6 offset:22016
    ds_read_b32 v19, v6 offset:30464
    s_waitcnt lgkmcnt(0)
    v_add_f32 v16, v16, v17
    v_add_f32 v18, v18, v19
    v_add_f32 v16, v16, v18
    s_mov_b32 s33, 5120
    buffer_store_dword v16, v7, s[16:19], s33 offen
    ds_read_b32 v16, v6 offset:6144
    ds_read_b32 v17, v6 offset:14592
    ds_read_b32 v18, v6 offset:23040
    ds_read_b32 v19, v6 offset:31488
    s_waitcnt lgkmcnt(0)
    v_add_f32 v16, v16, v17
    v_add_f32 v18, v18, v19
    v_add_f32 v16, v16, v18
    s_mov_b32 s33, 6144
    buffer_store_dword v16, v7, s[16:19], s33 offen
    ds_read_b32 v16, v6 offset:7168
    ds_read_b32 v17, v6 offset:15616
    ds_read_b32 v18, v6 offset:24064
    ds_read_b32 v19, v6 offset:32512
    s_waitcnt lgkmcnt(0)
    v_add_f32 v16, v16, v17
    v_add_f32 v18, v18, v19
    v_add_f32 v16, v16, v18
    s_mov_b32 s33, 7168
    buffer_store_dword v16, v7, s[16:19], s33 offen
    v_cmp_gt_u32 vcc, 64, v60
    s_and_saveexec_b64 s[36:37], vcc
    ds_read_b32 v16, v6 offset:8192
    ds_read_b32 v17, v6 offset:16640
    ds_read_b32 v18, v6 offset:25088
    ds_read_b32 v19, v6 offset:33536
    s_waitcnt lgkmcnt(0)
    v_add_f32 v16, v16, v17
    v_add_f32 v18, v18, v19
    v_add_f32 v16, v16, v18
    s_mov_b32 s33, 8192
    buffer_store_dword v16, v7, s[16:19], s33 offen
L_done_akv_0_kernel:
    s_endpgm
.globl ao_0_kernel
.p2align 8
.type ao_0_kernel,@function
ao_0_kernel:
    s_cmp_ge_u32 s2, 256
    s_cbranch_scc1 L_done_ao_0_kernel
    s_load_dwordx2 s[40:41], s[0:1], 16
    s_load_dwordx2 s[42:43], s[0:1], 88
    s_waitcnt lgkmcnt(0)
    s_add_u32 s8, s42, 4194304
    s_addc_u32 s9, s43, 0
    s_mov_b32 s10, 12582912
    s_mov_b32 s11, 0x00020000
    s_mov_b32 s12, s40
    s_mov_b32 s13, s41
    s_mov_b32 s14, 65536
    s_mov_b32 s15, 0x00020000
    s_add_u32 s16, s42, 16777216
    s_addc_u32 s17, s43, 0
    s_mov_b32 s18, 2162688
    s_mov_b32 s19, 0x00020000
    s_add_u32 s20, s42, 20971520
    s_addc_u32 s21, s43, 0
    s_mov_b32 s22, 4194304
    s_mov_b32 s23, 0x00020000
    s_and_b32 s28, s2, 31
    s_lshr_b32 s29, s2, 5
    v_lshrrev_b32 v1, 6, v0
    s_nop 0
    v_readfirstlane_b32 s30, v1
    v_mov_b32 v60, v0
    v_and_b32 v0, 63, v0
    v_and_b32 v2, 31, v0
    v_lshrrev_b32 v3, 5, v0
    v_xor_b32 v4, 32, v0
    v_lshlrev_b32 v4, 2, v4
    s_lshl_b32 s31, s28, 11
    v_lshlrev_b32 v5, 9, v3
    v_lshlrev_b32 v6, 1, v2
    v_add_u32 v5, v5, v6
    v_add_u32 v5, s31, v5
    buffer_load_ushort v16, v5, s[12:15], 0 offen offset:0
    buffer_load_ushort v17, v5, s[12:15], 0 offen offset:64
    buffer_load_ushort v18, v5, s[12:15], 0 offen offset:128
    buffer_load_ushort v19, v5, s[12:15], 0 offen offset:192
    buffer_load_ushort v20, v5, s[12:15], 0 offen offset:256
    buffer_load_ushort v21, v5, s[12:15], 0 offen offset:320
    buffer_load_ushort v22, v5, s[12:15], 0 offen offset:384
    buffer_load_ushort v23, v5, s[12:15], 0 offen offset:448
    buffer_load_ushort v24, v5, s[12:15], 0 offen offset:1024
    buffer_load_ushort v25, v5, s[12:15], 0 offen offset:1088
    buffer_load_ushort v26, v5, s[12:15], 0 offen offset:1152
    buffer_load_ushort v27, v5, s[12:15], 0 offen offset:1216
    buffer_load_ushort v28, v5, s[12:15], 0 offen offset:1280
    buffer_load_ushort v29, v5, s[12:15], 0 offen offset:1344
    buffer_load_ushort v30, v5, s[12:15], 0 offen offset:1408
    buffer_load_ushort v31, v5, s[12:15], 0 offen offset:1472
    s_waitcnt vmcnt(0)
    v_lshl_or_b32 v8, v17, 16, v16
    v_lshl_or_b32 v9, v19, 16, v18
    v_lshl_or_b32 v10, v21, 16, v20
    v_lshl_or_b32 v11, v23, 16, v22
    v_lshl_or_b32 v12, v25, 16, v24
    v_lshl_or_b32 v13, v27, 16, v26
    v_lshl_or_b32 v14, v29, 16, v28
    v_lshl_or_b32 v15, v31, 16, v30
    v_lshlrev_b32 v6, 2, v60
    s_mul_i32 s31, s28, 67584
    v_add_u32 v7, s31, v6
    s_mov_b32 s33, 0
    buffer_load_dword v64, v7, s[16:19], s33 offen
    s_mov_b32 s33, 8448
    buffer_load_dword v65, v7, s[16:19], s33 offen
    s_mov_b32 s33, 16896
    buffer_load_dword v66, v7, s[16:19], s33 offen
    s_mov_b32 s33, 25344
    buffer_load_dword v67, v7, s[16:19], s33 offen
    s_mov_b32 s33, 33792
    buffer_load_dword v68, v7, s[16:19], s33 offen
    s_mov_b32 s33, 42240
    buffer_load_dword v69, v7, s[16:19], s33 offen
    s_mov_b32 s33, 50688
    buffer_load_dword v70, v7, s[16:19], s33 offen
    s_mov_b32 s33, 59136
    buffer_load_dword v71, v7, s[16:19], s33 offen
    s_mov_b32 s33, 1024
    buffer_load_dword v72, v7, s[16:19], s33 offen
    s_mov_b32 s33, 9472
    buffer_load_dword v73, v7, s[16:19], s33 offen
    s_mov_b32 s33, 17920
    buffer_load_dword v74, v7, s[16:19], s33 offen
    s_mov_b32 s33, 26368
    buffer_load_dword v75, v7, s[16:19], s33 offen
    s_mov_b32 s33, 34816
    buffer_load_dword v76, v7, s[16:19], s33 offen
    s_mov_b32 s33, 43264
    buffer_load_dword v77, v7, s[16:19], s33 offen
    s_mov_b32 s33, 51712
    buffer_load_dword v78, v7, s[16:19], s33 offen
    s_mov_b32 s33, 60160
    buffer_load_dword v79, v7, s[16:19], s33 offen
    s_mov_b32 s33, 2048
    buffer_load_dword v80, v7, s[16:19], s33 offen
    s_mov_b32 s33, 10496
    buffer_load_dword v81, v7, s[16:19], s33 offen
    s_mov_b32 s33, 18944
    buffer_load_dword v82, v7, s[16:19], s33 offen
    s_mov_b32 s33, 27392
    buffer_load_dword v83, v7, s[16:19], s33 offen
    s_mov_b32 s33, 35840
    buffer_load_dword v84, v7, s[16:19], s33 offen
    s_mov_b32 s33, 44288
    buffer_load_dword v85, v7, s[16:19], s33 offen
    s_mov_b32 s33, 52736
    buffer_load_dword v86, v7, s[16:19], s33 offen
    s_mov_b32 s33, 61184
    buffer_load_dword v87, v7, s[16:19], s33 offen
    s_mov_b32 s33, 3072
    buffer_load_dword v88, v7, s[16:19], s33 offen
    s_mov_b32 s33, 11520
    buffer_load_dword v89, v7, s[16:19], s33 offen
    s_mov_b32 s33, 19968
    buffer_load_dword v90, v7, s[16:19], s33 offen
    s_mov_b32 s33, 28416
    buffer_load_dword v91, v7, s[16:19], s33 offen
    s_mov_b32 s33, 36864
    buffer_load_dword v92, v7, s[16:19], s33 offen
    s_mov_b32 s33, 45312
    buffer_load_dword v93, v7, s[16:19], s33 offen
    s_mov_b32 s33, 53760
    buffer_load_dword v94, v7, s[16:19], s33 offen
    s_mov_b32 s33, 62208
    buffer_load_dword v95, v7, s[16:19], s33 offen
    s_mov_b32 s33, 4096
    buffer_load_dword v96, v7, s[16:19], s33 offen
    s_mov_b32 s33, 12544
    buffer_load_dword v97, v7, s[16:19], s33 offen
    s_mov_b32 s33, 20992
    buffer_load_dword v98, v7, s[16:19], s33 offen
    s_mov_b32 s33, 29440
    buffer_load_dword v99, v7, s[16:19], s33 offen
    s_mov_b32 s33, 37888
    buffer_load_dword v100, v7, s[16:19], s33 offen
    s_mov_b32 s33, 46336
    buffer_load_dword v101, v7, s[16:19], s33 offen
    s_mov_b32 s33, 54784
    buffer_load_dword v102, v7, s[16:19], s33 offen
    s_mov_b32 s33, 63232
    buffer_load_dword v103, v7, s[16:19], s33 offen
    s_mov_b32 s33, 5120
    buffer_load_dword v104, v7, s[16:19], s33 offen
    s_mov_b32 s33, 13568
    buffer_load_dword v105, v7, s[16:19], s33 offen
    s_mov_b32 s33, 22016
    buffer_load_dword v106, v7, s[16:19], s33 offen
    s_mov_b32 s33, 30464
    buffer_load_dword v107, v7, s[16:19], s33 offen
    s_mov_b32 s33, 38912
    buffer_load_dword v108, v7, s[16:19], s33 offen
    s_mov_b32 s33, 47360
    buffer_load_dword v109, v7, s[16:19], s33 offen
    s_mov_b32 s33, 55808
    buffer_load_dword v110, v7, s[16:19], s33 offen
    s_mov_b32 s33, 64256
    buffer_load_dword v111, v7, s[16:19], s33 offen
    s_mov_b32 s33, 6144
    buffer_load_dword v112, v7, s[16:19], s33 offen
    s_mov_b32 s33, 14592
    buffer_load_dword v113, v7, s[16:19], s33 offen
    s_mov_b32 s33, 23040
    buffer_load_dword v114, v7, s[16:19], s33 offen
    s_mov_b32 s33, 31488
    buffer_load_dword v115, v7, s[16:19], s33 offen
    s_mov_b32 s33, 39936
    buffer_load_dword v116, v7, s[16:19], s33 offen
    s_mov_b32 s33, 48384
    buffer_load_dword v117, v7, s[16:19], s33 offen
    s_mov_b32 s33, 56832
    buffer_load_dword v118, v7, s[16:19], s33 offen
    s_mov_b32 s33, 65280
    buffer_load_dword v119, v7, s[16:19], s33 offen
    s_mov_b32 s33, 7168
    buffer_load_dword v120, v7, s[16:19], s33 offen
    s_mov_b32 s33, 15616
    buffer_load_dword v121, v7, s[16:19], s33 offen
    s_mov_b32 s33, 24064
    buffer_load_dword v122, v7, s[16:19], s33 offen
    s_mov_b32 s33, 32512
    buffer_load_dword v123, v7, s[16:19], s33 offen
    s_mov_b32 s33, 40960
    buffer_load_dword v124, v7, s[16:19], s33 offen
    s_mov_b32 s33, 49408
    buffer_load_dword v125, v7, s[16:19], s33 offen
    s_mov_b32 s33, 57856
    buffer_load_dword v126, v7, s[16:19], s33 offen
    s_mov_b32 s33, 66304
    buffer_load_dword v127, v7, s[16:19], s33 offen
    v_cmp_gt_u32 vcc, 64, v60
    s_and_saveexec_b64 s[36:37], vcc
    s_mov_b32 s33, 8192
    buffer_load_dword v128, v7, s[16:19], s33 offen
    s_mov_b32 s33, 16640
    buffer_load_dword v129, v7, s[16:19], s33 offen
    s_mov_b32 s33, 25088
    buffer_load_dword v130, v7, s[16:19], s33 offen
    s_mov_b32 s33, 33536
    buffer_load_dword v131, v7, s[16:19], s33 offen
    s_mov_b32 s33, 41984
    buffer_load_dword v132, v7, s[16:19], s33 offen
    s_mov_b32 s33, 50432
    buffer_load_dword v133, v7, s[16:19], s33 offen
    s_mov_b32 s33, 58880
    buffer_load_dword v134, v7, s[16:19], s33 offen
    s_mov_b32 s33, 67328
    buffer_load_dword v135, v7, s[16:19], s33 offen
    s_mov_b64 exec, -1
    s_waitcnt vmcnt(0)
    v_add_f32 v64, v64, v65
    v_add_f32 v64, v64, v66
    v_add_f32 v64, v64, v67
    v_add_f32 v64, v64, v68
    v_add_f32 v64, v64, v69
    v_add_f32 v64, v64, v70
    v_add_f32 v64, v64, v71
    v_cvt_pk_bf16_f32 v64, v64, v64
    v_lshlrev_b32 v64, 16, v64
    ds_write_b32 v6, v64 offset:0
    v_add_f32 v72, v72, v73
    v_add_f32 v72, v72, v74
    v_add_f32 v72, v72, v75
    v_add_f32 v72, v72, v76
    v_add_f32 v72, v72, v77
    v_add_f32 v72, v72, v78
    v_add_f32 v72, v72, v79
    v_cvt_pk_bf16_f32 v72, v72, v72
    v_lshlrev_b32 v72, 16, v72
    ds_write_b32 v6, v72 offset:1024
    v_add_f32 v80, v80, v81
    v_add_f32 v80, v80, v82
    v_add_f32 v80, v80, v83
    v_add_f32 v80, v80, v84
    v_add_f32 v80, v80, v85
    v_add_f32 v80, v80, v86
    v_add_f32 v80, v80, v87
    v_cvt_pk_bf16_f32 v80, v80, v80
    v_lshlrev_b32 v80, 16, v80
    ds_write_b32 v6, v80 offset:2048
    v_add_f32 v88, v88, v89
    v_add_f32 v88, v88, v90
    v_add_f32 v88, v88, v91
    v_add_f32 v88, v88, v92
    v_add_f32 v88, v88, v93
    v_add_f32 v88, v88, v94
    v_add_f32 v88, v88, v95
    v_cvt_pk_bf16_f32 v88, v88, v88
    v_lshlrev_b32 v88, 16, v88
    ds_write_b32 v6, v88 offset:3072
    v_add_f32 v96, v96, v97
    v_add_f32 v96, v96, v98
    v_add_f32 v96, v96, v99
    v_add_f32 v96, v96, v100
    v_add_f32 v96, v96, v101
    v_add_f32 v96, v96, v102
    v_add_f32 v96, v96, v103
    v_cvt_pk_bf16_f32 v96, v96, v96
    v_lshlrev_b32 v96, 16, v96
    ds_write_b32 v6, v96 offset:4096
    v_add_f32 v104, v104, v105
    v_add_f32 v104, v104, v106
    v_add_f32 v104, v104, v107
    v_add_f32 v104, v104, v108
    v_add_f32 v104, v104, v109
    v_add_f32 v104, v104, v110
    v_add_f32 v104, v104, v111
    v_cvt_pk_bf16_f32 v104, v104, v104
    v_lshlrev_b32 v104, 16, v104
    ds_write_b32 v6, v104 offset:5120
    v_add_f32 v112, v112, v113
    v_add_f32 v112, v112, v114
    v_add_f32 v112, v112, v115
    v_add_f32 v112, v112, v116
    v_add_f32 v112, v112, v117
    v_add_f32 v112, v112, v118
    v_add_f32 v112, v112, v119
    v_cvt_pk_bf16_f32 v112, v112, v112
    v_lshlrev_b32 v112, 16, v112
    ds_write_b32 v6, v112 offset:6144
    v_add_f32 v120, v120, v121
    v_add_f32 v120, v120, v122
    v_add_f32 v120, v120, v123
    v_add_f32 v120, v120, v124
    v_add_f32 v120, v120, v125
    v_add_f32 v120, v120, v126
    v_add_f32 v120, v120, v127
    v_cvt_pk_bf16_f32 v120, v120, v120
    v_lshlrev_b32 v120, 16, v120
    ds_write_b32 v6, v120 offset:7168
    v_cmp_gt_u32 vcc, 64, v60
    s_and_saveexec_b64 s[36:37], vcc
    v_add_f32 v128, v128, v129
    v_add_f32 v128, v128, v130
    v_add_f32 v128, v128, v131
    v_add_f32 v128, v128, v132
    v_add_f32 v128, v128, v133
    v_add_f32 v128, v128, v134
    v_add_f32 v128, v128, v135
    v_cvt_pk_bf16_f32 v128, v128, v128
    v_lshlrev_b32 v128, 16, v128
    ds_write_b32 v6, v128 offset:8192
    s_mov_b64 exec, -1
    s_waitcnt lgkmcnt(0)
    s_barrier
    v_lshlrev_b32 v6, 2, v2
    v_lshlrev_b32 v7, 9, v3
    v_add_u32 v6, v6, v7
    ds_read_b32 v80, v6 offset:0
    ds_read_b32 v81, v6 offset:128
    ds_read_b32 v82, v6 offset:256
    ds_read_b32 v83, v6 offset:384
    ds_read_b32 v84, v6 offset:1024
    ds_read_b32 v85, v6 offset:1152
    ds_read_b32 v86, v6 offset:1280
    ds_read_b32 v87, v6 offset:1408
    ds_read_b32 v88, v6 offset:2048
    ds_read_b32 v89, v6 offset:2176
    ds_read_b32 v90, v6 offset:2304
    ds_read_b32 v91, v6 offset:2432
    ds_read_b32 v92, v6 offset:3072
    ds_read_b32 v93, v6 offset:3200
    ds_read_b32 v94, v6 offset:3328
    ds_read_b32 v95, v6 offset:3456
    ds_read_b32 v96, v6 offset:4096
    ds_read_b32 v97, v6 offset:4224
    ds_read_b32 v98, v6 offset:4352
    ds_read_b32 v99, v6 offset:4480
    ds_read_b32 v100, v6 offset:5120
    ds_read_b32 v101, v6 offset:5248
    ds_read_b32 v102, v6 offset:5376
    ds_read_b32 v103, v6 offset:5504
    ds_read_b32 v104, v6 offset:6144
    ds_read_b32 v105, v6 offset:6272
    ds_read_b32 v106, v6 offset:6400
    ds_read_b32 v107, v6 offset:6528
    ds_read_b32 v108, v6 offset:7168
    ds_read_b32 v109, v6 offset:7296
    ds_read_b32 v110, v6 offset:7424
    ds_read_b32 v111, v6 offset:7552
    v_lshlrev_b32 v7, 4, v3
    ds_read_b32 v112, v7 offset:8192
    ds_read_b32 v113, v7 offset:8196
    ds_read_b32 v114, v7 offset:8200
    ds_read_b32 v115, v7 offset:8204
    ds_read_b32 v116, v7 offset:8224
    ds_read_b32 v117, v7 offset:8228
    ds_read_b32 v118, v7 offset:8232
    ds_read_b32 v119, v7 offset:8236
    ds_read_b32 v120, v7 offset:8256
    ds_read_b32 v121, v7 offset:8260
    ds_read_b32 v122, v7 offset:8264
    ds_read_b32 v123, v7 offset:8268
    ds_read_b32 v124, v7 offset:8288
    ds_read_b32 v125, v7 offset:8292
    ds_read_b32 v126, v7 offset:8296
    ds_read_b32 v127, v7 offset:8300
    ds_read_b32 v128, v7 offset:8320
    ds_read_b32 v129, v7 offset:8324
    ds_read_b32 v130, v7 offset:8328
    ds_read_b32 v131, v7 offset:8332
    ds_read_b32 v132, v7 offset:8352
    ds_read_b32 v133, v7 offset:8356
    ds_read_b32 v134, v7 offset:8360
    ds_read_b32 v135, v7 offset:8364
    ds_read_b32 v136, v7 offset:8384
    ds_read_b32 v137, v7 offset:8388
    ds_read_b32 v138, v7 offset:8392
    ds_read_b32 v139, v7 offset:8396
    ds_read_b32 v140, v7 offset:8416
    ds_read_b32 v141, v7 offset:8420
    ds_read_b32 v142, v7 offset:8424
    ds_read_b32 v143, v7 offset:8428
    s_waitcnt lgkmcnt(0)
    v_cvt_pk_bf16_f32 v64, v80, v81
    v_cvt_pk_bf16_f32 v65, v82, v83
    v_cvt_pk_bf16_f32 v66, v84, v85
    v_cvt_pk_bf16_f32 v67, v86, v87
    v_cvt_pk_bf16_f32 v68, v88, v89
    v_cvt_pk_bf16_f32 v69, v90, v91
    v_cvt_pk_bf16_f32 v70, v92, v93
    v_cvt_pk_bf16_f32 v71, v94, v95
    v_cvt_pk_bf16_f32 v72, v96, v97
    v_cvt_pk_bf16_f32 v73, v98, v99
    v_cvt_pk_bf16_f32 v74, v100, v101
    v_cvt_pk_bf16_f32 v75, v102, v103
    v_cvt_pk_bf16_f32 v76, v104, v105
    v_cvt_pk_bf16_f32 v77, v106, v107
    v_cvt_pk_bf16_f32 v78, v108, v109
    v_cvt_pk_bf16_f32 v79, v110, v111
    s_lshl_b32 s31, s29, 8
    s_lshl_b32 s33, s30, 6
    s_add_u32 s31, s31, s33
    s_add_u32 s31, s31, 0
    s_mul_i32 s33, s31, 6144
    v_mul_u32_u24 v7, 6144, v2
    v_add_u32 v7, s33, v7
    s_lshl_b32 s34, s28, 6
    v_lshlrev_b32 v6, 4, v3
    v_add_u32 v6, v7, v6
    v_add_u32 v6, s34, v6
    buffer_load_dwordx4 v[48:51], v6, s[8:11], 0 offen
    buffer_load_dwordx4 v[52:55], v6, s[8:11], 0 offen offset:32
    v_mov_b32 v16, 0
    v_mov_b32 v17, 0
    v_mov_b32 v18, 0
    v_mov_b32 v19, 0
    v_mov_b32 v20, 0
    v_mov_b32 v21, 0
    v_mov_b32 v22, 0
    v_mov_b32 v23, 0
    v_mov_b32 v24, 0
    v_mov_b32 v25, 0
    v_mov_b32 v26, 0
    v_mov_b32 v27, 0
    v_mov_b32 v28, 0
    v_mov_b32 v29, 0
    v_mov_b32 v30, 0
    v_mov_b32 v31, 0
    s_waitcnt vmcnt(0)
    v_mfma_f32_32x32x16_bf16 v[16:31], v[8:11], v[48:51], v[16:31]
    v_mfma_f32_32x32x16_bf16 v[16:31], v[12:15], v[52:55], v[16:31]
    s_nop 15
    s_nop 3
    v_cvt_pk_bf16_f32 v16, v16, v16
    v_lshlrev_b32 v16, 16, v16
    v_cvt_pk_bf16_f32 v17, v17, v17
    v_lshlrev_b32 v17, 16, v17
    v_cvt_pk_bf16_f32 v18, v18, v18
    v_lshlrev_b32 v18, 16, v18
    v_cvt_pk_bf16_f32 v19, v19, v19
    v_lshlrev_b32 v19, 16, v19
    v_cvt_pk_bf16_f32 v20, v20, v20
    v_lshlrev_b32 v20, 16, v20
    v_cvt_pk_bf16_f32 v21, v21, v21
    v_lshlrev_b32 v21, 16, v21
    v_cvt_pk_bf16_f32 v22, v22, v22
    v_lshlrev_b32 v22, 16, v22
    v_cvt_pk_bf16_f32 v23, v23, v23
    v_lshlrev_b32 v23, 16, v23
    v_cvt_pk_bf16_f32 v24, v24, v24
    v_lshlrev_b32 v24, 16, v24
    v_cvt_pk_bf16_f32 v25, v25, v25
    v_lshlrev_b32 v25, 16, v25
    v_cvt_pk_bf16_f32 v26, v26, v26
    v_lshlrev_b32 v26, 16, v26
    v_cvt_pk_bf16_f32 v27, v27, v27
    v_lshlrev_b32 v27, 16, v27
    v_cvt_pk_bf16_f32 v28, v28, v28
    v_lshlrev_b32 v28, 16, v28
    v_cvt_pk_bf16_f32 v29, v29, v29
    v_lshlrev_b32 v29, 16, v29
    v_cvt_pk_bf16_f32 v30, v30, v30
    v_lshlrev_b32 v30, 16, v30
    v_cvt_pk_bf16_f32 v31, v31, v31
    v_lshlrev_b32 v31, 16, v31
    v_mov_b32 v56, v16
    v_mov_b32 v57, v16
    v_max_f32 v56, v56, v17
    v_min_f32 v57, v57, v17
    v_max_f32 v56, v56, v18
    v_min_f32 v57, v57, v18
    v_max_f32 v56, v56, v19
    v_min_f32 v57, v57, v19
    v_max_f32 v56, v56, v20
    v_min_f32 v57, v57, v20
    v_max_f32 v56, v56, v21
    v_min_f32 v57, v57, v21
    v_max_f32 v56, v56, v22
    v_min_f32 v57, v57, v22
    v_max_f32 v56, v56, v23
    v_min_f32 v57, v57, v23
    v_max_f32 v56, v56, v24
    v_min_f32 v57, v57, v24
    v_max_f32 v56, v56, v25
    v_min_f32 v57, v57, v25
    v_max_f32 v56, v56, v26
    v_min_f32 v57, v57, v26
    v_max_f32 v56, v56, v27
    v_min_f32 v57, v57, v27
    v_max_f32 v56, v56, v28
    v_min_f32 v57, v57, v28
    v_max_f32 v56, v56, v29
    v_min_f32 v57, v57, v29
    v_max_f32 v56, v56, v30
    v_min_f32 v57, v57, v30
    v_max_f32 v56, v56, v31
    v_min_f32 v57, v57, v31
    ds_bpermute_b32 v58, v4, v56
    ds_bpermute_b32 v59, v4, v57
    s_waitcnt lgkmcnt(0)
    v_max_f32 v56, v56, v58
    v_min_f32 v57, v57, v59
    v_mov_b32 v58, 0
    v_mov_b32 v59, 0
    s_mov_b32 s35, 0x3fb8aa3b
    v_sub_f32 v32, v57, v16
    v_sub_f32 v16, v16, v56
    v_mul_f32 v32, s35, v32
    v_mul_f32 v16, s35, v16
    v_exp_f32 v32, v32
    v_exp_f32 v16, v16
    s_nop 0
    v_add_f32 v58, v58, v16
    v_add_f32 v59, v59, v32
    v_sub_f32 v33, v57, v17
    v_sub_f32 v17, v17, v56
    v_mul_f32 v33, s35, v33
    v_mul_f32 v17, s35, v17
    v_exp_f32 v33, v33
    v_exp_f32 v17, v17
    s_nop 0
    v_add_f32 v58, v58, v17
    v_add_f32 v59, v59, v33
    v_sub_f32 v34, v57, v18
    v_sub_f32 v18, v18, v56
    v_mul_f32 v34, s35, v34
    v_mul_f32 v18, s35, v18
    v_exp_f32 v34, v34
    v_exp_f32 v18, v18
    s_nop 0
    v_add_f32 v58, v58, v18
    v_add_f32 v59, v59, v34
    v_sub_f32 v35, v57, v19
    v_sub_f32 v19, v19, v56
    v_mul_f32 v35, s35, v35
    v_mul_f32 v19, s35, v19
    v_exp_f32 v35, v35
    v_exp_f32 v19, v19
    s_nop 0
    v_add_f32 v58, v58, v19
    v_add_f32 v59, v59, v35
    v_sub_f32 v36, v57, v20
    v_sub_f32 v20, v20, v56
    v_mul_f32 v36, s35, v36
    v_mul_f32 v20, s35, v20
    v_exp_f32 v36, v36
    v_exp_f32 v20, v20
    s_nop 0
    v_add_f32 v58, v58, v20
    v_add_f32 v59, v59, v36
    v_sub_f32 v37, v57, v21
    v_sub_f32 v21, v21, v56
    v_mul_f32 v37, s35, v37
    v_mul_f32 v21, s35, v21
    v_exp_f32 v37, v37
    v_exp_f32 v21, v21
    s_nop 0
    v_add_f32 v58, v58, v21
    v_add_f32 v59, v59, v37
    v_sub_f32 v38, v57, v22
    v_sub_f32 v22, v22, v56
    v_mul_f32 v38, s35, v38
    v_mul_f32 v22, s35, v22
    v_exp_f32 v38, v38
    v_exp_f32 v22, v22
    s_nop 0
    v_add_f32 v58, v58, v22
    v_add_f32 v59, v59, v38
    v_sub_f32 v39, v57, v23
    v_sub_f32 v23, v23, v56
    v_mul_f32 v39, s35, v39
    v_mul_f32 v23, s35, v23
    v_exp_f32 v39, v39
    v_exp_f32 v23, v23
    s_nop 0
    v_add_f32 v58, v58, v23
    v_add_f32 v59, v59, v39
    v_sub_f32 v40, v57, v24
    v_sub_f32 v24, v24, v56
    v_mul_f32 v40, s35, v40
    v_mul_f32 v24, s35, v24
    v_exp_f32 v40, v40
    v_exp_f32 v24, v24
    s_nop 0
    v_add_f32 v58, v58, v24
    v_add_f32 v59, v59, v40
    v_sub_f32 v41, v57, v25
    v_sub_f32 v25, v25, v56
    v_mul_f32 v41, s35, v41
    v_mul_f32 v25, s35, v25
    v_exp_f32 v41, v41
    v_exp_f32 v25, v25
    s_nop 0
    v_add_f32 v58, v58, v25
    v_add_f32 v59, v59, v41
    v_sub_f32 v42, v57, v26
    v_sub_f32 v26, v26, v56
    v_mul_f32 v42, s35, v42
    v_mul_f32 v26, s35, v26
    v_exp_f32 v42, v42
    v_exp_f32 v26, v26
    s_nop 0
    v_add_f32 v58, v58, v26
    v_add_f32 v59, v59, v42
    v_sub_f32 v43, v57, v27
    v_sub_f32 v27, v27, v56
    v_mul_f32 v43, s35, v43
    v_mul_f32 v27, s35, v27
    v_exp_f32 v43, v43
    v_exp_f32 v27, v27
    s_nop 0
    v_add_f32 v58, v58, v27
    v_add_f32 v59, v59, v43
    v_sub_f32 v44, v57, v28
    v_sub_f32 v28, v28, v56
    v_mul_f32 v44, s35, v44
    v_mul_f32 v28, s35, v28
    v_exp_f32 v44, v44
    v_exp_f32 v28, v28
    s_nop 0
    v_add_f32 v58, v58, v28
    v_add_f32 v59, v59, v44
    v_sub_f32 v45, v57, v29
    v_sub_f32 v29, v29, v56
    v_mul_f32 v45, s35, v45
    v_mul_f32 v29, s35, v29
    v_exp_f32 v45, v45
    v_exp_f32 v29, v29
    s_nop 0
    v_add_f32 v58, v58, v29
    v_add_f32 v59, v59, v45
    v_sub_f32 v46, v57, v30
    v_sub_f32 v30, v30, v56
    v_mul_f32 v46, s35, v46
    v_mul_f32 v30, s35, v30
    v_exp_f32 v46, v46
    v_exp_f32 v30, v30
    s_nop 0
    v_add_f32 v58, v58, v30
    v_add_f32 v59, v59, v46
    v_sub_f32 v47, v57, v31
    v_sub_f32 v31, v31, v56
    v_mul_f32 v47, s35, v47
    v_mul_f32 v31, s35, v31
    v_exp_f32 v47, v47
    v_exp_f32 v31, v31
    s_nop 0
    v_add_f32 v58, v58, v31
    v_add_f32 v59, v59, v47
    ds_bpermute_b32 v56, v4, v58
    ds_bpermute_b32 v57, v4, v59
    s_waitcnt lgkmcnt(0)
    v_add_f32 v58, v58, v56
    v_add_f32 v59, v59, v57
    v_rcp_f32 v58, v58
    v_rcp_f32 v59, v59
    s_nop 0
    v_mul_f32 v16, v16, v58
    v_mul_f32 v32, v32, v59
    v_cvt_pk_bf16_f32 v16, v16, v16
    v_lshlrev_b32 v16, 16, v16
    v_cvt_pk_bf16_f32 v32, v32, v32
    v_lshlrev_b32 v32, 16, v32
    v_mul_f32 v17, v17, v58
    v_mul_f32 v33, v33, v59
    v_cvt_pk_bf16_f32 v17, v17, v17
    v_lshlrev_b32 v17, 16, v17
    v_cvt_pk_bf16_f32 v33, v33, v33
    v_lshlrev_b32 v33, 16, v33
    v_mul_f32 v18, v18, v58
    v_mul_f32 v34, v34, v59
    v_cvt_pk_bf16_f32 v18, v18, v18
    v_lshlrev_b32 v18, 16, v18
    v_cvt_pk_bf16_f32 v34, v34, v34
    v_lshlrev_b32 v34, 16, v34
    v_mul_f32 v19, v19, v58
    v_mul_f32 v35, v35, v59
    v_cvt_pk_bf16_f32 v19, v19, v19
    v_lshlrev_b32 v19, 16, v19
    v_cvt_pk_bf16_f32 v35, v35, v35
    v_lshlrev_b32 v35, 16, v35
    v_mul_f32 v20, v20, v58
    v_mul_f32 v36, v36, v59
    v_cvt_pk_bf16_f32 v20, v20, v20
    v_lshlrev_b32 v20, 16, v20
    v_cvt_pk_bf16_f32 v36, v36, v36
    v_lshlrev_b32 v36, 16, v36
    v_mul_f32 v21, v21, v58
    v_mul_f32 v37, v37, v59
    v_cvt_pk_bf16_f32 v21, v21, v21
    v_lshlrev_b32 v21, 16, v21
    v_cvt_pk_bf16_f32 v37, v37, v37
    v_lshlrev_b32 v37, 16, v37
    v_mul_f32 v22, v22, v58
    v_mul_f32 v38, v38, v59
    v_cvt_pk_bf16_f32 v22, v22, v22
    v_lshlrev_b32 v22, 16, v22
    v_cvt_pk_bf16_f32 v38, v38, v38
    v_lshlrev_b32 v38, 16, v38
    v_mul_f32 v23, v23, v58
    v_mul_f32 v39, v39, v59
    v_cvt_pk_bf16_f32 v23, v23, v23
    v_lshlrev_b32 v23, 16, v23
    v_cvt_pk_bf16_f32 v39, v39, v39
    v_lshlrev_b32 v39, 16, v39
    v_mul_f32 v24, v24, v58
    v_mul_f32 v40, v40, v59
    v_cvt_pk_bf16_f32 v24, v24, v24
    v_lshlrev_b32 v24, 16, v24
    v_cvt_pk_bf16_f32 v40, v40, v40
    v_lshlrev_b32 v40, 16, v40
    v_mul_f32 v25, v25, v58
    v_mul_f32 v41, v41, v59
    v_cvt_pk_bf16_f32 v25, v25, v25
    v_lshlrev_b32 v25, 16, v25
    v_cvt_pk_bf16_f32 v41, v41, v41
    v_lshlrev_b32 v41, 16, v41
    v_mul_f32 v26, v26, v58
    v_mul_f32 v42, v42, v59
    v_cvt_pk_bf16_f32 v26, v26, v26
    v_lshlrev_b32 v26, 16, v26
    v_cvt_pk_bf16_f32 v42, v42, v42
    v_lshlrev_b32 v42, 16, v42
    v_mul_f32 v27, v27, v58
    v_mul_f32 v43, v43, v59
    v_cvt_pk_bf16_f32 v27, v27, v27
    v_lshlrev_b32 v27, 16, v27
    v_cvt_pk_bf16_f32 v43, v43, v43
    v_lshlrev_b32 v43, 16, v43
    v_mul_f32 v28, v28, v58
    v_mul_f32 v44, v44, v59
    v_cvt_pk_bf16_f32 v28, v28, v28
    v_lshlrev_b32 v28, 16, v28
    v_cvt_pk_bf16_f32 v44, v44, v44
    v_lshlrev_b32 v44, 16, v44
    v_mul_f32 v29, v29, v58
    v_mul_f32 v45, v45, v59
    v_cvt_pk_bf16_f32 v29, v29, v29
    v_lshlrev_b32 v29, 16, v29
    v_cvt_pk_bf16_f32 v45, v45, v45
    v_lshlrev_b32 v45, 16, v45
    v_mul_f32 v30, v30, v58
    v_mul_f32 v46, v46, v59
    v_cvt_pk_bf16_f32 v30, v30, v30
    v_lshlrev_b32 v30, 16, v30
    v_cvt_pk_bf16_f32 v46, v46, v46
    v_lshlrev_b32 v46, 16, v46
    v_mul_f32 v31, v31, v58
    v_mul_f32 v47, v47, v59
    v_cvt_pk_bf16_f32 v31, v31, v31
    v_lshlrev_b32 v31, 16, v31
    v_cvt_pk_bf16_f32 v47, v47, v47
    v_lshlrev_b32 v47, 16, v47
    v_mov_b32 v56, 0
    v_fmac_f32 v56, v16, v112
    v_fmac_f32 v56, v17, v113
    v_fmac_f32 v56, v18, v114
    v_fmac_f32 v56, v19, v115
    v_fmac_f32 v56, v20, v116
    v_fmac_f32 v56, v21, v117
    v_fmac_f32 v56, v22, v118
    v_fmac_f32 v56, v23, v119
    v_fmac_f32 v56, v24, v120
    v_fmac_f32 v56, v25, v121
    v_fmac_f32 v56, v26, v122
    v_fmac_f32 v56, v27, v123
    v_fmac_f32 v56, v28, v124
    v_fmac_f32 v56, v29, v125
    v_fmac_f32 v56, v30, v126
    v_fmac_f32 v56, v31, v127
    v_fmac_f32 v56, v32, v128
    v_fmac_f32 v56, v33, v129
    v_fmac_f32 v56, v34, v130
    v_fmac_f32 v56, v35, v131
    v_fmac_f32 v56, v36, v132
    v_fmac_f32 v56, v37, v133
    v_fmac_f32 v56, v38, v134
    v_fmac_f32 v56, v39, v135
    v_fmac_f32 v56, v40, v136
    v_fmac_f32 v56, v41, v137
    v_fmac_f32 v56, v42, v138
    v_fmac_f32 v56, v43, v139
    v_fmac_f32 v56, v44, v140
    v_fmac_f32 v56, v45, v141
    v_fmac_f32 v56, v46, v142
    v_fmac_f32 v56, v47, v143
    ds_bpermute_b32 v57, v4, v56
    v_cvt_pk_bf16_f32 v80, v16, v17
    v_cvt_pk_bf16_f32 v81, v18, v19
    v_cvt_pk_bf16_f32 v82, v20, v21
    v_cvt_pk_bf16_f32 v83, v22, v23
    v_cvt_pk_bf16_f32 v84, v24, v25
    v_cvt_pk_bf16_f32 v85, v26, v27
    v_cvt_pk_bf16_f32 v86, v28, v29
    v_cvt_pk_bf16_f32 v87, v30, v31
    v_cvt_pk_bf16_f32 v88, v32, v33
    v_cvt_pk_bf16_f32 v89, v34, v35
    v_cvt_pk_bf16_f32 v90, v36, v37
    v_cvt_pk_bf16_f32 v91, v38, v39
    v_cvt_pk_bf16_f32 v92, v40, v41
    v_cvt_pk_bf16_f32 v93, v42, v43
    v_cvt_pk_bf16_f32 v94, v44, v45
    v_cvt_pk_bf16_f32 v95, v46, v47
    v_mov_b32 v16, 0
    v_mov_b32 v17, 0
    v_mov_b32 v18, 0
    v_mov_b32 v19, 0
    v_mov_b32 v20, 0
    v_mov_b32 v21, 0
    v_mov_b32 v22, 0
    v_mov_b32 v23, 0
    v_mov_b32 v24, 0
    v_mov_b32 v25, 0
    v_mov_b32 v26, 0
    v_mov_b32 v27, 0
    v_mov_b32 v28, 0
    v_mov_b32 v29, 0
    v_mov_b32 v30, 0
    v_mov_b32 v31, 0
    s_waitcnt lgkmcnt(0)
    v_add_f32 v56, v56, v57
    v_cvt_pk_bf16_f32 v56, v56, v56
    v_lshlrev_b32 v56, 16, v56
    v_add_f32 v56, 0x358637bd, v56
    v_cvt_pk_bf16_f32 v56, v56, v56
    v_lshlrev_b32 v56, 16, v56
    v_rcp_f32 v56, v56
    v_mfma_f32_32x32x16_bf16 v[16:31], v[64:67], v[80:83], v[16:31]
    v_mfma_f32_32x32x16_bf16 v[16:31], v[68:71], v[84:87], v[16:31]
    v_mfma_f32_32x32x16_bf16 v[16:31], v[72:75], v[88:91], v[16:31]
    v_mfma_f32_32x32x16_bf16 v[16:31], v[76:79], v[92:95], v[16:31]
    s_nop 15
    s_nop 3
    s_lshl_b32 s33, s31, 11
    v_lshlrev_b32 v6, 11, v2
    v_add_u32 v6, s33, v6
    v_lshlrev_b32 v7, 3, v3
    v_add_u32 v6, v6, v7
    v_add_u32 v6, s34, v6
    v_cvt_pk_bf16_f32 v16, v16, v16
    v_lshlrev_b32 v16, 16, v16
    v_mul_f32 v16, v16, v56
    v_cvt_pk_bf16_f32 v17, v17, v17
    v_lshlrev_b32 v17, 16, v17
    v_mul_f32 v17, v17, v56
    v_cvt_pk_bf16_f32 v18, v18, v18
    v_lshlrev_b32 v18, 16, v18
    v_mul_f32 v18, v18, v56
    v_cvt_pk_bf16_f32 v19, v19, v19
    v_lshlrev_b32 v19, 16, v19
    v_mul_f32 v19, v19, v56
    v_cvt_pk_bf16_f32 v16, v16, v17
    v_cvt_pk_bf16_f32 v17, v18, v19
    buffer_store_dwordx2 v[16:17], v6, s[20:23], 0 offen offset:0
    v_cvt_pk_bf16_f32 v20, v20, v20
    v_lshlrev_b32 v20, 16, v20
    v_mul_f32 v20, v20, v56
    v_cvt_pk_bf16_f32 v21, v21, v21
    v_lshlrev_b32 v21, 16, v21
    v_mul_f32 v21, v21, v56
    v_cvt_pk_bf16_f32 v22, v22, v22
    v_lshlrev_b32 v22, 16, v22
    v_mul_f32 v22, v22, v56
    v_cvt_pk_bf16_f32 v23, v23, v23
    v_lshlrev_b32 v23, 16, v23
    v_mul_f32 v23, v23, v56
    v_cvt_pk_bf16_f32 v20, v20, v21
    v_cvt_pk_bf16_f32 v21, v22, v23
    buffer_store_dwordx2 v[20:21], v6, s[20:23], 0 offen offset:16
    v_cvt_pk_bf16_f32 v24, v24, v24
    v_lshlrev_b32 v24, 16, v24
    v_mul_f32 v24, v24, v56
    v_cvt_pk_bf16_f32 v25, v25, v25
    v_lshlrev_b32 v25, 16, v25
    v_mul_f32 v25, v25, v56
    v_cvt_pk_bf16_f32 v26, v26, v26
    v_lshlrev_b32 v26, 16, v26
    v_mul_f32 v26, v26, v56
    v_cvt_pk_bf16_f32 v27, v27, v27
    v_lshlrev_b32 v27, 16, v27
    v_mul_f32 v27, v27, v56
    v_cvt_pk_bf16_f32 v24, v24, v25
    v_cvt_pk_bf16_f32 v25, v26, v27
    buffer_store_dwordx2 v[24:25], v6, s[20:23], 0 offen offset:32
    v_cvt_pk_bf16_f32 v28, v28, v28
    v_lshlrev_b32 v28, 16, v28
    v_mul_f32 v28, v28, v56
    v_cvt_pk_bf16_f32 v29, v29, v29
    v_lshlrev_b32 v29, 16, v29
    v_mul_f32 v29, v29, v56
    v_cvt_pk_bf16_f32 v30, v30, v30
    v_lshlrev_b32 v30, 16, v30
    v_mul_f32 v30, v30, v56
    v_cvt_pk_bf16_f32 v31, v31, v31
    v_lshlrev_b32 v31, 16, v31
    v_mul_f32 v31, v31, v56
    v_cvt_pk_bf16_f32 v28, v28, v29
    v_cvt_pk_bf16_f32 v29, v30, v31
    buffer_store_dwordx2 v[28:29], v6, s[20:23], 0 offen offset:48
    s_nop 3
    s_lshl_b32 s31, s29, 8
    s_lshl_b32 s33, s30, 6
    s_add_u32 s31, s31, s33
    s_add_u32 s31, s31, 32
    s_mul_i32 s33, s31, 6144
    v_mul_u32_u24 v7, 6144, v2
    v_add_u32 v7, s33, v7
    s_lshl_b32 s34, s28, 6
    v_lshlrev_b32 v6, 4, v3
    v_add_u32 v6, v7, v6
    v_add_u32 v6, s34, v6
    buffer_load_dwordx4 v[48:51], v6, s[8:11], 0 offen
    buffer_load_dwordx4 v[52:55], v6, s[8:11], 0 offen offset:32
    v_mov_b32 v16, 0
    v_mov_b32 v17, 0
    v_mov_b32 v18, 0
    v_mov_b32 v19, 0
    v_mov_b32 v20, 0
    v_mov_b32 v21, 0
    v_mov_b32 v22, 0
    v_mov_b32 v23, 0
    v_mov_b32 v24, 0
    v_mov_b32 v25, 0
    v_mov_b32 v26, 0
    v_mov_b32 v27, 0
    v_mov_b32 v28, 0
    v_mov_b32 v29, 0
    v_mov_b32 v30, 0
    v_mov_b32 v31, 0
    s_waitcnt vmcnt(0)
    v_mfma_f32_32x32x16_bf16 v[16:31], v[8:11], v[48:51], v[16:31]
    v_mfma_f32_32x32x16_bf16 v[16:31], v[12:15], v[52:55], v[16:31]
    s_nop 15
    s_nop 3
    v_cvt_pk_bf16_f32 v16, v16, v16
    v_lshlrev_b32 v16, 16, v16
    v_cvt_pk_bf16_f32 v17, v17, v17
    v_lshlrev_b32 v17, 16, v17
    v_cvt_pk_bf16_f32 v18, v18, v18
    v_lshlrev_b32 v18, 16, v18
    v_cvt_pk_bf16_f32 v19, v19, v19
    v_lshlrev_b32 v19, 16, v19
    v_cvt_pk_bf16_f32 v20, v20, v20
    v_lshlrev_b32 v20, 16, v20
    v_cvt_pk_bf16_f32 v21, v21, v21
    v_lshlrev_b32 v21, 16, v21
    v_cvt_pk_bf16_f32 v22, v22, v22
    v_lshlrev_b32 v22, 16, v22
    v_cvt_pk_bf16_f32 v23, v23, v23
    v_lshlrev_b32 v23, 16, v23
    v_cvt_pk_bf16_f32 v24, v24, v24
    v_lshlrev_b32 v24, 16, v24
    v_cvt_pk_bf16_f32 v25, v25, v25
    v_lshlrev_b32 v25, 16, v25
    v_cvt_pk_bf16_f32 v26, v26, v26
    v_lshlrev_b32 v26, 16, v26
    v_cvt_pk_bf16_f32 v27, v27, v27
    v_lshlrev_b32 v27, 16, v27
    v_cvt_pk_bf16_f32 v28, v28, v28
    v_lshlrev_b32 v28, 16, v28
    v_cvt_pk_bf16_f32 v29, v29, v29
    v_lshlrev_b32 v29, 16, v29
    v_cvt_pk_bf16_f32 v30, v30, v30
    v_lshlrev_b32 v30, 16, v30
    v_cvt_pk_bf16_f32 v31, v31, v31
    v_lshlrev_b32 v31, 16, v31
    v_mov_b32 v56, v16
    v_mov_b32 v57, v16
    v_max_f32 v56, v56, v17
    v_min_f32 v57, v57, v17
    v_max_f32 v56, v56, v18
    v_min_f32 v57, v57, v18
    v_max_f32 v56, v56, v19
    v_min_f32 v57, v57, v19
    v_max_f32 v56, v56, v20
    v_min_f32 v57, v57, v20
    v_max_f32 v56, v56, v21
    v_min_f32 v57, v57, v21
    v_max_f32 v56, v56, v22
    v_min_f32 v57, v57, v22
    v_max_f32 v56, v56, v23
    v_min_f32 v57, v57, v23
    v_max_f32 v56, v56, v24
    v_min_f32 v57, v57, v24
    v_max_f32 v56, v56, v25
    v_min_f32 v57, v57, v25
    v_max_f32 v56, v56, v26
    v_min_f32 v57, v57, v26
    v_max_f32 v56, v56, v27
    v_min_f32 v57, v57, v27
    v_max_f32 v56, v56, v28
    v_min_f32 v57, v57, v28
    v_max_f32 v56, v56, v29
    v_min_f32 v57, v57, v29
    v_max_f32 v56, v56, v30
    v_min_f32 v57, v57, v30
    v_max_f32 v56, v56, v31
    v_min_f32 v57, v57, v31
    ds_bpermute_b32 v58, v4, v56
    ds_bpermute_b32 v59, v4, v57
    s_waitcnt lgkmcnt(0)
    v_max_f32 v56, v56, v58
    v_min_f32 v57, v57, v59
    v_mov_b32 v58, 0
    v_mov_b32 v59, 0
    s_mov_b32 s35, 0x3fb8aa3b
    v_sub_f32 v32, v57, v16
    v_sub_f32 v16, v16, v56
    v_mul_f32 v32, s35, v32
    v_mul_f32 v16, s35, v16
    v_exp_f32 v32, v32
    v_exp_f32 v16, v16
    s_nop 0
    v_add_f32 v58, v58, v16
    v_add_f32 v59, v59, v32
    v_sub_f32 v33, v57, v17
    v_sub_f32 v17, v17, v56
    v_mul_f32 v33, s35, v33
    v_mul_f32 v17, s35, v17
    v_exp_f32 v33, v33
    v_exp_f32 v17, v17
    s_nop 0
    v_add_f32 v58, v58, v17
    v_add_f32 v59, v59, v33
    v_sub_f32 v34, v57, v18
    v_sub_f32 v18, v18, v56
    v_mul_f32 v34, s35, v34
    v_mul_f32 v18, s35, v18
    v_exp_f32 v34, v34
    v_exp_f32 v18, v18
    s_nop 0
    v_add_f32 v58, v58, v18
    v_add_f32 v59, v59, v34
    v_sub_f32 v35, v57, v19
    v_sub_f32 v19, v19, v56
    v_mul_f32 v35, s35, v35
    v_mul_f32 v19, s35, v19
    v_exp_f32 v35, v35
    v_exp_f32 v19, v19
    s_nop 0
    v_add_f32 v58, v58, v19
    v_add_f32 v59, v59, v35
    v_sub_f32 v36, v57, v20
    v_sub_f32 v20, v20, v56
    v_mul_f32 v36, s35, v36
    v_mul_f32 v20, s35, v20
    v_exp_f32 v36, v36
    v_exp_f32 v20, v20
    s_nop 0
    v_add_f32 v58, v58, v20
    v_add_f32 v59, v59, v36
    v_sub_f32 v37, v57, v21
    v_sub_f32 v21, v21, v56
    v_mul_f32 v37, s35, v37
    v_mul_f32 v21, s35, v21
    v_exp_f32 v37, v37
    v_exp_f32 v21, v21
    s_nop 0
    v_add_f32 v58, v58, v21
    v_add_f32 v59, v59, v37
    v_sub_f32 v38, v57, v22
    v_sub_f32 v22, v22, v56
    v_mul_f32 v38, s35, v38
    v_mul_f32 v22, s35, v22
    v_exp_f32 v38, v38
    v_exp_f32 v22, v22
    s_nop 0
    v_add_f32 v58, v58, v22
    v_add_f32 v59, v59, v38
    v_sub_f32 v39, v57, v23
    v_sub_f32 v23, v23, v56
    v_mul_f32 v39, s35, v39
    v_mul_f32 v23, s35, v23
    v_exp_f32 v39, v39
    v_exp_f32 v23, v23
    s_nop 0
    v_add_f32 v58, v58, v23
    v_add_f32 v59, v59, v39
    v_sub_f32 v40, v57, v24
    v_sub_f32 v24, v24, v56
    v_mul_f32 v40, s35, v40
    v_mul_f32 v24, s35, v24
    v_exp_f32 v40, v40
    v_exp_f32 v24, v24
    s_nop 0
    v_add_f32 v58, v58, v24
    v_add_f32 v59, v59, v40
    v_sub_f32 v41, v57, v25
    v_sub_f32 v25, v25, v56
    v_mul_f32 v41, s35, v41
    v_mul_f32 v25, s35, v25
    v_exp_f32 v41, v41
    v_exp_f32 v25, v25
    s_nop 0
    v_add_f32 v58, v58, v25
    v_add_f32 v59, v59, v41
    v_sub_f32 v42, v57, v26
    v_sub_f32 v26, v26, v56
    v_mul_f32 v42, s35, v42
    v_mul_f32 v26, s35, v26
    v_exp_f32 v42, v42
    v_exp_f32 v26, v26
    s_nop 0
    v_add_f32 v58, v58, v26
    v_add_f32 v59, v59, v42
    v_sub_f32 v43, v57, v27
    v_sub_f32 v27, v27, v56
    v_mul_f32 v43, s35, v43
    v_mul_f32 v27, s35, v27
    v_exp_f32 v43, v43
    v_exp_f32 v27, v27
    s_nop 0
    v_add_f32 v58, v58, v27
    v_add_f32 v59, v59, v43
    v_sub_f32 v44, v57, v28
    v_sub_f32 v28, v28, v56
    v_mul_f32 v44, s35, v44
    v_mul_f32 v28, s35, v28
    v_exp_f32 v44, v44
    v_exp_f32 v28, v28
    s_nop 0
    v_add_f32 v58, v58, v28
    v_add_f32 v59, v59, v44
    v_sub_f32 v45, v57, v29
    v_sub_f32 v29, v29, v56
    v_mul_f32 v45, s35, v45
    v_mul_f32 v29, s35, v29
    v_exp_f32 v45, v45
    v_exp_f32 v29, v29
    s_nop 0
    v_add_f32 v58, v58, v29
    v_add_f32 v59, v59, v45
    v_sub_f32 v46, v57, v30
    v_sub_f32 v30, v30, v56
    v_mul_f32 v46, s35, v46
    v_mul_f32 v30, s35, v30
    v_exp_f32 v46, v46
    v_exp_f32 v30, v30
    s_nop 0
    v_add_f32 v58, v58, v30
    v_add_f32 v59, v59, v46
    v_sub_f32 v47, v57, v31
    v_sub_f32 v31, v31, v56
    v_mul_f32 v47, s35, v47
    v_mul_f32 v31, s35, v31
    v_exp_f32 v47, v47
    v_exp_f32 v31, v31
    s_nop 0
    v_add_f32 v58, v58, v31
    v_add_f32 v59, v59, v47
    ds_bpermute_b32 v56, v4, v58
    ds_bpermute_b32 v57, v4, v59
    s_waitcnt lgkmcnt(0)
    v_add_f32 v58, v58, v56
    v_add_f32 v59, v59, v57
    v_rcp_f32 v58, v58
    v_rcp_f32 v59, v59
    s_nop 0
    v_mul_f32 v16, v16, v58
    v_mul_f32 v32, v32, v59
    v_cvt_pk_bf16_f32 v16, v16, v16
    v_lshlrev_b32 v16, 16, v16
    v_cvt_pk_bf16_f32 v32, v32, v32
    v_lshlrev_b32 v32, 16, v32
    v_mul_f32 v17, v17, v58
    v_mul_f32 v33, v33, v59
    v_cvt_pk_bf16_f32 v17, v17, v17
    v_lshlrev_b32 v17, 16, v17
    v_cvt_pk_bf16_f32 v33, v33, v33
    v_lshlrev_b32 v33, 16, v33
    v_mul_f32 v18, v18, v58
    v_mul_f32 v34, v34, v59
    v_cvt_pk_bf16_f32 v18, v18, v18
    v_lshlrev_b32 v18, 16, v18
    v_cvt_pk_bf16_f32 v34, v34, v34
    v_lshlrev_b32 v34, 16, v34
    v_mul_f32 v19, v19, v58
    v_mul_f32 v35, v35, v59
    v_cvt_pk_bf16_f32 v19, v19, v19
    v_lshlrev_b32 v19, 16, v19
    v_cvt_pk_bf16_f32 v35, v35, v35
    v_lshlrev_b32 v35, 16, v35
    v_mul_f32 v20, v20, v58
    v_mul_f32 v36, v36, v59
    v_cvt_pk_bf16_f32 v20, v20, v20
    v_lshlrev_b32 v20, 16, v20
    v_cvt_pk_bf16_f32 v36, v36, v36
    v_lshlrev_b32 v36, 16, v36
    v_mul_f32 v21, v21, v58
    v_mul_f32 v37, v37, v59
    v_cvt_pk_bf16_f32 v21, v21, v21
    v_lshlrev_b32 v21, 16, v21
    v_cvt_pk_bf16_f32 v37, v37, v37
    v_lshlrev_b32 v37, 16, v37
    v_mul_f32 v22, v22, v58
    v_mul_f32 v38, v38, v59
    v_cvt_pk_bf16_f32 v22, v22, v22
    v_lshlrev_b32 v22, 16, v22
    v_cvt_pk_bf16_f32 v38, v38, v38
    v_lshlrev_b32 v38, 16, v38
    v_mul_f32 v23, v23, v58
    v_mul_f32 v39, v39, v59
    v_cvt_pk_bf16_f32 v23, v23, v23
    v_lshlrev_b32 v23, 16, v23
    v_cvt_pk_bf16_f32 v39, v39, v39
    v_lshlrev_b32 v39, 16, v39
    v_mul_f32 v24, v24, v58
    v_mul_f32 v40, v40, v59
    v_cvt_pk_bf16_f32 v24, v24, v24
    v_lshlrev_b32 v24, 16, v24
    v_cvt_pk_bf16_f32 v40, v40, v40
    v_lshlrev_b32 v40, 16, v40
    v_mul_f32 v25, v25, v58
    v_mul_f32 v41, v41, v59
    v_cvt_pk_bf16_f32 v25, v25, v25
    v_lshlrev_b32 v25, 16, v25
    v_cvt_pk_bf16_f32 v41, v41, v41
    v_lshlrev_b32 v41, 16, v41
    v_mul_f32 v26, v26, v58
    v_mul_f32 v42, v42, v59
    v_cvt_pk_bf16_f32 v26, v26, v26
    v_lshlrev_b32 v26, 16, v26
    v_cvt_pk_bf16_f32 v42, v42, v42
    v_lshlrev_b32 v42, 16, v42
    v_mul_f32 v27, v27, v58
    v_mul_f32 v43, v43, v59
    v_cvt_pk_bf16_f32 v27, v27, v27
    v_lshlrev_b32 v27, 16, v27
    v_cvt_pk_bf16_f32 v43, v43, v43
    v_lshlrev_b32 v43, 16, v43
    v_mul_f32 v28, v28, v58
    v_mul_f32 v44, v44, v59
    v_cvt_pk_bf16_f32 v28, v28, v28
    v_lshlrev_b32 v28, 16, v28
    v_cvt_pk_bf16_f32 v44, v44, v44
    v_lshlrev_b32 v44, 16, v44
    v_mul_f32 v29, v29, v58
    v_mul_f32 v45, v45, v59
    v_cvt_pk_bf16_f32 v29, v29, v29
    v_lshlrev_b32 v29, 16, v29
    v_cvt_pk_bf16_f32 v45, v45, v45
    v_lshlrev_b32 v45, 16, v45
    v_mul_f32 v30, v30, v58
    v_mul_f32 v46, v46, v59
    v_cvt_pk_bf16_f32 v30, v30, v30
    v_lshlrev_b32 v30, 16, v30
    v_cvt_pk_bf16_f32 v46, v46, v46
    v_lshlrev_b32 v46, 16, v46
    v_mul_f32 v31, v31, v58
    v_mul_f32 v47, v47, v59
    v_cvt_pk_bf16_f32 v31, v31, v31
    v_lshlrev_b32 v31, 16, v31
    v_cvt_pk_bf16_f32 v47, v47, v47
    v_lshlrev_b32 v47, 16, v47
    v_mov_b32 v56, 0
    v_fmac_f32 v56, v16, v112
    v_fmac_f32 v56, v17, v113
    v_fmac_f32 v56, v18, v114
    v_fmac_f32 v56, v19, v115
    v_fmac_f32 v56, v20, v116
    v_fmac_f32 v56, v21, v117
    v_fmac_f32 v56, v22, v118
    v_fmac_f32 v56, v23, v119
    v_fmac_f32 v56, v24, v120
    v_fmac_f32 v56, v25, v121
    v_fmac_f32 v56, v26, v122
    v_fmac_f32 v56, v27, v123
    v_fmac_f32 v56, v28, v124
    v_fmac_f32 v56, v29, v125
    v_fmac_f32 v56, v30, v126
    v_fmac_f32 v56, v31, v127
    v_fmac_f32 v56, v32, v128
    v_fmac_f32 v56, v33, v129
    v_fmac_f32 v56, v34, v130
    v_fmac_f32 v56, v35, v131
    v_fmac_f32 v56, v36, v132
    v_fmac_f32 v56, v37, v133
    v_fmac_f32 v56, v38, v134
    v_fmac_f32 v56, v39, v135
    v_fmac_f32 v56, v40, v136
    v_fmac_f32 v56, v41, v137
    v_fmac_f32 v56, v42, v138
    v_fmac_f32 v56, v43, v139
    v_fmac_f32 v56, v44, v140
    v_fmac_f32 v56, v45, v141
    v_fmac_f32 v56, v46, v142
    v_fmac_f32 v56, v47, v143
    ds_bpermute_b32 v57, v4, v56
    v_cvt_pk_bf16_f32 v80, v16, v17
    v_cvt_pk_bf16_f32 v81, v18, v19
    v_cvt_pk_bf16_f32 v82, v20, v21
    v_cvt_pk_bf16_f32 v83, v22, v23
    v_cvt_pk_bf16_f32 v84, v24, v25
    v_cvt_pk_bf16_f32 v85, v26, v27
    v_cvt_pk_bf16_f32 v86, v28, v29
    v_cvt_pk_bf16_f32 v87, v30, v31
    v_cvt_pk_bf16_f32 v88, v32, v33
    v_cvt_pk_bf16_f32 v89, v34, v35
    v_cvt_pk_bf16_f32 v90, v36, v37
    v_cvt_pk_bf16_f32 v91, v38, v39
    v_cvt_pk_bf16_f32 v92, v40, v41
    v_cvt_pk_bf16_f32 v93, v42, v43
    v_cvt_pk_bf16_f32 v94, v44, v45
    v_cvt_pk_bf16_f32 v95, v46, v47
    v_mov_b32 v16, 0
    v_mov_b32 v17, 0
    v_mov_b32 v18, 0
    v_mov_b32 v19, 0
    v_mov_b32 v20, 0
    v_mov_b32 v21, 0
    v_mov_b32 v22, 0
    v_mov_b32 v23, 0
    v_mov_b32 v24, 0
    v_mov_b32 v25, 0
    v_mov_b32 v26, 0
    v_mov_b32 v27, 0
    v_mov_b32 v28, 0
    v_mov_b32 v29, 0
    v_mov_b32 v30, 0
    v_mov_b32 v31, 0
    s_waitcnt lgkmcnt(0)
    v_add_f32 v56, v56, v57
    v_cvt_pk_bf16_f32 v56, v56, v56
    v_lshlrev_b32 v56, 16, v56
    v_add_f32 v56, 0x358637bd, v56
    v_cvt_pk_bf16_f32 v56, v56, v56
    v_lshlrev_b32 v56, 16, v56
    v_rcp_f32 v56, v56
    v_mfma_f32_32x32x16_bf16 v[16:31], v[64:67], v[80:83], v[16:31]
    v_mfma_f32_32x32x16_bf16 v[16:31], v[68:71], v[84:87], v[16:31]
    v_mfma_f32_32x32x16_bf16 v[16:31], v[72:75], v[88:91], v[16:31]
    v_mfma_f32_32x32x16_bf16 v[16:31], v[76:79], v[92:95], v[16:31]
    s_nop 15
    s_nop 3
    s_lshl_b32 s33, s31, 11
    v_lshlrev_b32 v6, 11, v2
    v_add_u32 v6, s33, v6
    v_lshlrev_b32 v7, 3, v3
    v_add_u32 v6, v6, v7
    v_add_u32 v6, s34, v6
    v_cvt_pk_bf16_f32 v16, v16, v16
    v_lshlrev_b32 v16, 16, v16
    v_mul_f32 v16, v16, v56
    v_cvt_pk_bf16_f32 v17, v17, v17
    v_lshlrev_b32 v17, 16, v17
    v_mul_f32 v17, v17, v56
    v_cvt_pk_bf16_f32 v18, v18, v18
    v_lshlrev_b32 v18, 16, v18
    v_mul_f32 v18, v18, v56
    v_cvt_pk_bf16_f32 v19, v19, v19
    v_lshlrev_b32 v19, 16, v19
    v_mul_f32 v19, v19, v56
    v_cvt_pk_bf16_f32 v16, v16, v17
    v_cvt_pk_bf16_f32 v17, v18, v19
    buffer_store_dwordx2 v[16:17], v6, s[20:23], 0 offen offset:0
    v_cvt_pk_bf16_f32 v20, v20, v20
    v_lshlrev_b32 v20, 16, v20
    v_mul_f32 v20, v20, v56
    v_cvt_pk_bf16_f32 v21, v21, v21
    v_lshlrev_b32 v21, 16, v21
    v_mul_f32 v21, v21, v56
    v_cvt_pk_bf16_f32 v22, v22, v22
    v_lshlrev_b32 v22, 16, v22
    v_mul_f32 v22, v22, v56
    v_cvt_pk_bf16_f32 v23, v23, v23
    v_lshlrev_b32 v23, 16, v23
    v_mul_f32 v23, v23, v56
    v_cvt_pk_bf16_f32 v20, v20, v21
    v_cvt_pk_bf16_f32 v21, v22, v23
    buffer_store_dwordx2 v[20:21], v6, s[20:23], 0 offen offset:16
    v_cvt_pk_bf16_f32 v24, v24, v24
    v_lshlrev_b32 v24, 16, v24
    v_mul_f32 v24, v24, v56
    v_cvt_pk_bf16_f32 v25, v25, v25
    v_lshlrev_b32 v25, 16, v25
    v_mul_f32 v25, v25, v56
    v_cvt_pk_bf16_f32 v26, v26, v26
    v_lshlrev_b32 v26, 16, v26
    v_mul_f32 v26, v26, v56
    v_cvt_pk_bf16_f32 v27, v27, v27
    v_lshlrev_b32 v27, 16, v27
    v_mul_f32 v27, v27, v56
    v_cvt_pk_bf16_f32 v24, v24, v25
    v_cvt_pk_bf16_f32 v25, v26, v27
    buffer_store_dwordx2 v[24:25], v6, s[20:23], 0 offen offset:32
    v_cvt_pk_bf16_f32 v28, v28, v28
    v_lshlrev_b32 v28, 16, v28
    v_mul_f32 v28, v28, v56
    v_cvt_pk_bf16_f32 v29, v29, v29
    v_lshlrev_b32 v29, 16, v29
    v_mul_f32 v29, v29, v56
    v_cvt_pk_bf16_f32 v30, v30, v30
    v_lshlrev_b32 v30, 16, v30
    v_mul_f32 v30, v30, v56
    v_cvt_pk_bf16_f32 v31, v31, v31
    v_lshlrev_b32 v31, 16, v31
    v_mul_f32 v31, v31, v56
    v_cvt_pk_bf16_f32 v28, v28, v29
    v_cvt_pk_bf16_f32 v29, v30, v31
    buffer_store_dwordx2 v[28:29], v6, s[20:23], 0 offen offset:48
    s_nop 3
L_done_ao_0_kernel:
    s_endpgm
.globl gwo_0_kernel
.p2align 8
.type gwo_0_kernel,@function
gwo_0_kernel:
    s_cmp_ge_u32 s2, 256
    s_cbranch_scc1 L_done_gwo_0_kernel
    s_load_dwordx2 s[40:41], s[0:1], 0
    s_load_dwordx2 s[42:43], s[0:1], 24
    s_load_dwordx2 s[44:45], s[0:1], 88
    s_waitcnt lgkmcnt(0)
    s_add_u32 s8, s44, 20971520
    s_addc_u32 s9, s45, 0
    s_mov_b32 s10, 4194304
    s_mov_b32 s11, 0x00020000
    s_mov_b32 s12, s42
    s_mov_b32 s13, s43
    s_mov_b32 s14, 2097152
    s_mov_b32 s15, 0x00020000
    s_add_u32 s16, s44, 25165824
    s_addc_u32 s17, s45, 0
    s_mov_b32 s18, 4194304
    s_mov_b32 s19, 0x00020000
    s_mov_b32 s20, s40
    s_mov_b32 s21, s41
    s_mov_b32 s22, 4194304
    s_mov_b32 s23, 0x00020000
    s_mov_b32 s36, 0x3d372713
    s_mov_b32 s37, 0xc0135761
    s_and_b32 s3, s2, 7
    s_lshr_b32 s4, s2, 3
    s_mul_i32 s5, s4, 8192
    s_lshr_b32 s5, s5, 16
    s_mul_i32 s6, s5, 8
    s_sub_u32 s6, s4, s6
    s_lshr_b32 s7, s3, 1
    s_mul_i32 s7, s7, 4
    s_add_u32 s28, s7, s5
    s_and_b32 s7, s3, 1
    s_mul_i32 s7, s7, 8
    s_add_u32 s29, s7, s6
    v_lshrrev_b32 v1, 6, v0
    s_nop 0
    v_readfirstlane_b32 s30, v1
    v_and_b32 v0, 63, v0
    v_lshrrev_b32 v1, 3, v0
    s_lshl_b32 s31, s30, 4
    s_lshl_b32 s34, s28, 7
    s_add_u32 s31, s31, s34
    v_add_u32 v1, s31, v1
    v_add_u32 v6, 0, v1
    v_lshrrev_b32 v7, 1, v6
    v_and_b32 v7, 7, v7
    v_and_b32 v8, 7, v0
    v_xor_b32 v7, v7, v8
    v_lshlrev_b32 v7, 4, v7
    s_mov_b32 s35, 2048
    v_mul_lo_u32 v6, v6, s35
    v_add_u32 v2, v6, v7
    v_add_u32 v6, 8, v1
    v_lshrrev_b32 v7, 1, v6
    v_and_b32 v7, 7, v7
    v_and_b32 v8, 7, v0
    v_xor_b32 v7, v7, v8
    v_lshlrev_b32 v7, 4, v7
    s_mov_b32 s35, 2048
    v_mul_lo_u32 v6, v6, s35
    v_add_u32 v3, v6, v7
    s_mul_i32 s31, s30, 64
    s_mul_i32 s34, s29, 128
    v_add_u32 v6, s31, v0
    v_add_u32 v6, 0, v6
    v_mul_u32_u24 v7, 8192, v6
    v_lshrrev_b32 v7, 16, v7
    v_mul_u32_u24 v8, 8, v7
    v_sub_u32 v8, v6, v8
    v_lshlrev_b32 v9, 1, v7
    v_and_b32 v9, 4, v9
    v_xor_b32 v8, v8, v9
    v_lshlrev_b32 v8, 4, v8
    s_mov_b32 s35, 2048
    v_mul_lo_u32 v7, v7, s35
    v_add_u32 v7, v7, v8
    v_add_u32 v10, s34, v7
    s_lshr_b32 s31, s30, 1
    s_and_b32 s34, s30, 1
    s_mul_i32 s38, s31, 32
    s_mul_i32 s39, s34, 32
    v_and_b32 v6, 31, v0
    v_add_u32 v6, s38, v6
    v_lshrrev_b32 v7, 1, v6
    v_and_b32 v7, 7, v7
    v_lshrrev_b32 v8, 5, v0
    v_xor_b32 v7, v7, v8
    v_lshlrev_b32 v7, 4, v7
    v_lshlrev_b32 v6, 7, v6
    v_add_u32 v6, v6, v7
    v_xor_b32 v20, 0, v6
    v_add_u32 v36, 65536, v20
    v_xor_b32 v21, 32, v6
    v_add_u32 v37, 65536, v21
    v_xor_b32 v22, 64, v6
    v_add_u32 v38, 65536, v22
    v_xor_b32 v23, 96, v6
    v_add_u32 v39, 65536, v23
    v_lshrrev_b32 v6, 5, v0
    v_lshlrev_b32 v6, 3, v6
    v_bfe_u32 v7, v0, 2, 2
    v_add_u32 v6, v6, v7
    v_bfe_u32 v8, v0, 4, 1
    v_lshlrev_b32 v8, 4, v8
    v_and_b32 v9, 3, v0
    v_lshlrev_b32 v9, 2, v9
    v_add_u32 v8, v8, v9
    v_add_u32 v8, s39, v8
    v_add_u32 v9, 0, v8
    v_lshlrev_b32 v9, 1, v9
    v_lshlrev_b32 v18, 5, v7
    v_and_b32 v18, 64, v18
    v_xor_b32 v9, v9, v18
    v_mul_u32_u24 v19, 128, v6
    v_add_u32 v24, v19, v9
    v_add_u32 v24, 98304, v24
    v_add_u32 v28, 16384, v24
    v_add_u32 v32, 32768, v24
    v_mov_b32 v40, 0
    v_mov_b32 v41, 0
    v_mov_b32 v42, 0
    v_mov_b32 v43, 0
    v_mov_b32 v44, 0
    v_mov_b32 v45, 0
    v_mov_b32 v46, 0
    v_mov_b32 v47, 0
    v_mov_b32 v48, 0
    v_mov_b32 v49, 0
    v_mov_b32 v50, 0
    v_mov_b32 v51, 0
    v_mov_b32 v52, 0
    v_mov_b32 v53, 0
    v_mov_b32 v54, 0
    v_mov_b32 v55, 0
    s_lshl_b32 s40, s30, 11
    s_mul_i32 s41, s30, 1024
    s_add_u32 s41, s41, 98304
    s_mov_b32 s32, 0
    s_mov_b32 s33, 0
    s_and_b32 s42, s4, 15
    s_mov_b32 s42, 0
    s_mov_b32 s35, 0
    s_add_u32 s35, s35, s42
    s_sub_u32 s34, s35, 16
    s_cmp_ge_u32 s35, 16
    s_cselect_b32 s35, s34, s35
    s_mul_i32 s33, s35, 131072
    s_lshl_b32 s32, s35, 7
    s_add_u32 m0, s40, 0
    s_nop 0
    buffer_load_dwordx4 v2, s[8:11], s32 offen lds
    s_add_u32 m0, s40, 1024
    s_nop 0
    buffer_load_dwordx4 v3, s[8:11], s32 offen lds
    s_add_u32 m0, s41, 0
    s_nop 0
    buffer_load_dwordx4 v10, s[12:15], s33 offen lds
    s_mov_b32 s35, 1
    s_add_u32 s35, s35, s42
    s_sub_u32 s34, s35, 16
    s_cmp_ge_u32 s35, 16
    s_cselect_b32 s35, s34, s35
    s_mul_i32 s33, s35, 131072
    s_lshl_b32 s32, s35, 7
    s_add_u32 m0, s40, 16384
    s_nop 0
    buffer_load_dwordx4 v2, s[8:11], s32 offen lds
    s_add_u32 m0, s40, 17408
    s_nop 0
    buffer_load_dwordx4 v3, s[8:11], s32 offen lds
    s_add_u32 m0, s41, 8192
    s_nop 0
    buffer_load_dwordx4 v10, s[12:15], s33 offen lds
    s_mov_b32 s35, 2
    s_add_u32 s35, s35, s42
    s_sub_u32 s34, s35, 16
    s_cmp_ge_u32 s35, 16
    s_cselect_b32 s35, s34, s35
    s_mul_i32 s33, s35, 131072
    s_lshl_b32 s32, s35, 7
    s_add_u32 m0, s40, 32768
    s_nop 0
    buffer_load_dwordx4 v2, s[8:11], s32 offen lds
    s_add_u32 m0, s40, 33792
    s_nop 0
    buffer_load_dwordx4 v3, s[8:11], s32 offen lds
    s_add_u32 m0, s41, 16384
    s_nop 0
    buffer_load_dwordx4 v10, s[12:15], s33 offen lds
    s_mov_b32 s35, 3
    s_add_u32 s35, s35, s42
    s_sub_u32 s34, s35, 16
    s_cmp_ge_u32 s35, 16
    s_cselect_b32 s35, s34, s35
    s_mul_i32 s33, s35, 131072
    s_lshl_b32 s32, s35, 7
    s_add_u32 m0, s40, 49152
    s_nop 0
    buffer_load_dwordx4 v2, s[8:11], s32 offen lds
    s_add_u32 m0, s40, 50176
    s_nop 0
    buffer_load_dwordx4 v3, s[8:11], s32 offen lds
    s_add_u32 m0, s41, 24576
    s_nop 0
    buffer_load_dwordx4 v10, s[12:15], s33 offen lds
    s_mov_b32 s35, 4
    s_add_u32 s35, s35, s42
    s_sub_u32 s34, s35, 16
    s_cmp_ge_u32 s35, 16
    s_cselect_b32 s35, s34, s35
    s_mul_i32 s33, s35, 131072
    s_lshl_b32 s32, s35, 7
    s_add_u32 m0, s40, 65536
    s_nop 0
    buffer_load_dwordx4 v2, s[8:11], s32 offen lds
    s_add_u32 m0, s40, 66560
    s_nop 0
    buffer_load_dwordx4 v3, s[8:11], s32 offen lds
    s_add_u32 m0, s41, 32768
    s_nop 0
    buffer_load_dwordx4 v10, s[12:15], s33 offen lds
    s_mov_b32 s31, 0
    s_waitcnt vmcnt(12)
    s_barrier
    ds_read_b128 v[56:59], v20 offset:0
    ds_read_b64_tr_b16 v[60:61], v24 offset:0
    ds_read_b64_tr_b16 v[62:63], v24 offset:512
L_loop_gwo_0_kernel:
    s_cmp_ge_u32 s31, 16
    s_cbranch_scc1 L_lend_gwo_0_kernel
    s_cmp_ge_u32 s31, 11
    s_cbranch_scc1 L_gwo_0_kernel_tail1
    s_waitcnt vmcnt(9)
    s_barrier
    s_add_u32 s35, s31, 5
    s_add_u32 s35, s35, s42
    s_sub_u32 s34, s35, 16
    s_cmp_ge_u32 s35, 16
    s_cselect_b32 s35, s34, s35
    s_mul_i32 s33, s35, 131072
    s_lshl_b32 s32, s35, 7
    s_add_u32 m0, s40, 81920
    s_nop 0
    buffer_load_dwordx4 v2, s[8:11], s32 offen lds
    s_add_u32 m0, s40, 82944
    s_nop 0
    buffer_load_dwordx4 v3, s[8:11], s32 offen lds
    s_add_u32 m0, s41, 40960
    s_nop 0
    buffer_load_dwordx4 v10, s[12:15], s33 offen lds
    s_branch L_gwo_0_kernel_join2
L_gwo_0_kernel_tail1:
    s_waitcnt vmcnt(0)
    s_barrier
L_gwo_0_kernel_join2:
    ds_read_b128 v[64:67], v21 offset:0
    ds_read_b64_tr_b16 v[68:69], v24 offset:2048
    ds_read_b64_tr_b16 v[70:71], v24 offset:2560
    s_waitcnt lgkmcnt(3)
    v_mfma_f32_32x32x16_bf16 v[40:55], v[60:63], v[56:59], v[40:55]
    ds_read_b128 v[56:59], v22 offset:0
    ds_read_b64_tr_b16 v[60:61], v24 offset:4096
    ds_read_b64_tr_b16 v[62:63], v24 offset:4608
    s_waitcnt lgkmcnt(3)
    v_mfma_f32_32x32x16_bf16 v[40:55], v[68:71], v[64:67], v[40:55]
    ds_read_b128 v[64:67], v23 offset:0
    ds_read_b64_tr_b16 v[68:69], v24 offset:6144
    ds_read_b64_tr_b16 v[70:71], v24 offset:6656
    s_waitcnt lgkmcnt(3)
    v_mfma_f32_32x32x16_bf16 v[40:55], v[60:63], v[56:59], v[40:55]
    ds_read_b128 v[56:59], v20 offset:16384
    ds_read_b64_tr_b16 v[60:61], v24 offset:8192
    ds_read_b64_tr_b16 v[62:63], v24 offset:8704
    s_waitcnt lgkmcnt(3)
    v_mfma_f32_32x32x16_bf16 v[40:55], v[68:71], v[64:67], v[40:55]
    s_cmp_ge_u32 s31, 15
    s_cbranch_scc1 L_lend_gwo_0_kernel
    s_cmp_ge_u32 s31, 10
    s_cbranch_scc1 L_gwo_0_kernel_tail3
    s_waitcnt vmcnt(9)
    s_barrier
    s_add_u32 s35, s31, 6
    s_add_u32 s35, s35, s42
    s_sub_u32 s34, s35, 16
    s_cmp_ge_u32 s35, 16
    s_cselect_b32 s35, s34, s35
    s_mul_i32 s33, s35, 131072
    s_lshl_b32 s32, s35, 7
    s_add_u32 m0, s40, 0
    s_nop 0
    buffer_load_dwordx4 v2, s[8:11], s32 offen lds
    s_add_u32 m0, s40, 1024
    s_nop 0
    buffer_load_dwordx4 v3, s[8:11], s32 offen lds
    s_add_u32 m0, s41, 0
    s_nop 0
    buffer_load_dwordx4 v10, s[12:15], s33 offen lds
    s_branch L_gwo_0_kernel_join4
L_gwo_0_kernel_tail3:
    s_waitcnt vmcnt(0)
    s_barrier
L_gwo_0_kernel_join4:
    ds_read_b128 v[64:67], v21 offset:16384
    ds_read_b64_tr_b16 v[68:69], v24 offset:10240
    ds_read_b64_tr_b16 v[70:71], v24 offset:10752
    s_waitcnt lgkmcnt(3)
    v_mfma_f32_32x32x16_bf16 v[40:55], v[60:63], v[56:59], v[40:55]
    ds_read_b128 v[56:59], v22 offset:16384
    ds_read_b64_tr_b16 v[60:61], v24 offset:12288
    ds_read_b64_tr_b16 v[62:63], v24 offset:12800
    s_waitcnt lgkmcnt(3)
    v_mfma_f32_32x32x16_bf16 v[40:55], v[68:71], v[64:67], v[40:55]
    ds_read_b128 v[64:67], v23 offset:16384
    ds_read_b64_tr_b16 v[68:69], v24 offset:14336
    ds_read_b64_tr_b16 v[70:71], v24 offset:14848
    s_waitcnt lgkmcnt(3)
    v_mfma_f32_32x32x16_bf16 v[40:55], v[60:63], v[56:59], v[40:55]
    ds_read_b128 v[56:59], v20 offset:32768
    ds_read_b64_tr_b16 v[60:61], v28 offset:0
    ds_read_b64_tr_b16 v[62:63], v28 offset:512
    s_waitcnt lgkmcnt(3)
    v_mfma_f32_32x32x16_bf16 v[40:55], v[68:71], v[64:67], v[40:55]
    s_cmp_ge_u32 s31, 14
    s_cbranch_scc1 L_lend_gwo_0_kernel
    s_cmp_ge_u32 s31, 9
    s_cbranch_scc1 L_gwo_0_kernel_tail5
    s_waitcnt vmcnt(9)
    s_barrier
    s_add_u32 s35, s31, 7
    s_add_u32 s35, s35, s42
    s_sub_u32 s34, s35, 16
    s_cmp_ge_u32 s35, 16
    s_cselect_b32 s35, s34, s35
    s_mul_i32 s33, s35, 131072
    s_lshl_b32 s32, s35, 7
    s_add_u32 m0, s40, 16384
    s_nop 0
    buffer_load_dwordx4 v2, s[8:11], s32 offen lds
    s_add_u32 m0, s40, 17408
    s_nop 0
    buffer_load_dwordx4 v3, s[8:11], s32 offen lds
    s_add_u32 m0, s41, 8192
    s_nop 0
    buffer_load_dwordx4 v10, s[12:15], s33 offen lds
    s_branch L_gwo_0_kernel_join6
L_gwo_0_kernel_tail5:
    s_waitcnt vmcnt(0)
    s_barrier
L_gwo_0_kernel_join6:
    ds_read_b128 v[64:67], v21 offset:32768
    ds_read_b64_tr_b16 v[68:69], v28 offset:2048
    ds_read_b64_tr_b16 v[70:71], v28 offset:2560
    s_waitcnt lgkmcnt(3)
    v_mfma_f32_32x32x16_bf16 v[40:55], v[60:63], v[56:59], v[40:55]
    ds_read_b128 v[56:59], v22 offset:32768
    ds_read_b64_tr_b16 v[60:61], v28 offset:4096
    ds_read_b64_tr_b16 v[62:63], v28 offset:4608
    s_waitcnt lgkmcnt(3)
    v_mfma_f32_32x32x16_bf16 v[40:55], v[68:71], v[64:67], v[40:55]
    ds_read_b128 v[64:67], v23 offset:32768
    ds_read_b64_tr_b16 v[68:69], v28 offset:6144
    ds_read_b64_tr_b16 v[70:71], v28 offset:6656
    s_waitcnt lgkmcnt(3)
    v_mfma_f32_32x32x16_bf16 v[40:55], v[60:63], v[56:59], v[40:55]
    ds_read_b128 v[56:59], v20 offset:49152
    ds_read_b64_tr_b16 v[60:61], v28 offset:8192
    ds_read_b64_tr_b16 v[62:63], v28 offset:8704
    s_waitcnt lgkmcnt(3)
    v_mfma_f32_32x32x16_bf16 v[40:55], v[68:71], v[64:67], v[40:55]
    s_cmp_ge_u32 s31, 13
    s_cbranch_scc1 L_lend_gwo_0_kernel
    s_cmp_ge_u32 s31, 8
    s_cbranch_scc1 L_gwo_0_kernel_tail7
    s_waitcnt vmcnt(9)
    s_barrier
    s_add_u32 s35, s31, 8
    s_add_u32 s35, s35, s42
    s_sub_u32 s34, s35, 16
    s_cmp_ge_u32 s35, 16
    s_cselect_b32 s35, s34, s35
    s_mul_i32 s33, s35, 131072
    s_lshl_b32 s32, s35, 7
    s_add_u32 m0, s40, 32768
    s_nop 0
    buffer_load_dwordx4 v2, s[8:11], s32 offen lds
    s_add_u32 m0, s40, 33792
    s_nop 0
    buffer_load_dwordx4 v3, s[8:11], s32 offen lds
    s_add_u32 m0, s41, 16384
    s_nop 0
    buffer_load_dwordx4 v10, s[12:15], s33 offen lds
    s_branch L_gwo_0_kernel_join8
L_gwo_0_kernel_tail7:
    s_waitcnt vmcnt(0)
    s_barrier
L_gwo_0_kernel_join8:
    ds_read_b128 v[64:67], v21 offset:49152
    ds_read_b64_tr_b16 v[68:69], v28 offset:10240
    ds_read_b64_tr_b16 v[70:71], v28 offset:10752
    s_waitcnt lgkmcnt(3)
    v_mfma_f32_32x32x16_bf16 v[40:55], v[60:63], v[56:59], v[40:55]
    ds_read_b128 v[56:59], v22 offset:49152
    ds_read_b64_tr_b16 v[60:61], v28 offset:12288
    ds_read_b64_tr_b16 v[62:63], v28 offset:12800
    s_waitcnt lgkmcnt(3)
    v_mfma_f32_32x32x16_bf16 v[40:55], v[68:71], v[64:67], v[40:55]
    ds_read_b128 v[64:67], v23 offset:49152
    ds_read_b64_tr_b16 v[68:69], v28 offset:14336
    ds_read_b64_tr_b16 v[70:71], v28 offset:14848
    s_waitcnt lgkmcnt(3)
    v_mfma_f32_32x32x16_bf16 v[40:55], v[60:63], v[56:59], v[40:55]
    ds_read_b128 v[56:59], v36 offset:0
    ds_read_b64_tr_b16 v[60:61], v32 offset:0
    ds_read_b64_tr_b16 v[62:63], v32 offset:512
    s_waitcnt lgkmcnt(3)
    v_mfma_f32_32x32x16_bf16 v[40:55], v[68:71], v[64:67], v[40:55]
    s_cmp_ge_u32 s31, 12
    s_cbranch_scc1 L_lend_gwo_0_kernel
    s_cmp_ge_u32 s31, 7
    s_cbranch_scc1 L_gwo_0_kernel_tail9
    s_waitcnt vmcnt(9)
    s_barrier
    s_add_u32 s35, s31, 9
    s_add_u32 s35, s35, s42
    s_sub_u32 s34, s35, 16
    s_cmp_ge_u32 s35, 16
    s_cselect_b32 s35, s34, s35
    s_mul_i32 s33, s35, 131072
    s_lshl_b32 s32, s35, 7
    s_add_u32 m0, s40, 49152
    s_nop 0
    buffer_load_dwordx4 v2, s[8:11], s32 offen lds
    s_add_u32 m0, s40, 50176
    s_nop 0
    buffer_load_dwordx4 v3, s[8:11], s32 offen lds
    s_add_u32 m0, s41, 24576
    s_nop 0
    buffer_load_dwordx4 v10, s[12:15], s33 offen lds
    s_branch L_gwo_0_kernel_join10
L_gwo_0_kernel_tail9:
    s_waitcnt vmcnt(0)
    s_barrier
L_gwo_0_kernel_join10:
    ds_read_b128 v[64:67], v37 offset:0
    ds_read_b64_tr_b16 v[68:69], v32 offset:2048
    ds_read_b64_tr_b16 v[70:71], v32 offset:2560
    s_waitcnt lgkmcnt(3)
    v_mfma_f32_32x32x16_bf16 v[40:55], v[60:63], v[56:59], v[40:55]
    ds_read_b128 v[56:59], v38 offset:0
    ds_read_b64_tr_b16 v[60:61], v32 offset:4096
    ds_read_b64_tr_b16 v[62:63], v32 offset:4608
    s_waitcnt lgkmcnt(3)
    v_mfma_f32_32x32x16_bf16 v[40:55], v[68:71], v[64:67], v[40:55]
    ds_read_b128 v[64:67], v39 offset:0
    ds_read_b64_tr_b16 v[68:69], v32 offset:6144
    ds_read_b64_tr_b16 v[70:71], v32 offset:6656
    s_waitcnt lgkmcnt(3)
    v_mfma_f32_32x32x16_bf16 v[40:55], v[60:63], v[56:59], v[40:55]
    ds_read_b128 v[56:59], v36 offset:16384
    ds_read_b64_tr_b16 v[60:61], v32 offset:8192
    ds_read_b64_tr_b16 v[62:63], v32 offset:8704
    s_waitcnt lgkmcnt(3)
    v_mfma_f32_32x32x16_bf16 v[40:55], v[68:71], v[64:67], v[40:55]
    s_cmp_ge_u32 s31, 11
    s_cbranch_scc1 L_lend_gwo_0_kernel
    s_cmp_ge_u32 s31, 6
    s_cbranch_scc1 L_gwo_0_kernel_tail11
    s_waitcnt vmcnt(9)
    s_barrier
    s_add_u32 s35, s31, 10
    s_add_u32 s35, s35, s42
    s_sub_u32 s34, s35, 16
    s_cmp_ge_u32 s35, 16
    s_cselect_b32 s35, s34, s35
    s_mul_i32 s33, s35, 131072
    s_lshl_b32 s32, s35, 7
    s_add_u32 m0, s40, 65536
    s_nop 0
    buffer_load_dwordx4 v2, s[8:11], s32 offen lds
    s_add_u32 m0, s40, 66560
    s_nop 0
    buffer_load_dwordx4 v3, s[8:11], s32 offen lds
    s_add_u32 m0, s41, 32768
    s_nop 0
    buffer_load_dwordx4 v10, s[12:15], s33 offen lds
    s_branch L_gwo_0_kernel_join12
L_gwo_0_kernel_tail11:
    s_waitcnt vmcnt(0)
    s_barrier
L_gwo_0_kernel_join12:
    ds_read_b128 v[64:67], v37 offset:16384
    ds_read_b64_tr_b16 v[68:69], v32 offset:10240
    ds_read_b64_tr_b16 v[70:71], v32 offset:10752
    s_waitcnt lgkmcnt(3)
    v_mfma_f32_32x32x16_bf16 v[40:55], v[60:63], v[56:59], v[40:55]
    ds_read_b128 v[56:59], v38 offset:16384
    ds_read_b64_tr_b16 v[60:61], v32 offset:12288
    ds_read_b64_tr_b16 v[62:63], v32 offset:12800
    s_waitcnt lgkmcnt(3)
    v_mfma_f32_32x32x16_bf16 v[40:55], v[68:71], v[64:67], v[40:55]
    ds_read_b128 v[64:67], v39 offset:16384
    ds_read_b64_tr_b16 v[68:69], v32 offset:14336
    ds_read_b64_tr_b16 v[70:71], v32 offset:14848
    s_waitcnt lgkmcnt(3)
    v_mfma_f32_32x32x16_bf16 v[40:55], v[60:63], v[56:59], v[40:55]
    ds_read_b128 v[56:59], v20 offset:0
    ds_read_b64_tr_b16 v[60:61], v24 offset:0
    ds_read_b64_tr_b16 v[62:63], v24 offset:512
    s_waitcnt lgkmcnt(3)
    v_mfma_f32_32x32x16_bf16 v[40:55], v[68:71], v[64:67], v[40:55]
    s_add_u32 s31, s31, 6
    s_cmp_lt_u32 s31, 16
    s_cbranch_scc1 L_loop_gwo_0_kernel
L_lend_gwo_0_kernel:
    s_nop 15
    s_nop 7
    s_lshr_b32 s31, s30, 1
    s_and_b32 s34, s30, 1
    s_mul_i32 s38, s31, 32
    s_mul_i32 s39, s34, 32
    s_lshl_b32 s31, s28, 7
    s_add_u32 s38, s38, s31
    s_mul_i32 s31, s29, 64
    s_add_u32 s39, s39, s31
    s_barrier
    s_mul_i32 s32, s30, 2560
    v_and_b32 v1, 31, v0
    v_mul_u32_u24 v1, 80, v1
    v_lshrrev_b32 v2, 5, v0
    v_lshlrev_b32 v2, 3, v2
    v_add_u32 v1, v1, v2
    v_add_u32 v1, s32, v1
    v_cvt_pk_bf16_f32 v40, v40, v41
    v_cvt_pk_bf16_f32 v41, v42, v43
    ds_write_b64 v1, v[40:41] offset:0
    v_cvt_pk_bf16_f32 v44, v44, v45
    v_cvt_pk_bf16_f32 v45, v46, v47
    ds_write_b64 v1, v[44:45] offset:16
    v_cvt_pk_bf16_f32 v48, v48, v49
    v_cvt_pk_bf16_f32 v49, v50, v51
    ds_write_b64 v1, v[48:49] offset:32
    v_cvt_pk_bf16_f32 v52, v52, v53
    v_cvt_pk_bf16_f32 v53, v54, v55
    ds_write_b64 v1, v[52:53] offset:48
    s_mov_b32 s35, 2048
    s_lshl_b32 s39, s39, 1
    v_add_u32 v2, 0, v0
    v_mul_u32_u24 v3, 16384, v2
    v_lshrrev_b32 v3, 16, v3
    v_mul_u32_u24 v4, 4, v3
    v_sub_u32 v4, v2, v4
    v_lshlrev_b32 v4, 4, v4
    v_mul_u32_u24 v5, 80, v3
    v_add_u32 v5, v5, v4
    v_add_u32 v8, s32, v5
    v_add_u32 v3, s38, v3
    v_mul_lo_u32 v3, v3, s35
    v_add_u32 v3, v3, v4
    v_add_u32 v16, s39, v3
    v_add_u32 v2, 64, v0
    v_mul_u32_u24 v3, 16384, v2
    v_lshrrev_b32 v3, 16, v3
    v_mul_u32_u24 v4, 4, v3
    v_sub_u32 v4, v2, v4
    v_lshlrev_b32 v4, 4, v4
    v_mul_u32_u24 v5, 80, v3
    v_add_u32 v5, v5, v4
    v_add_u32 v9, s32, v5
    v_add_u32 v3, s38, v3
    v_mul_lo_u32 v3, v3, s35
    v_add_u32 v3, v3, v4
    v_add_u32 v17, s39, v3
    s_waitcnt lgkmcnt(0)
    ds_read_b128 v[40:43], v8
    buffer_load_dwordx4 v[48:51], v16, s[20:23], 0 offen
    ds_read_b128 v[44:47], v9
    buffer_load_dwordx4 v[52:55], v17, s[20:23], 0 offen
    s_waitcnt lgkmcnt(0)
    s_waitcnt vmcnt(0)
    v_lshlrev_b32 v72, 16, v40
    v_and_b32 v73, 0xffff0000, v40
    v_lshlrev_b32 v74, 16, v48
    v_and_b32 v75, 0xffff0000, v48
    v_add_f32 v72, v72, v74
    v_add_f32 v73, v73, v75
    v_cvt_pk_bf16_f32 v40, v72, v73
    v_lshlrev_b32 v72, 16, v41
    v_and_b32 v73, 0xffff0000, v41
    v_lshlrev_b32 v74, 16, v49
    v_and_b32 v75, 0xffff0000, v49
    v_add_f32 v72, v72, v74
    v_add_f32 v73, v73, v75
    v_cvt_pk_bf16_f32 v41, v72, v73
    v_lshlrev_b32 v72, 16, v42
    v_and_b32 v73, 0xffff0000, v42
    v_lshlrev_b32 v74, 16, v50
    v_and_b32 v75, 0xffff0000, v50
    v_add_f32 v72, v72, v74
    v_add_f32 v73, v73, v75
    v_cvt_pk_bf16_f32 v42, v72, v73
    v_lshlrev_b32 v72, 16, v43
    v_and_b32 v73, 0xffff0000, v43
    v_lshlrev_b32 v74, 16, v51
    v_and_b32 v75, 0xffff0000, v51
    v_add_f32 v72, v72, v74
    v_add_f32 v73, v73, v75
    v_cvt_pk_bf16_f32 v43, v72, v73
    buffer_store_dwordx4 v[40:43], v16, s[16:19], 0 offen
    v_lshlrev_b32 v72, 16, v44
    v_and_b32 v73, 0xffff0000, v44
    v_lshlrev_b32 v74, 16, v52
    v_and_b32 v75, 0xffff0000, v52
    v_add_f32 v72, v72, v74
    v_add_f32 v73, v73, v75
    v_cvt_pk_bf16_f32 v44, v72, v73
    v_lshlrev_b32 v72, 16, v45
    v_and_b32 v73, 0xffff0000, v45
    v_lshlrev_b32 v74, 16, v53
    v_and_b32 v75, 0xffff0000, v53
    v_add_f32 v72, v72, v74
    v_add_f32 v73, v73, v75
    v_cvt_pk_bf16_f32 v45, v72, v73
    v_lshlrev_b32 v72, 16, v46
    v_and_b32 v73, 0xffff0000, v46
    v_lshlrev_b32 v74, 16, v54
    v_and_b32 v75, 0xffff0000, v54
    v_add_f32 v72, v72, v74
    v_add_f32 v73, v73, v75
    v_cvt_pk_bf16_f32 v46, v72, v73
    v_lshlrev_b32 v72, 16, v47
    v_and_b32 v73, 0xffff0000, v47
    v_lshlrev_b32 v74, 16, v55
    v_and_b32 v75, 0xffff0000, v55
    v_add_f32 v72, v72, v74
    v_add_f32 v73, v73, v75
    v_cvt_pk_bf16_f32 v47, v72, v73
    buffer_store_dwordx4 v[44:47], v17, s[16:19], 0 offen
L_done_gwo_0_kernel:
    s_endpgm
.globl lnb_0_kernel
.p2align 8
.type lnb_0_kernel,@function
lnb_0_kernel:
    s_cmp_ge_u32 s2, 512
    s_cbranch_scc1 L_done_lnb_0_kernel
    s_load_dwordx2 s[40:41], s[0:1], 88
    s_waitcnt lgkmcnt(0)
    s_add_u32 s8, s40, 25165824
    s_addc_u32 s9, s41, 0
    s_mov_b32 s10, 4194304
    s_mov_b32 s11, 0x00020000
    s_add_u32 s12, s40, 29360128
    s_addc_u32 s13, s41, 0
    s_mov_b32 s14, 4194304
    s_mov_b32 s15, 0x00020000
    s_add_u32 s16, s40, 33554432
    s_addc_u32 s17, s41, 0
    s_mov_b32 s18, 4194304
    s_mov_b32 s19, 0x00020000
    s_add_u32 s20, s40, 37748736
    s_addc_u32 s21, s41, 0
    s_mov_b32 s22, 4202496
    s_mov_b32 s23, 0x00020000
    s_lshl_b32 s3, s2, 2
    v_lshrrev_b32 v1, 6, v0
    v_add_u32 v1, s3, v1
    v_lshlrev_b32 v1, 11, v1
    v_and_b32 v2, 63, v0
    v_lshlrev_b32 v2, 4, v2
    v_add_u32 v1, v1, v2
    buffer_load_dwordx4 v[8:11], v1, s[8:11], 0 offen
    buffer_load_dwordx4 v[12:15], v1, s[8:11], 0 offen offset:1024
    s_cmp_lg_u32 s2, 0
    s_cbranch_scc1 L_lnb_0_kernel_nopad1
    v_lshrrev_b32 v3, 6, v0
    v_and_b32 v4, 2, v3
    v_mul_u32_u24 v4, 1024, v4
    v_add_u32 v3, v3, v4
    v_lshlrev_b32 v3, 11, v3
    v_add_u32 v3, v3, v2
    v_mov_b32 v48, 0
    v_mov_b32 v49, 0
    v_mov_b32 v50, 0
    v_mov_b32 v51, 0
    buffer_store_dwordx4 v[48:51], v3, s[20:23], 0 offen
    buffer_store_dwordx4 v[48:51], v3, s[20:23], 0 offen offset:1024
L_lnb_0_kernel_nopad1:
    s_waitcnt vmcnt(0)
    v_lshlrev_b32 v16, 16, v8
    v_and_b32 v17, 0xffff0000, v8
    v_lshlrev_b32 v18, 16, v9
    v_and_b32 v19, 0xffff0000, v9
    v_lshlrev_b32 v20, 16, v10
    v_and_b32 v21, 0xffff0000, v10
    v_lshlrev_b32 v22, 16, v11
    v_and_b32 v23, 0xffff0000, v11
    v_lshlrev_b32 v24, 16, v12
    v_and_b32 v25, 0xffff0000, v12
    v_lshlrev_b32 v26, 16, v13
    v_and_b32 v27, 0xffff0000, v13
    v_lshlrev_b32 v28, 16, v14
    v_and_b32 v29, 0xffff0000, v14
    v_lshlrev_b32 v30, 16, v15
    v_and_b32 v31, 0xffff0000, v15
    v_mov_b32 v4, 0
    v_add_f32 v4, v4, v16
    v_add_f32 v4, v4, v17
    v_add_f32 v4, v4, v18
    v_add_f32 v4, v4, v19
    v_add_f32 v4, v4, v20
    v_add_f32 v4, v4, v21
    v_add_f32 v4, v4, v22
    v_add_f32 v4, v4, v23
    v_add_f32 v4, v4, v24
    v_add_f32 v4, v4, v25
    v_add_f32 v4, v4, v26
    v_add_f32 v4, v4, v27
    v_add_f32 v4, v4, v28
    v_add_f32 v4, v4, v29
    v_add_f32 v4, v4, v30
    v_add_f32 v4, v4, v31
    ds_swizzle_b32 v5, v4 offset:0x041F
    s_waitcnt lgkmcnt(0)
    v_add_f32 v4, v4, v5
    ds_swizzle_b32 v5, v4 offset:0x081F
    s_waitcnt lgkmcnt(0)
    v_add_f32 v4, v4, v5
    ds_swizzle_b32 v5, v4 offset:0x101F
    s_waitcnt lgkmcnt(0)
    v_add_f32 v4, v4, v5
    ds_swizzle_b32 v5, v4 offset:0x201F
    s_waitcnt lgkmcnt(0)
    v_add_f32 v4, v4, v5
    ds_swizzle_b32 v5, v4 offset:0x401F
    s_waitcnt lgkmcnt(0)
    v_add_f32 v4, v4, v5
    s_nop 0
    v_readlane_b32 s30, v4, 32
    v_readlane_b32 s31, v4, 0
    s_nop 1
    v_mov_b32 v4, s30
    v_add_f32 v4, s31, v4
    v_mul_f32 v4, 0x3a800000, v4
    v_mov_b32 v6, 0
    v_sub_f32 v16, v16, v4
    v_fmac_f32 v6, v16, v16
    v_sub_f32 v17, v17, v4
    v_fmac_f32 v6, v17, v17
    v_sub_f32 v18, v18, v4
    v_fmac_f32 v6, v18, v18
    v_sub_f32 v19, v19, v4
    v_fmac_f32 v6, v19, v19
    v_sub_f32 v20, v20, v4
    v_fmac_f32 v6, v20, v20
    v_sub_f32 v21, v21, v4
    v_fmac_f32 v6, v21, v21
    v_sub_f32 v22, v22, v4
    v_fmac_f32 v6, v22, v22
    v_sub_f32 v23, v23, v4
    v_fmac_f32 v6, v23, v23
    v_sub_f32 v24, v24, v4
    v_fmac_f32 v6, v24, v24
    v_sub_f32 v25, v25, v4
    v_fmac_f32 v6, v25, v25
    v_sub_f32 v26, v26, v4
    v_fmac_f32 v6, v26, v26
    v_sub_f32 v27, v27, v4
    v_fmac_f32 v6, v27, v27
    v_sub_f32 v28, v28, v4
    v_fmac_f32 v6, v28, v28
    v_sub_f32 v29, v29, v4
    v_fmac_f32 v6, v29, v29
    v_sub_f32 v30, v30, v4
    v_fmac_f32 v6, v30, v30
    v_sub_f32 v31, v31, v4
    v_fmac_f32 v6, v31, v31
    ds_swizzle_b32 v5, v6 offset:0x041F
    s_waitcnt lgkmcnt(0)
    v_add_f32 v6, v6, v5
    ds_swizzle_b32 v5, v6 offset:0x081F
    s_waitcnt lgkmcnt(0)
    v_add_f32 v6, v6, v5
    ds_swizzle_b32 v5, v6 offset:0x101F
    s_waitcnt lgkmcnt(0)
    v_add_f32 v6, v6, v5
    ds_swizzle_b32 v5, v6 offset:0x201F
    s_waitcnt lgkmcnt(0)
    v_add_f32 v6, v6, v5
    ds_swizzle_b32 v5, v6 offset:0x401F
    s_waitcnt lgkmcnt(0)
    v_add_f32 v6, v6, v5
    s_nop 0
    v_readlane_b32 s30, v6, 32
    v_readlane_b32 s31, v6, 0
    s_nop 1
    v_mov_b32 v6, s30
    v_add_f32 v6, s31, v6
    v_mov_b32 v5, 0x3727c5ac
    v_fmac_f32 v5, 0x3a800000, v6
    v_rsq_f32 v5, v5
    s_nop 0
    v_mul_f32 v16, v16, v5
    v_mul_f32 v17, v17, v5
    v_mul_f32 v18, v18, v5
    v_mul_f32 v19, v19, v5
    v_mul_f32 v20, v20, v5
    v_mul_f32 v21, v21, v5
    v_mul_f32 v22, v22, v5
    v_mul_f32 v23, v23, v5
    v_mul_f32 v24, v24, v5
    v_mul_f32 v25, v25, v5
    v_mul_f32 v26, v26, v5
    v_mul_f32 v27, v27, v5
    v_mul_f32 v28, v28, v5
    v_mul_f32 v29, v29, v5
    v_mul_f32 v30, v30, v5
    v_mul_f32 v31, v31, v5
    v_cvt_pk_bf16_f32 v32, v16, v17
    v_cvt_pk_bf16_f32 v33, v18, v19
    v_cvt_pk_bf16_f32 v34, v20, v21
    v_cvt_pk_bf16_f32 v35, v22, v23
    v_cvt_pk_bf16_f32 v36, v24, v25
    v_cvt_pk_bf16_f32 v37, v26, v27
    v_cvt_pk_bf16_f32 v38, v28, v29
    v_cvt_pk_bf16_f32 v39, v30, v31
    buffer_store_dwordx4 v[32:35], v1, s[12:15], 0 offen
    buffer_store_dwordx4 v[36:39], v1, s[12:15], 0 offen offset:1024
    v_cvt_pk_bf16_f32 v16, v16, v16
    v_lshlrev_b32 v16, 16, v16
    v_cvt_pk_bf16_f32 v17, v17, v17
    v_lshlrev_b32 v17, 16, v17
    v_cvt_pk_bf16_f32 v18, v18, v18
    v_lshlrev_b32 v18, 16, v18
    v_cvt_pk_bf16_f32 v19, v19, v19
    v_lshlrev_b32 v19, 16, v19
    v_cvt_pk_bf16_f32 v20, v20, v20
    v_lshlrev_b32 v20, 16, v20
    v_cvt_pk_bf16_f32 v21, v21, v21
    v_lshlrev_b32 v21, 16, v21
    v_cvt_pk_bf16_f32 v22, v22, v22
    v_lshlrev_b32 v22, 16, v22
    v_cvt_pk_bf16_f32 v23, v23, v23
    v_lshlrev_b32 v23, 16, v23
    v_cvt_pk_bf16_f32 v24, v24, v24
    v_lshlrev_b32 v24, 16, v24
    v_cvt_pk_bf16_f32 v25, v25, v25
    v_lshlrev_b32 v25, 16, v25
    v_cvt_pk_bf16_f32 v26, v26, v26
    v_lshlrev_b32 v26, 16, v26
    v_cvt_pk_bf16_f32 v27, v27, v27
    v_lshlrev_b32 v27, 16, v27
    v_cvt_pk_bf16_f32 v28, v28, v28
    v_lshlrev_b32 v28, 16, v28
    v_cvt_pk_bf16_f32 v29, v29, v29
    v_lshlrev_b32 v29, 16, v29
    v_cvt_pk_bf16_f32 v30, v30, v30
    v_lshlrev_b32 v30, 16, v30
    v_cvt_pk_bf16_f32 v31, v31, v31
    v_lshlrev_b32 v31, 16, v31
    v_mov_b32 v4, 0
    v_add_f32 v4, v4, v16
    v_add_f32 v4, v4, v17
    v_add_f32 v4, v4, v18
    v_add_f32 v4, v4, v19
    v_add_f32 v4, v4, v20
    v_add_f32 v4, v4, v21
    v_add_f32 v4, v4, v22
    v_add_f32 v4, v4, v23
    v_add_f32 v4, v4, v24
    v_add_f32 v4, v4, v25
    v_add_f32 v4, v4, v26
    v_add_f32 v4, v4, v27
    v_add_f32 v4, v4, v28
    v_add_f32 v4, v4, v29
    v_add_f32 v4, v4, v30
    v_add_f32 v4, v4, v31
    ds_swizzle_b32 v5, v4 offset:0x041F
    s_waitcnt lgkmcnt(0)
    v_add_f32 v4, v4, v5
    ds_swizzle_b32 v5, v4 offset:0x081F
    s_waitcnt lgkmcnt(0)
    v_add_f32 v4, v4, v5
    ds_swizzle_b32 v5, v4 offset:0x101F
    s_waitcnt lgkmcnt(0)
    v_add_f32 v4, v4, v5
    ds_swizzle_b32 v5, v4 offset:0x201F
    s_waitcnt lgkmcnt(0)
    v_add_f32 v4, v4, v5
    ds_swizzle_b32 v5, v4 offset:0x401F
    s_waitcnt lgkmcnt(0)
    v_add_f32 v4, v4, v5
    s_nop 0
    v_readlane_b32 s30, v4, 32
    v_readlane_b32 s31, v4, 0
    s_nop 1
    v_mov_b32 v4, s30
    v_add_f32 v4, s31, v4
    v_mul_f32 v4, 0x3a800000, v4
    v_mov_b32 v6, 0
    v_sub_f32 v16, v16, v4
    v_fmac_f32 v6, v16, v16
    v_sub_f32 v17, v17, v4
    v_fmac_f32 v6, v17, v17
    v_sub_f32 v18, v18, v4
    v_fmac_f32 v6, v18, v18
    v_sub_f32 v19, v19, v4
    v_fmac_f32 v6, v19, v19
    v_sub_f32 v20, v20, v4
    v_fmac_f32 v6, v20, v20
    v_sub_f32 v21, v21, v4
    v_fmac_f32 v6, v21, v21
    v_sub_f32 v22, v22, v4
    v_fmac_f32 v6, v22, v22
    v_sub_f32 v23, v23, v4
    v_fmac_f32 v6, v23, v23
    v_sub_f32 v24, v24, v4
    v_fmac_f32 v6, v24, v24
    v_sub_f32 v25, v25, v4
    v_fmac_f32 v6, v25, v25
    v_sub_f32 v26, v26, v4
    v_fmac_f32 v6, v26, v26
    v_sub_f32 v27, v27, v4
    v_fmac_f32 v6, v27, v27
    v_sub_f32 v28, v28, v4
    v_fmac_f32 v6, v28, v28
    v_sub_f32 v29, v29, v4
    v_fmac_f32 v6, v29, v29
    v_sub_f32 v30, v30, v4
    v_fmac_f32 v6, v30, v30
    v_sub_f32 v31, v31, v4
    v_fmac_f32 v6, v31, v31
    ds_swizzle_b32 v5, v6 offset:0x041F
    s_waitcnt lgkmcnt(0)
    v_add_f32 v6, v6, v5
    ds_swizzle_b32 v5, v6 offset:0x081F
    s_waitcnt lgkmcnt(0)
    v_add_f32 v6, v6, v5
    ds_swizzle_b32 v5, v6 offset:0x101F
    s_waitcnt lgkmcnt(0)
    v_add_f32 v6, v6, v5
    ds_swizzle_b32 v5, v6 offset:0x201F
    s_waitcnt lgkmcnt(0)
    v_add_f32 v6, v6, v5
    ds_swizzle_b32 v5, v6 offset:0x401F
    s_waitcnt lgkmcnt(0)
    v_add_f32 v6, v6, v5
    s_nop 0
    v_readlane_b32 s30, v6, 32
    v_readlane_b32 s31, v6, 0
    s_nop 1
    v_mov_b32 v6, s30
    v_add_f32 v6, s31, v6
    v_mov_b32 v5, 0x3727c5ac
    v_fmac_f32 v5, 0x3a800000, v6
    v_rsq_f32 v5, v5
    s_nop 0
    v_mul_f32 v16, v16, v5
    v_mul_f32 v17, v17, v5
    v_mul_f32 v18, v18, v5
    v_mul_f32 v19, v19, v5
    v_mul_f32 v20, v20, v5
    v_mul_f32 v21, v21, v5
    v_mul_f32 v22, v22, v5
    v_mul_f32 v23, v23, v5
    v_mul_f32 v24, v24, v5
    v_mul_f32 v25, v25, v5
    v_mul_f32 v26, v26, v5
    v_mul_f32 v27, v27, v5
    v_mul_f32 v28, v28, v5
    v_mul_f32 v29, v29, v5
    v_mul_f32 v30, v30, v5
    v_mul_f32 v31, v31, v5
    s_nop 1
    v_cvt_pk_bf16_f32 v32, v16, v17
    v_cvt_pk_bf16_f32 v33, v18, v19
    v_cvt_pk_bf16_f32 v34, v20, v21
    v_cvt_pk_bf16_f32 v35, v22, v23
    v_cvt_pk_bf16_f32 v36, v24, v25
    v_cvt_pk_bf16_f32 v37, v26, v27
    v_cvt_pk_bf16_f32 v38, v28, v29
    v_cvt_pk_bf16_f32 v39, v30, v31
    buffer_store_dwordx4 v[32:35], v1, s[16:19], 0 offen
    buffer_store_dwordx4 v[36:39], v1, s[16:19], 0 offen offset:1024
L_done_lnb_0_kernel:
    s_endpgm
.globl gw1_0_kernel
.p2align 8
.type gw1_0_kernel,@function
gw1_0_kernel:
    s_cmp_ge_u32 s2, 256
    s_cbranch_scc1 L_done_gw1_0_kernel
    s_load_dwordx2 s[40:41], s[0:1], 40
    s_load_dwordx2 s[42:43], s[0:1], 88
    s_waitcnt lgkmcnt(0)
    s_add_u32 s8, s42, 33554432
    s_addc_u32 s9, s43, 0
    s_mov_b32 s10, 4194304
    s_mov_b32 s11, 0x00020000
    s_mov_b32 s12, s40
    s_mov_b32 s13, s41
    s_mov_b32 s14, 2097152
    s_mov_b32 s15, 0x00020000
    s_add_u32 s16, s42, 37752832
    s_addc_u32 s17, s43, 0
    s_mov_b32 s18, 4194304
    s_mov_b32 s19, 0x00020000
    s_mov_b32 s36, 0x3d372713
    s_mov_b32 s37, 0xc0135761
    s_and_b32 s3, s2, 7
    s_lshr_b32 s4, s2, 3
    s_mul_i32 s5, s4, 8192
    s_lshr_b32 s5, s5, 16
    s_mul_i32 s6, s5, 8
    s_sub_u32 s6, s4, s6
    s_lshr_b32 s7, s3, 1
    s_mul_i32 s7, s7, 4
    s_add_u32 s28, s7, s5
    s_and_b32 s7, s3, 1
    s_mul_i32 s7, s7, 8
    s_add_u32 s29, s7, s6
    v_lshrrev_b32 v1, 6, v0
    s_nop 0
    v_readfirstlane_b32 s30, v1
    v_and_b32 v0, 63, v0
    v_lshrrev_b32 v1, 3, v0
    s_lshl_b32 s31, s30, 4
    s_lshl_b32 s34, s28, 7
    s_add_u32 s31, s31, s34
    v_add_u32 v1, s31, v1
    v_add_u32 v6, 0, v1
    v_lshrrev_b32 v7, 1, v6
    v_and_b32 v7, 7, v7
    v_and_b32 v8, 7, v0
    v_xor_b32 v7, v7, v8
    v_lshlrev_b32 v7, 4, v7
    s_mov_b32 s35, 2048
    v_mul_lo_u32 v6, v6, s35
    v_add_u32 v2, v6, v7
    v_add_u32 v6, 8, v1
    v_lshrrev_b32 v7, 1, v6
    v_and_b32 v7, 7, v7
    v_and_b32 v8, 7, v0
    v_xor_b32 v7, v7, v8
    v_lshlrev_b32 v7, 4, v7
    s_mov_b32 s35, 2048
    v_mul_lo_u32 v6, v6, s35
    v_add_u32 v3, v6, v7
    s_mul_i32 s31, s30, 64
    s_mul_i32 s34, s29, 128
    v_add_u32 v6, s31, v0
    v_add_u32 v6, 0, v6
    v_mul_u32_u24 v7, 8192, v6
    v_lshrrev_b32 v7, 16, v7
    v_mul_u32_u24 v8, 8, v7
    v_sub_u32 v8, v6, v8
    v_lshlrev_b32 v9, 1, v7
    v_and_b32 v9, 4, v9
    v_xor_b32 v8, v8, v9
    v_lshlrev_b32 v8, 4, v8
    s_mov_b32 s35, 2048
    v_mul_lo_u32 v7, v7, s35
    v_add_u32 v7, v7, v8
    v_add_u32 v10, s34, v7
    s_lshr_b32 s31, s30, 1
    s_and_b32 s34, s30, 1
    s_mul_i32 s38, s31, 32
    s_mul_i32 s39, s34, 32
    v_and_b32 v6, 31, v0
    v_add_u32 v6, s38, v6
    v_lshrrev_b32 v7, 1, v6
    v_and_b32 v7, 7, v7
    v_lshrrev_b32 v8, 5, v0
    v_xor_b32 v7, v7, v8
    v_lshlrev_b32 v7, 4, v7
    v_lshlrev_b32 v6, 7, v6
    v_add_u32 v6, v6, v7
    v_xor_b32 v20, 0, v6
    v_add_u32 v36, 65536, v20
    v_xor_b32 v21, 32, v6
    v_add_u32 v37, 65536, v21
    v_xor_b32 v22, 64, v6
    v_add_u32 v38, 65536, v22
    v_xor_b32 v23, 96, v6
    v_add_u32 v39, 65536, v23
    v_lshrrev_b32 v6, 5, v0
    v_lshlrev_b32 v6, 3, v6
    v_bfe_u32 v7, v0, 2, 2
    v_add_u32 v6, v6, v7
    v_bfe_u32 v8, v0, 4, 1
    v_lshlrev_b32 v8, 4, v8
    v_and_b32 v9, 3, v0
    v_lshlrev_b32 v9, 2, v9
    v_add_u32 v8, v8, v9
    v_add_u32 v8, s39, v8
    v_add_u32 v9, 0, v8
    v_lshlrev_b32 v9, 1, v9
    v_lshlrev_b32 v18, 5, v7
    v_and_b32 v18, 64, v18
    v_xor_b32 v9, v9, v18
    v_mul_u32_u24 v19, 128, v6
    v_add_u32 v24, v19, v9
    v_add_u32 v24, 98304, v24
    v_add_u32 v28, 16384, v24
    v_add_u32 v32, 32768, v24
    v_mov_b32 v40, 0
    v_mov_b32 v41, 0
    v_mov_b32 v42, 0
    v_mov_b32 v43, 0
    v_mov_b32 v44, 0
    v_mov_b32 v45, 0
    v_mov_b32 v46, 0
    v_mov_b32 v47, 0
    v_mov_b32 v48, 0
    v_mov_b32 v49, 0
    v_mov_b32 v50, 0
    v_mov_b32 v51, 0
    v_mov_b32 v52, 0
    v_mov_b32 v53, 0
    v_mov_b32 v54, 0
    v_mov_b32 v55, 0
    s_lshl_b32 s40, s30, 11
    s_mul_i32 s41, s30, 1024
    s_add_u32 s41, s41, 98304
    s_mov_b32 s32, 0
    s_mov_b32 s33, 0
    s_and_b32 s42, s4, 15
    s_mov_b32 s42, 0
    s_mov_b32 s35, 0
    s_add_u32 s35, s35, s42
    s_sub_u32 s34, s35, 16
    s_cmp_ge_u32 s35, 16
    s_cselect_b32 s35, s34, s35
    s_mul_i32 s33, s35, 131072
    s_lshl_b32 s32, s35, 7
    s_add_u32 m0, s40, 0
    s_nop 0
    buffer_load_dwordx4 v2, s[8:11], s32 offen lds
    s_add_u32 m0, s40, 1024
    s_nop 0
    buffer_load_dwordx4 v3, s[8:11], s32 offen lds
    s_add_u32 m0, s41, 0
    s_nop 0
    buffer_load_dwordx4 v10, s[12:15], s33 offen lds
    s_mov_b32 s35, 1
    s_add_u32 s35, s35, s42
    s_sub_u32 s34, s35, 16
    s_cmp_ge_u32 s35, 16
    s_cselect_b32 s35, s34, s35
    s_mul_i32 s33, s35, 131072
    s_lshl_b32 s32, s35, 7
    s_add_u32 m0, s40, 16384
    s_nop 0
    buffer_load_dwordx4 v2, s[8:11], s32 offen lds
    s_add_u32 m0, s40, 17408
    s_nop 0
    buffer_load_dwordx4 v3, s[8:11], s32 offen lds
    s_add_u32 m0, s41, 8192
    s_nop 0
    buffer_load_dwordx4 v10, s[12:15], s33 offen lds
    s_mov_b32 s35, 2
    s_add_u32 s35, s35, s42
    s_sub_u32 s34, s35, 16
    s_cmp_ge_u32 s35, 16
    s_cselect_b32 s35, s34, s35
    s_mul_i32 s33, s35, 131072
    s_lshl_b32 s32, s35, 7
    s_add_u32 m0, s40, 32768
    s_nop 0
    buffer_load_dwordx4 v2, s[8:11], s32 offen lds
    s_add_u32 m0, s40, 33792
    s_nop 0
    buffer_load_dwordx4 v3, s[8:11], s32 offen lds
    s_add_u32 m0, s41, 16384
    s_nop 0
    buffer_load_dwordx4 v10, s[12:15], s33 offen lds
    s_mov_b32 s35, 3
    s_add_u32 s35, s35, s42
    s_sub_u32 s34, s35, 16
    s_cmp_ge_u32 s35, 16
    s_cselect_b32 s35, s34, s35
    s_mul_i32 s33, s35, 131072
    s_lshl_b32 s32, s35, 7
    s_add_u32 m0, s40, 49152
    s_nop 0
    buffer_load_dwordx4 v2, s[8:11], s32 offen lds
    s_add_u32 m0, s40, 50176
    s_nop 0
    buffer_load_dwordx4 v3, s[8:11], s32 offen lds
    s_add_u32 m0, s41, 24576
    s_nop 0
    buffer_load_dwordx4 v10, s[12:15], s33 offen lds
    s_mov_b32 s35, 4
    s_add_u32 s35, s35, s42
    s_sub_u32 s34, s35, 16
    s_cmp_ge_u32 s35, 16
    s_cselect_b32 s35, s34, s35
    s_mul_i32 s33, s35, 131072
    s_lshl_b32 s32, s35, 7
    s_add_u32 m0, s40, 65536
    s_nop 0
    buffer_load_dwordx4 v2, s[8:11], s32 offen lds
    s_add_u32 m0, s40, 66560
    s_nop 0
    buffer_load_dwordx4 v3, s[8:11], s32 offen lds
    s_add_u32 m0, s41, 32768
    s_nop 0
    buffer_load_dwordx4 v10, s[12:15], s33 offen lds
    s_mov_b32 s31, 0
    s_waitcnt vmcnt(12)
    s_barrier
    ds_read_b128 v[56:59], v20 offset:0
    ds_read_b64_tr_b16 v[60:61], v24 offset:0
    ds_read_b64_tr_b16 v[62:63], v24 offset:512
L_loop_gw1_0_kernel:
    s_cmp_ge_u32 s31, 16
    s_cbranch_scc1 L_lend_gw1_0_kernel
    s_cmp_ge_u32 s31, 11
    s_cbranch_scc1 L_gw1_0_kernel_tail1
    s_waitcnt vmcnt(9)
    s_barrier
    s_add_u32 s35, s31, 5
    s_add_u32 s35, s35, s42
    s_sub_u32 s34, s35, 16
    s_cmp_ge_u32 s35, 16
    s_cselect_b32 s35, s34, s35
    s_mul_i32 s33, s35, 131072
    s_lshl_b32 s32, s35, 7
    s_add_u32 m0, s40, 81920
    s_nop 0
    buffer_load_dwordx4 v2, s[8:11], s32 offen lds
    s_add_u32 m0, s40, 82944
    s_nop 0
    buffer_load_dwordx4 v3, s[8:11], s32 offen lds
    s_add_u32 m0, s41, 40960
    s_nop 0
    buffer_load_dwordx4 v10, s[12:15], s33 offen lds
    s_branch L_gw1_0_kernel_join2
L_gw1_0_kernel_tail1:
    s_waitcnt vmcnt(0)
    s_barrier
L_gw1_0_kernel_join2:
    ds_read_b128 v[64:67], v21 offset:0
    ds_read_b64_tr_b16 v[68:69], v24 offset:2048
    ds_read_b64_tr_b16 v[70:71], v24 offset:2560
    s_waitcnt lgkmcnt(3)
    v_mfma_f32_32x32x16_bf16 v[40:55], v[60:63], v[56:59], v[40:55]
    ds_read_b128 v[56:59], v22 offset:0
    ds_read_b64_tr_b16 v[60:61], v24 offset:4096
    ds_read_b64_tr_b16 v[62:63], v24 offset:4608
    s_waitcnt lgkmcnt(3)
    v_mfma_f32_32x32x16_bf16 v[40:55], v[68:71], v[64:67], v[40:55]
    ds_read_b128 v[64:67], v23 offset:0
    ds_read_b64_tr_b16 v[68:69], v24 offset:6144
    ds_read_b64_tr_b16 v[70:71], v24 offset:6656
    s_waitcnt lgkmcnt(3)
    v_mfma_f32_32x32x16_bf16 v[40:55], v[60:63], v[56:59], v[40:55]
    ds_read_b128 v[56:59], v20 offset:16384
    ds_read_b64_tr_b16 v[60:61], v24 offset:8192
    ds_read_b64_tr_b16 v[62:63], v24 offset:8704
    s_waitcnt lgkmcnt(3)
    v_mfma_f32_32x32x16_bf16 v[40:55], v[68:71], v[64:67], v[40:55]
    s_cmp_ge_u32 s31, 15
    s_cbranch_scc1 L_lend_gw1_0_kernel
    s_cmp_ge_u32 s31, 10
    s_cbranch_scc1 L_gw1_0_kernel_tail3
    s_waitcnt vmcnt(9)
    s_barrier
    s_add_u32 s35, s31, 6
    s_add_u32 s35, s35, s42
    s_sub_u32 s34, s35, 16
    s_cmp_ge_u32 s35, 16
    s_cselect_b32 s35, s34, s35
    s_mul_i32 s33, s35, 131072
    s_lshl_b32 s32, s35, 7
    s_add_u32 m0, s40, 0
    s_nop 0
    buffer_load_dwordx4 v2, s[8:11], s32 offen lds
    s_add_u32 m0, s40, 1024
    s_nop 0
    buffer_load_dwordx4 v3, s[8:11], s32 offen lds
    s_add_u32 m0, s41, 0
    s_nop 0
    buffer_load_dwordx4 v10, s[12:15], s33 offen lds
    s_branch L_gw1_0_kernel_join4
L_gw1_0_kernel_tail3:
    s_waitcnt vmcnt(0)
    s_barrier
L_gw1_0_kernel_join4:
    ds_read_b128 v[64:67], v21 offset:16384
    ds_read_b64_tr_b16 v[68:69], v24 offset:10240
    ds_read_b64_tr_b16 v[70:71], v24 offset:10752
    s_waitcnt lgkmcnt(3)
    v_mfma_f32_32x32x16_bf16 v[40:55], v[60:63], v[56:59], v[40:55]
    ds_read_b128 v[56:59], v22 offset:16384
    ds_read_b64_tr_b16 v[60:61], v24 offset:12288
    ds_read_b64_tr_b16 v[62:63], v24 offset:12800
    s_waitcnt lgkmcnt(3)
    v_mfma_f32_32x32x16_bf16 v[40:55], v[68:71], v[64:67], v[40:55]
    ds_read_b128 v[64:67], v23 offset:16384
    ds_read_b64_tr_b16 v[68:69], v24 offset:14336
    ds_read_b64_tr_b16 v[70:71], v24 offset:14848
    s_waitcnt lgkmcnt(3)
    v_mfma_f32_32x32x16_bf16 v[40:55], v[60:63], v[56:59], v[40:55]
    ds_read_b128 v[56:59], v20 offset:32768
    ds_read_b64_tr_b16 v[60:61], v28 offset:0
    ds_read_b64_tr_b16 v[62:63], v28 offset:512
    s_waitcnt lgkmcnt(3)
    v_mfma_f32_32x32x16_bf16 v[40:55], v[68:71], v[64:67], v[40:55]
    s_cmp_ge_u32 s31, 14
    s_cbranch_scc1 L_lend_gw1_0_kernel
    s_cmp_ge_u32 s31, 9
    s_cbranch_scc1 L_gw1_0_kernel_tail5
    s_waitcnt vmcnt(9)
    s_barrier
    s_add_u32 s35, s31, 7
    s_add_u32 s35, s35, s42
    s_sub_u32 s34, s35, 16
    s_cmp_ge_u32 s35, 16
    s_cselect_b32 s35, s34, s35
    s_mul_i32 s33, s35, 131072
    s_lshl_b32 s32, s35, 7
    s_add_u32 m0, s40, 16384
    s_nop 0
    buffer_load_dwordx4 v2, s[8:11], s32 offen lds
    s_add_u32 m0, s40, 17408
    s_nop 0
    buffer_load_dwordx4 v3, s[8:11], s32 offen lds
    s_add_u32 m0, s41, 8192
    s_nop 0
    buffer_load_dwordx4 v10, s[12:15], s33 offen lds
    s_branch L_gw1_0_kernel_join6
L_gw1_0_kernel_tail5:
    s_waitcnt vmcnt(0)
    s_barrier
L_gw1_0_kernel_join6:
    ds_read_b128 v[64:67], v21 offset:32768
    ds_read_b64_tr_b16 v[68:69], v28 offset:2048
    ds_read_b64_tr_b16 v[70:71], v28 offset:2560
    s_waitcnt lgkmcnt(3)
    v_mfma_f32_32x32x16_bf16 v[40:55], v[60:63], v[56:59], v[40:55]
    ds_read_b128 v[56:59], v22 offset:32768
    ds_read_b64_tr_b16 v[60:61], v28 offset:4096
    ds_read_b64_tr_b16 v[62:63], v28 offset:4608
    s_waitcnt lgkmcnt(3)
    v_mfma_f32_32x32x16_bf16 v[40:55], v[68:71], v[64:67], v[40:55]
    ds_read_b128 v[64:67], v23 offset:32768
    ds_read_b64_tr_b16 v[68:69], v28 offset:6144
    ds_read_b64_tr_b16 v[70:71], v28 offset:6656
    s_waitcnt lgkmcnt(3)
    v_mfma_f32_32x32x16_bf16 v[40:55], v[60:63], v[56:59], v[40:55]
    ds_read_b128 v[56:59], v20 offset:49152
    ds_read_b64_tr_b16 v[60:61], v28 offset:8192
    ds_read_b64_tr_b16 v[62:63], v28 offset:8704
    s_waitcnt lgkmcnt(3)
    v_mfma_f32_32x32x16_bf16 v[40:55], v[68:71], v[64:67], v[40:55]
    s_cmp_ge_u32 s31, 13
    s_cbranch_scc1 L_lend_gw1_0_kernel
    s_cmp_ge_u32 s31, 8
    s_cbranch_scc1 L_gw1_0_kernel_tail7
    s_waitcnt vmcnt(9)
    s_barrier
    s_add_u32 s35, s31, 8
    s_add_u32 s35, s35, s42
    s_sub_u32 s34, s35, 16
    s_cmp_ge_u32 s35, 16
    s_cselect_b32 s35, s34, s35
    s_mul_i32 s33, s35, 131072
    s_lshl_b32 s32, s35, 7
    s_add_u32 m0, s40, 32768
    s_nop 0
    buffer_load_dwordx4 v2, s[8:11], s32 offen lds
    s_add_u32 m0, s40, 33792
    s_nop 0
    buffer_load_dwordx4 v3, s[8:11], s32 offen lds
    s_add_u32 m0, s41, 16384
    s_nop 0
    buffer_load_dwordx4 v10, s[12:15], s33 offen lds
    s_branch L_gw1_0_kernel_join8
L_gw1_0_kernel_tail7:
    s_waitcnt vmcnt(0)
    s_barrier
L_gw1_0_kernel_join8:
    ds_read_b128 v[64:67], v21 offset:49152
    ds_read_b64_tr_b16 v[68:69], v28 offset:10240
    ds_read_b64_tr_b16 v[70:71], v28 offset:10752
    s_waitcnt lgkmcnt(3)
    v_mfma_f32_32x32x16_bf16 v[40:55], v[60:63], v[56:59], v[40:55]
    ds_read_b128 v[56:59], v22 offset:49152
    ds_read_b64_tr_b16 v[60:61], v28 offset:12288
    ds_read_b64_tr_b16 v[62:63], v28 offset:12800
    s_waitcnt lgkmcnt(3)
    v_mfma_f32_32x32x16_bf16 v[40:55], v[68:71], v[64:67], v[40:55]
    ds_read_b128 v[64:67], v23 offset:49152
    ds_read_b64_tr_b16 v[68:69], v28 offset:14336
    ds_read_b64_tr_b16 v[70:71], v28 offset:14848
    s_waitcnt lgkmcnt(3)
    v_mfma_f32_32x32x16_bf16 v[40:55], v[60:63], v[56:59], v[40:55]
    ds_read_b128 v[56:59], v36 offset:0
    ds_read_b64_tr_b16 v[60:61], v32 offset:0
    ds_read_b64_tr_b16 v[62:63], v32 offset:512
    s_waitcnt lgkmcnt(3)
    v_mfma_f32_32x32x16_bf16 v[40:55], v[68:71], v[64:67], v[40:55]
    s_cmp_ge_u32 s31, 12
    s_cbranch_scc1 L_lend_gw1_0_kernel
    s_cmp_ge_u32 s31, 7
    s_cbranch_scc1 L_gw1_0_kernel_tail9
    s_waitcnt vmcnt(9)
    s_barrier
    s_add_u32 s35, s31, 9
    s_add_u32 s35, s35, s42
    s_sub_u32 s34, s35, 16
    s_cmp_ge_u32 s35, 16
    s_cselect_b32 s35, s34, s35
    s_mul_i32 s33, s35, 131072
    s_lshl_b32 s32, s35, 7
    s_add_u32 m0, s40, 49152
    s_nop 0
    buffer_load_dwordx4 v2, s[8:11], s32 offen lds
    s_add_u32 m0, s40, 50176
    s_nop 0
    buffer_load_dwordx4 v3, s[8:11], s32 offen lds
    s_add_u32 m0, s41, 24576
    s_nop 0
    buffer_load_dwordx4 v10, s[12:15], s33 offen lds
    s_branch L_gw1_0_kernel_join10
L_gw1_0_kernel_tail9:
    s_waitcnt vmcnt(0)
    s_barrier
L_gw1_0_kernel_join10:
    ds_read_b128 v[64:67], v37 offset:0
    ds_read_b64_tr_b16 v[68:69], v32 offset:2048
    ds_read_b64_tr_b16 v[70:71], v32 offset:2560
    s_waitcnt lgkmcnt(3)
    v_mfma_f32_32x32x16_bf16 v[40:55], v[60:63], v[56:59], v[40:55]
    ds_read_b128 v[56:59], v38 offset:0
    ds_read_b64_tr_b16 v[60:61], v32 offset:4096
    ds_read_b64_tr_b16 v[62:63], v32 offset:4608
    s_waitcnt lgkmcnt(3)
    v_mfma_f32_32x32x16_bf16 v[40:55], v[68:71], v[64:67], v[40:55]
    ds_read_b128 v[64:67], v39 offset:0
    ds_read_b64_tr_b16 v[68:69], v32 offset:6144
    ds_read_b64_tr_b16 v[70:71], v32 offset:6656
    s_waitcnt lgkmcnt(3)
    v_mfma_f32_32x32x16_bf16 v[40:55], v[60:63], v[56:59], v[40:55]
    ds_read_b128 v[56:59], v36 offset:16384
    ds_read_b64_tr_b16 v[60:61], v32 offset:8192
    ds_read_b64_tr_b16 v[62:63], v32 offset:8704
    s_waitcnt lgkmcnt(3)
    v_mfma_f32_32x32x16_bf16 v[40:55], v[68:71], v[64:67], v[40:55]
    s_cmp_ge_u32 s31, 11
    s_cbranch_scc1 L_lend_gw1_0_kernel
    s_cmp_ge_u32 s31, 6
    s_cbranch_scc1 L_gw1_0_kernel_tail11
    s_waitcnt vmcnt(9)
    s_barrier
    s_add_u32 s35, s31, 10
    s_add_u32 s35, s35, s42
    s_sub_u32 s34, s35, 16
    s_cmp_ge_u32 s35, 16
    s_cselect_b32 s35, s34, s35
    s_mul_i32 s33, s35, 131072
    s_lshl_b32 s32, s35, 7
    s_add_u32 m0, s40, 65536
    s_nop 0
    buffer_load_dwordx4 v2, s[8:11], s32 offen lds
    s_add_u32 m0, s40, 66560
    s_nop 0
    buffer_load_dwordx4 v3, s[8:11], s32 offen lds
    s_add_u32 m0, s41, 32768
    s_nop 0
    buffer_load_dwordx4 v10, s[12:15], s33 offen lds
    s_branch L_gw1_0_kernel_join12
L_gw1_0_kernel_tail11:
    s_waitcnt vmcnt(0)
    s_barrier
L_gw1_0_kernel_join12:
    ds_read_b128 v[64:67], v37 offset:16384
    ds_read_b64_tr_b16 v[68:69], v32 offset:10240
    ds_read_b64_tr_b16 v[70:71], v32 offset:10752
    s_waitcnt lgkmcnt(3)
    v_mfma_f32_32x32x16_bf16 v[40:55], v[60:63], v[56:59], v[40:55]
    ds_read_b128 v[56:59], v38 offset:16384
    ds_read_b64_tr_b16 v[60:61], v32 offset:12288
    ds_read_b64_tr_b16 v[62:63], v32 offset:12800
    s_waitcnt lgkmcnt(3)
    v_mfma_f32_32x32x16_bf16 v[40:55], v[68:71], v[64:67], v[40:55]
    ds_read_b128 v[64:67], v39 offset:16384
    ds_read_b64_tr_b16 v[68:69], v32 offset:14336
    ds_read_b64_tr_b16 v[70:71], v32 offset:14848
    s_waitcnt lgkmcnt(3)
    v_mfma_f32_32x32x16_bf16 v[40:55], v[60:63], v[56:59], v[40:55]
    ds_read_b128 v[56:59], v20 offset:0
    ds_read_b64_tr_b16 v[60:61], v24 offset:0
    ds_read_b64_tr_b16 v[62:63], v24 offset:512
    s_waitcnt lgkmcnt(3)
    v_mfma_f32_32x32x16_bf16 v[40:55], v[68:71], v[64:67], v[40:55]
    s_add_u32 s31, s31, 6
    s_cmp_lt_u32 s31, 16
    s_cbranch_scc1 L_loop_gw1_0_kernel
L_lend_gw1_0_kernel:
    s_nop 15
    s_nop 7
    s_lshr_b32 s31, s30, 1
    s_and_b32 s34, s30, 1
    s_mul_i32 s38, s31, 32
    s_mul_i32 s39, s34, 32
    s_lshl_b32 s31, s28, 7
    s_add_u32 s38, s38, s31
    s_mul_i32 s31, s29, 64
    s_add_u32 s39, s39, s31
    s_barrier
    s_mul_i32 s32, s30, 2560
    v_and_b32 v1, 31, v0
    v_mul_u32_u24 v1, 80, v1
    v_lshrrev_b32 v2, 5, v0
    v_lshlrev_b32 v2, 3, v2
    v_add_u32 v1, v1, v2
    v_add_u32 v1, s32, v1
    v_cvt_pk_bf16_f32 v40, v40, v40
    v_lshlrev_b32 v40, 16, v40
    v_cvt_pk_bf16_f32 v41, v41, v41
    v_lshlrev_b32 v41, 16, v41
    v_cvt_pk_bf16_f32 v42, v42, v42
    v_lshlrev_b32 v42, 16, v42
    v_cvt_pk_bf16_f32 v43, v43, v43
    v_lshlrev_b32 v43, 16, v43
    v_mul_f32 v76, v40, v40
    v_fma_f32 v76, v76, s36, 1.0
    v_mul_f32 v76, v76, v40
    v_mul_f32 v76, s37, v76
    v_exp_f32 v76, v76
    s_nop 0
    v_add_f32 v76, 1.0, v76
    v_rcp_f32 v76, v76
    s_nop 0
    v_mul_f32 v40, v40, v76
    v_mul_f32 v76, v41, v41
    v_fma_f32 v76, v76, s36, 1.0
    v_mul_f32 v76, v76, v41
    v_mul_f32 v76, s37, v76
    v_exp_f32 v76, v76
    s_nop 0
    v_add_f32 v76, 1.0, v76
    v_rcp_f32 v76, v76
    s_nop 0
    v_mul_f32 v41, v41, v76
    v_mul_f32 v76, v42, v42
    v_fma_f32 v76, v76, s36, 1.0
    v_mul_f32 v76, v76, v42
    v_mul_f32 v76, s37, v76
    v_exp_f32 v76, v76
    s_nop 0
    v_add_f32 v76, 1.0, v76
    v_rcp_f32 v76, v76
    s_nop 0
    v_mul_f32 v42, v42, v76
    v_mul_f32 v76, v43, v43
    v_fma_f32 v76, v76, s36, 1.0
    v_mul_f32 v76, v76, v43
    v_mul_f32 v76, s37, v76
    v_exp_f32 v76, v76
    s_nop 0
    v_add_f32 v76, 1.0, v76
    v_rcp_f32 v76, v76
    s_nop 0
    v_mul_f32 v43, v43, v76
    v_cvt_pk_bf16_f32 v40, v40, v41
    v_cvt_pk_bf16_f32 v41, v42, v43
    ds_write_b64 v1, v[40:41] offset:0
    v_cvt_pk_bf16_f32 v44, v44, v44
    v_lshlrev_b32 v44, 16, v44
    v_cvt_pk_bf16_f32 v45, v45, v45
    v_lshlrev_b32 v45, 16, v45
    v_cvt_pk_bf16_f32 v46, v46, v46
    v_lshlrev_b32 v46, 16, v46
    v_cvt_pk_bf16_f32 v47, v47, v47
    v_lshlrev_b32 v47, 16, v47
    v_mul_f32 v76, v44, v44
    v_fma_f32 v76, v76, s36, 1.0
    v_mul_f32 v76, v76, v44
    v_mul_f32 v76, s37, v76
    v_exp_f32 v76, v76
    s_nop 0
    v_add_f32 v76, 1.0, v76
    v_rcp_f32 v76, v76
    s_nop 0
    v_mul_f32 v44, v44, v76
    v_mul_f32 v76, v45, v45
    v_fma_f32 v76, v76, s36, 1.0
    v_mul_f32 v76, v76, v45
    v_mul_f32 v76, s37, v76
    v_exp_f32 v76, v76
    s_nop 0
    v_add_f32 v76, 1.0, v76
    v_rcp_f32 v76, v76
    s_nop 0
    v_mul_f32 v45, v45, v76
    v_mul_f32 v76, v46, v46
    v_fma_f32 v76, v76, s36, 1.0
    v_mul_f32 v76, v76, v46
    v_mul_f32 v76, s37, v76
    v_exp_f32 v76, v76
    s_nop 0
    v_add_f32 v76, 1.0, v76
    v_rcp_f32 v76, v76
    s_nop 0
    v_mul_f32 v46, v46, v76
    v_mul_f32 v76, v47, v47
    v_fma_f32 v76, v76, s36, 1.0
    v_mul_f32 v76, v76, v47
    v_mul_f32 v76, s37, v76
    v_exp_f32 v76, v76
    s_nop 0
    v_add_f32 v76, 1.0, v76
    v_rcp_f32 v76, v76
    s_nop 0
    v_mul_f32 v47, v47, v76
    v_cvt_pk_bf16_f32 v44, v44, v45
    v_cvt_pk_bf16_f32 v45, v46, v47
    ds_write_b64 v1, v[44:45] offset:16
    v_cvt_pk_bf16_f32 v48, v48, v48
    v_lshlrev_b32 v48, 16, v48
    v_cvt_pk_bf16_f32 v49, v49, v49
    v_lshlrev_b32 v49, 16, v49
    v_cvt_pk_bf16_f32 v50, v50, v50
    v_lshlrev_b32 v50, 16, v50
    v_cvt_pk_bf16_f32 v51, v51, v51
    v_lshlrev_b32 v51, 16, v51
    v_mul_f32 v76, v48, v48
    v_fma_f32 v76, v76, s36, 1.0
    v_mul_f32 v76, v76, v48
    v_mul_f32 v76, s37, v76
    v_exp_f32 v76, v76
    s_nop 0
    v_add_f32 v76, 1.0, v76
    v_rcp_f32 v76, v76
    s_nop 0
    v_mul_f32 v48, v48, v76
    v_mul_f32 v76, v49, v49
    v_fma_f32 v76, v76, s36, 1.0
    v_mul_f32 v76, v76, v49
    v_mul_f32 v76, s37, v76
    v_exp_f32 v76, v76
    s_nop 0
    v_add_f32 v76, 1.0, v76
    v_rcp_f32 v76, v76
    s_nop 0
    v_mul_f32 v49, v49, v76
    v_mul_f32 v76, v50, v50
    v_fma_f32 v76, v76, s36, 1.0
    v_mul_f32 v76, v76, v50
    v_mul_f32 v76, s37, v76
    v_exp_f32 v76, v76
    s_nop 0
    v_add_f32 v76, 1.0, v76
    v_rcp_f32 v76, v76
    s_nop 0
    v_mul_f32 v50, v50, v76
    v_mul_f32 v76, v51, v51
    v_fma_f32 v76, v76, s36, 1.0
    v_mul_f32 v76, v76, v51
    v_mul_f32 v76, s37, v76
    v_exp_f32 v76, v76
    s_nop 0
    v_add_f32 v76, 1.0, v76
    v_rcp_f32 v76, v76
    s_nop 0
    v_mul_f32 v51, v51, v76
    v_cvt_pk_bf16_f32 v48, v48, v49
    v_cvt_pk_bf16_f32 v49, v50, v51
    ds_write_b64 v1, v[48:49] offset:32
    v_cvt_pk_bf16_f32 v52, v52, v52
    v_lshlrev_b32 v52, 16, v52
    v_cvt_pk_bf16_f32 v53, v53, v53
    v_lshlrev_b32 v53, 16, v53
    v_cvt_pk_bf16_f32 v54, v54, v54
    v_lshlrev_b32 v54, 16, v54
    v_cvt_pk_bf16_f32 v55, v55, v55
    v_lshlrev_b32 v55, 16, v55
    v_mul_f32 v76, v52, v52
    v_fma_f32 v76, v76, s36, 1.0
    v_mul_f32 v76, v76, v52
    v_mul_f32 v76, s37, v76
    v_exp_f32 v76, v76
    s_nop 0
    v_add_f32 v76, 1.0, v76
    v_rcp_f32 v76, v76
    s_nop 0
    v_mul_f32 v52, v52, v76
    v_mul_f32 v76, v53, v53
    v_fma_f32 v76, v76, s36, 1.0
    v_mul_f32 v76, v76, v53
    v_mul_f32 v76, s37, v76
    v_exp_f32 v76, v76
    s_nop 0
    v_add_f32 v76, 1.0, v76
    v_rcp_f32 v76, v76
    s_nop 0
    v_mul_f32 v53, v53, v76
    v_mul_f32 v76, v54, v54
    v_fma_f32 v76, v76, s36, 1.0
    v_mul_f32 v76, v76, v54
    v_mul_f32 v76, s37, v76
    v_exp_f32 v76, v76
    s_nop 0
    v_add_f32 v76, 1.0, v76
    v_rcp_f32 v76, v76
    s_nop 0
    v_mul_f32 v54, v54, v76
    v_mul_f32 v76, v55, v55
    v_fma_f32 v76, v76, s36, 1.0
    v_mul_f32 v76, v76, v55
    v_mul_f32 v76, s37, v76
    v_exp_f32 v76, v76
    s_nop 0
    v_add_f32 v76, 1.0, v76
    v_rcp_f32 v76, v76
    s_nop 0
    v_mul_f32 v55, v55, v76
    v_cvt_pk_bf16_f32 v52, v52, v53
    v_cvt_pk_bf16_f32 v53, v54, v55
    ds_write_b64 v1, v[52:53] offset:48
    s_mov_b32 s35, 2048
    s_lshl_b32 s39, s39, 1
    v_add_u32 v2, 0, v0
    v_mul_u32_u24 v3, 16384, v2
    v_lshrrev_b32 v3, 16, v3
    v_mul_u32_u24 v4, 4, v3
    v_sub_u32 v4, v2, v4
    v_lshlrev_b32 v4, 4, v4
    v_mul_u32_u24 v5, 80, v3
    v_add_u32 v5, v5, v4
    v_add_u32 v8, s32, v5
    v_add_u32 v3, s38, v3
    v_mul_lo_u32 v3, v3, s35
    v_add_u32 v3, v3, v4
    v_add_u32 v16, s39, v3
    v_add_u32 v2, 64, v0
    v_mul_u32_u24 v3, 16384, v2
    v_lshrrev_b32 v3, 16, v3
    v_mul_u32_u24 v4, 4, v3
    v_sub_u32 v4, v2, v4
    v_lshlrev_b32 v4, 4, v4
    v_mul_u32_u24 v5, 80, v3
    v_add_u32 v5, v5, v4
    v_add_u32 v9, s32, v5
    v_add_u32 v3, s38, v3
    v_mul_lo_u32 v3, v3, s35
    v_add_u32 v3, v3, v4
    v_add_u32 v17, s39, v3
    s_waitcnt lgkmcnt(0)
    ds_read_b128 v[40:43], v8
    ds_read_b128 v[44:47], v9
    s_waitcnt lgkmcnt(0)
    buffer_store_dwordx4 v[40:43], v16, s[16:19], 0 offen
    buffer_store_dwordx4 v[44:47], v17, s[16:19], 0 offen
L_done_gw1_0_kernel:
    s_endpgm
.globl gw2_0_kernel
.p2align 8
.type gw2_0_kernel,@function
gw2_0_kernel:
    s_cmp_ge_u32 s2, 256
    s_cbranch_scc1 L_done_gw2_0_kernel
    s_load_dwordx2 s[40:41], s[0:1], 48
    s_load_dwordx2 s[42:43], s[0:1], 88
    s_waitcnt lgkmcnt(0)
    s_add_u32 s8, s42, 37748736
    s_addc_u32 s9, s43, 0
    s_mov_b32 s10, 4202496
    s_mov_b32 s11, 0x00020000
    s_mov_b32 s12, s40
    s_mov_b32 s13, s41
    s_mov_b32 s14, 2097152
    s_mov_b32 s15, 0x00020000
    s_add_u32 s16, s42, 44040192
    s_addc_u32 s17, s43, 0
    s_mov_b32 s18, 4194304
    s_mov_b32 s19, 0x00020000
    s_add_u32 s20, s42, 29360128
    s_addc_u32 s21, s43, 0
    s_mov_b32 s22, 4194304
    s_mov_b32 s23, 0x00020000
    s_mov_b32 s36, 0x3d372713
    s_mov_b32 s37, 0xc0135761
    s_and_b32 s3, s2, 7
    s_lshr_b32 s4, s2, 3
    s_mul_i32 s5, s4, 8192
    s_lshr_b32 s5, s5, 16
    s_mul_i32 s6, s5, 8
    s_sub_u32 s6, s4, s6
    s_lshr_b32 s7, s3, 1
    s_mul_i32 s7, s7, 4
    s_add_u32 s28, s7, s5
    s_and_b32 s7, s3, 1
    s_mul_i32 s7, s7, 8
    s_add_u32 s29, s7, s6
    v_lshrrev_b32 v1, 6, v0
    s_nop 0
    v_readfirstlane_b32 s30, v1
    v_and_b32 v0, 63, v0
    v_lshrrev_b32 v1, 3, v0
    s_lshl_b32 s31, s30, 4
    s_lshl_b32 s34, s28, 7
    s_add_u32 s31, s31, s34
    v_add_u32 v1, s31, v1
    v_add_u32 v6, 0, v1
    v_lshrrev_b32 v7, 1, v6
    v_and_b32 v7, 7, v7
    v_and_b32 v8, 7, v0
    v_xor_b32 v7, v7, v8
    v_lshlrev_b32 v7, 4, v7
    s_mov_b32 s35, 2048
    v_mul_lo_u32 v6, v6, s35
    v_add_u32 v2, v6, v7
    v_add_u32 v6, 8, v1
    v_lshrrev_b32 v7, 1, v6
    v_and_b32 v7, 7, v7
    v_and_b32 v8, 7, v0
    v_xor_b32 v7, v7, v8
    v_lshlrev_b32 v7, 4, v7
    s_mov_b32 s35, 2048
    v_mul_lo_u32 v6, v6, s35
    v_add_u32 v3, v6, v7
    s_mul_i32 s31, s30, 64
    s_mul_i32 s34, s29, 128
    v_add_u32 v6, s31, v0
    v_add_u32 v6, 0, v6
    v_mul_u32_u24 v7, 8192, v6
    v_lshrrev_b32 v7, 16, v7
    v_mul_u32_u24 v8, 8, v7
    v_sub_u32 v8, v6, v8
    v_lshlrev_b32 v9, 1, v7
    v_and_b32 v9, 4, v9
    v_xor_b32 v8, v8, v9
    v_lshlrev_b32 v8, 4, v8
    s_mov_b32 s35, 2048
    v_mul_lo_u32 v7, v7, s35
    v_add_u32 v7, v7, v8
    v_add_u32 v10, s34, v7
    s_lshr_b32 s31, s30, 1
    s_and_b32 s34, s30, 1
    s_mul_i32 s38, s31, 32
    s_mul_i32 s39, s34, 32
    v_and_b32 v6, 31, v0
    v_add_u32 v6, s38, v6
    v_lshrrev_b32 v7, 1, v6
    v_and_b32 v7, 7, v7
    v_lshrrev_b32 v8, 5, v0
    v_xor_b32 v7, v7, v8
    v_lshlrev_b32 v7, 4, v7
    v_lshlrev_b32 v6, 7, v6
    v_add_u32 v6, v6, v7
    v_xor_b32 v20, 0, v6
    v_add_u32 v36, 65536, v20
    v_xor_b32 v21, 32, v6
    v_add_u32 v37, 65536, v21
    v_xor_b32 v22, 64, v6
    v_add_u32 v38, 65536, v22
    v_xor_b32 v23, 96, v6
    v_add_u32 v39, 65536, v23
    v_lshrrev_b32 v6, 5, v0
    v_lshlrev_b32 v6, 3, v6
    v_bfe_u32 v7, v0, 2, 2
    v_add_u32 v6, v6, v7
    v_bfe_u32 v8, v0, 4, 1
    v_lshlrev_b32 v8, 4, v8
    v_and_b32 v9, 3, v0
    v_lshlrev_b32 v9, 2, v9
    v_add_u32 v8, v8, v9
    v_add_u32 v8, s39, v8
    v_add_u32 v9, 0, v8
    v_lshlrev_b32 v9, 1, v9
    v_lshlrev_b32 v18, 5, v7
    v_and_b32 v18, 64, v18
    v_xor_b32 v9, v9, v18
    v_mul_u32_u24 v19, 128, v6
    v_add_u32 v24, v19, v9
    v_add_u32 v24, 98304, v24
    v_add_u32 v28, 16384, v24
    v_add_u32 v32, 32768, v24
    v_mov_b32 v40, 0
    v_mov_b32 v41, 0
    v_mov_b32 v42, 0
    v_mov_b32 v43, 0
    v_mov_b32 v44, 0
    v_mov_b32 v45, 0
    v_mov_b32 v46, 0
    v_mov_b32 v47, 0
    v_mov_b32 v48, 0
    v_mov_b32 v49, 0
    v_mov_b32 v50, 0
    v_mov_b32 v51, 0
    v_mov_b32 v52, 0
    v_mov_b32 v53, 0
    v_mov_b32 v54, 0
    v_mov_b32 v55, 0
    s_lshl_b32 s40, s30, 11
    s_mul_i32 s41, s30, 1024
    s_add_u32 s41, s41, 98304
    s_mov_b32 s32, 0
    s_mov_b32 s33, 0
    s_and_b32 s42, s4, 15
    s_mov_b32 s42, 0
    s_mov_b32 s35, 0
    s_add_u32 s35, s35, s42
    s_sub_u32 s34, s35, 16
    s_cmp_ge_u32 s35, 16
    s_cselect_b32 s35, s34, s35
    s_mul_i32 s33, s35, 131072
    s_lshl_b32 s32, s35, 7
    s_lshr_b32 s34, s35, 2
    s_mov_b32 s39, 0x04000301
    s_lshl_b32 s34, s34, 3
    s_lshr_b32 s39, s39, s34
    s_and_b32 s39, s39, 0xff
    s_mul_i32 s39, s39, 2048
    s_add_u32 s32, s32, s39
    s_add_u32 m0, s40, 0
    s_nop 0
    buffer_load_dwordx4 v2, s[8:11], s32 offen lds
    s_add_u32 m0, s40, 1024
    s_nop 0
    buffer_load_dwordx4 v3, s[8:11], s32 offen lds
    s_add_u32 m0, s41, 0
    s_nop 0
    buffer_load_dwordx4 v10, s[12:15], s33 offen lds
    s_mov_b32 s35, 1
    s_add_u32 s35, s35, s42
    s_sub_u32 s34, s35, 16
    s_cmp_ge_u32 s35, 16
    s_cselect_b32 s35, s34, s35
    s_mul_i32 s33, s35, 131072
    s_lshl_b32 s32, s35, 7
    s_lshr_b32 s34, s35, 2
    s_mov_b32 s39, 0x04000301
    s_lshl_b32 s34, s34, 3
    s_lshr_b32 s39, s39, s34
    s_and_b32 s39, s39, 0xff
    s_mul_i32 s39, s39, 2048
    s_add_u32 s32, s32, s39
    s_add_u32 m0, s40, 16384
    s_nop 0
    buffer_load_dwordx4 v2, s[8:11], s32 offen lds
    s_add_u32 m0, s40, 17408
    s_nop 0
    buffer_load_dwordx4 v3, s[8:11], s32 offen lds
    s_add_u32 m0, s41, 8192
    s_nop 0
    buffer_load_dwordx4 v10, s[12:15], s33 offen lds
    s_mov_b32 s35, 2
    s_add_u32 s35, s35, s42
    s_sub_u32 s34, s35, 16
    s_cmp_ge_u32 s35, 16
    s_cselect_b32 s35, s34, s35
    s_mul_i32 s33, s35, 131072
    s_lshl_b32 s32, s35, 7
    s_lshr_b32 s34, s35, 2
    s_mov_b32 s39, 0x04000301
    s_lshl_b32 s34, s34, 3
    s_lshr_b32 s39, s39, s34
    s_and_b32 s39, s39, 0xff
    s_mul_i32 s39, s39, 2048
    s_add_u32 s32, s32, s39
    s_add_u32 m0, s40, 32768
    s_nop 0
    buffer_load_dwordx4 v2, s[8:11], s32 offen lds
    s_add_u32 m0, s40, 33792
    s_nop 0
    buffer_load_dwordx4 v3, s[8:11], s32 offen lds
    s_add_u32 m0, s41, 16384
    s_nop 0
    buffer_load_dwordx4 v10, s[12:15], s33 offen lds
    s_mov_b32 s35, 3
    s_add_u32 s35, s35, s42
    s_sub_u32 s34, s35, 16
    s_cmp_ge_u32 s35, 16
    s_cselect_b32 s35, s34, s35
    s_mul_i32 s33, s35, 131072
    s_lshl_b32 s32, s35, 7
    s_lshr_b32 s34, s35, 2
    s_mov_b32 s39, 0x04000301
    s_lshl_b32 s34, s34, 3
    s_lshr_b32 s39, s39, s34
    s_and_b32 s39, s39, 0xff
    s_mul_i32 s39, s39, 2048
    s_add_u32 s32, s32, s39
    s_add_u32 m0, s40, 49152
    s_nop 0
    buffer_load_dwordx4 v2, s[8:11], s32 offen lds
    s_add_u32 m0, s40, 50176
    s_nop 0
    buffer_load_dwordx4 v3, s[8:11], s32 offen lds
    s_add_u32 m0, s41, 24576
    s_nop 0
    buffer_load_dwordx4 v10, s[12:15], s33 offen lds
    s_mov_b32 s35, 4
    s_add_u32 s35, s35, s42
    s_sub_u32 s34, s35, 16
    s_cmp_ge_u32 s35, 16
    s_cselect_b32 s35, s34, s35
    s_mul_i32 s33, s35, 131072
    s_lshl_b32 s32, s35, 7
    s_lshr_b32 s34, s35, 2
    s_mov_b32 s39, 0x04000301
    s_lshl_b32 s34, s34, 3
    s_lshr_b32 s39, s39, s34
    s_and_b32 s39, s39, 0xff
    s_mul_i32 s39, s39, 2048
    s_add_u32 s32, s32, s39
    s_add_u32 m0, s40, 65536
    s_nop 0
    buffer_load_dwordx4 v2, s[8:11], s32 offen lds
    s_add_u32 m0, s40, 66560
    s_nop 0
    buffer_load_dwordx4 v3, s[8:11], s32 offen lds
    s_add_u32 m0, s41, 32768
    s_nop 0
    buffer_load_dwordx4 v10, s[12:15], s33 offen lds
    s_mov_b32 s31, 0
    s_waitcnt vmcnt(12)
    s_barrier
    ds_read_b128 v[56:59], v20 offset:0
    ds_read_b64_tr_b16 v[60:61], v24 offset:0
    ds_read_b64_tr_b16 v[62:63], v24 offset:512
L_loop_gw2_0_kernel:
    s_cmp_ge_u32 s31, 16
    s_cbranch_scc1 L_lend_gw2_0_kernel
    s_cmp_ge_u32 s31, 11
    s_cbranch_scc1 L_gw2_0_kernel_tail1
    s_waitcnt vmcnt(9)
    s_barrier
    s_add_u32 s35, s31, 5
    s_add_u32 s35, s35, s42
    s_sub_u32 s34, s35, 16
    s_cmp_ge_u32 s35, 16
    s_cselect_b32 s35, s34, s35
    s_mul_i32 s33, s35, 131072
    s_lshl_b32 s32, s35, 7
    s_lshr_b32 s34, s35, 2
    s_mov_b32 s39, 0x04000301
    s_lshl_b32 s34, s34, 3
    s_lshr_b32 s39, s39, s34
    s_and_b32 s39, s39, 0xff
    s_mul_i32 s39, s39, 2048
    s_add_u32 s32, s32, s39
    s_add_u32 m0, s40, 81920
    s_nop 0
    buffer_load_dwordx4 v2, s[8:11], s32 offen lds
    s_add_u32 m0, s40, 82944
    s_nop 0
    buffer_load_dwordx4 v3, s[8:11], s32 offen lds
    s_add_u32 m0, s41, 40960
    s_nop 0
    buffer_load_dwordx4 v10, s[12:15], s33 offen lds
    s_branch L_gw2_0_kernel_join2
L_gw2_0_kernel_tail1:
    s_waitcnt vmcnt(0)
    s_barrier
L_gw2_0_kernel_join2:
    ds_read_b128 v[64:67], v21 offset:0
    ds_read_b64_tr_b16 v[68:69], v24 offset:2048
    ds_read_b64_tr_b16 v[70:71], v24 offset:2560
    s_waitcnt lgkmcnt(3)
    v_mfma_f32_32x32x16_bf16 v[40:55], v[60:63], v[56:59], v[40:55]
    ds_read_b128 v[56:59], v22 offset:0
    ds_read_b64_tr_b16 v[60:61], v24 offset:4096
    ds_read_b64_tr_b16 v[62:63], v24 offset:4608
    s_waitcnt lgkmcnt(3)
    v_mfma_f32_32x32x16_bf16 v[40:55], v[68:71], v[64:67], v[40:55]
    ds_read_b128 v[64:67], v23 offset:0
    ds_read_b64_tr_b16 v[68:69], v24 offset:6144
    ds_read_b64_tr_b16 v[70:71], v24 offset:6656
    s_waitcnt lgkmcnt(3)
    v_mfma_f32_32x32x16_bf16 v[40:55], v[60:63], v[56:59], v[40:55]
    ds_read_b128 v[56:59], v20 offset:16384
    ds_read_b64_tr_b16 v[60:61], v24 offset:8192
    ds_read_b64_tr_b16 v[62:63], v24 offset:8704
    s_waitcnt lgkmcnt(3)
    v_mfma_f32_32x32x16_bf16 v[40:55], v[68:71], v[64:67], v[40:55]
    s_cmp_ge_u32 s31, 15
    s_cbranch_scc1 L_lend_gw2_0_kernel
    s_cmp_ge_u32 s31, 10
    s_cbranch_scc1 L_gw2_0_kernel_tail3
    s_waitcnt vmcnt(9)
    s_barrier
    s_add_u32 s35, s31, 6
    s_add_u32 s35, s35, s42
    s_sub_u32 s34, s35, 16
    s_cmp_ge_u32 s35, 16
    s_cselect_b32 s35, s34, s35
    s_mul_i32 s33, s35, 131072
    s_lshl_b32 s32, s35, 7
    s_lshr_b32 s34, s35, 2
    s_mov_b32 s39, 0x04000301
    s_lshl_b32 s34, s34, 3
    s_lshr_b32 s39, s39, s34
    s_and_b32 s39, s39, 0xff
    s_mul_i32 s39, s39, 2048
    s_add_u32 s32, s32, s39
    s_add_u32 m0, s40, 0
    s_nop 0
    buffer_load_dwordx4 v2, s[8:11], s32 offen lds
    s_add_u32 m0, s40, 1024
    s_nop 0
    buffer_load_dwordx4 v3, s[8:11], s32 offen lds
    s_add_u32 m0, s41, 0
    s_nop 0
    buffer_load_dwordx4 v10, s[12:15], s33 offen lds
    s_branch L_gw2_0_kernel_join4
L_gw2_0_kernel_tail3:
    s_waitcnt vmcnt(0)
    s_barrier
L_gw2_0_kernel_join4:
    ds_read_b128 v[64:67], v21 offset:16384
    ds_read_b64_tr_b16 v[68:69], v24 offset:10240
    ds_read_b64_tr_b16 v[70:71], v24 offset:10752
    s_waitcnt lgkmcnt(3)
    v_mfma_f32_32x32x16_bf16 v[40:55], v[60:63], v[56:59], v[40:55]
    ds_read_b128 v[56:59], v22 offset:16384
    ds_read_b64_tr_b16 v[60:61], v24 offset:12288
    ds_read_b64_tr_b16 v[62:63], v24 offset:12800
    s_waitcnt lgkmcnt(3)
    v_mfma_f32_32x32x16_bf16 v[40:55], v[68:71], v[64:67], v[40:55]
    ds_read_b128 v[64:67], v23 offset:16384
    ds_read_b64_tr_b16 v[68:69], v24 offset:14336
    ds_read_b64_tr_b16 v[70:71], v24 offset:14848
    s_waitcnt lgkmcnt(3)
    v_mfma_f32_32x32x16_bf16 v[40:55], v[60:63], v[56:59], v[40:55]
    ds_read_b128 v[56:59], v20 offset:32768
    ds_read_b64_tr_b16 v[60:61], v28 offset:0
    ds_read_b64_tr_b16 v[62:63], v28 offset:512
    s_waitcnt lgkmcnt(3)
    v_mfma_f32_32x32x16_bf16 v[40:55], v[68:71], v[64:67], v[40:55]
    s_cmp_ge_u32 s31, 14
    s_cbranch_scc1 L_lend_gw2_0_kernel
    s_cmp_ge_u32 s31, 9
    s_cbranch_scc1 L_gw2_0_kernel_tail5
    s_waitcnt vmcnt(9)
    s_barrier
    s_add_u32 s35, s31, 7
    s_add_u32 s35, s35, s42
    s_sub_u32 s34, s35, 16
    s_cmp_ge_u32 s35, 16
    s_cselect_b32 s35, s34, s35
    s_mul_i32 s33, s35, 131072
    s_lshl_b32 s32, s35, 7
    s_lshr_b32 s34, s35, 2
    s_mov_b32 s39, 0x04000301
    s_lshl_b32 s34, s34, 3
    s_lshr_b32 s39, s39, s34
    s_and_b32 s39, s39, 0xff
    s_mul_i32 s39, s39, 2048
    s_add_u32 s32, s32, s39
    s_add_u32 m0, s40, 16384
    s_nop 0
    buffer_load_dwordx4 v2, s[8:11], s32 offen lds
    s_add_u32 m0, s40, 17408
    s_nop 0
    buffer_load_dwordx4 v3, s[8:11], s32 offen lds
    s_add_u32 m0, s41, 8192
    s_nop 0
    buffer_load_dwordx4 v10, s[12:15], s33 offen lds
    s_branch L_gw2_0_kernel_join6
L_gw2_0_kernel_tail5:
    s_waitcnt vmcnt(0)
    s_barrier
L_gw2_0_kernel_join6:
    ds_read_b128 v[64:67], v21 offset:32768
    ds_read_b64_tr_b16 v[68:69], v28 offset:2048
    ds_read_b64_tr_b16 v[70:71], v28 offset:2560
    s_waitcnt lgkmcnt(3)
    v_mfma_f32_32x32x16_bf16 v[40:55], v[60:63], v[56:59], v[40:55]
    ds_read_b128 v[56:59], v22 offset:32768
    ds_read_b64_tr_b16 v[60:61], v28 offset:4096
    ds_read_b64_tr_b16 v[62:63], v28 offset:4608
    s_waitcnt lgkmcnt(3)
    v_mfma_f32_32x32x16_bf16 v[40:55], v[68:71], v[64:67], v[40:55]
    ds_read_b128 v[64:67], v23 offset:32768
    ds_read_b64_tr_b16 v[68:69], v28 offset:6144
    ds_read_b64_tr_b16 v[70:71], v28 offset:6656
    s_waitcnt lgkmcnt(3)
    v_mfma_f32_32x32x16_bf16 v[40:55], v[60:63], v[56:59], v[40:55]
    ds_read_b128 v[56:59], v20 offset:49152
    ds_read_b64_tr_b16 v[60:61], v28 offset:8192
    ds_read_b64_tr_b16 v[62:63], v28 offset:8704
    s_waitcnt lgkmcnt(3)
    v_mfma_f32_32x32x16_bf16 v[40:55], v[68:71], v[64:67], v[40:55]
    s_cmp_ge_u32 s31, 13
    s_cbranch_scc1 L_lend_gw2_0_kernel
    s_cmp_ge_u32 s31, 8
    s_cbranch_scc1 L_gw2_0_kernel_tail7
    s_waitcnt vmcnt(9)
    s_barrier
    s_add_u32 s35, s31, 8
    s_add_u32 s35, s35, s42
    s_sub_u32 s34, s35, 16
    s_cmp_ge_u32 s35, 16
    s_cselect_b32 s35, s34, s35
    s_mul_i32 s33, s35, 131072
    s_lshl_b32 s32, s35, 7
    s_lshr_b32 s34, s35, 2
    s_mov_b32 s39, 0x04000301
    s_lshl_b32 s34, s34, 3
    s_lshr_b32 s39, s39, s34
    s_and_b32 s39, s39, 0xff
    s_mul_i32 s39, s39, 2048
    s_add_u32 s32, s32, s39
    s_add_u32 m0, s40, 32768
    s_nop 0
    buffer_load_dwordx4 v2, s[8:11], s32 offen lds
    s_add_u32 m0, s40, 33792
    s_nop 0
    buffer_load_dwordx4 v3, s[8:11], s32 offen lds
    s_add_u32 m0, s41, 16384
    s_nop 0
    buffer_load_dwordx4 v10, s[12:15], s33 offen lds
    s_branch L_gw2_0_kernel_join8
L_gw2_0_kernel_tail7:
    s_waitcnt vmcnt(0)
    s_barrier
L_gw2_0_kernel_join8:
    ds_read_b128 v[64:67], v21 offset:49152
    ds_read_b64_tr_b16 v[68:69], v28 offset:10240
    ds_read_b64_tr_b16 v[70:71], v28 offset:10752
    s_waitcnt lgkmcnt(3)
    v_mfma_f32_32x32x16_bf16 v[40:55], v[60:63], v[56:59], v[40:55]
    ds_read_b128 v[56:59], v22 offset:49152
    ds_read_b64_tr_b16 v[60:61], v28 offset:12288
    ds_read_b64_tr_b16 v[62:63], v28 offset:12800
    s_waitcnt lgkmcnt(3)
    v_mfma_f32_32x32x16_bf16 v[40:55], v[68:71], v[64:67], v[40:55]
    ds_read_b128 v[64:67], v23 offset:49152
    ds_read_b64_tr_b16 v[68:69], v28 offset:14336
    ds_read_b64_tr_b16 v[70:71], v28 offset:14848
    s_waitcnt lgkmcnt(3)
    v_mfma_f32_32x32x16_bf16 v[40:55], v[60:63], v[56:59], v[40:55]
    ds_read_b128 v[56:59], v36 offset:0
    ds_read_b64_tr_b16 v[60:61], v32 offset:0
    ds_read_b64_tr_b16 v[62:63], v32 offset:512
    s_waitcnt lgkmcnt(3)
    v_mfma_f32_32x32x16_bf16 v[40:55], v[68:71], v[64:67], v[40:55]
    s_cmp_ge_u32 s31, 12
    s_cbranch_scc1 L_lend_gw2_0_kernel
    s_cmp_ge_u32 s31, 7
    s_cbranch_scc1 L_gw2_0_kernel_tail9
    s_waitcnt vmcnt(9)
    s_barrier
    s_add_u32 s35, s31, 9
    s_add_u32 s35, s35, s42
    s_sub_u32 s34, s35, 16
    s_cmp_ge_u32 s35, 16
    s_cselect_b32 s35, s34, s35
    s_mul_i32 s33, s35, 131072
    s_lshl_b32 s32, s35, 7
    s_lshr_b32 s34, s35, 2
    s_mov_b32 s39, 0x04000301
    s_lshl_b32 s34, s34, 3
    s_lshr_b32 s39, s39, s34
    s_and_b32 s39, s39, 0xff
    s_mul_i32 s39, s39, 2048
    s_add_u32 s32, s32, s39
    s_add_u32 m0, s40, 49152
    s_nop 0
    buffer_load_dwordx4 v2, s[8:11], s32 offen lds
    s_add_u32 m0, s40, 50176
    s_nop 0
    buffer_load_dwordx4 v3, s[8:11], s32 offen lds
    s_add_u32 m0, s41, 24576
    s_nop 0
    buffer_load_dwordx4 v10, s[12:15], s33 offen lds
    s_branch L_gw2_0_kernel_join10
L_gw2_0_kernel_tail9:
    s_waitcnt vmcnt(0)
    s_barrier
L_gw2_0_kernel_join10:
    ds_read_b128 v[64:67], v37 offset:0
    ds_read_b64_tr_b16 v[68:69], v32 offset:2048
    ds_read_b64_tr_b16 v[70:71], v32 offset:2560
    s_waitcnt lgkmcnt(3)
    v_mfma_f32_32x32x16_bf16 v[40:55], v[60:63], v[56:59], v[40:55]
    ds_read_b128 v[56:59], v38 offset:0
    ds_read_b64_tr_b16 v[60:61], v32 offset:4096
    ds_read_b64_tr_b16 v[62:63], v32 offset:4608
    s_waitcnt lgkmcnt(3)
    v_mfma_f32_32x32x16_bf16 v[40:55], v[68:71], v[64:67], v[40:55]
    ds_read_b128 v[64:67], v39 offset:0
    ds_read_b64_tr_b16 v[68:69], v32 offset:6144
    ds_read_b64_tr_b16 v[70:71], v32 offset:6656
    s_waitcnt lgkmcnt(3)
    v_mfma_f32_32x32x16_bf16 v[40:55], v[60:63], v[56:59], v[40:55]
    ds_read_b128 v[56:59], v36 offset:16384
    ds_read_b64_tr_b16 v[60:61], v32 offset:8192
    ds_read_b64_tr_b16 v[62:63], v32 offset:8704
    s_waitcnt lgkmcnt(3)
    v_mfma_f32_32x32x16_bf16 v[40:55], v[68:71], v[64:67], v[40:55]
    s_cmp_ge_u32 s31, 11
    s_cbranch_scc1 L_lend_gw2_0_kernel
    s_cmp_ge_u32 s31, 6
    s_cbranch_scc1 L_gw2_0_kernel_tail11
    s_waitcnt vmcnt(9)
    s_barrier
    s_add_u32 s35, s31, 10
    s_add_u32 s35, s35, s42
    s_sub_u32 s34, s35, 16
    s_cmp_ge_u32 s35, 16
    s_cselect_b32 s35, s34, s35
    s_mul_i32 s33, s35, 131072
    s_lshl_b32 s32, s35, 7
    s_lshr_b32 s34, s35, 2
    s_mov_b32 s39, 0x04000301
    s_lshl_b32 s34, s34, 3
    s_lshr_b32 s39, s39, s34
    s_and_b32 s39, s39, 0xff
    s_mul_i32 s39, s39, 2048
    s_add_u32 s32, s32, s39
    s_add_u32 m0, s40, 65536
    s_nop 0
    buffer_load_dwordx4 v2, s[8:11], s32 offen lds
    s_add_u32 m0, s40, 66560
    s_nop 0
    buffer_load_dwordx4 v3, s[8:11], s32 offen lds
    s_add_u32 m0, s41, 32768
    s_nop 0
    buffer_load_dwordx4 v10, s[12:15], s33 offen lds
    s_branch L_gw2_0_kernel_join12
L_gw2_0_kernel_tail11:
    s_waitcnt vmcnt(0)
    s_barrier
L_gw2_0_kernel_join12:
    ds_read_b128 v[64:67], v37 offset:16384
    ds_read_b64_tr_b16 v[68:69], v32 offset:10240
    ds_read_b64_tr_b16 v[70:71], v32 offset:10752
    s_waitcnt lgkmcnt(3)
    v_mfma_f32_32x32x16_bf16 v[40:55], v[60:63], v[56:59], v[40:55]
    ds_read_b128 v[56:59], v38 offset:16384
    ds_read_b64_tr_b16 v[60:61], v32 offset:12288
    ds_read_b64_tr_b16 v[62:63], v32 offset:12800
    s_waitcnt lgkmcnt(3)
    v_mfma_f32_32x32x16_bf16 v[40:55], v[68:71], v[64:67], v[40:55]
    ds_read_b128 v[64:67], v39 offset:16384
    ds_read_b64_tr_b16 v[68:69], v32 offset:14336
    ds_read_b64_tr_b16 v[70:71], v32 offset:14848
    s_waitcnt lgkmcnt(3)
    v_mfma_f32_32x32x16_bf16 v[40:55], v[60:63], v[56:59], v[40:55]
    ds_read_b128 v[56:59], v20 offset:0
    ds_read_b64_tr_b16 v[60:61], v24 offset:0
    ds_read_b64_tr_b16 v[62:63], v24 offset:512
    s_waitcnt lgkmcnt(3)
    v_mfma_f32_32x32x16_bf16 v[40:55], v[68:71], v[64:67], v[40:55]
    s_add_u32 s31, s31, 6
    s_cmp_lt_u32 s31, 16
    s_cbranch_scc1 L_loop_gw2_0_kernel
L_lend_gw2_0_kernel:
    s_nop 15
    s_nop 7
    s_lshr_b32 s31, s30, 1
    s_and_b32 s34, s30, 1
    s_mul_i32 s38, s31, 32
    s_mul_i32 s39, s34, 32
    s_lshl_b32 s31, s28, 7
    s_add_u32 s38, s38, s31
    s_mul_i32 s31, s29, 64
    s_add_u32 s39, s39, s31
    s_barrier
    s_mul_i32 s32, s30, 2560
    v_and_b32 v1, 31, v0
    v_mul_u32_u24 v1, 80, v1
    v_lshrrev_b32 v2, 5, v0
    v_lshlrev_b32 v2, 3, v2
    v_add_u32 v1, v1, v2
    v_add_u32 v1, s32, v1
    v_cvt_pk_bf16_f32 v40, v40, v41
    v_cvt_pk_bf16_f32 v41, v42, v43
    ds_write_b64 v1, v[40:41] offset:0
    v_cvt_pk_bf16_f32 v44, v44, v45
    v_cvt_pk_bf16_f32 v45, v46, v47
    ds_write_b64 v1, v[44:45] offset:16
    v_cvt_pk_bf16_f32 v48, v48, v49
    v_cvt_pk_bf16_f32 v49, v50, v51
    ds_write_b64 v1, v[48:49] offset:32
    v_cvt_pk_bf16_f32 v52, v52, v53
    v_cvt_pk_bf16_f32 v53, v54, v55
    ds_write_b64 v1, v[52:53] offset:48
    s_mov_b32 s35, 2048
    s_lshl_b32 s39, s39, 1
    v_add_u32 v2, 0, v0
    v_mul_u32_u24 v3, 16384, v2
    v_lshrrev_b32 v3, 16, v3
    v_mul_u32_u24 v4, 4, v3
    v_sub_u32 v4, v2, v4
    v_lshlrev_b32 v4, 4, v4
    v_mul_u32_u24 v5, 80, v3
    v_add_u32 v5, v5, v4
    v_add_u32 v8, s32, v5
    v_add_u32 v3, s38, v3
    v_mul_lo_u32 v3, v3, s35
    v_add_u32 v3, v3, v4
    v_add_u32 v16, s39, v3
    v_add_u32 v2, 64, v0
    v_mul_u32_u24 v3, 16384, v2
    v_lshrrev_b32 v3, 16, v3
    v_mul_u32_u24 v4, 4, v3
    v_sub_u32 v4, v2, v4
    v_lshlrev_b32 v4, 4, v4
    v_mul_u32_u24 v5, 80, v3
    v_add_u32 v5, v5, v4
    v_add_u32 v9, s32, v5
    v_add_u32 v3, s38, v3
    v_mul_lo_u32 v3, v3, s35
    v_add_u32 v3, v3, v4
    v_add_u32 v17, s39, v3
    s_waitcnt lgkmcnt(0)
    ds_read_b128 v[40:43], v8
    buffer_load_dwordx4 v[48:51], v16, s[20:23], 0 offen
    ds_read_b128 v[44:47], v9
    buffer_load_dwordx4 v[52:55], v17, s[20:23], 0 offen
    s_waitcnt lgkmcnt(0)
    s_waitcnt vmcnt(0)
    v_lshlrev_b32 v72, 16, v40
    v_and_b32 v73, 0xffff0000, v40
    v_lshlrev_b32 v74, 16, v48
    v_and_b32 v75, 0xffff0000, v48
    v_add_f32 v72, v72, v74
    v_add_f32 v73, v73, v75
    v_cvt_pk_bf16_f32 v40, v72, v73
    v_lshlrev_b32 v72, 16, v41
    v_and_b32 v73, 0xffff0000, v41
    v_lshlrev_b32 v74, 16, v49
    v_and_b32 v75, 0xffff0000, v49
    v_add_f32 v72, v72, v74
    v_add_f32 v73, v73, v75
    v_cvt_pk_bf16_f32 v41, v72, v73
    v_lshlrev_b32 v72, 16, v42
    v_and_b32 v73, 0xffff0000, v42
    v_lshlrev_b32 v74, 16, v50
    v_and_b32 v75, 0xffff0000, v50
    v_add_f32 v72, v72, v74
    v_add_f32 v73, v73, v75
    v_cvt_pk_bf16_f32 v42, v72, v73
    v_lshlrev_b32 v72, 16, v43
    v_and_b32 v73, 0xffff0000, v43
    v_lshlrev_b32 v74, 16, v51
    v_and_b32 v75, 0xffff0000, v51
    v_add_f32 v72, v72, v74
    v_add_f32 v73, v73, v75
    v_cvt_pk_bf16_f32 v43, v72, v73
    buffer_store_dwordx4 v[40:43], v16, s[16:19], 0 offen
    v_lshlrev_b32 v72, 16, v44
    v_and_b32 v73, 0xffff0000, v44
    v_lshlrev_b32 v74, 16, v52
    v_and_b32 v75, 0xffff0000, v52
    v_add_f32 v72, v72, v74
    v_add_f32 v73, v73, v75
    v_cvt_pk_bf16_f32 v44, v72, v73
    v_lshlrev_b32 v72, 16, v45
    v_and_b32 v73, 0xffff0000, v45
    v_lshlrev_b32 v74, 16, v53
    v_and_b32 v75, 0xffff0000, v53
    v_add_f32 v72, v72, v74
    v_add_f32 v73, v73, v75
    v_cvt_pk_bf16_f32 v45, v72, v73
    v_lshlrev_b32 v72, 16, v46
    v_and_b32 v73, 0xffff0000, v46
    v_lshlrev_b32 v74, 16, v54
    v_and_b32 v75, 0xffff0000, v54
    v_add_f32 v72, v72, v74
    v_add_f32 v73, v73, v75
    v_cvt_pk_bf16_f32 v46, v72, v73
    v_lshlrev_b32 v72, 16, v47
    v_and_b32 v73, 0xffff0000, v47
    v_lshlrev_b32 v74, 16, v55
    v_and_b32 v75, 0xffff0000, v55
    v_add_f32 v72, v72, v74
    v_add_f32 v73, v73, v75
    v_cvt_pk_bf16_f32 v47, v72, v73
    buffer_store_dwordx4 v[44:47], v17, s[16:19], 0 offen
L_done_gw2_0_kernel:
    s_endpgm
.globl lnc_0_kernel
.p2align 8
.type lnc_0_kernel,@function
lnc_0_kernel:
    s_cmp_ge_u32 s2, 512
    s_cbranch_scc1 L_done_lnc_0_kernel
    s_load_dwordx2 s[40:41], s[0:1], 88
    s_waitcnt lgkmcnt(0)
    s_add_u32 s8, s40, 44040192
    s_addc_u32 s9, s41, 0
    s_mov_b32 s10, 4194304
    s_mov_b32 s11, 0x00020000
    s_add_u32 s12, s40, 48234496
    s_addc_u32 s13, s41, 0
    s_mov_b32 s14, 4194304
    s_mov_b32 s15, 0x00020000
    s_lshl_b32 s3, s2, 2
    v_lshrrev_b32 v1, 6, v0
    v_add_u32 v1, s3, v1
    v_lshlrev_b32 v1, 11, v1
    v_and_b32 v2, 63, v0
    v_lshlrev_b32 v2, 4, v2
    v_add_u32 v1, v1, v2
    buffer_load_dwordx4 v[8:11], v1, s[8:11], 0 offen
    buffer_load_dwordx4 v[12:15], v1, s[8:11], 0 offen offset:1024
    s_waitcnt vmcnt(0)
    v_lshlrev_b32 v16, 16, v8
    v_and_b32 v17, 0xffff0000, v8
    v_lshlrev_b32 v18, 16, v9
    v_and_b32 v19, 0xffff0000, v9
    v_lshlrev_b32 v20, 16, v10
    v_and_b32 v21, 0xffff0000, v10
    v_lshlrev_b32 v22, 16, v11
    v_and_b32 v23, 0xffff0000, v11
    v_lshlrev_b32 v24, 16, v12
    v_and_b32 v25, 0xffff0000, v12
    v_lshlrev_b32 v26, 16, v13
    v_and_b32 v27, 0xffff0000, v13
    v_lshlrev_b32 v28, 16, v14
    v_and_b32 v29, 0xffff0000, v14
    v_lshlrev_b32 v30, 16, v15
    v_and_b32 v31, 0xffff0000, v15
    v_mov_b32 v4, 0
    v_add_f32 v4, v4, v16
    v_add_f32 v4, v4, v17
    v_add_f32 v4, v4, v18
    v_add_f32 v4, v4, v19
    v_add_f32 v4, v4, v20
    v_add_f32 v4, v4, v21
    v_add_f32 v4, v4, v22
    v_add_f32 v4, v4, v23
    v_add_f32 v4, v4, v24
    v_add_f32 v4, v4, v25
    v_add_f32 v4, v4, v26
    v_add_f32 v4, v4, v27
    v_add_f32 v4, v4, v28
    v_add_f32 v4, v4, v29
    v_add_f32 v4, v4, v30
    v_add_f32 v4, v4, v31
    ds_swizzle_b32 v5, v4 offset:0x041F
    s_waitcnt lgkmcnt(0)
    v_add_f32 v4, v4, v5
    ds_swizzle_b32 v5, v4 offset:0x081F
    s_waitcnt lgkmcnt(0)
    v_add_f32 v4, v4, v5
    ds_swizzle_b32 v5, v4 offset:0x101F
    s_waitcnt lgkmcnt(0)
    v_add_f32 v4, v4, v5
    ds_swizzle_b32 v5, v4 offset:0x201F
    s_waitcnt lgkmcnt(0)
    v_add_f32 v4, v4, v5
    ds_swizzle_b32 v5, v4 offset:0x401F
    s_waitcnt lgkmcnt(0)
    v_add_f32 v4, v4, v5
    s_nop 0
    v_readlane_b32 s30, v4, 32
    v_readlane_b32 s31, v4, 0
    s_nop 1
    v_mov_b32 v4, s30
    v_add_f32 v4, s31, v4
    v_mul_f32 v4, 0x3a800000, v4
    v_mov_b32 v6, 0
    v_sub_f32 v16, v16, v4
    v_fmac_f32 v6, v16, v16
    v_sub_f32 v17, v17, v4
    v_fmac_f32 v6, v17, v17
    v_sub_f32 v18, v18, v4
    v_fmac_f32 v6, v18, v18
    v_sub_f32 v19, v19, v4
    v_fmac_f32 v6, v19, v19
    v_sub_f32 v20, v20, v4
    v_fmac_f32 v6, v20, v20
    v_sub_f32 v21, v21, v4
    v_fmac_f32 v6, v21, v21
    v_sub_f32 v22, v22, v4
    v_fmac_f32 v6, v22, v22
    v_sub_f32 v23, v23, v4
    v_fmac_f32 v6, v23, v23
    v_sub_f32 v24, v24, v4
    v_fmac_f32 v6, v24, v24
    v_sub_f32 v25, v25, v4
    v_fmac_f32 v6, v25, v25
    v_sub_f32 v26, v26, v4
    v_fmac_f32 v6, v26, v26
    v_sub_f32 v27, v27, v4
    v_fmac_f32 v6, v27, v27
    v_sub_f32 v28, v28, v4
    v_fmac_f32 v6, v28, v28
    v_sub_f32 v29, v29, v4
    v_fmac_f32 v6, v29, v29
    v_sub_f32 v30, v30, v4
    v_fmac_f32 v6, v30, v30
    v_sub_f32 v31, v31, v4
    v_fmac_f32 v6, v31, v31
    ds_swizzle_b32 v5, v6 offset:0x041F
    s_waitcnt lgkmcnt(0)
    v_add_f32 v6, v6, v5
    ds_swizzle_b32 v5, v6 offset:0x081F
    s_waitcnt lgkmcnt(0)
    v_add_f32 v6, v6, v5
    ds_swizzle_b32 v5, v6 offset:0x101F
    s_waitcnt lgkmcnt(0)
    v_add_f32 v6, v6, v5
    ds_swizzle_b32 v5, v6 offset:0x201F
    s_waitcnt lgkmcnt(0)
    v_add_f32 v6, v6, v5
    ds_swizzle_b32 v5, v6 offset:0x401F
    s_waitcnt lgkmcnt(0)
    v_add_f32 v6, v6, v5
    s_nop 0
    v_readlane_b32 s30, v6, 32
    v_readlane_b32 s31, v6, 0
    s_nop 1
    v_mov_b32 v6, s30
    v_add_f32 v6, s31, v6
    v_mov_b32 v5, 0x3727c5ac
    v_fmac_f32 v5, 0x3a800000, v6
    v_rsq_f32 v5, v5
    s_nop 0
    v_mul_f32 v16, v16, v5
    v_mul_f32 v17, v17, v5
    v_mul_f32 v18, v18, v5
    v_mul_f32 v19, v19, v5
    v_mul_f32 v20, v20, v5
    v_mul_f32 v21, v21, v5
    v_mul_f32 v22, v22, v5
    v_mul_f32 v23, v23, v5
    v_mul_f32 v24, v24, v5
    v_mul_f32 v25, v25, v5
    v_mul_f32 v26, v26, v5
    v_mul_f32 v27, v27, v5
    v_mul_f32 v28, v28, v5
    v_mul_f32 v29, v29, v5
    v_mul_f32 v30, v30, v5
    v_mul_f32 v31, v31, v5
    v_cvt_pk_bf16_f32 v32, v16, v17
    v_cvt_pk_bf16_f32 v33, v18, v19
    v_cvt_pk_bf16_f32 v34, v20, v21
    v_cvt_pk_bf16_f32 v35, v22, v23
    v_cvt_pk_bf16_f32 v36, v24, v25
    v_cvt_pk_bf16_f32 v37, v26, v27
    v_cvt_pk_bf16_f32 v38, v28, v29
    v_cvt_pk_bf16_f32 v39, v30, v31
    buffer_store_dwordx4 v[32:35], v1, s[12:15], 0 offen
    buffer_store_dwordx4 v[36:39], v1, s[12:15], 0 offen offset:1024
L_done_lnc_0_kernel:
    s_endpgm
.globl gw3_0_kernel
.p2align 8
.type gw3_0_kernel,@function
gw3_0_kernel:
    s_cmp_ge_u32 s2, 224
    s_cbranch_scc1 L_done_gw3_0_kernel
    s_load_dwordx2 s[40:41], s[0:1], 56
    s_load_dwordx2 s[42:43], s[0:1], 88
    s_waitcnt lgkmcnt(0)
    s_add_u32 s8, s42, 48234496
    s_addc_u32 s9, s43, 0
    s_mov_b32 s10, 4194304
    s_mov_b32 s11, 0x00020000
    s_mov_b32 s12, s40
    s_mov_b32 s13, s41
    s_mov_b32 s14, 7340032
    s_mov_b32 s15, 0x00020000
    s_add_u32 s16, s42, 52428800
    s_addc_u32 s17, s43, 0
    s_mov_b32 s18, 14680064
    s_mov_b32 s19, 0x00020000
    s_mov_b32 s36, 0x3d372713
    s_mov_b32 s37, 0xc0135761
    s_and_b32 s3, s2, 7
    s_lshr_b32 s4, s2, 3
    s_mul_i32 s5, s4, 9363
    s_lshr_b32 s5, s5, 16
    s_mul_i32 s6, s5, 7
    s_sub_u32 s6, s4, s6
    s_lshr_b32 s7, s3, 1
    s_mul_i32 s7, s7, 4
    s_add_u32 s28, s7, s5
    s_and_b32 s7, s3, 1
    s_mul_i32 s7, s7, 7
    s_add_u32 s29, s7, s6
    v_lshrrev_b32 v1, 6, v0
    s_nop 0
    v_readfirstlane_b32 s30, v1
    v_and_b32 v0, 63, v0
    v_lshrrev_b32 v1, 3, v0
    s_lshl_b32 s31, s30, 4
    s_lshl_b32 s34, s28, 7
    s_add_u32 s31, s31, s34
    v_add_u32 v1, s31, v1
    v_add_u32 v6, 0, v1
    v_lshrrev_b32 v7, 1, v6
    v_and_b32 v7, 7, v7
    v_and_b32 v8, 7, v0
    v_xor_b32 v7, v7, v8
    v_lshlrev_b32 v7, 4, v7
    s_mov_b32 s35, 2048
    v_mul_lo_u32 v6, v6, s35
    v_add_u32 v2, v6, v7
    v_add_u32 v6, 8, v1
    v_lshrrev_b32 v7, 1, v6
    v_and_b32 v7, 7, v7
    v_and_b32 v8, 7, v0
    v_xor_b32 v7, v7, v8
    v_lshlrev_b32 v7, 4, v7
    s_mov_b32 s35, 2048
    v_mul_lo_u32 v6, v6, s35
    v_add_u32 v3, v6, v7
    s_mul_i32 s31, s30, 256
    s_mul_i32 s34, s29, 512
    v_add_u32 v6, s31, v0
    v_add_u32 v6, 0, v6
    v_mul_u32_u24 v7, 2048, v6
    v_lshrrev_b32 v7, 16, v7
    v_mul_u32_u24 v8, 32, v7
    v_sub_u32 v8, v6, v8
    v_lshlrev_b32 v9, 1, v7
    v_and_b32 v9, 4, v9
    v_xor_b32 v8, v8, v9
    v_lshlrev_b32 v8, 4, v8
    s_mov_b32 s35, 7168
    v_mul_lo_u32 v7, v7, s35
    v_add_u32 v7, v7, v8
    v_add_u32 v10, s34, v7
    v_add_u32 v6, s31, v0
    v_add_u32 v6, 64, v6
    v_mul_u32_u24 v7, 2048, v6
    v_lshrrev_b32 v7, 16, v7
    v_mul_u32_u24 v8, 32, v7
    v_sub_u32 v8, v6, v8
    v_lshlrev_b32 v9, 1, v7
    v_and_b32 v9, 4, v9
    v_xor_b32 v8, v8, v9
    v_lshlrev_b32 v8, 4, v8
    s_mov_b32 s35, 7168
    v_mul_lo_u32 v7, v7, s35
    v_add_u32 v7, v7, v8
    v_add_u32 v11, s34, v7
    v_add_u32 v6, s31, v0
    v_add_u32 v6, 128, v6
    v_mul_u32_u24 v7, 2048, v6
    v_lshrrev_b32 v7, 16, v7
    v_mul_u32_u24 v8, 32, v7
    v_sub_u32 v8, v6, v8
    v_lshlrev_b32 v9, 1, v7
    v_and_b32 v9, 4, v9
    v_xor_b32 v8, v8, v9
    v_lshlrev_b32 v8, 4, v8
    s_mov_b32 s35, 7168
    v_mul_lo_u32 v7, v7, s35
    v_add_u32 v7, v7, v8
    v_add_u32 v12, s34, v7
    v_add_u32 v6, s31, v0
    v_add_u32 v6, 192, v6
    v_mul_u32_u24 v7, 2048, v6
    v_lshrrev_b32 v7, 16, v7
    v_mul_u32_u24 v8, 32, v7
    v_sub_u32 v8, v6, v8
    v_lshlrev_b32 v9, 1, v7
    v_and_b32 v9, 4, v9
    v_xor_b32 v8, v8, v9
    v_lshlrev_b32 v8, 4, v8
    s_mov_b32 s35, 7168
    v_mul_lo_u32 v7, v7, s35
    v_add_u32 v7, v7, v8
    v_add_u32 v13, s34, v7
    s_lshr_b32 s31, s30, 1
    s_and_b32 s34, s30, 1
    s_mul_i32 s38, s31, 32
    s_mul_i32 s39, s34, 128
    v_and_b32 v6, 31, v0
    v_add_u32 v6, s38, v6
    v_lshrrev_b32 v7, 1, v6
    v_and_b32 v7, 7, v7
    v_lshrrev_b32 v8, 5, v0
    v_xor_b32 v7, v7, v8
    v_lshlrev_b32 v7, 4, v7
    v_lshlrev_b32 v6, 7, v6
    v_add_u32 v6, v6, v7
    v_xor_b32 v20, 0, v6
    v_add_u32 v36, 65536, v20
    v_xor_b32 v21, 32, v6
    v_add_u32 v37, 65536, v21
    v_xor_b32 v22, 64, v6
    v_add_u32 v38, 65536, v22
    v_xor_b32 v23, 96, v6
    v_add_u32 v39, 65536, v23
    v_lshrrev_b32 v6, 5, v0
    v_lshlrev_b32 v6, 3, v6
    v_bfe_u32 v7, v0, 2, 2
    v_add_u32 v6, v6, v7
    v_bfe_u32 v8, v0, 4, 1
    v_lshlrev_b32 v8, 4, v8
    v_and_b32 v9, 3, v0
    v_lshlrev_b32 v9, 2, v9
    v_add_u32 v8, v8, v9
    v_add_u32 v8, s39, v8
    v_add_u32 v9, 0, v8
    v_lshlrev_b32 v9, 1, v9
    v_lshlrev_b32 v18, 5, v7
    v_and_b32 v18, 64, v18
    v_xor_b32 v9, v9, v18
    v_mul_u32_u24 v19, 512, v6
    v_add_u32 v24, v19, v9
    v_add_u32 v24, 49152, v24
    v_add_u32 v28, 65536, v24
    v_add_u32 v9, 32, v8
    v_lshlrev_b32 v9, 1, v9
    v_lshlrev_b32 v18, 5, v7
    v_and_b32 v18, 64, v18
    v_xor_b32 v9, v9, v18
    v_mul_u32_u24 v19, 512, v6
    v_add_u32 v25, v19, v9
    v_add_u32 v25, 49152, v25
    v_add_u32 v29, 65536, v25
    v_add_u32 v9, 64, v8
    v_lshlrev_b32 v9, 1, v9
    v_lshlrev_b32 v18, 5, v7
    v_and_b32 v18, 64, v18
    v_xor_b32 v9, v9, v18
    v_mul_u32_u24 v19, 512, v6
    v_add_u32 v26, v19, v9
    v_add_u32 v26, 49152, v26
    v_add_u32 v30, 65536, v26
    v_add_u32 v9, 96, v8
    v_lshlrev_b32 v9, 1, v9
    v_lshlrev_b32 v18, 5, v7
    v_and_b32 v18, 64, v18
    v_xor_b32 v9, v9, v18
    v_mul_u32_u24 v19, 512, v6
    v_add_u32 v27, v19, v9
    v_add_u32 v27, 49152, v27
    v_add_u32 v31, 65536, v27
    v_mov_b32 v40, 0
    v_mov_b32 v41, 0
    v_mov_b32 v42, 0
    v_mov_b32 v43, 0
    v_mov_b32 v44, 0
    v_mov_b32 v45, 0
    v_mov_b32 v46, 0
    v_mov_b32 v47, 0
    v_mov_b32 v48, 0
    v_mov_b32 v49, 0
    v_mov_b32 v50, 0
    v_mov_b32 v51, 0
    v_mov_b32 v52, 0
    v_mov_b32 v53, 0
    v_mov_b32 v54, 0
    v_mov_b32 v55, 0
    v_mov_b32 v56, 0
    v_mov_b32 v57, 0
    v_mov_b32 v58, 0
    v_mov_b32 v59, 0
    v_mov_b32 v60, 0
    v_mov_b32 v61, 0
    v_mov_b32 v62, 0
    v_mov_b32 v63, 0
    v_mov_b32 v64, 0
    v_mov_b32 v65, 0
    v_mov_b32 v66, 0
    v_mov_b32 v67, 0
    v_mov_b32 v68, 0
    v_mov_b32 v69, 0
    v_mov_b32 v70, 0
    v_mov_b32 v71, 0
    v_mov_b32 v72, 0
    v_mov_b32 v73, 0
    v_mov_b32 v74, 0
    v_mov_b32 v75, 0
    v_mov_b32 v76, 0
    v_mov_b32 v77, 0
    v_mov_b32 v78, 0
    v_mov_b32 v79, 0
    v_mov_b32 v80, 0
    v_mov_b32 v81, 0
    v_mov_b32 v82, 0
    v_mov_b32 v83, 0
    v_mov_b32 v84, 0
    v_mov_b32 v85, 0
    v_mov_b32 v86, 0
    v_mov_b32 v87, 0
    v_mov_b32 v88, 0
    v_mov_b32 v89, 0
    v_mov_b32 v90, 0
    v_mov_b32 v91, 0
    v_mov_b32 v92, 0
    v_mov_b32 v93, 0
    v_mov_b32 v94, 0
    v_mov_b32 v95, 0
    v_mov_b32 v96, 0
    v_mov_b32 v97, 0
    v_mov_b32 v98, 0
    v_mov_b32 v99, 0
    v_mov_b32 v100, 0
    v_mov_b32 v101, 0
    v_mov_b32 v102, 0
    v_mov_b32 v103, 0
    s_lshl_b32 s40, s30, 11
    s_mul_i32 s41, s30, 4096
    s_add_u32 s41, s41, 49152
    s_mov_b32 s32, 0
    s_mov_b32 s33, 0
    s_and_b32 s42, s4, 15
    s_mov_b32 s42, 0
    s_mov_b32 s35, 0
    s_add_u32 s35, s35, s42
    s_sub_u32 s34, s35, 16
    s_cmp_ge_u32 s35, 16
    s_cselect_b32 s35, s34, s35
    s_mul_i32 s33, s35, 458752
    s_lshl_b32 s32, s35, 7
    s_add_u32 m0, s40, 0
    s_nop 0
    buffer_load_dwordx4 v2, s[8:11], s32 offen lds
    s_add_u32 m0, s40, 1024
    s_nop 0
    buffer_load_dwordx4 v3, s[8:11], s32 offen lds
    s_add_u32 m0, s41, 0
    s_nop 0
    buffer_load_dwordx4 v10, s[12:15], s33 offen lds
    s_add_u32 m0, s41, 1024
    s_nop 0
    buffer_load_dwordx4 v11, s[12:15], s33 offen lds
    s_add_u32 m0, s41, 2048
    s_nop 0
    buffer_load_dwordx4 v12, s[12:15], s33 offen lds
    s_add_u32 m0, s41, 3072
    s_nop 0
    buffer_load_dwordx4 v13, s[12:15], s33 offen lds
    s_mov_b32 s35, 1
    s_add_u32 s35, s35, s42
    s_sub_u32 s34, s35, 16
    s_cmp_ge_u32 s35, 16
    s_cselect_b32 s35, s34, s35
    s_mul_i32 s33, s35, 458752
    s_lshl_b32 s32, s35, 7
    s_add_u32 m0, s40, 16384
    s_nop 0
    buffer_load_dwordx4 v2, s[8:11], s32 offen lds
    s_add_u32 m0, s40, 17408
    s_nop 0
    buffer_load_dwordx4 v3, s[8:11], s32 offen lds
    s_add_u32 m0, s41, 32768
    s_nop 0
    buffer_load_dwordx4 v10, s[12:15], s33 offen lds
    s_add_u32 m0, s41, 33792
    s_nop 0
    buffer_load_dwordx4 v11, s[12:15], s33 offen lds
    s_add_u32 m0, s41, 34816
    s_nop 0
    buffer_load_dwordx4 v12, s[12:15], s33 offen lds
    s_add_u32 m0, s41, 35840
    s_nop 0
    buffer_load_dwordx4 v13, s[12:15], s33 offen lds
    s_mov_b32 s31, 0
    s_waitcnt vmcnt(6)
    s_barrier
    ds_read_b128 v[104:107], v20 offset:0
    ds_read_b64_tr_b16 v[108:109], v24 offset:0
    ds_read_b64_tr_b16 v[110:111], v24 offset:2048
    ds_read_b64_tr_b16 v[112:113], v25 offset:0
    ds_read_b64_tr_b16 v[114:115], v25 offset:2048
    ds_read_b64_tr_b16 v[116:117], v26 offset:0
    ds_read_b64_tr_b16 v[118:119], v26 offset:2048
    ds_read_b64_tr_b16 v[120:121], v27 offset:0
    ds_read_b64_tr_b16 v[122:123], v27 offset:2048
L_loop_gw3_0_kernel:
    s_cmp_ge_u32 s31, 16
    s_cbranch_scc1 L_lend_gw3_0_kernel
    s_cmp_ge_u32 s31, 14
    s_cbranch_scc1 L_gw3_0_kernel_tail1
    s_waitcnt vmcnt(0)
    s_barrier
    s_add_u32 s35, s31, 2
    s_add_u32 s35, s35, s42
    s_sub_u32 s34, s35, 16
    s_cmp_ge_u32 s35, 16
    s_cselect_b32 s35, s34, s35
    s_mul_i32 s33, s35, 458752
    s_lshl_b32 s32, s35, 7
    s_add_u32 m0, s40, 32768
    s_nop 0
    buffer_load_dwordx4 v2, s[8:11], s32 offen lds
    s_add_u32 m0, s40, 33792
    s_nop 0
    buffer_load_dwordx4 v3, s[8:11], s32 offen lds
    s_add_u32 m0, s41, 65536
    s_nop 0
    buffer_load_dwordx4 v10, s[12:15], s33 offen lds
    s_add_u32 m0, s41, 66560
    s_nop 0
    buffer_load_dwordx4 v11, s[12:15], s33 offen lds
    s_add_u32 m0, s41, 67584
    s_nop 0
    buffer_load_dwordx4 v12, s[12:15], s33 offen lds
    s_add_u32 m0, s41, 68608
    s_nop 0
    buffer_load_dwordx4 v13, s[12:15], s33 offen lds
    s_branch L_gw3_0_kernel_join2
L_gw3_0_kernel_tail1:
    s_waitcnt vmcnt(0)
    s_barrier
L_gw3_0_kernel_join2:
    ds_read_b128 v[124:127], v21 offset:0
    ds_read_b64_tr_b16 v[128:129], v24 offset:8192
    ds_read_b64_tr_b16 v[130:131], v24 offset:10240
    ds_read_b64_tr_b16 v[132:133], v25 offset:8192
    ds_read_b64_tr_b16 v[134:135], v25 offset:10240
    ds_read_b64_tr_b16 v[136:137], v26 offset:8192
    ds_read_b64_tr_b16 v[138:139], v26 offset:10240
    ds_read_b64_tr_b16 v[140:141], v27 offset:8192
    ds_read_b64_tr_b16 v[142:143], v27 offset:10240
    s_waitcnt lgkmcnt(9)
    v_mfma_f32_32x32x16_bf16 v[40:55], v[108:111], v[104:107], v[40:55]
    v_mfma_f32_32x32x16_bf16 v[56:71], v[112:115], v[104:107], v[56:71]
    v_mfma_f32_32x32x16_bf16 v[72:87], v[116:119], v[104:107], v[72:87]
    v_mfma_f32_32x32x16_bf16 v[88:103], v[120:123], v[104:107], v[88:103]
    ds_read_b128 v[104:107], v22 offset:0
    ds_read_b64_tr_b16 v[108:109], v24 offset:16384
    ds_read_b64_tr_b16 v[110:111], v24 offset:18432
    ds_read_b64_tr_b16 v[112:113], v25 offset:16384
    ds_read_b64_tr_b16 v[114:115], v25 offset:18432
    ds_read_b64_tr_b16 v[116:117], v26 offset:16384
    ds_read_b64_tr_b16 v[118:119], v26 offset:18432
    ds_read_b64_tr_b16 v[120:121], v27 offset:16384
    ds_read_b64_tr_b16 v[122:123], v27 offset:18432
    s_waitcnt lgkmcnt(9)
    v_mfma_f32_32x32x16_bf16 v[40:55], v[128:131], v[124:127], v[40:55]
    v_mfma_f32_32x32x16_bf16 v[56:71], v[132:135], v[124:127], v[56:71]
    v_mfma_f32_32x32x16_bf16 v[72:87], v[136:139], v[124:127], v[72:87]
    v_mfma_f32_32x32x16_bf16 v[88:103], v[140:143], v[124:127], v[88:103]
    ds_read_b128 v[124:127], v23 offset:0
    ds_read_b64_tr_b16 v[128:129], v24 offset:24576
    ds_read_b64_tr_b16 v[130:131], v24 offset:26624
    ds_read_b64_tr_b16 v[132:133], v25 offset:24576
    ds_read_b64_tr_b16 v[134:135], v25 offset:26624
    ds_read_b64_tr_b16 v[136:137], v26 offset:24576
    ds_read_b64_tr_b16 v[138:139], v26 offset:26624
    ds_read_b64_tr_b16 v[140:141], v27 offset:24576
    ds_read_b64_tr_b16 v[142:143], v27 offset:26624
    s_waitcnt lgkmcnt(9)
    v_mfma_f32_32x32x16_bf16 v[40:55], v[108:111], v[104:107], v[40:55]
    v_mfma_f32_32x32x16_bf16 v[56:71], v[112:115], v[104:107], v[56:71]
    v_mfma_f32_32x32x16_bf16 v[72:87], v[116:119], v[104:107], v[72:87]
    v_mfma_f32_32x32x16_bf16 v[88:103], v[120:123], v[104:107], v[88:103]
    ds_read_b128 v[104:107], v20 offset:16384
    ds_read_b64_tr_b16 v[108:109], v24 offset:32768
    ds_read_b64_tr_b16 v[110:111], v24 offset:34816
    ds_read_b64_tr_b16 v[112:113], v25 offset:32768
    ds_read_b64_tr_b16 v[114:115], v25 offset:34816
    ds_read_b64_tr_b16 v[116:117], v26 offset:32768
    ds_read_b64_tr_b16 v[118:119], v26 offset:34816
    ds_read_b64_tr_b16 v[120:121], v27 offset:32768
    ds_read_b64_tr_b16 v[122:123], v27 offset:34816
    s_waitcnt lgkmcnt(9)
    v_mfma_f32_32x32x16_bf16 v[40:55], v[128:131], v[124:127], v[40:55]
    v_mfma_f32_32x32x16_bf16 v[56:71], v[132:135], v[124:127], v[56:71]
    v_mfma_f32_32x32x16_bf16 v[72:87], v[136:139], v[124:127], v[72:87]
    v_mfma_f32_32x32x16_bf16 v[88:103], v[140:143], v[124:127], v[88:103]
    s_cmp_ge_u32 s31, 15
    s_cbranch_scc1 L_lend_gw3_0_kernel
    s_cmp_ge_u32 s31, 13
    s_cbranch_scc1 L_gw3_0_kernel_tail3
    s_waitcnt vmcnt(0)
    s_barrier
    s_add_u32 s35, s31, 3
    s_add_u32 s35, s35, s42
    s_sub_u32 s34, s35, 16
    s_cmp_ge_u32 s35, 16
    s_cselect_b32 s35, s34, s35
    s_mul_i32 s33, s35, 458752
    s_lshl_b32 s32, s35, 7
    s_add_u32 m0, s40, 0
    s_nop 0
    buffer_load_dwordx4 v2, s[8:11], s32 offen lds
    s_add_u32 m0, s40, 1024
    s_nop 0
    buffer_load_dwordx4 v3, s[8:11], s32 offen lds
    s_add_u32 m0, s41, 0
    s_nop 0
    buffer_load_dwordx4 v10, s[12:15], s33 offen lds
    s_add_u32 m0, s41, 1024
    s_nop 0
    buffer_load_dwordx4 v11, s[12:15], s33 offen lds
    s_add_u32 m0, s41, 2048
    s_nop 0
    buffer_load_dwordx4 v12, s[12:15], s33 offen lds
    s_add_u32 m0, s41, 3072
    s_nop 0
    buffer_load_dwordx4 v13, s[12:15], s33 offen lds
    s_branch L_gw3_0_kernel_join4
L_gw3_0_kernel_tail3:
    s_waitcnt vmcnt(0)
    s_barrier
L_gw3_0_kernel_join4:
    ds_read_b128 v[124:127], v21 offset:16384
    ds_read_b64_tr_b16 v[128:129], v24 offset:40960
    ds_read_b64_tr_b16 v[130:131], v24 offset:43008
    ds_read_b64_tr_b16 v[132:133], v25 offset:40960
    ds_read_b64_tr_b16 v[134:135], v25 offset:43008
    ds_read_b64_tr_b16 v[136:137], v26 offset:40960
    ds_read_b64_tr_b16 v[138:139], v26 offset:43008
    ds_read_b64_tr_b16 v[140:141], v27 offset:40960
    ds_read_b64_tr_b16 v[142:143], v27 offset:43008
    s_waitcnt lgkmcnt(9)
    v_mfma_f32_32x32x16_bf16 v[40:55], v[108:111], v[104:107], v[40:55]
    v_mfma_f32_32x32x16_bf16 v[56:71], v[112:115], v[104:107], v[56:71]
    v_mfma_f32_32x32x16_bf16 v[72:87], v[116:119], v[104:107], v[72:87]
    v_mfma_f32_32x32x16_bf16 v[88:103], v[120:123], v[104:107], v[88:103]
    ds_read_b128 v[104:107], v22 offset:16384
    ds_read_b64_tr_b16 v[108:109], v24 offset:49152
    ds_read_b64_tr_b16 v[110:111], v24 offset:51200
    ds_read_b64_tr_b16 v[112:113], v25 offset:49152
    ds_read_b64_tr_b16 v[114:115], v25 offset:51200
    ds_read_b64_tr_b16 v[116:117], v26 offset:49152
    ds_read_b64_tr_b16 v[118:119], v26 offset:51200
    ds_read_b64_tr_b16 v[120:121], v27 offset:49152
    ds_read_b64_tr_b16 v[122:123], v27 offset:51200
    s_waitcnt lgkmcnt(9)
    v_mfma_f32_32x32x16_bf16 v[40:55], v[128:131], v[124:127], v[40:55]
    v_mfma_f32_32x32x16_bf16 v[56:71], v[132:135], v[124:127], v[56:71]
    v_mfma_f32_32x32x16_bf16 v[72:87], v[136:139], v[124:127], v[72:87]
    v_mfma_f32_32x32x16_bf16 v[88:103], v[140:143], v[124:127], v[88:103]
    ds_read_b128 v[124:127], v23 offset:16384
    ds_read_b64_tr_b16 v[128:129], v24 offset:57344
    ds_read_b64_tr_b16 v[130:131], v24 offset:59392
    ds_read_b64_tr_b16 v[132:133], v25 offset:57344
    ds_read_b64_tr_b16 v[134:135], v25 offset:59392
    ds_read_b64_tr_b16 v[136:137], v26 offset:57344
    ds_read_b64_tr_b16 v[138:139], v26 offset:59392
    ds_read_b64_tr_b16 v[140:141], v27 offset:57344
    ds_read_b64_tr_b16 v[142:143], v27 offset:59392
    s_waitcnt lgkmcnt(9)
    v_mfma_f32_32x32x16_bf16 v[40:55], v[108:111], v[104:107], v[40:55]
    v_mfma_f32_32x32x16_bf16 v[56:71], v[112:115], v[104:107], v[56:71]
    v_mfma_f32_32x32x16_bf16 v[72:87], v[116:119], v[104:107], v[72:87]
    v_mfma_f32_32x32x16_bf16 v[88:103], v[120:123], v[104:107], v[88:103]
    ds_read_b128 v[104:107], v20 offset:32768
    ds_read_b64_tr_b16 v[108:109], v28 offset:0
    ds_read_b64_tr_b16 v[110:111], v28 offset:2048
    ds_read_b64_tr_b16 v[112:113], v29 offset:0
    ds_read_b64_tr_b16 v[114:115], v29 offset:2048
    ds_read_b64_tr_b16 v[116:117], v30 offset:0
    ds_read_b64_tr_b16 v[118:119], v30 offset:2048
    ds_read_b64_tr_b16 v[120:121], v31 offset:0
    ds_read_b64_tr_b16 v[122:123], v31 offset:2048
    s_waitcnt lgkmcnt(9)
    v_mfma_f32_32x32x16_bf16 v[40:55], v[128:131], v[124:127], v[40:55]
    v_mfma_f32_32x32x16_bf16 v[56:71], v[132:135], v[124:127], v[56:71]
    v_mfma_f32_32x32x16_bf16 v[72:87], v[136:139], v[124:127], v[72:87]
    v_mfma_f32_32x32x16_bf16 v[88:103], v[140:143], v[124:127], v[88:103]
    s_cmp_ge_u32 s31, 14
    s_cbranch_scc1 L_lend_gw3_0_kernel
    s_cmp_ge_u32 s31, 12
    s_cbranch_scc1 L_gw3_0_kernel_tail5
    s_waitcnt vmcnt(0)
    s_barrier
    s_add_u32 s35, s31, 4
    s_add_u32 s35, s35, s42
    s_sub_u32 s34, s35, 16
    s_cmp_ge_u32 s35, 16
    s_cselect_b32 s35, s34, s35
    s_mul_i32 s33, s35, 458752
    s_lshl_b32 s32, s35, 7
    s_add_u32 m0, s40, 16384
    s_nop 0
    buffer_load_dwordx4 v2, s[8:11], s32 offen lds
    s_add_u32 m0, s40, 17408
    s_nop 0
    buffer_load_dwordx4 v3, s[8:11], s32 offen lds
    s_add_u32 m0, s41, 32768
    s_nop 0
    buffer_load_dwordx4 v10, s[12:15], s33 offen lds
    s_add_u32 m0, s41, 33792
    s_nop 0
    buffer_load_dwordx4 v11, s[12:15], s33 offen lds
    s_add_u32 m0, s41, 34816
    s_nop 0
    buffer_load_dwordx4 v12, s[12:15], s33 offen lds
    s_add_u32 m0, s41, 35840
    s_nop 0
    buffer_load_dwordx4 v13, s[12:15], s33 offen lds
    s_branch L_gw3_0_kernel_join6
L_gw3_0_kernel_tail5:
    s_waitcnt vmcnt(0)
    s_barrier
L_gw3_0_kernel_join6:
    ds_read_b128 v[124:127], v21 offset:32768
    ds_read_b64_tr_b16 v[128:129], v28 offset:8192
    ds_read_b64_tr_b16 v[130:131], v28 offset:10240
    ds_read_b64_tr_b16 v[132:133], v29 offset:8192
    ds_read_b64_tr_b16 v[134:135], v29 offset:10240
    ds_read_b64_tr_b16 v[136:137], v30 offset:8192
    ds_read_b64_tr_b16 v[138:139], v30 offset:10240
    ds_read_b64_tr_b16 v[140:141], v31 offset:8192
    ds_read_b64_tr_b16 v[142:143], v31 offset:10240
    s_waitcnt lgkmcnt(9)
    v_mfma_f32_32x32x16_bf16 v[40:55], v[108:111], v[104:107], v[40:55]
    v_mfma_f32_32x32x16_bf16 v[56:71], v[112:115], v[104:107], v[56:71]
    v_mfma_f32_32x32x16_bf16 v[72:87], v[116:119], v[104:107], v[72:87]
    v_mfma_f32_32x32x16_bf16 v[88:103], v[120:123], v[104:107], v[88:103]
    ds_read_b128 v[104:107], v22 offset:32768
    ds_read_b64_tr_b16 v[108:109], v28 offset:16384
    ds_read_b64_tr_b16 v[110:111], v28 offset:18432
    ds_read_b64_tr_b16 v[112:113], v29 offset:16384
    ds_read_b64_tr_b16 v[114:115], v29 offset:18432
    ds_read_b64_tr_b16 v[116:117], v30 offset:16384
    ds_read_b64_tr_b16 v[118:119], v30 offset:18432
    ds_read_b64_tr_b16 v[120:121], v31 offset:16384
    ds_read_b64_tr_b16 v[122:123], v31 offset:18432
    s_waitcnt lgkmcnt(9)
    v_mfma_f32_32x32x16_bf16 v[40:55], v[128:131], v[124:127], v[40:55]
    v_mfma_f32_32x32x16_bf16 v[56:71], v[132:135], v[124:127], v[56:71]
    v_mfma_f32_32x32x16_bf16 v[72:87], v[136:139], v[124:127], v[72:87]
    v_mfma_f32_32x32x16_bf16 v[88:103], v[140:143], v[124:127], v[88:103]
    ds_read_b128 v[124:127], v23 offset:32768
    ds_read_b64_tr_b16 v[128:129], v28 offset:24576
    ds_read_b64_tr_b16 v[130:131], v28 offset:26624
    ds_read_b64_tr_b16 v[132:133], v29 offset:24576
    ds_read_b64_tr_b16 v[134:135], v29 offset:26624
    ds_read_b64_tr_b16 v[136:137], v30 offset:24576
    ds_read_b64_tr_b16 v[138:139], v30 offset:26624
    ds_read_b64_tr_b16 v[140:141], v31 offset:24576
    ds_read_b64_tr_b16 v[142:143], v31 offset:26624
    s_waitcnt lgkmcnt(9)
    v_mfma_f32_32x32x16_bf16 v[40:55], v[108:111], v[104:107], v[40:55]
    v_mfma_f32_32x32x16_bf16 v[56:71], v[112:115], v[104:107], v[56:71]
    v_mfma_f32_32x32x16_bf16 v[72:87], v[116:119], v[104:107], v[72:87]
    v_mfma_f32_32x32x16_bf16 v[88:103], v[120:123], v[104:107], v[88:103]
    ds_read_b128 v[104:107], v20 offset:0
    ds_read_b64_tr_b16 v[108:109], v24 offset:0
    ds_read_b64_tr_b16 v[110:111], v24 offset:2048
    ds_read_b64_tr_b16 v[112:113], v25 offset:0
    ds_read_b64_tr_b16 v[114:115], v25 offset:2048
    ds_read_b64_tr_b16 v[116:117], v26 offset:0
    ds_read_b64_tr_b16 v[118:119], v26 offset:2048
    ds_read_b64_tr_b16 v[120:121], v27 offset:0
    ds_read_b64_tr_b16 v[122:123], v27 offset:2048
    s_waitcnt lgkmcnt(9)
    v_mfma_f32_32x32x16_bf16 v[40:55], v[128:131], v[124:127], v[40:55]
    v_mfma_f32_32x32x16_bf16 v[56:71], v[132:135], v[124:127], v[56:71]
    v_mfma_f32_32x32x16_bf16 v[72:87], v[136:139], v[124:127], v[72:87]
    v_mfma_f32_32x32x16_bf16 v[88:103], v[140:143], v[124:127], v[88:103]
    s_add_u32 s31, s31, 3
    s_cmp_lt_u32 s31, 16
    s_cbranch_scc1 L_loop_gw3_0_kernel
L_lend_gw3_0_kernel:
    s_nop 15
    s_nop 7
    s_lshr_b32 s31, s30, 1
    s_and_b32 s34, s30, 1
    s_mul_i32 s38, s31, 32
    s_mul_i32 s39, s34, 128
    s_lshl_b32 s31, s28, 7
    s_add_u32 s38, s38, s31
    s_mul_i32 s31, s29, 256
    s_add_u32 s39, s39, s31
    s_barrier
    s_mul_i32 s32, s30, 8704
    v_and_b32 v1, 31, v0
    v_mul_u32_u24 v1, 272, v1
    v_lshrrev_b32 v2, 5, v0
    v_lshlrev_b32 v2, 3, v2
    v_add_u32 v1, v1, v2
    v_add_u32 v1, s32, v1
    v_cvt_pk_bf16_f32 v40, v40, v40
    v_lshlrev_b32 v40, 16, v40
    v_cvt_pk_bf16_f32 v41, v41, v41
    v_lshlrev_b32 v41, 16, v41
    v_cvt_pk_bf16_f32 v42, v42, v42
    v_lshlrev_b32 v42, 16, v42
    v_cvt_pk_bf16_f32 v43, v43, v43
    v_lshlrev_b32 v43, 16, v43
    v_mul_f32 v148, v40, v40
    v_fma_f32 v148, v148, s36, 1.0
    v_mul_f32 v148, v148, v40
    v_mul_f32 v148, s37, v148
    v_exp_f32 v148, v148
    s_nop 0
    v_add_f32 v148, 1.0, v148
    v_rcp_f32 v148, v148
    s_nop 0
    v_mul_f32 v40, v40, v148
    v_mul_f32 v148, v41, v41
    v_fma_f32 v148, v148, s36, 1.0
    v_mul_f32 v148, v148, v41
    v_mul_f32 v148, s37, v148
    v_exp_f32 v148, v148
    s_nop 0
    v_add_f32 v148, 1.0, v148
    v_rcp_f32 v148, v148
    s_nop 0
    v_mul_f32 v41, v41, v148
    v_mul_f32 v148, v42, v42
    v_fma_f32 v148, v148, s36, 1.0
    v_mul_f32 v148, v148, v42
    v_mul_f32 v148, s37, v148
    v_exp_f32 v148, v148
    s_nop 0
    v_add_f32 v148, 1.0, v148
    v_rcp_f32 v148, v148
    s_nop 0
    v_mul_f32 v42, v42, v148
    v_mul_f32 v148, v43, v43
    v_fma_f32 v148, v148, s36, 1.0
    v_mul_f32 v148, v148, v43
    v_mul_f32 v148, s37, v148
    v_exp_f32 v148, v148
    s_nop 0
    v_add_f32 v148, 1.0, v148
    v_rcp_f32 v148, v148
    s_nop 0
    v_mul_f32 v43, v43, v148
    v_cvt_pk_bf16_f32 v40, v40, v41
    v_cvt_pk_bf16_f32 v41, v42, v43
    ds_write_b64 v1, v[40:41] offset:0
    v_cvt_pk_bf16_f32 v44, v44, v44
    v_lshlrev_b32 v44, 16, v44
    v_cvt_pk_bf16_f32 v45, v45, v45
    v_lshlrev_b32 v45, 16, v45
    v_cvt_pk_bf16_f32 v46, v46, v46
    v_lshlrev_b32 v46, 16, v46
    v_cvt_pk_bf16_f32 v47, v47, v47
    v_lshlrev_b32 v47, 16, v47
    v_mul_f32 v148, v44, v44
    v_fma_f32 v148, v148, s36, 1.0
    v_mul_f32 v148, v148, v44
    v_mul_f32 v148, s37, v148
    v_exp_f32 v148, v148
    s_nop 0
    v_add_f32 v148, 1.0, v148
    v_rcp_f32 v148, v148
    s_nop 0
    v_mul_f32 v44, v44, v148
    v_mul_f32 v148, v45, v45
    v_fma_f32 v148, v148, s36, 1.0
    v_mul_f32 v148, v148, v45
    v_mul_f32 v148, s37, v148
    v_exp_f32 v148, v148
    s_nop 0
    v_add_f32 v148, 1.0, v148
    v_rcp_f32 v148, v148
    s_nop 0
    v_mul_f32 v45, v45, v148
    v_mul_f32 v148, v46, v46
    v_fma_f32 v148, v148, s36, 1.0
    v_mul_f32 v148, v148, v46
    v_mul_f32 v148, s37, v148
    v_exp_f32 v148, v148
    s_nop 0
    v_add_f32 v148, 1.0, v148
    v_rcp_f32 v148, v148
    s_nop 0
    v_mul_f32 v46, v46, v148
    v_mul_f32 v148, v47, v47
    v_fma_f32 v148, v148, s36, 1.0
    v_mul_f32 v148, v148, v47
    v_mul_f32 v148, s37, v148
    v_exp_f32 v148, v148
    s_nop 0
    v_add_f32 v148, 1.0, v148
    v_rcp_f32 v148, v148
    s_nop 0
    v_mul_f32 v47, v47, v148
    v_cvt_pk_bf16_f32 v44, v44, v45
    v_cvt_pk_bf16_f32 v45, v46, v47
    ds_write_b64 v1, v[44:45] offset:16
    v_cvt_pk_bf16_f32 v48, v48, v48
    v_lshlrev_b32 v48, 16, v48
    v_cvt_pk_bf16_f32 v49, v49, v49
    v_lshlrev_b32 v49, 16, v49
    v_cvt_pk_bf16_f32 v50, v50, v50
    v_lshlrev_b32 v50, 16, v50
    v_cvt_pk_bf16_f32 v51, v51, v51
    v_lshlrev_b32 v51, 16, v51
    v_mul_f32 v148, v48, v48
    v_fma_f32 v148, v148, s36, 1.0
    v_mul_f32 v148, v148, v48
    v_mul_f32 v148, s37, v148
    v_exp_f32 v148, v148
    s_nop 0
    v_add_f32 v148, 1.0, v148
    v_rcp_f32 v148, v148
    s_nop 0
    v_mul_f32 v48, v48, v148
    v_mul_f32 v148, v49, v49
    v_fma_f32 v148, v148, s36, 1.0
    v_mul_f32 v148, v148, v49
    v_mul_f32 v148, s37, v148
    v_exp_f32 v148, v148
    s_nop 0
    v_add_f32 v148, 1.0, v148
    v_rcp_f32 v148, v148
    s_nop 0
    v_mul_f32 v49, v49, v148
    v_mul_f32 v148, v50, v50
    v_fma_f32 v148, v148, s36, 1.0
    v_mul_f32 v148, v148, v50
    v_mul_f32 v148, s37, v148
    v_exp_f32 v148, v148
    s_nop 0
    v_add_f32 v148, 1.0, v148
    v_rcp_f32 v148, v148
    s_nop 0
    v_mul_f32 v50, v50, v148
    v_mul_f32 v148, v51, v51
    v_fma_f32 v148, v148, s36, 1.0
    v_mul_f32 v148, v148, v51
    v_mul_f32 v148, s37, v148
    v_exp_f32 v148, v148
    s_nop 0
    v_add_f32 v148, 1.0, v148
    v_rcp_f32 v148, v148
    s_nop 0
    v_mul_f32 v51, v51, v148
    v_cvt_pk_bf16_f32 v48, v48, v49
    v_cvt_pk_bf16_f32 v49, v50, v51
    ds_write_b64 v1, v[48:49] offset:32
    v_cvt_pk_bf16_f32 v52, v52, v52
    v_lshlrev_b32 v52, 16, v52
    v_cvt_pk_bf16_f32 v53, v53, v53
    v_lshlrev_b32 v53, 16, v53
    v_cvt_pk_bf16_f32 v54, v54, v54
    v_lshlrev_b32 v54, 16, v54
    v_cvt_pk_bf16_f32 v55, v55, v55
    v_lshlrev_b32 v55, 16, v55
    v_mul_f32 v148, v52, v52
    v_fma_f32 v148, v148, s36, 1.0
    v_mul_f32 v148, v148, v52
    v_mul_f32 v148, s37, v148
    v_exp_f32 v148, v148
    s_nop 0
    v_add_f32 v148, 1.0, v148
    v_rcp_f32 v148, v148
    s_nop 0
    v_mul_f32 v52, v52, v148
    v_mul_f32 v148, v53, v53
    v_fma_f32 v148, v148, s36, 1.0
    v_mul_f32 v148, v148, v53
    v_mul_f32 v148, s37, v148
    v_exp_f32 v148, v148
    s_nop 0
    v_add_f32 v148, 1.0, v148
    v_rcp_f32 v148, v148
    s_nop 0
    v_mul_f32 v53, v53, v148
    v_mul_f32 v148, v54, v54
    v_fma_f32 v148, v148, s36, 1.0
    v_mul_f32 v148, v148, v54
    v_mul_f32 v148, s37, v148
    v_exp_f32 v148, v148
    s_nop 0
    v_add_f32 v148, 1.0, v148
    v_rcp_f32 v148, v148
    s_nop 0
    v_mul_f32 v54, v54, v148
    v_mul_f32 v148, v55, v55
    v_fma_f32 v148, v148, s36, 1.0
    v_mul_f32 v148, v148, v55
    v_mul_f32 v148, s37, v148
    v_exp_f32 v148, v148
    s_nop 0
    v_add_f32 v148, 1.0, v148
    v_rcp_f32 v148, v148
    s_nop 0
    v_mul_f32 v55, v55, v148
    v_cvt_pk_bf16_f32 v52, v52, v53
    v_cvt_pk_bf16_f32 v53, v54, v55
    ds_write_b64 v1, v[52:53] offset:48
    v_cvt_pk_bf16_f32 v56, v56, v56
    v_lshlrev_b32 v56, 16, v56
    v_cvt_pk_bf16_f32 v57, v57, v57
    v_lshlrev_b32 v57, 16, v57
    v_cvt_pk_bf16_f32 v58, v58, v58
    v_lshlrev_b32 v58, 16, v58
    v_cvt_pk_bf16_f32 v59, v59, v59
    v_lshlrev_b32 v59, 16, v59
    v_mul_f32 v148, v56, v56
    v_fma_f32 v148, v148, s36, 1.0
    v_mul_f32 v148, v148, v56
    v_mul_f32 v148, s37, v148
    v_exp_f32 v148, v148
    s_nop 0
    v_add_f32 v148, 1.0, v148
    v_rcp_f32 v148, v148
    s_nop 0
    v_mul_f32 v56, v56, v148
    v_mul_f32 v148, v57, v57
    v_fma_f32 v148, v148, s36, 1.0
    v_mul_f32 v148, v148, v57
    v_mul_f32 v148, s37, v148
    v_exp_f32 v148, v148
    s_nop 0
    v_add_f32 v148, 1.0, v148
    v_rcp_f32 v148, v148
    s_nop 0
    v_mul_f32 v57, v57, v148
    v_mul_f32 v148, v58, v58
    v_fma_f32 v148, v148, s36, 1.0
    v_mul_f32 v148, v148, v58
    v_mul_f32 v148, s37, v148
    v_exp_f32 v148, v148
    s_nop 0
    v_add_f32 v148, 1.0, v148
    v_rcp_f32 v148, v148
    s_nop 0
    v_mul_f32 v58, v58, v148
    v_mul_f32 v148, v59, v59
    v_fma_f32 v148, v148, s36, 1.0
    v_mul_f32 v148, v148, v59
    v_mul_f32 v148, s37, v148
    v_exp_f32 v148, v148
    s_nop 0
    v_add_f32 v148, 1.0, v148
    v_rcp_f32 v148, v148
    s_nop 0
    v_mul_f32 v59, v59, v148
    v_cvt_pk_bf16_f32 v56, v56, v57
    v_cvt_pk_bf16_f32 v57, v58, v59
    ds_write_b64 v1, v[56:57] offset:64
    v_cvt_pk_bf16_f32 v60, v60, v60
    v_lshlrev_b32 v60, 16, v60
    v_cvt_pk_bf16_f32 v61, v61, v61
    v_lshlrev_b32 v61, 16, v61
    v_cvt_pk_bf16_f32 v62, v62, v62
    v_lshlrev_b32 v62, 16, v62
    v_cvt_pk_bf16_f32 v63, v63, v63
    v_lshlrev_b32 v63, 16, v63
    v_mul_f32 v148, v60, v60
    v_fma_f32 v148, v148, s36, 1.0
    v_mul_f32 v148, v148, v60
    v_mul_f32 v148, s37, v148
    v_exp_f32 v148, v148
    s_nop 0
    v_add_f32 v148, 1.0, v148
    v_rcp_f32 v148, v148
    s_nop 0
    v_mul_f32 v60, v60, v148
    v_mul_f32 v148, v61, v61
    v_fma_f32 v148, v148, s36, 1.0
    v_mul_f32 v148, v148, v61
    v_mul_f32 v148, s37, v148
    v_exp_f32 v148, v148
    s_nop 0
    v_add_f32 v148, 1.0, v148
    v_rcp_f32 v148, v148
    s_nop 0
    v_mul_f32 v61, v61, v148
    v_mul_f32 v148, v62, v62
    v_fma_f32 v148, v148, s36, 1.0
    v_mul_f32 v148, v148, v62
    v_mul_f32 v148, s37, v148
    v_exp_f32 v148, v148
    s_nop 0
    v_add_f32 v148, 1.0, v148
    v_rcp_f32 v148, v148
    s_nop 0
    v_mul_f32 v62, v62, v148
    v_mul_f32 v148, v63, v63
    v_fma_f32 v148, v148, s36, 1.0
    v_mul_f32 v148, v148, v63
    v_mul_f32 v148, s37, v148
    v_exp_f32 v148, v148
    s_nop 0
    v_add_f32 v148, 1.0, v148
    v_rcp_f32 v148, v148
    s_nop 0
    v_mul_f32 v63, v63, v148
    v_cvt_pk_bf16_f32 v60, v60, v61
    v_cvt_pk_bf16_f32 v61, v62, v63
    ds_write_b64 v1, v[60:61] offset:80
    v_cvt_pk_bf16_f32 v64, v64, v64
    v_lshlrev_b32 v64, 16, v64
    v_cvt_pk_bf16_f32 v65, v65, v65
    v_lshlrev_b32 v65, 16, v65
    v_cvt_pk_bf16_f32 v66, v66, v66
    v_lshlrev_b32 v66, 16, v66
    v_cvt_pk_bf16_f32 v67, v67, v67
    v_lshlrev_b32 v67, 16, v67
    v_mul_f32 v148, v64, v64
    v_fma_f32 v148, v148, s36, 1.0
    v_mul_f32 v148, v148, v64
    v_mul_f32 v148, s37, v148
    v_exp_f32 v148, v148
    s_nop 0
    v_add_f32 v148, 1.0, v148
    v_rcp_f32 v148, v148
    s_nop 0
    v_mul_f32 v64, v64, v148
    v_mul_f32 v148, v65, v65
    v_fma_f32 v148, v148, s36, 1.0
    v_mul_f32 v148, v148, v65
    v_mul_f32 v148, s37, v148
    v_exp_f32 v148, v148
    s_nop 0
    v_add_f32 v148, 1.0, v148
    v_rcp_f32 v148, v148
    s_nop 0
    v_mul_f32 v65, v65, v148
    v_mul_f32 v148, v66, v66
    v_fma_f32 v148, v148, s36, 1.0
    v_mul_f32 v148, v148, v66
    v_mul_f32 v148, s37, v148
    v_exp_f32 v148, v148
    s_nop 0
    v_add_f32 v148, 1.0, v148
    v_rcp_f32 v148, v148
    s_nop 0
    v_mul_f32 v66, v66, v148
    v_mul_f32 v148, v67, v67
    v_fma_f32 v148, v148, s36, 1.0
    v_mul_f32 v148, v148, v67
    v_mul_f32 v148, s37, v148
    v_exp_f32 v148, v148
    s_nop 0
    v_add_f32 v148, 1.0, v148
    v_rcp_f32 v148, v148
    s_nop 0
    v_mul_f32 v67, v67, v148
    v_cvt_pk_bf16_f32 v64, v64, v65
    v_cvt_pk_bf16_f32 v65, v66, v67
    ds_write_b64 v1, v[64:65] offset:96
    v_cvt_pk_bf16_f32 v68, v68, v68
    v_lshlrev_b32 v68, 16, v68
    v_cvt_pk_bf16_f32 v69, v69, v69
    v_lshlrev_b32 v69, 16, v69
    v_cvt_pk_bf16_f32 v70, v70, v70
    v_lshlrev_b32 v70, 16, v70
    v_cvt_pk_bf16_f32 v71, v71, v71
    v_lshlrev_b32 v71, 16, v71
    v_mul_f32 v148, v68, v68
    v_fma_f32 v148, v148, s36, 1.0
    v_mul_f32 v148, v148, v68
    v_mul_f32 v148, s37, v148
    v_exp_f32 v148, v148
    s_nop 0
    v_add_f32 v148, 1.0, v148
    v_rcp_f32 v148, v148
    s_nop 0
    v_mul_f32 v68, v68, v148
    v_mul_f32 v148, v69, v69
    v_fma_f32 v148, v148, s36, 1.0
    v_mul_f32 v148, v148, v69
    v_mul_f32 v148, s37, v148
    v_exp_f32 v148, v148
    s_nop 0
    v_add_f32 v148, 1.0, v148
    v_rcp_f32 v148, v148
    s_nop 0
    v_mul_f32 v69, v69, v148
    v_mul_f32 v148, v70, v70
    v_fma_f32 v148, v148, s36, 1.0
    v_mul_f32 v148, v148, v70
    v_mul_f32 v148, s37, v148
    v_exp_f32 v148, v148
    s_nop 0
    v_add_f32 v148, 1.0, v148
    v_rcp_f32 v148, v148
    s_nop 0
    v_mul_f32 v70, v70, v148
    v_mul_f32 v148, v71, v71
    v_fma_f32 v148, v148, s36, 1.0
    v_mul_f32 v148, v148, v71
    v_mul_f32 v148, s37, v148
    v_exp_f32 v148, v148
    s_nop 0
    v_add_f32 v148, 1.0, v148
    v_rcp_f32 v148, v148
    s_nop 0
    v_mul_f32 v71, v71, v148
    v_cvt_pk_bf16_f32 v68, v68, v69
    v_cvt_pk_bf16_f32 v69, v70, v71
    ds_write_b64 v1, v[68:69] offset:112
    v_cvt_pk_bf16_f32 v72, v72, v72
    v_lshlrev_b32 v72, 16, v72
    v_cvt_pk_bf16_f32 v73, v73, v73
    v_lshlrev_b32 v73, 16, v73
    v_cvt_pk_bf16_f32 v74, v74, v74
    v_lshlrev_b32 v74, 16, v74
    v_cvt_pk_bf16_f32 v75, v75, v75
    v_lshlrev_b32 v75, 16, v75
    v_mul_f32 v148, v72, v72
    v_fma_f32 v148, v148, s36, 1.0
    v_mul_f32 v148, v148, v72
    v_mul_f32 v148, s37, v148
    v_exp_f32 v148, v148
    s_nop 0
    v_add_f32 v148, 1.0, v148
    v_rcp_f32 v148, v148
    s_nop 0
    v_mul_f32 v72, v72, v148
    v_mul_f32 v148, v73, v73
    v_fma_f32 v148, v148, s36, 1.0
    v_mul_f32 v148, v148, v73
    v_mul_f32 v148, s37, v148
    v_exp_f32 v148, v148
    s_nop 0
    v_add_f32 v148, 1.0, v148
    v_rcp_f32 v148, v148
    s_nop 0
    v_mul_f32 v73, v73, v148
    v_mul_f32 v148, v74, v74
    v_fma_f32 v148, v148, s36, 1.0
    v_mul_f32 v148, v148, v74
    v_mul_f32 v148, s37, v148
    v_exp_f32 v148, v148
    s_nop 0
    v_add_f32 v148, 1.0, v148
    v_rcp_f32 v148, v148
    s_nop 0
    v_mul_f32 v74, v74, v148
    v_mul_f32 v148, v75, v75
    v_fma_f32 v148, v148, s36, 1.0
    v_mul_f32 v148, v148, v75
    v_mul_f32 v148, s37, v148
    v_exp_f32 v148, v148
    s_nop 0
    v_add_f32 v148, 1.0, v148
    v_rcp_f32 v148, v148
    s_nop 0
    v_mul_f32 v75, v75, v148
    v_cvt_pk_bf16_f32 v72, v72, v73
    v_cvt_pk_bf16_f32 v73, v74, v75
    ds_write_b64 v1, v[72:73] offset:128
    v_cvt_pk_bf16_f32 v76, v76, v76
    v_lshlrev_b32 v76, 16, v76
    v_cvt_pk_bf16_f32 v77, v77, v77
    v_lshlrev_b32 v77, 16, v77
    v_cvt_pk_bf16_f32 v78, v78, v78
    v_lshlrev_b32 v78, 16, v78
    v_cvt_pk_bf16_f32 v79, v79, v79
    v_lshlrev_b32 v79, 16, v79
    v_mul_f32 v148, v76, v76
    v_fma_f32 v148, v148, s36, 1.0
    v_mul_f32 v148, v148, v76
    v_mul_f32 v148, s37, v148
    v_exp_f32 v148, v148
    s_nop 0
    v_add_f32 v148, 1.0, v148
    v_rcp_f32 v148, v148
    s_nop 0
    v_mul_f32 v76, v76, v148
    v_mul_f32 v148, v77, v77
    v_fma_f32 v148, v148, s36, 1.0
    v_mul_f32 v148, v148, v77
    v_mul_f32 v148, s37, v148
    v_exp_f32 v148, v148
    s_nop 0
    v_add_f32 v148, 1.0, v148
    v_rcp_f32 v148, v148
    s_nop 0
    v_mul_f32 v77, v77, v148
    v_mul_f32 v148, v78, v78
    v_fma_f32 v148, v148, s36, 1.0
    v_mul_f32 v148, v148, v78
    v_mul_f32 v148, s37, v148
    v_exp_f32 v148, v148
    s_nop 0
    v_add_f32 v148, 1.0, v148
    v_rcp_f32 v148, v148
    s_nop 0
    v_mul_f32 v78, v78, v148
    v_mul_f32 v148, v79, v79
    v_fma_f32 v148, v148, s36, 1.0
    v_mul_f32 v148, v148, v79
    v_mul_f32 v148, s37, v148
    v_exp_f32 v148, v148
    s_nop 0
    v_add_f32 v148, 1.0, v148
    v_rcp_f32 v148, v148
    s_nop 0
    v_mul_f32 v79, v79, v148
    v_cvt_pk_bf16_f32 v76, v76, v77
    v_cvt_pk_bf16_f32 v77, v78, v79
    ds_write_b64 v1, v[76:77] offset:144
    v_cvt_pk_bf16_f32 v80, v80, v80
    v_lshlrev_b32 v80, 16, v80
    v_cvt_pk_bf16_f32 v81, v81, v81
    v_lshlrev_b32 v81, 16, v81
    v_cvt_pk_bf16_f32 v82, v82, v82
    v_lshlrev_b32 v82, 16, v82
    v_cvt_pk_bf16_f32 v83, v83, v83
    v_lshlrev_b32 v83, 16, v83
    v_mul_f32 v148, v80, v80
    v_fma_f32 v148, v148, s36, 1.0
    v_mul_f32 v148, v148, v80
    v_mul_f32 v148, s37, v148
    v_exp_f32 v148, v148
    s_nop 0
    v_add_f32 v148, 1.0, v148
    v_rcp_f32 v148, v148
    s_nop 0
    v_mul_f32 v80, v80, v148
    v_mul_f32 v148, v81, v81
    v_fma_f32 v148, v148, s36, 1.0
    v_mul_f32 v148, v148, v81
    v_mul_f32 v148, s37, v148
    v_exp_f32 v148, v148
    s_nop 0
    v_add_f32 v148, 1.0, v148
    v_rcp_f32 v148, v148
    s_nop 0
    v_mul_f32 v81, v81, v148
    v_mul_f32 v148, v82, v82
    v_fma_f32 v148, v148, s36, 1.0
    v_mul_f32 v148, v148, v82
    v_mul_f32 v148, s37, v148
    v_exp_f32 v148, v148
    s_nop 0
    v_add_f32 v148, 1.0, v148
    v_rcp_f32 v148, v148
    s_nop 0
    v_mul_f32 v82, v82, v148
    v_mul_f32 v148, v83, v83
    v_fma_f32 v148, v148, s36, 1.0
    v_mul_f32 v148, v148, v83
    v_mul_f32 v148, s37, v148
    v_exp_f32 v148, v148
    s_nop 0
    v_add_f32 v148, 1.0, v148
    v_rcp_f32 v148, v148
    s_nop 0
    v_mul_f32 v83, v83, v148
    v_cvt_pk_bf16_f32 v80, v80, v81
    v_cvt_pk_bf16_f32 v81, v82, v83
    ds_write_b64 v1, v[80:81] offset:160
    v_cvt_pk_bf16_f32 v84, v84, v84
    v_lshlrev_b32 v84, 16, v84
    v_cvt_pk_bf16_f32 v85, v85, v85
    v_lshlrev_b32 v85, 16, v85
    v_cvt_pk_bf16_f32 v86, v86, v86
    v_lshlrev_b32 v86, 16, v86
    v_cvt_pk_bf16_f32 v87, v87, v87
    v_lshlrev_b32 v87, 16, v87
    v_mul_f32 v148, v84, v84
    v_fma_f32 v148, v148, s36, 1.0
    v_mul_f32 v148, v148, v84
    v_mul_f32 v148, s37, v148
    v_exp_f32 v148, v148
    s_nop 0
    v_add_f32 v148, 1.0, v148
    v_rcp_f32 v148, v148
    s_nop 0
    v_mul_f32 v84, v84, v148
    v_mul_f32 v148, v85, v85
    v_fma_f32 v148, v148, s36, 1.0
    v_mul_f32 v148, v148, v85
    v_mul_f32 v148, s37, v148
    v_exp_f32 v148, v148
    s_nop 0
    v_add_f32 v148, 1.0, v148
    v_rcp_f32 v148, v148
    s_nop 0
    v_mul_f32 v85, v85, v148
    v_mul_f32 v148, v86, v86
    v_fma_f32 v148, v148, s36, 1.0
    v_mul_f32 v148, v148, v86
    v_mul_f32 v148, s37, v148
    v_exp_f32 v148, v148
    s_nop 0
    v_add_f32 v148, 1.0, v148
    v_rcp_f32 v148, v148
    s_nop 0
    v_mul_f32 v86, v86, v148
    v_mul_f32 v148, v87, v87
    v_fma_f32 v148, v148, s36, 1.0
    v_mul_f32 v148, v148, v87
    v_mul_f32 v148, s37, v148
    v_exp_f32 v148, v148
    s_nop 0
    v_add_f32 v148, 1.0, v148
    v_rcp_f32 v148, v148
    s_nop 0
    v_mul_f32 v87, v87, v148
    v_cvt_pk_bf16_f32 v84, v84, v85
    v_cvt_pk_bf16_f32 v85, v86, v87
    ds_write_b64 v1, v[84:85] offset:176
    v_cvt_pk_bf16_f32 v88, v88, v88
    v_lshlrev_b32 v88, 16, v88
    v_cvt_pk_bf16_f32 v89, v89, v89
    v_lshlrev_b32 v89, 16, v89
    v_cvt_pk_bf16_f32 v90, v90, v90
    v_lshlrev_b32 v90, 16, v90
    v_cvt_pk_bf16_f32 v91, v91, v91
    v_lshlrev_b32 v91, 16, v91
    v_mul_f32 v148, v88, v88
    v_fma_f32 v148, v148, s36, 1.0
    v_mul_f32 v148, v148, v88
    v_mul_f32 v148, s37, v148
    v_exp_f32 v148, v148
    s_nop 0
    v_add_f32 v148, 1.0, v148
    v_rcp_f32 v148, v148
    s_nop 0
    v_mul_f32 v88, v88, v148
    v_mul_f32 v148, v89, v89
    v_fma_f32 v148, v148, s36, 1.0
    v_mul_f32 v148, v148, v89
    v_mul_f32 v148, s37, v148
    v_exp_f32 v148, v148
    s_nop 0
    v_add_f32 v148, 1.0, v148
    v_rcp_f32 v148, v148
    s_nop 0
    v_mul_f32 v89, v89, v148
    v_mul_f32 v148, v90, v90
    v_fma_f32 v148, v148, s36, 1.0
    v_mul_f32 v148, v148, v90
    v_mul_f32 v148, s37, v148
    v_exp_f32 v148, v148
    s_nop 0
    v_add_f32 v148, 1.0, v148
    v_rcp_f32 v148, v148
    s_nop 0
    v_mul_f32 v90, v90, v148
    v_mul_f32 v148, v91, v91
    v_fma_f32 v148, v148, s36, 1.0
    v_mul_f32 v148, v148, v91
    v_mul_f32 v148, s37, v148
    v_exp_f32 v148, v148
    s_nop 0
    v_add_f32 v148, 1.0, v148
    v_rcp_f32 v148, v148
    s_nop 0
    v_mul_f32 v91, v91, v148
    v_cvt_pk_bf16_f32 v88, v88, v89
    v_cvt_pk_bf16_f32 v89, v90, v91
    ds_write_b64 v1, v[88:89] offset:192
    v_cvt_pk_bf16_f32 v92, v92, v92
    v_lshlrev_b32 v92, 16, v92
    v_cvt_pk_bf16_f32 v93, v93, v93
    v_lshlrev_b32 v93, 16, v93
    v_cvt_pk_bf16_f32 v94, v94, v94
    v_lshlrev_b32 v94, 16, v94
    v_cvt_pk_bf16_f32 v95, v95, v95
    v_lshlrev_b32 v95, 16, v95
    v_mul_f32 v148, v92, v92
    v_fma_f32 v148, v148, s36, 1.0
    v_mul_f32 v148, v148, v92
    v_mul_f32 v148, s37, v148
    v_exp_f32 v148, v148
    s_nop 0
    v_add_f32 v148, 1.0, v148
    v_rcp_f32 v148, v148
    s_nop 0
    v_mul_f32 v92, v92, v148
    v_mul_f32 v148, v93, v93
    v_fma_f32 v148, v148, s36, 1.0
    v_mul_f32 v148, v148, v93
    v_mul_f32 v148, s37, v148
    v_exp_f32 v148, v148
    s_nop 0
    v_add_f32 v148, 1.0, v148
    v_rcp_f32 v148, v148
    s_nop 0
    v_mul_f32 v93, v93, v148
    v_mul_f32 v148, v94, v94
    v_fma_f32 v148, v148, s36, 1.0
    v_mul_f32 v148, v148, v94
    v_mul_f32 v148, s37, v148
    v_exp_f32 v148, v148
    s_nop 0
    v_add_f32 v148, 1.0, v148
    v_rcp_f32 v148, v148
    s_nop 0
    v_mul_f32 v94, v94, v148
    v_mul_f32 v148, v95, v95
    v_fma_f32 v148, v148, s36, 1.0
    v_mul_f32 v148, v148, v95
    v_mul_f32 v148, s37, v148
    v_exp_f32 v148, v148
    s_nop 0
    v_add_f32 v148, 1.0, v148
    v_rcp_f32 v148, v148
    s_nop 0
    v_mul_f32 v95, v95, v148
    v_cvt_pk_bf16_f32 v92, v92, v93
    v_cvt_pk_bf16_f32 v93, v94, v95
    ds_write_b64 v1, v[92:93] offset:208
    v_cvt_pk_bf16_f32 v96, v96, v96
    v_lshlrev_b32 v96, 16, v96
    v_cvt_pk_bf16_f32 v97, v97, v97
    v_lshlrev_b32 v97, 16, v97
    v_cvt_pk_bf16_f32 v98, v98, v98
    v_lshlrev_b32 v98, 16, v98
    v_cvt_pk_bf16_f32 v99, v99, v99
    v_lshlrev_b32 v99, 16, v99
    v_mul_f32 v148, v96, v96
    v_fma_f32 v148, v148, s36, 1.0
    v_mul_f32 v148, v148, v96
    v_mul_f32 v148, s37, v148
    v_exp_f32 v148, v148
    s_nop 0
    v_add_f32 v148, 1.0, v148
    v_rcp_f32 v148, v148
    s_nop 0
    v_mul_f32 v96, v96, v148
    v_mul_f32 v148, v97, v97
    v_fma_f32 v148, v148, s36, 1.0
    v_mul_f32 v148, v148, v97
    v_mul_f32 v148, s37, v148
    v_exp_f32 v148, v148
    s_nop 0
    v_add_f32 v148, 1.0, v148
    v_rcp_f32 v148, v148
    s_nop 0
    v_mul_f32 v97, v97, v148
    v_mul_f32 v148, v98, v98
    v_fma_f32 v148, v148, s36, 1.0
    v_mul_f32 v148, v148, v98
    v_mul_f32 v148, s37, v148
    v_exp_f32 v148, v148
    s_nop 0
    v_add_f32 v148, 1.0, v148
    v_rcp_f32 v148, v148
    s_nop 0
    v_mul_f32 v98, v98, v148
    v_mul_f32 v148, v99, v99
    v_fma_f32 v148, v148, s36, 1.0
    v_mul_f32 v148, v148, v99
    v_mul_f32 v148, s37, v148
    v_exp_f32 v148, v148
    s_nop 0
    v_add_f32 v148, 1.0, v148
    v_rcp_f32 v148, v148
    s_nop 0
    v_mul_f32 v99, v99, v148
    v_cvt_pk_bf16_f32 v96, v96, v97
    v_cvt_pk_bf16_f32 v97, v98, v99
    ds_write_b64 v1, v[96:97] offset:224
    v_cvt_pk_bf16_f32 v100, v100, v100
    v_lshlrev_b32 v100, 16, v100
    v_cvt_pk_bf16_f32 v101, v101, v101
    v_lshlrev_b32 v101, 16, v101
    v_cvt_pk_bf16_f32 v102, v102, v102
    v_lshlrev_b32 v102, 16, v102
    v_cvt_pk_bf16_f32 v103, v103, v103
    v_lshlrev_b32 v103, 16, v103
    v_mul_f32 v148, v100, v100
    v_fma_f32 v148, v148, s36, 1.0
    v_mul_f32 v148, v148, v100
    v_mul_f32 v148, s37, v148
    v_exp_f32 v148, v148
    s_nop 0
    v_add_f32 v148, 1.0, v148
    v_rcp_f32 v148, v148
    s_nop 0
    v_mul_f32 v100, v100, v148
    v_mul_f32 v148, v101, v101
    v_fma_f32 v148, v148, s36, 1.0
    v_mul_f32 v148, v148, v101
    v_mul_f32 v148, s37, v148
    v_exp_f32 v148, v148
    s_nop 0
    v_add_f32 v148, 1.0, v148
    v_rcp_f32 v148, v148
    s_nop 0
    v_mul_f32 v101, v101, v148
    v_mul_f32 v148, v102, v102
    v_fma_f32 v148, v148, s36, 1.0
    v_mul_f32 v148, v148, v102
    v_mul_f32 v148, s37, v148
    v_exp_f32 v148, v148
    s_nop 0
    v_add_f32 v148, 1.0, v148
    v_rcp_f32 v148, v148
    s_nop 0
    v_mul_f32 v102, v102, v148
    v_mul_f32 v148, v103, v103
    v_fma_f32 v148, v148, s36, 1.0
    v_mul_f32 v148, v148, v103
    v_mul_f32 v148, s37, v148
    v_exp_f32 v148, v148
    s_nop 0
    v_add_f32 v148, 1.0, v148
    v_rcp_f32 v148, v148
    s_nop 0
    v_mul_f32 v103, v103, v148
    v_cvt_pk_bf16_f32 v100, v100, v101
    v_cvt_pk_bf16_f32 v101, v102, v103
    ds_write_b64 v1, v[100:101] offset:240
    s_mov_b32 s35, 7168
    s_lshl_b32 s39, s39, 1
    v_add_u32 v2, 0, v0
    v_mul_u32_u24 v3, 4096, v2
    v_lshrrev_b32 v3, 16, v3
    v_mul_u32_u24 v4, 16, v3
    v_sub_u32 v4, v2, v4
    v_lshlrev_b32 v4, 4, v4
    v_mul_u32_u24 v5, 272, v3
    v_add_u32 v5, v5, v4
    v_add_u32 v8, s32, v5
    v_add_u32 v3, s38, v3
    v_mul_lo_u32 v3, v3, s35
    v_add_u32 v3, v3, v4
    v_add_u32 v16, s39, v3
    v_add_u32 v2, 64, v0
    v_mul_u32_u24 v3, 4096, v2
    v_lshrrev_b32 v3, 16, v3
    v_mul_u32_u24 v4, 16, v3
    v_sub_u32 v4, v2, v4
    v_lshlrev_b32 v4, 4, v4
    v_mul_u32_u24 v5, 272, v3
    v_add_u32 v5, v5, v4
    v_add_u32 v9, s32, v5
    v_add_u32 v3, s38, v3
    v_mul_lo_u32 v3, v3, s35
    v_add_u32 v3, v3, v4
    v_add_u32 v17, s39, v3
    v_add_u32 v2, 128, v0
    v_mul_u32_u24 v3, 4096, v2
    v_lshrrev_b32 v3, 16, v3
    v_mul_u32_u24 v4, 16, v3
    v_sub_u32 v4, v2, v4
    v_lshlrev_b32 v4, 4, v4
    v_mul_u32_u24 v5, 272, v3
    v_add_u32 v5, v5, v4
    v_add_u32 v10, s32, v5
    v_add_u32 v3, s38, v3
    v_mul_lo_u32 v3, v3, s35
    v_add_u32 v3, v3, v4
    v_add_u32 v18, s39, v3
    v_add_u32 v2, 192, v0
    v_mul_u32_u24 v3, 4096, v2
    v_lshrrev_b32 v3, 16, v3
    v_mul_u32_u24 v4, 16, v3
    v_sub_u32 v4, v2, v4
    v_lshlrev_b32 v4, 4, v4
    v_mul_u32_u24 v5, 272, v3
    v_add_u32 v5, v5, v4
    v_add_u32 v11, s32, v5
    v_add_u32 v3, s38, v3
    v_mul_lo_u32 v3, v3, s35
    v_add_u32 v3, v3, v4
    v_add_u32 v19, s39, v3
    v_add_u32 v2, 256, v0
    v_mul_u32_u24 v3, 4096, v2
    v_lshrrev_b32 v3, 16, v3
    v_mul_u32_u24 v4, 16, v3
    v_sub_u32 v4, v2, v4
    v_lshlrev_b32 v4, 4, v4
    v_mul_u32_u24 v5, 272, v3
    v_add_u32 v5, v5, v4
    v_add_u32 v12, s32, v5
    v_add_u32 v3, s38, v3
    v_mul_lo_u32 v3, v3, s35
    v_add_u32 v3, v3, v4
    v_add_u32 v20, s39, v3
    v_add_u32 v2, 320, v0
    v_mul_u32_u24 v3, 4096, v2
    v_lshrrev_b32 v3, 16, v3
    v_mul_u32_u24 v4, 16, v3
    v_sub_u32 v4, v2, v4
    v_lshlrev_b32 v4, 4, v4
    v_mul_u32_u24 v5, 272, v3
    v_add_u32 v5, v5, v4
    v_add_u32 v13, s32, v5
    v_add_u32 v3, s38, v3
    v_mul_lo_u32 v3, v3, s35
    v_add_u32 v3, v3, v4
    v_add_u32 v21, s39, v3
    v_add_u32 v2, 384, v0
    v_mul_u32_u24 v3, 4096, v2
    v_lshrrev_b32 v3, 16, v3
    v_mul_u32_u24 v4, 16, v3
    v_sub_u32 v4, v2, v4
    v_lshlrev_b32 v4, 4, v4
    v_mul_u32_u24 v5, 272, v3
    v_add_u32 v5, v5, v4
    v_add_u32 v14, s32, v5
    v_add_u32 v3, s38, v3
    v_mul_lo_u32 v3, v3, s35
    v_add_u32 v3, v3, v4
    v_add_u32 v22, s39, v3
    v_add_u32 v2, 448, v0
    v_mul_u32_u24 v3, 4096, v2
    v_lshrrev_b32 v3, 16, v3
    v_mul_u32_u24 v4, 16, v3
    v_sub_u32 v4, v2, v4
    v_lshlrev_b32 v4, 4, v4
    v_mul_u32_u24 v5, 272, v3
    v_add_u32 v5, v5, v4
    v_add_u32 v15, s32, v5
    v_add_u32 v3, s38, v3
    v_mul_lo_u32 v3, v3, s35
    v_add_u32 v3, v3, v4
    v_add_u32 v23, s39, v3
    s_waitcnt lgkmcnt(0)
    ds_read_b128 v[40:43], v8
    ds_read_b128 v[44:47], v9
    ds_read_b128 v[48:51], v10
    ds_read_b128 v[52:55], v11
    ds_read_b128 v[56:59], v12
    ds_read_b128 v[60:63], v13
    ds_read_b128 v[64:67], v14
    ds_read_b128 v[68:71], v15
    s_waitcnt lgkmcnt(0)
    buffer_store_dwordx4 v[40:43], v16, s[16:19], 0 offen
    buffer_store_dwordx4 v[44:47], v17, s[16:19], 0 offen
    buffer_store_dwordx4 v[48:51], v18, s[16:19], 0 offen
    buffer_store_dwordx4 v[52:55], v19, s[16:19], 0 offen
    buffer_store_dwordx4 v[56:59], v20, s[16:19], 0 offen
    buffer_store_dwordx4 v[60:63], v21, s[16:19], 0 offen
    buffer_store_dwordx4 v[64:67], v22, s[16:19], 0 offen
    buffer_store_dwordx4 v[68:71], v23, s[16:19], 0 offen
L_done_gw3_0_kernel:
    s_endpgm
.globl gw4_0_kernel
.p2align 8
.type gw4_0_kernel,@function
gw4_0_kernel:
    s_cmp_ge_u32 s2, 256
    s_cbranch_scc1 L_done_gw4_0_kernel
    s_load_dwordx2 s[40:41], s[0:1], 64
    s_load_dwordx2 s[42:43], s[0:1], 88
    s_waitcnt lgkmcnt(0)
    s_add_u32 s8, s42, 52428800
    s_addc_u32 s9, s43, 0
    s_mov_b32 s10, 14680064
    s_mov_b32 s11, 0x00020000
    s_mov_b32 s12, s40
    s_mov_b32 s13, s41
    s_mov_b32 s14, 7340032
    s_mov_b32 s15, 0x00020000
    s_add_u32 s16, s42, 69206016
    s_addc_u32 s17, s43, 0
    s_mov_b32 s18, 4194304
    s_mov_b32 s19, 0x00020000
    s_add_u32 s20, s42, 44040192
    s_addc_u32 s21, s43, 0
    s_mov_b32 s22, 4194304
    s_mov_b32 s23, 0x00020000
    s_add_u32 s24, s42, 25165824
    s_addc_u32 s25, s43, 0
    s_mov_b32 s26, 4194304
    s_mov_b32 s27, 0x00020000
    s_mov_b32 s36, 0x3d372713
    s_mov_b32 s37, 0xc0135761
    s_and_b32 s3, s2, 7
    s_lshr_b32 s4, s2, 3
    s_mul_i32 s5, s4, 8192
    s_lshr_b32 s5, s5, 16
    s_mul_i32 s6, s5, 8
    s_sub_u32 s6, s4, s6
    s_lshr_b32 s7, s3, 1
    s_mul_i32 s7, s7, 4
    s_add_u32 s28, s7, s5
    s_and_b32 s7, s3, 1
    s_mul_i32 s7, s7, 8
    s_add_u32 s29, s7, s6
    v_lshrrev_b32 v1, 6, v0
    s_nop 0
    v_readfirstlane_b32 s30, v1
    v_and_b32 v0, 63, v0
    v_lshrrev_b32 v1, 3, v0
    s_lshl_b32 s31, s30, 4
    s_lshl_b32 s34, s28, 7
    s_add_u32 s31, s31, s34
    v_add_u32 v1, s31, v1
    v_add_u32 v6, 0, v1
    v_lshrrev_b32 v7, 1, v6
    v_and_b32 v7, 7, v7
    v_and_b32 v8, 7, v0
    v_xor_b32 v7, v7, v8
    v_lshlrev_b32 v7, 4, v7
    s_mov_b32 s35, 7168
    v_mul_lo_u32 v6, v6, s35
    v_add_u32 v2, v6, v7
    v_add_u32 v6, 8, v1
    v_lshrrev_b32 v7, 1, v6
    v_and_b32 v7, 7, v7
    v_and_b32 v8, 7, v0
    v_xor_b32 v7, v7, v8
    v_lshlrev_b32 v7, 4, v7
    s_mov_b32 s35, 7168
    v_mul_lo_u32 v6, v6, s35
    v_add_u32 v3, v6, v7
    s_mul_i32 s31, s30, 64
    s_mul_i32 s34, s29, 128
    v_add_u32 v6, s31, v0
    v_add_u32 v6, 0, v6
    v_mul_u32_u24 v7, 8192, v6
    v_lshrrev_b32 v7, 16, v7
    v_mul_u32_u24 v8, 8, v7
    v_sub_u32 v8, v6, v8
    v_lshlrev_b32 v9, 1, v7
    v_and_b32 v9, 4, v9
    v_xor_b32 v8, v8, v9
    v_lshlrev_b32 v8, 4, v8
    s_mov_b32 s35, 2048
    v_mul_lo_u32 v7, v7, s35
    v_add_u32 v7, v7, v8
    v_add_u32 v10, s34, v7
    s_lshr_b32 s31, s30, 1
    s_and_b32 s34, s30, 1
    s_mul_i32 s38, s31, 32
    s_mul_i32 s39, s34, 32
    v_and_b32 v6, 31, v0
    v_add_u32 v6, s38, v6
    v_lshrrev_b32 v7, 1, v6
    v_and_b32 v7, 7, v7
    v_lshrrev_b32 v8, 5, v0
    v_xor_b32 v7, v7, v8
    v_lshlrev_b32 v7, 4, v7
    v_lshlrev_b32 v6, 7, v6
    v_add_u32 v6, v6, v7
    v_xor_b32 v20, 0, v6
    v_add_u32 v36, 65536, v20
    v_xor_b32 v21, 32, v6
    v_add_u32 v37, 65536, v21
    v_xor_b32 v22, 64, v6
    v_add_u32 v38, 65536, v22
    v_xor_b32 v23, 96, v6
    v_add_u32 v39, 65536, v23
    v_lshrrev_b32 v6, 5, v0
    v_lshlrev_b32 v6, 3, v6
    v_bfe_u32 v7, v0, 2, 2
    v_add_u32 v6, v6, v7
    v_bfe_u32 v8, v0, 4, 1
    v_lshlrev_b32 v8, 4, v8
    v_and_b32 v9, 3, v0
    v_lshlrev_b32 v9, 2, v9
    v_add_u32 v8, v8, v9
    v_add_u32 v8, s39, v8
    v_add_u32 v9, 0, v8
    v_lshlrev_b32 v9, 1, v9
    v_lshlrev_b32 v18, 5, v7
    v_and_b32 v18, 64, v18
    v_xor_b32 v9, v9, v18
    v_mul_u32_u24 v19, 128, v6
    v_add_u32 v24, v19, v9
    v_add_u32 v24, 98304, v24
    v_add_u32 v28, 16384, v24
    v_add_u32 v32, 32768, v24
    v_mov_b32 v40, 0
    v_mov_b32 v41, 0
    v_mov_b32 v42, 0
    v_mov_b32 v43, 0
    v_mov_b32 v44, 0
    v_mov_b32 v45, 0
    v_mov_b32 v46, 0
    v_mov_b32 v47, 0
    v_mov_b32 v48, 0
    v_mov_b32 v49, 0
    v_mov_b32 v50, 0
    v_mov_b32 v51, 0
    v_mov_b32 v52, 0
    v_mov_b32 v53, 0
    v_mov_b32 v54, 0
    v_mov_b32 v55, 0
    s_lshl_b32 s40, s30, 11
    s_mul_i32 s41, s30, 1024
    s_add_u32 s41, s41, 98304
    s_mov_b32 s32, 0
    s_mov_b32 s33, 0
    s_and_b32 s42, s4, 7
    s_mul_i32 s42, s42, 7
    s_mov_b32 s42, 0
    s_mov_b32 s35, 0
    s_add_u32 s35, s35, s42
    s_sub_u32 s34, s35, 56
    s_cmp_ge_u32 s35, 56
    s_cselect_b32 s35, s34, s35
    s_mul_i32 s33, s35, 131072
    s_lshl_b32 s32, s35, 7
    s_add_u32 m0, s40, 0
    s_nop 0
    buffer_load_dwordx4 v2, s[8:11], s32 offen lds
    s_add_u32 m0, s40, 1024
    s_nop 0
    buffer_load_dwordx4 v3, s[8:11], s32 offen lds
    s_add_u32 m0, s41, 0
    s_nop 0
    buffer_load_dwordx4 v10, s[12:15], s33 offen lds
    s_mov_b32 s35, 1
    s_add_u32 s35, s35, s42
    s_sub_u32 s34, s35, 56
    s_cmp_ge_u32 s35, 56
    s_cselect_b32 s35, s34, s35
    s_mul_i32 s33, s35, 131072
    s_lshl_b32 s32, s35, 7
    s_add_u32 m0, s40, 16384
    s_nop 0
    buffer_load_dwordx4 v2, s[8:11], s32 offen lds
    s_add_u32 m0, s40, 17408
    s_nop 0
    buffer_load_dwordx4 v3, s[8:11], s32 offen lds
    s_add_u32 m0, s41, 8192
    s_nop 0
    buffer_load_dwordx4 v10, s[12:15], s33 offen lds
    s_mov_b32 s35, 2
    s_add_u32 s35, s35, s42
    s_sub_u32 s34, s35, 56
    s_cmp_ge_u32 s35, 56
    s_cselect_b32 s35, s34, s35
    s_mul_i32 s33, s35, 131072
    s_lshl_b32 s32, s35, 7
    s_add_u32 m0, s40, 32768
    s_nop 0
    buffer_load_dwordx4 v2, s[8:11], s32 offen lds
    s_add_u32 m0, s40, 33792
    s_nop 0
    buffer_load_dwordx4 v3, s[8:11], s32 offen lds
    s_add_u32 m0, s41, 16384
    s_nop 0
    buffer_load_dwordx4 v10, s[12:15], s33 offen lds
    s_mov_b32 s35, 3
    s_add_u32 s35, s35, s42
    s_sub_u32 s34, s35, 56
    s_cmp_ge_u32 s35, 56
    s_cselect_b32 s35, s34, s35
    s_mul_i32 s33, s35, 131072
    s_lshl_b32 s32, s35, 7
    s_add_u32 m0, s40, 49152
    s_nop 0
    buffer_load_dwordx4 v2, s[8:11], s32 offen lds
    s_add_u32 m0, s40, 50176
    s_nop 0
    buffer_load_dwordx4 v3, s[8:11], s32 offen lds
    s_add_u32 m0, s41, 24576
    s_nop 0
    buffer_load_dwordx4 v10, s[12:15], s33 offen lds
    s_mov_b32 s35, 4
    s_add_u32 s35, s35, s42
    s_sub_u32 s34, s35, 56
    s_cmp_ge_u32 s35, 56
    s_cselect_b32 s35, s34, s35
    s_mul_i32 s33, s35, 131072
    s_lshl_b32 s32, s35, 7
    s_add_u32 m0, s40, 65536
    s_nop 0
    buffer_load_dwordx4 v2, s[8:11], s32 offen lds
    s_add_u32 m0, s40, 66560
    s_nop 0
    buffer_load_dwordx4 v3, s[8:11], s32 offen lds
    s_add_u32 m0, s41, 32768
    s_nop 0
    buffer_load_dwordx4 v10, s[12:15], s33 offen lds
    s_mov_b32 s31, 0
    s_waitcnt vmcnt(12)
    s_barrier
    ds_read_b128 v[56:59], v20 offset:0
    ds_read_b64_tr_b16 v[60:61], v24 offset:0
    ds_read_b64_tr_b16 v[62:63], v24 offset:512
L_loop_gw4_0_kernel:
    s_cmp_ge_u32 s31, 56
    s_cbranch_scc1 L_lend_gw4_0_kernel
    s_cmp_ge_u32 s31, 51
    s_cbranch_scc1 L_gw4_0_kernel_tail1
    s_waitcnt vmcnt(9)
    s_barrier
    s_add_u32 s35, s31, 5
    s_add_u32 s35, s35, s42
    s_sub_u32 s34, s35, 56
    s_cmp_ge_u32 s35, 56
    s_cselect_b32 s35, s34, s35
    s_mul_i32 s33, s35, 131072
    s_lshl_b32 s32, s35, 7
    s_add_u32 m0, s40, 81920
    s_nop 0
    buffer_load_dwordx4 v2, s[8:11], s32 offen lds
    s_add_u32 m0, s40, 82944
    s_nop 0
    buffer_load_dwordx4 v3, s[8:11], s32 offen lds
    s_add_u32 m0, s41, 40960
    s_nop 0
    buffer_load_dwordx4 v10, s[12:15], s33 offen lds
    s_branch L_gw4_0_kernel_join2
L_gw4_0_kernel_tail1:
    s_waitcnt vmcnt(0)
    s_barrier
L_gw4_0_kernel_join2:
    ds_read_b128 v[64:67], v21 offset:0
    ds_read_b64_tr_b16 v[68:69], v24 offset:2048
    ds_read_b64_tr_b16 v[70:71], v24 offset:2560
    s_waitcnt lgkmcnt(3)
    v_mfma_f32_32x32x16_bf16 v[40:55], v[60:63], v[56:59], v[40:55]
    ds_read_b128 v[56:59], v22 offset:0
    ds_read_b64_tr_b16 v[60:61], v24 offset:4096
    ds_read_b64_tr_b16 v[62:63], v24 offset:4608
    s_waitcnt lgkmcnt(3)
    v_mfma_f32_32x32x16_bf16 v[40:55], v[68:71], v[64:67], v[40:55]
    ds_read_b128 v[64:67], v23 offset:0
    ds_read_b64_tr_b16 v[68:69], v24 offset:6144
    ds_read_b64_tr_b16 v[70:71], v24 offset:6656
    s_waitcnt lgkmcnt(3)
    v_mfma_f32_32x32x16_bf16 v[40:55], v[60:63], v[56:59], v[40:55]
    ds_read_b128 v[56:59], v20 offset:16384
    ds_read_b64_tr_b16 v[60:61], v24 offset:8192
    ds_read_b64_tr_b16 v[62:63], v24 offset:8704
    s_waitcnt lgkmcnt(3)
    v_mfma_f32_32x32x16_bf16 v[40:55], v[68:71], v[64:67], v[40:55]
    s_cmp_ge_u32 s31, 55
    s_cbranch_scc1 L_lend_gw4_0_kernel
    s_cmp_ge_u32 s31, 50
    s_cbranch_scc1 L_gw4_0_kernel_tail3
    s_waitcnt vmcnt(9)
    s_barrier
    s_add_u32 s35, s31, 6
    s_add_u32 s35, s35, s42
    s_sub_u32 s34, s35, 56
    s_cmp_ge_u32 s35, 56
    s_cselect_b32 s35, s34, s35
    s_mul_i32 s33, s35, 131072
    s_lshl_b32 s32, s35, 7
    s_add_u32 m0, s40, 0
    s_nop 0
    buffer_load_dwordx4 v2, s[8:11], s32 offen lds
    s_add_u32 m0, s40, 1024
    s_nop 0
    buffer_load_dwordx4 v3, s[8:11], s32 offen lds
    s_add_u32 m0, s41, 0
    s_nop 0
    buffer_load_dwordx4 v10, s[12:15], s33 offen lds
    s_branch L_gw4_0_kernel_join4
L_gw4_0_kernel_tail3:
    s_waitcnt vmcnt(0)
    s_barrier
L_gw4_0_kernel_join4:
    ds_read_b128 v[64:67], v21 offset:16384
    ds_read_b64_tr_b16 v[68:69], v24 offset:10240
    ds_read_b64_tr_b16 v[70:71], v24 offset:10752
    s_waitcnt lgkmcnt(3)
    v_mfma_f32_32x32x16_bf16 v[40:55], v[60:63], v[56:59], v[40:55]
    ds_read_b128 v[56:59], v22 offset:16384
    ds_read_b64_tr_b16 v[60:61], v24 offset:12288
    ds_read_b64_tr_b16 v[62:63], v24 offset:12800
    s_waitcnt lgkmcnt(3)
    v_mfma_f32_32x32x16_bf16 v[40:55], v[68:71], v[64:67], v[40:55]
    ds_read_b128 v[64:67], v23 offset:16384
    ds_read_b64_tr_b16 v[68:69], v24 offset:14336
    ds_read_b64_tr_b16 v[70:71], v24 offset:14848
    s_waitcnt lgkmcnt(3)
    v_mfma_f32_32x32x16_bf16 v[40:55], v[60:63], v[56:59], v[40:55]
    ds_read_b128 v[56:59], v20 offset:32768
    ds_read_b64_tr_b16 v[60:61], v28 offset:0
    ds_read_b64_tr_b16 v[62:63], v28 offset:512
    s_waitcnt lgkmcnt(3)
    v_mfma_f32_32x32x16_bf16 v[40:55], v[68:71], v[64:67], v[40:55]
    s_cmp_ge_u32 s31, 54
    s_cbranch_scc1 L_lend_gw4_0_kernel
    s_cmp_ge_u32 s31, 49
    s_cbranch_scc1 L_gw4_0_kernel_tail5
    s_waitcnt vmcnt(9)
    s_barrier
    s_add_u32 s35, s31, 7
    s_add_u32 s35, s35, s42
    s_sub_u32 s34, s35, 56
    s_cmp_ge_u32 s35, 56
    s_cselect_b32 s35, s34, s35
    s_mul_i32 s33, s35, 131072
    s_lshl_b32 s32, s35, 7
    s_add_u32 m0, s40, 16384
    s_nop 0
    buffer_load_dwordx4 v2, s[8:11], s32 offen lds
    s_add_u32 m0, s40, 17408
    s_nop 0
    buffer_load_dwordx4 v3, s[8:11], s32 offen lds
    s_add_u32 m0, s41, 8192
    s_nop 0
    buffer_load_dwordx4 v10, s[12:15], s33 offen lds
    s_branch L_gw4_0_kernel_join6
L_gw4_0_kernel_tail5:
    s_waitcnt vmcnt(0)
    s_barrier
L_gw4_0_kernel_join6:
    ds_read_b128 v[64:67], v21 offset:32768
    ds_read_b64_tr_b16 v[68:69], v28 offset:2048
    ds_read_b64_tr_b16 v[70:71], v28 offset:2560
    s_waitcnt lgkmcnt(3)
    v_mfma_f32_32x32x16_bf16 v[40:55], v[60:63], v[56:59], v[40:55]
    ds_read_b128 v[56:59], v22 offset:32768
    ds_read_b64_tr_b16 v[60:61], v28 offset:4096
    ds_read_b64_tr_b16 v[62:63], v28 offset:4608
    s_waitcnt lgkmcnt(3)
    v_mfma_f32_32x32x16_bf16 v[40:55], v[68:71], v[64:67], v[40:55]
    ds_read_b128 v[64:67], v23 offset:32768
    ds_read_b64_tr_b16 v[68:69], v28 offset:6144
    ds_read_b64_tr_b16 v[70:71], v28 offset:6656
    s_waitcnt lgkmcnt(3)
    v_mfma_f32_32x32x16_bf16 v[40:55], v[60:63], v[56:59], v[40:55]
    ds_read_b128 v[56:59], v20 offset:49152
    ds_read_b64_tr_b16 v[60:61], v28 offset:8192
    ds_read_b64_tr_b16 v[62:63], v28 offset:8704
    s_waitcnt lgkmcnt(3)
    v_mfma_f32_32x32x16_bf16 v[40:55], v[68:71], v[64:67], v[40:55]
    s_cmp_ge_u32 s31, 53
    s_cbranch_scc1 L_lend_gw4_0_kernel
    s_cmp_ge_u32 s31, 48
    s_cbranch_scc1 L_gw4_0_kernel_tail7
    s_waitcnt vmcnt(9)
    s_barrier
    s_add_u32 s35, s31, 8
    s_add_u32 s35, s35, s42
    s_sub_u32 s34, s35, 56
    s_cmp_ge_u32 s35, 56
    s_cselect_b32 s35, s34, s35
    s_mul_i32 s33, s35, 131072
    s_lshl_b32 s32, s35, 7
    s_add_u32 m0, s40, 32768
    s_nop 0
    buffer_load_dwordx4 v2, s[8:11], s32 offen lds
    s_add_u32 m0, s40, 33792
    s_nop 0
    buffer_load_dwordx4 v3, s[8:11], s32 offen lds
    s_add_u32 m0, s41, 16384
    s_nop 0
    buffer_load_dwordx4 v10, s[12:15], s33 offen lds
    s_branch L_gw4_0_kernel_join8
L_gw4_0_kernel_tail7:
    s_waitcnt vmcnt(0)
    s_barrier
L_gw4_0_kernel_join8:
    ds_read_b128 v[64:67], v21 offset:49152
    ds_read_b64_tr_b16 v[68:69], v28 offset:10240
    ds_read_b64_tr_b16 v[70:71], v28 offset:10752
    s_waitcnt lgkmcnt(3)
    v_mfma_f32_32x32x16_bf16 v[40:55], v[60:63], v[56:59], v[40:55]
    ds_read_b128 v[56:59], v22 offset:49152
    ds_read_b64_tr_b16 v[60:61], v28 offset:12288
    ds_read_b64_tr_b16 v[62:63], v28 offset:12800
    s_waitcnt lgkmcnt(3)
    v_mfma_f32_32x32x16_bf16 v[40:55], v[68:71], v[64:67], v[40:55]
    ds_read_b128 v[64:67], v23 offset:49152
    ds_read_b64_tr_b16 v[68:69], v28 offset:14336
    ds_read_b64_tr_b16 v[70:71], v28 offset:14848
    s_waitcnt lgkmcnt(3)
    v_mfma_f32_32x32x16_bf16 v[40:55], v[60:63], v[56:59], v[40:55]
    ds_read_b128 v[56:59], v36 offset:0
    ds_read_b64_tr_b16 v[60:61], v32 offset:0
    ds_read_b64_tr_b16 v[62:63], v32 offset:512
    s_waitcnt lgkmcnt(3)
    v_mfma_f32_32x32x16_bf16 v[40:55], v[68:71], v[64:67], v[40:55]
    s_cmp_ge_u32 s31, 52
    s_cbranch_scc1 L_lend_gw4_0_kernel
    s_cmp_ge_u32 s31, 47
    s_cbranch_scc1 L_gw4_0_kernel_tail9
    s_waitcnt vmcnt(9)
    s_barrier
    s_add_u32 s35, s31, 9
    s_add_u32 s35, s35, s42
    s_sub_u32 s34, s35, 56
    s_cmp_ge_u32 s35, 56
    s_cselect_b32 s35, s34, s35
    s_mul_i32 s33, s35, 131072
    s_lshl_b32 s32, s35, 7
    s_add_u32 m0, s40, 49152
    s_nop 0
    buffer_load_dwordx4 v2, s[8:11], s32 offen lds
    s_add_u32 m0, s40, 50176
    s_nop 0
    buffer_load_dwordx4 v3, s[8:11], s32 offen lds
    s_add_u32 m0, s41, 24576
    s_nop 0
    buffer_load_dwordx4 v10, s[12:15], s33 offen lds
    s_branch L_gw4_0_kernel_join10
L_gw4_0_kernel_tail9:
    s_waitcnt vmcnt(0)
    s_barrier
L_gw4_0_kernel_join10:
    ds_read_b128 v[64:67], v37 offset:0
    ds_read_b64_tr_b16 v[68:69], v32 offset:2048
    ds_read_b64_tr_b16 v[70:71], v32 offset:2560
    s_waitcnt lgkmcnt(3)
    v_mfma_f32_32x32x16_bf16 v[40:55], v[60:63], v[56:59], v[40:55]
    ds_read_b128 v[56:59], v38 offset:0
    ds_read_b64_tr_b16 v[60:61], v32 offset:4096
    ds_read_b64_tr_b16 v[62:63], v32 offset:4608
    s_waitcnt lgkmcnt(3)
    v_mfma_f32_32x32x16_bf16 v[40:55], v[68:71], v[64:67], v[40:55]
    ds_read_b128 v[64:67], v39 offset:0
    ds_read_b64_tr_b16 v[68:69], v32 offset:6144
    ds_read_b64_tr_b16 v[70:71], v32 offset:6656
    s_waitcnt lgkmcnt(3)
    v_mfma_f32_32x32x16_bf16 v[40:55], v[60:63], v[56:59], v[40:55]
    ds_read_b128 v[56:59], v36 offset:16384
    ds_read_b64_tr_b16 v[60:61], v32 offset:8192
    ds_read_b64_tr_b16 v[62:63], v32 offset:8704
    s_waitcnt lgkmcnt(3)
    v_mfma_f32_32x32x16_bf16 v[40:55], v[68:71], v[64:67], v[40:55]
    s_cmp_ge_u32 s31, 51
    s_cbranch_scc1 L_lend_gw4_0_kernel
    s_cmp_ge_u32 s31, 46
    s_cbranch_scc1 L_gw4_0_kernel_tail11
    s_waitcnt vmcnt(9)
    s_barrier
    s_add_u32 s35, s31, 10
    s_add_u32 s35, s35, s42
    s_sub_u32 s34, s35, 56
    s_cmp_ge_u32 s35, 56
    s_cselect_b32 s35, s34, s35
    s_mul_i32 s33, s35, 131072
    s_lshl_b32 s32, s35, 7
    s_add_u32 m0, s40, 65536
    s_nop 0
    buffer_load_dwordx4 v2, s[8:11], s32 offen lds
    s_add_u32 m0, s40, 66560
    s_nop 0
    buffer_load_dwordx4 v3, s[8:11], s32 offen lds
    s_add_u32 m0, s41, 32768
    s_nop 0
    buffer_load_dwordx4 v10, s[12:15], s33 offen lds
    s_branch L_gw4_0_kernel_join12
L_gw4_0_kernel_tail11:
    s_waitcnt vmcnt(0)
    s_barrier
L_gw4_0_kernel_join12:
    ds_read_b128 v[64:67], v37 offset:16384
    ds_read_b64_tr_b16 v[68:69], v32 offset:10240
    ds_read_b64_tr_b16 v[70:71], v32 offset:10752
    s_waitcnt lgkmcnt(3)
    v_mfma_f32_32x32x16_bf16 v[40:55], v[60:63], v[56:59], v[40:55]
    ds_read_b128 v[56:59], v38 offset:16384
    ds_read_b64_tr_b16 v[60:61], v32 offset:12288
    ds_read_b64_tr_b16 v[62:63], v32 offset:12800
    s_waitcnt lgkmcnt(3)
    v_mfma_f32_32x32x16_bf16 v[40:55], v[68:71], v[64:67], v[40:55]
    ds_read_b128 v[64:67], v39 offset:16384
    ds_read_b64_tr_b16 v[68:69], v32 offset:14336
    ds_read_b64_tr_b16 v[70:71], v32 offset:14848
    s_waitcnt lgkmcnt(3)
    v_mfma_f32_32x32x16_bf16 v[40:55], v[60:63], v[56:59], v[40:55]
    ds_read_b128 v[56:59], v20 offset:0
    ds_read_b64_tr_b16 v[60:61], v24 offset:0
    ds_read_b64_tr_b16 v[62:63], v24 offset:512
    s_waitcnt lgkmcnt(3)
    v_mfma_f32_32x32x16_bf16 v[40:55], v[68:71], v[64:67], v[40:55]
    s_add_u32 s31, s31, 6
    s_cmp_lt_u32 s31, 56
    s_cbranch_scc1 L_loop_gw4_0_kernel
L_lend_gw4_0_kernel:
    s_nop 15
    s_nop 7
    s_lshr_b32 s31, s30, 1
    s_and_b32 s34, s30, 1
    s_mul_i32 s38, s31, 32
    s_mul_i32 s39, s34, 32
    s_lshl_b32 s31, s28, 7
    s_add_u32 s38, s38, s31
    s_mul_i32 s31, s29, 64
    s_add_u32 s39, s39, s31
    s_barrier
    s_mul_i32 s32, s30, 2560
    v_and_b32 v1, 31, v0
    v_mul_u32_u24 v1, 80, v1
    v_lshrrev_b32 v2, 5, v0
    v_lshlrev_b32 v2, 3, v2
    v_add_u32 v1, v1, v2
    v_add_u32 v1, s32, v1
    v_cvt_pk_bf16_f32 v40, v40, v41
    v_cvt_pk_bf16_f32 v41, v42, v43
    ds_write_b64 v1, v[40:41] offset:0
    v_cvt_pk_bf16_f32 v44, v44, v45
    v_cvt_pk_bf16_f32 v45, v46, v47
    ds_write_b64 v1, v[44:45] offset:16
    v_cvt_pk_bf16_f32 v48, v48, v49
    v_cvt_pk_bf16_f32 v49, v50, v51
    ds_write_b64 v1, v[48:49] offset:32
    v_cvt_pk_bf16_f32 v52, v52, v53
    v_cvt_pk_bf16_f32 v53, v54, v55
    ds_write_b64 v1, v[52:53] offset:48
    s_mov_b32 s35, 2048
    s_lshl_b32 s39, s39, 1
    v_add_u32 v2, 0, v0
    v_mul_u32_u24 v3, 16384, v2
    v_lshrrev_b32 v3, 16, v3
    v_mul_u32_u24 v4, 4, v3
    v_sub_u32 v4, v2, v4
    v_lshlrev_b32 v4, 4, v4
    v_mul_u32_u24 v5, 80, v3
    v_add_u32 v5, v5, v4
    v_add_u32 v8, s32, v5
    v_add_u32 v3, s38, v3
    v_mul_lo_u32 v3, v3, s35
    v_add_u32 v3, v3, v4
    v_add_u32 v16, s39, v3
    v_add_u32 v2, 64, v0
    v_mul_u32_u24 v3, 16384, v2
    v_lshrrev_b32 v3, 16, v3
    v_mul_u32_u24 v4, 4, v3
    v_sub_u32 v4, v2, v4
    v_lshlrev_b32 v4, 4, v4
    v_mul_u32_u24 v5, 80, v3
    v_add_u32 v5, v5, v4
    v_add_u32 v9, s32, v5
    v_add_u32 v3, s38, v3
    v_mul_lo_u32 v3, v3, s35
    v_add_u32 v3, v3, v4
    v_add_u32 v17, s39, v3
    s_waitcnt lgkmcnt(0)
    ds_read_b128 v[40:43], v8
    buffer_load_dwordx4 v[48:51], v16, s[20:23], 0 offen
    buffer_load_dwordx4 v[56:59], v16, s[24:27], 0 offen
    ds_read_b128 v[44:47], v9
    buffer_load_dwordx4 v[52:55], v17, s[20:23], 0 offen
    buffer_load_dwordx4 v[60:63], v17, s[24:27], 0 offen
    s_waitcnt lgkmcnt(0)
    s_waitcnt vmcnt(0)
    v_lshlrev_b32 v72, 16, v40
    v_and_b32 v73, 0xffff0000, v40
    v_lshlrev_b32 v74, 16, v48
    v_and_b32 v75, 0xffff0000, v48
    v_add_f32 v72, v72, v74
    v_add_f32 v73, v73, v75
    v_cvt_pk_bf16_f32 v40, v72, v73
    v_lshlrev_b32 v72, 16, v40
    v_and_b32 v73, 0xffff0000, v40
    v_lshlrev_b32 v74, 16, v56
    v_and_b32 v75, 0xffff0000, v56
    v_add_f32 v72, v72, v74
    v_add_f32 v73, v73, v75
    v_cvt_pk_bf16_f32 v40, v72, v73
    v_lshlrev_b32 v72, 16, v41
    v_and_b32 v73, 0xffff0000, v41
    v_lshlrev_b32 v74, 16, v49
    v_and_b32 v75, 0xffff0000, v49
    v_add_f32 v72, v72, v74
    v_add_f32 v73, v73, v75
    v_cvt_pk_bf16_f32 v41, v72, v73
    v_lshlrev_b32 v72, 16, v41
    v_and_b32 v73, 0xffff0000, v41
    v_lshlrev_b32 v74, 16, v57
    v_and_b32 v75, 0xffff0000, v57
    v_add_f32 v72, v72, v74
    v_add_f32 v73, v73, v75
    v_cvt_pk_bf16_f32 v41, v72, v73
    v_lshlrev_b32 v72, 16, v42
    v_and_b32 v73, 0xffff0000, v42
    v_lshlrev_b32 v74, 16, v50
    v_and_b32 v75, 0xffff0000, v50
    v_add_f32 v72, v72, v74
    v_add_f32 v73, v73, v75
    v_cvt_pk_bf16_f32 v42, v72, v73
    v_lshlrev_b32 v72, 16, v42
    v_and_b32 v73, 0xffff0000, v42
    v_lshlrev_b32 v74, 16, v58
    v_and_b32 v75, 0xffff0000, v58
    v_add_f32 v72, v72, v74
    v_add_f32 v73, v73, v75
    v_cvt_pk_bf16_f32 v42, v72, v73
    v_lshlrev_b32 v72, 16, v43
    v_and_b32 v73, 0xffff0000, v43
    v_lshlrev_b32 v74, 16, v51
    v_and_b32 v75, 0xffff0000, v51
    v_add_f32 v72, v72, v74
    v_add_f32 v73, v73, v75
    v_cvt_pk_bf16_f32 v43, v72, v73
    v_lshlrev_b32 v72, 16, v43
    v_and_b32 v73, 0xffff0000, v43
    v_lshlrev_b32 v74, 16, v59
    v_and_b32 v75, 0xffff0000, v59
    v_add_f32 v72, v72, v74
    v_add_f32 v73, v73, v75
    v_cvt_pk_bf16_f32 v43, v72, v73
    buffer_store_dwordx4 v[40:43], v16, s[16:19], 0 offen
    v_lshlrev_b32 v72, 16, v44
    v_and_b32 v73, 0xffff0000, v44
    v_lshlrev_b32 v74, 16, v52
    v_and_b32 v75, 0xffff0000, v52
    v_add_f32 v72, v72, v74
    v_add_f32 v73, v73, v75
    v_cvt_pk_bf16_f32 v44, v72, v73
    v_lshlrev_b32 v72, 16, v44
    v_and_b32 v73, 0xffff0000, v44
    v_lshlrev_b32 v74, 16, v60
    v_and_b32 v75, 0xffff0000, v60
    v_add_f32 v72, v72, v74
    v_add_f32 v73, v73, v75
    v_cvt_pk_bf16_f32 v44, v72, v73
    v_lshlrev_b32 v72, 16, v45
    v_and_b32 v73, 0xffff0000, v45
    v_lshlrev_b32 v74, 16, v53
    v_and_b32 v75, 0xffff0000, v53
    v_add_f32 v72, v72, v74
    v_add_f32 v73, v73, v75
    v_cvt_pk_bf16_f32 v45, v72, v73
    v_lshlrev_b32 v72, 16, v45
    v_and_b32 v73, 0xffff0000, v45
    v_lshlrev_b32 v74, 16, v61
    v_and_b32 v75, 0xffff0000, v61
    v_add_f32 v72, v72, v74
    v_add_f32 v73, v73, v75
    v_cvt_pk_bf16_f32 v45, v72, v73
    v_lshlrev_b32 v72, 16, v46
    v_and_b32 v73, 0xffff0000, v46
    v_lshlrev_b32 v74, 16, v54
    v_and_b32 v75, 0xffff0000, v54
    v_add_f32 v72, v72, v74
    v_add_f32 v73, v73, v75
    v_cvt_pk_bf16_f32 v46, v72, v73
    v_lshlrev_b32 v72, 16, v46
    v_and_b32 v73, 0xffff0000, v46
    v_lshlrev_b32 v74, 16, v62
    v_and_b32 v75, 0xffff0000, v62
    v_add_f32 v72, v72, v74
    v_add_f32 v73, v73, v75
    v_cvt_pk_bf16_f32 v46, v72, v73
    v_lshlrev_b32 v72, 16, v47
    v_and_b32 v73, 0xffff0000, v47
    v_lshlrev_b32 v74, 16, v55
    v_and_b32 v75, 0xffff0000, v55
    v_add_f32 v72, v72, v74
    v_add_f32 v73, v73, v75
    v_cvt_pk_bf16_f32 v47, v72, v73
    v_lshlrev_b32 v72, 16, v47
    v_and_b32 v73, 0xffff0000, v47
    v_lshlrev_b32 v74, 16, v63
    v_and_b32 v75, 0xffff0000, v63
    v_add_f32 v72, v72, v74
    v_add_f32 v73, v73, v75
    v_cvt_pk_bf16_f32 v47, v72, v73
    buffer_store_dwordx4 v[44:47], v17, s[16:19], 0 offen
L_done_gw4_0_kernel:
    s_endpgm
.globl lna_1_kernel
.p2align 8
.type lna_1_kernel,@function
lna_1_kernel:
    s_cmp_ge_u32 s2, 512
    s_cbranch_scc1 L_done_lna_1_kernel
    s_load_dwordx2 s[40:41], s[0:1], 88
    s_waitcnt lgkmcnt(0)
    s_add_u32 s8, s40, 69206016
    s_addc_u32 s9, s41, 0
    s_mov_b32 s10, 4194304
    s_mov_b32 s11, 0x00020000
    s_mov_b32 s12, s40
    s_mov_b32 s13, s41
    s_mov_b32 s14, 4194304
    s_mov_b32 s15, 0x00020000
    s_lshl_b32 s3, s2, 2
    v_lshrrev_b32 v1, 6, v0
    v_add_u32 v1, s3, v1
    v_lshlrev_b32 v1, 11, v1
    v_and_b32 v2, 63, v0
    v_lshlrev_b32 v2, 4, v2
    v_add_u32 v1, v1, v2
    buffer_load_dwordx4 v[8:11], v1, s[8:11], 0 offen
    buffer_load_dwordx4 v[12:15], v1, s[8:11], 0 offen offset:1024
    s_waitcnt vmcnt(0)
    v_lshlrev_b32 v16, 16, v8
    v_and_b32 v17, 0xffff0000, v8
    v_lshlrev_b32 v18, 16, v9
    v_and_b32 v19, 0xffff0000, v9
    v_lshlrev_b32 v20, 16, v10
    v_and_b32 v21, 0xffff0000, v10
    v_lshlrev_b32 v22, 16, v11
    v_and_b32 v23, 0xffff0000, v11
    v_lshlrev_b32 v24, 16, v12
    v_and_b32 v25, 0xffff0000, v12
    v_lshlrev_b32 v26, 16, v13
    v_and_b32 v27, 0xffff0000, v13
    v_lshlrev_b32 v28, 16, v14
    v_and_b32 v29, 0xffff0000, v14
    v_lshlrev_b32 v30, 16, v15
    v_and_b32 v31, 0xffff0000, v15
    v_mov_b32 v4, 0
    v_add_f32 v4, v4, v16
    v_add_f32 v4, v4, v17
    v_add_f32 v4, v4, v18
    v_add_f32 v4, v4, v19
    v_add_f32 v4, v4, v20
    v_add_f32 v4, v4, v21
    v_add_f32 v4, v4, v22
    v_add_f32 v4, v4, v23
    v_add_f32 v4, v4, v24
    v_add_f32 v4, v4, v25
    v_add_f32 v4, v4, v26
    v_add_f32 v4, v4, v27
    v_add_f32 v4, v4, v28
    v_add_f32 v4, v4, v29
    v_add_f32 v4, v4, v30
    v_add_f32 v4, v4, v31
    ds_swizzle_b32 v5, v4 offset:0x041F
    s_waitcnt lgkmcnt(0)
    v_add_f32 v4, v4, v5
    ds_swizzle_b32 v5, v4 offset:0x081F
    s_waitcnt lgkmcnt(0)
    v_add_f32 v4, v4, v5
    ds_swizzle_b32 v5, v4 offset:0x101F
    s_waitcnt lgkmcnt(0)
    v_add_f32 v4, v4, v5
    ds_swizzle_b32 v5, v4 offset:0x201F
    s_waitcnt lgkmcnt(0)
    v_add_f32 v4, v4, v5
    ds_swizzle_b32 v5, v4 offset:0x401F
    s_waitcnt lgkmcnt(0)
    v_add_f32 v4, v4, v5
    s_nop 0
    v_readlane_b32 s30, v4, 32
    v_readlane_b32 s31, v4, 0
    s_nop 1
    v_mov_b32 v4, s30
    v_add_f32 v4, s31, v4
    v_mul_f32 v4, 0x3a800000, v4
    v_mov_b32 v6, 0
    v_sub_f32 v16, v16, v4
    v_fmac_f32 v6, v16, v16
    v_sub_f32 v17, v17, v4
    v_fmac_f32 v6, v17, v17
    v_sub_f32 v18, v18, v4
    v_fmac_f32 v6, v18, v18
    v_sub_f32 v19, v19, v4
    v_fmac_f32 v6, v19, v19
    v_sub_f32 v20, v20, v4
    v_fmac_f32 v6, v20, v20
    v_sub_f32 v21, v21, v4
    v_fmac_f32 v6, v21, v21
    v_sub_f32 v22, v22, v4
    v_fmac_f32 v6, v22, v22
    v_sub_f32 v23, v23, v4
    v_fmac_f32 v6, v23, v23
    v_sub_f32 v24, v24, v4
    v_fmac_f32 v6, v24, v24
    v_sub_f32 v25, v25, v4
    v_fmac_f32 v6, v25, v25
    v_sub_f32 v26, v26, v4
    v_fmac_f32 v6, v26, v26
    v_sub_f32 v27, v27, v4
    v_fmac_f32 v6, v27, v27
    v_sub_f32 v28, v28, v4
    v_fmac_f32 v6, v28, v28
    v_sub_f32 v29, v29, v4
    v_fmac_f32 v6, v29, v29
    v_sub_f32 v30, v30, v4
    v_fmac_f32 v6, v30, v30
    v_sub_f32 v31, v31, v4
    v_fmac_f32 v6, v31, v31
    ds_swizzle_b32 v5, v6 offset:0x041F
    s_waitcnt lgkmcnt(0)
    v_add_f32 v6, v6, v5
    ds_swizzle_b32 v5, v6 offset:0x081F
    s_waitcnt lgkmcnt(0)
    v_add_f32 v6, v6, v5
    ds_swizzle_b32 v5, v6 offset:0x101F
    s_waitcnt lgkmcnt(0)
    v_add_f32 v6, v6, v5
    ds_swizzle_b32 v5, v6 offset:0x201F
    s_waitcnt lgkmcnt(0)
    v_add_f32 v6, v6, v5
    ds_swizzle_b32 v5, v6 offset:0x401F
    s_waitcnt lgkmcnt(0)
    v_add_f32 v6, v6, v5
    s_nop 0
    v_readlane_b32 s30, v6, 32
    v_readlane_b32 s31, v6, 0
    s_nop 1
    v_mov_b32 v6, s30
    v_add_f32 v6, s31, v6
    v_mov_b32 v5, 0x3727c5ac
    v_fmac_f32 v5, 0x3a800000, v6
    v_rsq_f32 v5, v5
    s_nop 0
    v_mul_f32 v16, v16, v5
    v_mul_f32 v17, v17, v5
    v_mul_f32 v18, v18, v5
    v_mul_f32 v19, v19, v5
    v_mul_f32 v20, v20, v5
    v_mul_f32 v21, v21, v5
    v_mul_f32 v22, v22, v5
    v_mul_f32 v23, v23, v5
    v_mul_f32 v24, v24, v5
    v_mul_f32 v25, v25, v5
    v_mul_f32 v26, v26, v5
    v_mul_f32 v27, v27, v5
    v_mul_f32 v28, v28, v5
    v_mul_f32 v29, v29, v5
    v_mul_f32 v30, v30, v5
    v_mul_f32 v31, v31, v5
    v_cvt_pk_bf16_f32 v32, v16, v17
    v_cvt_pk_bf16_f32 v33, v18, v19
    v_cvt_pk_bf16_f32 v34, v20, v21
    v_cvt_pk_bf16_f32 v35, v22, v23
    v_cvt_pk_bf16_f32 v36, v24, v25
    v_cvt_pk_bf16_f32 v37, v26, v27
    v_cvt_pk_bf16_f32 v38, v28, v29
    v_cvt_pk_bf16_f32 v39, v30, v31
    buffer_store_dwordx4 v[32:35], v1, s[12:15], 0 offen
    buffer_store_dwordx4 v[36:39], v1, s[12:15], 0 offen offset:1024
L_done_lna_1_kernel:
    s_endpgm
.globl gqkv_1_kernel
.p2align 8
.type gqkv_1_kernel,@function
gqkv_1_kernel:
    s_cmp_ge_u32 s2, 256
    s_cbranch_scc1 L_done_gqkv_1_kernel
    s_load_dwordx2 s[40:41], s[0:1], 8
    s_load_dwordx2 s[42:43], s[0:1], 88
    s_waitcnt lgkmcnt(0)
    s_mov_b32 s8, s42
    s_mov_b32 s9, s43
    s_mov_b32 s10, 4194304
    s_mov_b32 s11, 0x00020000
    s_mov_b32 s12, s40
    s_mov_b32 s13, s41
    s_mov_b32 s14, 6291456
    s_mov_b32 s15, 0x00020000
    s_add_u32 s16, s42, 4194304
    s_addc_u32 s17, s43, 0
    s_mov_b32 s18, 12582912
    s_mov_b32 s19, 0x00020000
    s_mov_b32 s36, 0x3d372713
    s_mov_b32 s37, 0xc0135761
    s_and_b32 s3, s2, 7
    s_lshr_b32 s4, s2, 3
    s_mul_i32 s5, s4, 16384
    s_lshr_b32 s5, s5, 16
    s_mul_i32 s6, s5, 4
    s_sub_u32 s6, s4, s6
    s_lshr_b32 s7, s3, 2
    s_mul_i32 s7, s7, 8
    s_add_u32 s28, s7, s5
    s_and_b32 s7, s3, 3
    s_mul_i32 s7, s7, 4
    s_add_u32 s29, s7, s6
    v_lshrrev_b32 v1, 6, v0
    s_nop 0
    v_readfirstlane_b32 s30, v1
    v_and_b32 v0, 63, v0
    v_lshrrev_b32 v1, 3, v0
    s_lshl_b32 s31, s30, 4
    s_lshl_b32 s34, s28, 7
    s_add_u32 s31, s31, s34
    v_add_u32 v1, s31, v1
    v_add_u32 v6, 0, v1
    v_lshrrev_b32 v7, 1, v6
    v_and_b32 v7, 7, v7
    v_and_b32 v8, 7, v0
    v_xor_b32 v7, v7, v8
    v_lshlrev_b32 v7, 4, v7
    s_mov_b32 s35, 2048
    v_mul_lo_u32 v6, v6, s35
    v_add_u32 v2, v6, v7
    v_add_u32 v6, 8, v1
    v_lshrrev_b32 v7, 1, v6
    v_and_b32 v7, 7, v7
    v_and_b32 v8, 7, v0
    v_xor_b32 v7, v7, v8
    v_lshlrev_b32 v7, 4, v7
    s_mov_b32 s35, 2048
    v_mul_lo_u32 v6, v6, s35
    v_add_u32 v3, v6, v7
    s_mul_i32 s31, s30, 192
    s_mul_i32 s34, s29, 384
    v_add_u32 v6, s31, v0
    v_add_u32 v6, 0, v6
    v_mul_u32_u24 v7, 2731, v6
    v_lshrrev_b32 v7, 16, v7
    v_mul_u32_u24 v8, 24, v7
    v_sub_u32 v8, v6, v8
    v_lshlrev_b32 v9, 1, v7
    v_and_b32 v9, 4, v9
    v_xor_b32 v8, v8, v9
    v_lshlrev_b32 v8, 4, v8
    s_mov_b32 s35, 6144
    v_mul_lo_u32 v7, v7, s35
    v_add_u32 v7, v7, v8
    v_add_u32 v10, s34, v7
    v_add_u32 v6, s31, v0
    v_add_u32 v6, 64, v6
    v_mul_u32_u24 v7, 2731, v6
    v_lshrrev_b32 v7, 16, v7
    v_mul_u32_u24 v8, 24, v7
    v_sub_u32 v8, v6, v8
    v_lshlrev_b32 v9, 1, v7
    v_and_b32 v9, 4, v9
    v_xor_b32 v8, v8, v9
    v_lshlrev_b32 v8, 4, v8
    s_mov_b32 s35, 6144
    v_mul_lo_u32 v7, v7, s35
    v_add_u32 v7, v7, v8
    v_add_u32 v11, s34, v7
    v_add_u32 v6, s31, v0
    v_add_u32 v6, 128, v6
    v_mul_u32_u24 v7, 2731, v6
    v_lshrrev_b32 v7, 16, v7
    v_mul_u32_u24 v8, 24, v7
    v_sub_u32 v8, v6, v8
    v_lshlrev_b32 v9, 1, v7
    v_and_b32 v9, 4, v9
    v_xor_b32 v8, v8, v9
    v_lshlrev_b32 v8, 4, v8
    s_mov_b32 s35, 6144
    v_mul_lo_u32 v7, v7, s35
    v_add_u32 v7, v7, v8
    v_add_u32 v12, s34, v7
    s_lshr_b32 s31, s30, 1
    s_and_b32 s34, s30, 1
    s_mul_i32 s38, s31, 32
    s_mul_i32 s39, s34, 96
    v_and_b32 v6, 31, v0
    v_add_u32 v6, s38, v6
    v_lshrrev_b32 v7, 1, v6
    v_and_b32 v7, 7, v7
    v_lshrrev_b32 v8, 5, v0
    v_xor_b32 v7, v7, v8
    v_lshlrev_b32 v7, 4, v7
    v_lshlrev_b32 v6, 7, v6
    v_add_u32 v6, v6, v7
    v_xor_b32 v20, 0, v6
    v_add_u32 v36, 65536, v20
    v_xor_b32 v21, 32, v6
    v_add_u32 v37, 65536, v21
    v_xor_b32 v22, 64, v6
    v_add_u32 v38, 65536, v22
    v_xor_b32 v23, 96, v6
    v_add_u32 v39, 65536, v23
    v_lshrrev_b32 v6, 5, v0
    v_lshlrev_b32 v6, 3, v6
    v_bfe_u32 v7, v0, 2, 2
    v_add_u32 v6, v6, v7
    v_bfe_u32 v8, v0, 4, 1
    v_lshlrev_b32 v8, 4, v8
    v_and_b32 v9, 3, v0
    v_lshlrev_b32 v9, 2, v9
    v_add_u32 v8, v8, v9
    v_add_u32 v8, s39, v8
    v_add_u32 v9, 0, v8
    v_lshlrev_b32 v9, 1, v9
    v_lshlrev_b32 v18, 5, v7
    v_and_b32 v18, 64, v18
    v_xor_b32 v9, v9, v18
    v_mul_u32_u24 v19, 384, v6
    v_add_u32 v24, v19, v9
    v_add_u32 v24, 65536, v24
    v_add_u32 v28, 49152, v24
    v_add_u32 v9, 32, v8
    v_lshlrev_b32 v9, 1, v9
    v_lshlrev_b32 v18, 5, v7
    v_and_b32 v18, 64, v18
    v_xor_b32 v9, v9, v18
    v_mul_u32_u24 v19, 384, v6
    v_add_u32 v25, v19, v9
    v_add_u32 v25, 65536, v25
    v_add_u32 v29, 49152, v25
    v_add_u32 v9, 64, v8
    v_lshlrev_b32 v9, 1, v9
    v_lshlrev_b32 v18, 5, v7
    v_and_b32 v18, 64, v18
    v_xor_b32 v9, v9, v18
    v_mul_u32_u24 v19, 384, v6
    v_add_u32 v26, v19, v9
    v_add_u32 v26, 65536, v26
    v_add_u32 v30, 49152, v26
    v_mov_b32 v40, 0
    v_mov_b32 v41, 0
    v_mov_b32 v42, 0
    v_mov_b32 v43, 0
    v_mov_b32 v44, 0
    v_mov_b32 v45, 0
    v_mov_b32 v46, 0
    v_mov_b32 v47, 0
    v_mov_b32 v48, 0
    v_mov_b32 v49, 0
    v_mov_b32 v50, 0
    v_mov_b32 v51, 0
    v_mov_b32 v52, 0
    v_mov_b32 v53, 0
    v_mov_b32 v54, 0
    v_mov_b32 v55, 0
    v_mov_b32 v56, 0
    v_mov_b32 v57, 0
    v_mov_b32 v58, 0
    v_mov_b32 v59, 0
    v_mov_b32 v60, 0
    v_mov_b32 v61, 0
    v_mov_b32 v62, 0
    v_mov_b32 v63, 0
    v_mov_b32 v64, 0
    v_mov_b32 v65, 0
    v_mov_b32 v66, 0
    v_mov_b32 v67, 0
    v_mov_b32 v68, 0
    v_mov_b32 v69, 0
    v_mov_b32 v70, 0
    v_mov_b32 v71, 0
    v_mov_b32 v72, 0
    v_mov_b32 v73, 0
    v_mov_b32 v74, 0
    v_mov_b32 v75, 0
    v_mov_b32 v76, 0
    v_mov_b32 v77, 0
    v_mov_b32 v78, 0
    v_mov_b32 v79, 0
    v_mov_b32 v80, 0
    v_mov_b32 v81, 0
    v_mov_b32 v82, 0
    v_mov_b32 v83, 0
    v_mov_b32 v84, 0
    v_mov_b32 v85, 0
    v_mov_b32 v86, 0
    v_mov_b32 v87, 0
    s_lshl_b32 s40, s30, 11
    s_mul_i32 s41, s30, 3072
    s_add_u32 s41, s41, 65536
    s_mov_b32 s32, 0
    s_mov_b32 s33, 0
    s_and_b32 s42, s4, 15
    s_mov_b32 s42, 0
    s_mov_b32 s35, 0
    s_add_u32 s35, s35, s42
    s_sub_u32 s34, s35, 16
    s_cmp_ge_u32 s35, 16
    s_cselect_b32 s35, s34, s35
    s_mul_i32 s33, s35, 393216
    s_lshl_b32 s32, s35, 7
    s_add_u32 m0, s40, 0
    s_nop 0
    buffer_load_dwordx4 v2, s[8:11], s32 offen lds
    s_add_u32 m0, s40, 1024
    s_nop 0
    buffer_load_dwordx4 v3, s[8:11], s32 offen lds
    s_add_u32 m0, s41, 0
    s_nop 0
    buffer_load_dwordx4 v10, s[12:15], s33 offen lds
    s_add_u32 m0, s41, 1024
    s_nop 0
    buffer_load_dwordx4 v11, s[12:15], s33 offen lds
    s_add_u32 m0, s41, 2048
    s_nop 0
    buffer_load_dwordx4 v12, s[12:15], s33 offen lds
    s_mov_b32 s35, 1
    s_add_u32 s35, s35, s42
    s_sub_u32 s34, s35, 16
    s_cmp_ge_u32 s35, 16
    s_cselect_b32 s35, s34, s35
    s_mul_i32 s33, s35, 393216
    s_lshl_b32 s32, s35, 7
    s_add_u32 m0, s40, 16384
    s_nop 0
    buffer_load_dwordx4 v2, s[8:11], s32 offen lds
    s_add_u32 m0, s40, 17408
    s_nop 0
    buffer_load_dwordx4 v3, s[8:11], s32 offen lds
    s_add_u32 m0, s41, 24576
    s_nop 0
    buffer_load_dwordx4 v10, s[12:15], s33 offen lds
    s_add_u32 m0, s41, 25600
    s_nop 0
    buffer_load_dwordx4 v11, s[12:15], s33 offen lds
    s_add_u32 m0, s41, 26624
    s_nop 0
    buffer_load_dwordx4 v12, s[12:15], s33 offen lds
    s_mov_b32 s35, 2
    s_add_u32 s35, s35, s42
    s_sub_u32 s34, s35, 16
    s_cmp_ge_u32 s35, 16
    s_cselect_b32 s35, s34, s35
    s_mul_i32 s33, s35, 393216
    s_lshl_b32 s32, s35, 7
    s_add_u32 m0, s40, 32768
    s_nop 0
    buffer_load_dwordx4 v2, s[8:11], s32 offen lds
    s_add_u32 m0, s40, 33792
    s_nop 0
    buffer_load_dwordx4 v3, s[8:11], s32 offen lds
    s_add_u32 m0, s41, 49152
    s_nop 0
    buffer_load_dwordx4 v10, s[12:15], s33 offen lds
    s_add_u32 m0, s41, 50176
    s_nop 0
    buffer_load_dwordx4 v11, s[12:15], s33 offen lds
    s_add_u32 m0, s41, 51200
    s_nop 0
    buffer_load_dwordx4 v12, s[12:15], s33 offen lds
    s_mov_b32 s31, 0
    s_waitcnt vmcnt(10)
    s_barrier
    ds_read_b128 v[88:91], v20 offset:0
    ds_read_b64_tr_b16 v[92:93], v24 offset:0
    ds_read_b64_tr_b16 v[94:95], v24 offset:1536
    ds_read_b64_tr_b16 v[96:97], v25 offset:0
    ds_read_b64_tr_b16 v[98:99], v25 offset:1536
    ds_read_b64_tr_b16 v[100:101], v26 offset:0
    ds_read_b64_tr_b16 v[102:103], v26 offset:1536
L_loop_gqkv_1_kernel:
    s_cmp_ge_u32 s31, 13
    s_cbranch_scc1 L_gqkv_1_kernel_tail1
    s_waitcnt vmcnt(5)
    s_barrier
    s_add_u32 s35, s31, 3
    s_add_u32 s35, s35, s42
    s_sub_u32 s34, s35, 16
    s_cmp_ge_u32 s35, 16
    s_cselect_b32 s35, s34, s35
    s_mul_i32 s33, s35, 393216
    s_lshl_b32 s32, s35, 7
    s_add_u32 m0, s40, 49152
    s_nop 0
    buffer_load_dwordx4 v2, s[8:11], s32 offen lds
    s_add_u32 m0, s40, 50176
    s_nop 0
    buffer_load_dwordx4 v3, s[8:11], s32 offen lds
    s_add_u32 m0, s41, 73728
    s_nop 0
    buffer_load_dwordx4 v10, s[12:15], s33 offen lds
    s_add_u32 m0, s41, 74752
    s_nop 0
    buffer_load_dwordx4 v11, s[12:15], s33 offen lds
    s_add_u32 m0, s41, 75776
    s_nop 0
    buffer_load_dwordx4 v12, s[12:15], s33 offen lds
    s_branch L_gqkv_1_kernel_join2
L_gqkv_1_kernel_tail1:
    s_waitcnt vmcnt(0)
    s_barrier
L_gqkv_1_kernel_join2:
    ds_read_b128 v[104:107], v21 offset:0
    ds_read_b64_tr_b16 v[108:109], v24 offset:6144
    ds_read_b64_tr_b16 v[110:111], v24 offset:7680
    ds_read_b64_tr_b16 v[112:113], v25 offset:6144
    ds_read_b64_tr_b16 v[114:115], v25 offset:7680
    ds_read_b64_tr_b16 v[116:117], v26 offset:6144
    ds_read_b64_tr_b16 v[118:119], v26 offset:7680
    s_waitcnt lgkmcnt(7)
    v_mfma_f32_32x32x16_bf16 v[40:55], v[92:95], v[88:91], v[40:55]
    v_mfma_f32_32x32x16_bf16 v[56:71], v[96:99], v[88:91], v[56:71]
    v_mfma_f32_32x32x16_bf16 v[72:87], v[100:103], v[88:91], v[72:87]
    ds_read_b128 v[88:91], v22 offset:0
    ds_read_b64_tr_b16 v[92:93], v24 offset:12288
    ds_read_b64_tr_b16 v[94:95], v24 offset:13824
    ds_read_b64_tr_b16 v[96:97], v25 offset:12288
    ds_read_b64_tr_b16 v[98:99], v25 offset:13824
    ds_read_b64_tr_b16 v[100:101], v26 offset:12288
    ds_read_b64_tr_b16 v[102:103], v26 offset:13824
    s_waitcnt lgkmcnt(7)
    v_mfma_f32_32x32x16_bf16 v[40:55], v[108:111], v[104:107], v[40:55]
    v_mfma_f32_32x32x16_bf16 v[56:71], v[112:115], v[104:107], v[56:71]
    v_mfma_f32_32x32x16_bf16 v[72:87], v[116:119], v[104:107], v[72:87]
    ds_read_b128 v[104:107], v23 offset:0
    ds_read_b64_tr_b16 v[108:109], v24 offset:18432
    ds_read_b64_tr_b16 v[110:111], v24 offset:19968
    ds_read_b64_tr_b16 v[112:113], v25 offset:18432
    ds_read_b64_tr_b16 v[114:115], v25 offset:19968
    ds_read_b64_tr_b16 v[116:117], v26 offset:18432
    ds_read_b64_tr_b16 v[118:119], v26 offset:19968
    s_waitcnt lgkmcnt(7)
    v_mfma_f32_32x32x16_bf16 v[40:55], v[92:95], v[88:91], v[40:55]
    v_mfma_f32_32x32x16_bf16 v[56:71], v[96:99], v[88:91], v[56:71]
    v_mfma_f32_32x32x16_bf16 v[72:87], v[100:103], v[88:91], v[72:87]
    ds_read_b128 v[88:91], v20 offset:16384
    ds_read_b64_tr_b16 v[92:93], v24 offset:24576
    ds_read_b64_tr_b16 v[94:95], v24 offset:26112
    ds_read_b64_tr_b16 v[96:97], v25 offset:24576
    ds_read_b64_tr_b16 v[98:99], v25 offset:26112
    ds_read_b64_tr_b16 v[100:101], v26 offset:24576
    ds_read_b64_tr_b16 v[102:103], v26 offset:26112
    s_waitcnt lgkmcnt(7)
    v_mfma_f32_32x32x16_bf16 v[40:55], v[108:111], v[104:107], v[40:55]
    v_mfma_f32_32x32x16_bf16 v[56:71], v[112:115], v[104:107], v[56:71]
    v_mfma_f32_32x32x16_bf16 v[72:87], v[116:119], v[104:107], v[72:87]
    s_cmp_ge_u32 s31, 12
    s_cbranch_scc1 L_gqkv_1_kernel_tail3
    s_waitcnt vmcnt(5)
    s_barrier
    s_add_u32 s35, s31, 4
    s_add_u32 s35, s35, s42
    s_sub_u32 s34, s35, 16
    s_cmp_ge_u32 s35, 16
    s_cselect_b32 s35, s34, s35
    s_mul_i32 s33, s35, 393216
    s_lshl_b32 s32, s35, 7
    s_add_u32 m0, s40, 0
    s_nop 0
    buffer_load_dwordx4 v2, s[8:11], s32 offen lds
    s_add_u32 m0, s40, 1024
    s_nop 0
    buffer_load_dwordx4 v3, s[8:11], s32 offen lds
    s_add_u32 m0, s41, 0
    s_nop 0
    buffer_load_dwordx4 v10, s[12:15], s33 offen lds
    s_add_u32 m0, s41, 1024
    s_nop 0
    buffer_load_dwordx4 v11, s[12:15], s33 offen lds
    s_add_u32 m0, s41, 2048
    s_nop 0
    buffer_load_dwordx4 v12, s[12:15], s33 offen lds
    s_branch L_gqkv_1_kernel_join4
L_gqkv_1_kernel_tail3:
    s_waitcnt vmcnt(0)
    s_barrier
L_gqkv_1_kernel_join4:
    ds_read_b128 v[104:107], v21 offset:16384
    ds_read_b64_tr_b16 v[108:109], v24 offset:30720
    ds_read_b64_tr_b16 v[110:111], v24 offset:32256
    ds_read_b64_tr_b16 v[112:113], v25 offset:30720
    ds_read_b64_tr_b16 v[114:115], v25 offset:32256
    ds_read_b64_tr_b16 v[116:117], v26 offset:30720
    ds_read_b64_tr_b16 v[118:119], v26 offset:32256
    s_waitcnt lgkmcnt(7)
    v_mfma_f32_32x32x16_bf16 v[40:55], v[92:95], v[88:91], v[40:55]
    v_mfma_f32_32x32x16_bf16 v[56:71], v[96:99], v[88:91], v[56:71]
    v_mfma_f32_32x32x16_bf16 v[72:87], v[100:103], v[88:91], v[72:87]
    ds_read_b128 v[88:91], v22 offset:16384
    ds_read_b64_tr_b16 v[92:93], v24 offset:36864
    ds_read_b64_tr_b16 v[94:95], v24 offset:38400
    ds_read_b64_tr_b16 v[96:97], v25 offset:36864
    ds_read_b64_tr_b16 v[98:99], v25 offset:38400
    ds_read_b64_tr_b16 v[100:101], v26 offset:36864
    ds_read_b64_tr_b16 v[102:103], v26 offset:38400
    s_waitcnt lgkmcnt(7)
    v_mfma_f32_32x32x16_bf16 v[40:55], v[108:111], v[104:107], v[40:55]
    v_mfma_f32_32x32x16_bf16 v[56:71], v[112:115], v[104:107], v[56:71]
    v_mfma_f32_32x32x16_bf16 v[72:87], v[116:119], v[104:107], v[72:87]
    ds_read_b128 v[104:107], v23 offset:16384
    ds_read_b64_tr_b16 v[108:109], v24 offset:43008
    ds_read_b64_tr_b16 v[110:111], v24 offset:44544
    ds_read_b64_tr_b16 v[112:113], v25 offset:43008
    ds_read_b64_tr_b16 v[114:115], v25 offset:44544
    ds_read_b64_tr_b16 v[116:117], v26 offset:43008
    ds_read_b64_tr_b16 v[118:119], v26 offset:44544
    s_waitcnt lgkmcnt(7)
    v_mfma_f32_32x32x16_bf16 v[40:55], v[92:95], v[88:91], v[40:55]
    v_mfma_f32_32x32x16_bf16 v[56:71], v[96:99], v[88:91], v[56:71]
    v_mfma_f32_32x32x16_bf16 v[72:87], v[100:103], v[88:91], v[72:87]
    ds_read_b128 v[88:91], v20 offset:32768
    ds_read_b64_tr_b16 v[92:93], v28 offset:0
    ds_read_b64_tr_b16 v[94:95], v28 offset:1536
    ds_read_b64_tr_b16 v[96:97], v29 offset:0
    ds_read_b64_tr_b16 v[98:99], v29 offset:1536
    ds_read_b64_tr_b16 v[100:101], v30 offset:0
    ds_read_b64_tr_b16 v[102:103], v30 offset:1536
    s_waitcnt lgkmcnt(7)
    v_mfma_f32_32x32x16_bf16 v[40:55], v[108:111], v[104:107], v[40:55]
    v_mfma_f32_32x32x16_bf16 v[56:71], v[112:115], v[104:107], v[56:71]
    v_mfma_f32_32x32x16_bf16 v[72:87], v[116:119], v[104:107], v[72:87]
    s_cmp_ge_u32 s31, 11
    s_cbranch_scc1 L_gqkv_1_kernel_tail5
    s_waitcnt vmcnt(5)
    s_barrier
    s_add_u32 s35, s31, 5
    s_add_u32 s35, s35, s42
    s_sub_u32 s34, s35, 16
    s_cmp_ge_u32 s35, 16
    s_cselect_b32 s35, s34, s35
    s_mul_i32 s33, s35, 393216
    s_lshl_b32 s32, s35, 7
    s_add_u32 m0, s40, 16384
    s_nop 0
    buffer_load_dwordx4 v2, s[8:11], s32 offen lds
    s_add_u32 m0, s40, 17408
    s_nop 0
    buffer_load_dwordx4 v3, s[8:11], s32 offen lds
    s_add_u32 m0, s41, 24576
    s_nop 0
    buffer_load_dwordx4 v10, s[12:15], s33 offen lds
    s_add_u32 m0, s41, 25600
    s_nop 0
    buffer_load_dwordx4 v11, s[12:15], s33 offen lds
    s_add_u32 m0, s41, 26624
    s_nop 0
    buffer_load_dwordx4 v12, s[12:15], s33 offen lds
    s_branch L_gqkv_1_kernel_join6
L_gqkv_1_kernel_tail5:
    s_waitcnt vmcnt(0)
    s_barrier
L_gqkv_1_kernel_join6:
    ds_read_b128 v[104:107], v21 offset:32768
    ds_read_b64_tr_b16 v[108:109], v28 offset:6144
    ds_read_b64_tr_b16 v[110:111], v28 offset:7680
    ds_read_b64_tr_b16 v[112:113], v29 offset:6144
    ds_read_b64_tr_b16 v[114:115], v29 offset:7680
    ds_read_b64_tr_b16 v[116:117], v30 offset:6144
    ds_read_b64_tr_b16 v[118:119], v30 offset:7680
    s_waitcnt lgkmcnt(7)
    v_mfma_f32_32x32x16_bf16 v[40:55], v[92:95], v[88:91], v[40:55]
    v_mfma_f32_32x32x16_bf16 v[56:71], v[96:99], v[88:91], v[56:71]
    v_mfma_f32_32x32x16_bf16 v[72:87], v[100:103], v[88:91], v[72:87]
    ds_read_b128 v[88:91], v22 offset:32768
    ds_read_b64_tr_b16 v[92:93], v28 offset:12288
    ds_read_b64_tr_b16 v[94:95], v28 offset:13824
    ds_read_b64_tr_b16 v[96:97], v29 offset:12288
    ds_read_b64_tr_b16 v[98:99], v29 offset:13824
    ds_read_b64_tr_b16 v[100:101], v30 offset:12288
    ds_read_b64_tr_b16 v[102:103], v30 offset:13824
    s_waitcnt lgkmcnt(7)
    v_mfma_f32_32x32x16_bf16 v[40:55], v[108:111], v[104:107], v[40:55]
    v_mfma_f32_32x32x16_bf16 v[56:71], v[112:115], v[104:107], v[56:71]
    v_mfma_f32_32x32x16_bf16 v[72:87], v[116:119], v[104:107], v[72:87]
    ds_read_b128 v[104:107], v23 offset:32768
    ds_read_b64_tr_b16 v[108:109], v28 offset:18432
    ds_read_b64_tr_b16 v[110:111], v28 offset:19968
    ds_read_b64_tr_b16 v[112:113], v29 offset:18432
    ds_read_b64_tr_b16 v[114:115], v29 offset:19968
    ds_read_b64_tr_b16 v[116:117], v30 offset:18432
    ds_read_b64_tr_b16 v[118:119], v30 offset:19968
    s_waitcnt lgkmcnt(7)
    v_mfma_f32_32x32x16_bf16 v[40:55], v[92:95], v[88:91], v[40:55]
    v_mfma_f32_32x32x16_bf16 v[56:71], v[96:99], v[88:91], v[56:71]
    v_mfma_f32_32x32x16_bf16 v[72:87], v[100:103], v[88:91], v[72:87]
    ds_read_b128 v[88:91], v20 offset:49152
    ds_read_b64_tr_b16 v[92:93], v28 offset:24576
    ds_read_b64_tr_b16 v[94:95], v28 offset:26112
    ds_read_b64_tr_b16 v[96:97], v29 offset:24576
    ds_read_b64_tr_b16 v[98:99], v29 offset:26112
    ds_read_b64_tr_b16 v[100:101], v30 offset:24576
    ds_read_b64_tr_b16 v[102:103], v30 offset:26112
    s_waitcnt lgkmcnt(7)
    v_mfma_f32_32x32x16_bf16 v[40:55], v[108:111], v[104:107], v[40:55]
    v_mfma_f32_32x32x16_bf16 v[56:71], v[112:115], v[104:107], v[56:71]
    v_mfma_f32_32x32x16_bf16 v[72:87], v[116:119], v[104:107], v[72:87]
    s_cmp_ge_u32 s31, 10
    s_cbranch_scc1 L_gqkv_1_kernel_tail7
    s_waitcnt vmcnt(5)
    s_barrier
    s_add_u32 s35, s31, 6
    s_add_u32 s35, s35, s42
    s_sub_u32 s34, s35, 16
    s_cmp_ge_u32 s35, 16
    s_cselect_b32 s35, s34, s35
    s_mul_i32 s33, s35, 393216
    s_lshl_b32 s32, s35, 7
    s_add_u32 m0, s40, 32768
    s_nop 0
    buffer_load_dwordx4 v2, s[8:11], s32 offen lds
    s_add_u32 m0, s40, 33792
    s_nop 0
    buffer_load_dwordx4 v3, s[8:11], s32 offen lds
    s_add_u32 m0, s41, 49152
    s_nop 0
    buffer_load_dwordx4 v10, s[12:15], s33 offen lds
    s_add_u32 m0, s41, 50176
    s_nop 0
    buffer_load_dwordx4 v11, s[12:15], s33 offen lds
    s_add_u32 m0, s41, 51200
    s_nop 0
    buffer_load_dwordx4 v12, s[12:15], s33 offen lds
    s_branch L_gqkv_1_kernel_join8
L_gqkv_1_kernel_tail7:
    s_waitcnt vmcnt(0)
    s_barrier
L_gqkv_1_kernel_join8:
    ds_read_b128 v[104:107], v21 offset:49152
    ds_read_b64_tr_b16 v[108:109], v28 offset:30720
    ds_read_b64_tr_b16 v[110:111], v28 offset:32256
    ds_read_b64_tr_b16 v[112:113], v29 offset:30720
    ds_read_b64_tr_b16 v[114:115], v29 offset:32256
    ds_read_b64_tr_b16 v[116:117], v30 offset:30720
    ds_read_b64_tr_b16 v[118:119], v30 offset:32256
    s_waitcnt lgkmcnt(7)
    v_mfma_f32_32x32x16_bf16 v[40:55], v[92:95], v[88:91], v[40:55]
    v_mfma_f32_32x32x16_bf16 v[56:71], v[96:99], v[88:91], v[56:71]
    v_mfma_f32_32x32x16_bf16 v[72:87], v[100:103], v[88:91], v[72:87]
    ds_read_b128 v[88:91], v22 offset:49152
    ds_read_b64_tr_b16 v[92:93], v28 offset:36864
    ds_read_b64_tr_b16 v[94:95], v28 offset:38400
    ds_read_b64_tr_b16 v[96:97], v29 offset:36864
    ds_read_b64_tr_b16 v[98:99], v29 offset:38400
    ds_read_b64_tr_b16 v[100:101], v30 offset:36864
    ds_read_b64_tr_b16 v[102:103], v30 offset:38400
    s_waitcnt lgkmcnt(7)
    v_mfma_f32_32x32x16_bf16 v[40:55], v[108:111], v[104:107], v[40:55]
    v_mfma_f32_32x32x16_bf16 v[56:71], v[112:115], v[104:107], v[56:71]
    v_mfma_f32_32x32x16_bf16 v[72:87], v[116:119], v[104:107], v[72:87]
    ds_read_b128 v[104:107], v23 offset:49152
    ds_read_b64_tr_b16 v[108:109], v28 offset:43008
    ds_read_b64_tr_b16 v[110:111], v28 offset:44544
    ds_read_b64_tr_b16 v[112:113], v29 offset:43008
    ds_read_b64_tr_b16 v[114:115], v29 offset:44544
    ds_read_b64_tr_b16 v[116:117], v30 offset:43008
    ds_read_b64_tr_b16 v[118:119], v30 offset:44544
    s_waitcnt lgkmcnt(7)
    v_mfma_f32_32x32x16_bf16 v[40:55], v[92:95], v[88:91], v[40:55]
    v_mfma_f32_32x32x16_bf16 v[56:71], v[96:99], v[88:91], v[56:71]
    v_mfma_f32_32x32x16_bf16 v[72:87], v[100:103], v[88:91], v[72:87]
    ds_read_b128 v[88:91], v20 offset:0
    ds_read_b64_tr_b16 v[92:93], v24 offset:0
    ds_read_b64_tr_b16 v[94:95], v24 offset:1536
    ds_read_b64_tr_b16 v[96:97], v25 offset:0
    ds_read_b64_tr_b16 v[98:99], v25 offset:1536
    ds_read_b64_tr_b16 v[100:101], v26 offset:0
    ds_read_b64_tr_b16 v[102:103], v26 offset:1536
    s_waitcnt lgkmcnt(7)
    v_mfma_f32_32x32x16_bf16 v[40:55], v[108:111], v[104:107], v[40:55]
    v_mfma_f32_32x32x16_bf16 v[56:71], v[112:115], v[104:107], v[56:71]
    v_mfma_f32_32x32x16_bf16 v[72:87], v[116:119], v[104:107], v[72:87]
    s_add_u32 s31, s31, 4
    s_cmp_lt_u32 s31, 16
    s_cbranch_scc1 L_loop_gqkv_1_kernel
L_lend_gqkv_1_kernel:
    s_nop 15
    s_nop 7
    s_lshr_b32 s31, s30, 1
    s_and_b32 s34, s30, 1
    s_mul_i32 s38, s31, 32
    s_mul_i32 s39, s34, 96
    s_lshl_b32 s31, s28, 7
    s_add_u32 s38, s38, s31
    s_mul_i32 s31, s29, 192
    s_add_u32 s39, s39, s31
    s_barrier
    s_mul_i32 s32, s30, 6656
    v_and_b32 v1, 31, v0
    v_mul_u32_u24 v1, 208, v1
    v_lshrrev_b32 v2, 5, v0
    v_lshlrev_b32 v2, 3, v2
    v_add_u32 v1, v1, v2
    v_add_u32 v1, s32, v1
    v_cvt_pk_bf16_f32 v40, v40, v41
    v_cvt_pk_bf16_f32 v41, v42, v43
    ds_write_b64 v1, v[40:41] offset:0
    v_cvt_pk_bf16_f32 v44, v44, v45
    v_cvt_pk_bf16_f32 v45, v46, v47
    ds_write_b64 v1, v[44:45] offset:16
    v_cvt_pk_bf16_f32 v48, v48, v49
    v_cvt_pk_bf16_f32 v49, v50, v51
    ds_write_b64 v1, v[48:49] offset:32
    v_cvt_pk_bf16_f32 v52, v52, v53
    v_cvt_pk_bf16_f32 v53, v54, v55
    ds_write_b64 v1, v[52:53] offset:48
    v_cvt_pk_bf16_f32 v56, v56, v57
    v_cvt_pk_bf16_f32 v57, v58, v59
    ds_write_b64 v1, v[56:57] offset:64
    v_cvt_pk_bf16_f32 v60, v60, v61
    v_cvt_pk_bf16_f32 v61, v62, v63
    ds_write_b64 v1, v[60:61] offset:80
    v_cvt_pk_bf16_f32 v64, v64, v65
    v_cvt_pk_bf16_f32 v65, v66, v67
    ds_write_b64 v1, v[64:65] offset:96
    v_cvt_pk_bf16_f32 v68, v68, v69
    v_cvt_pk_bf16_f32 v69, v70, v71
    ds_write_b64 v1, v[68:69] offset:112
    v_cvt_pk_bf16_f32 v72, v72, v73
    v_cvt_pk_bf16_f32 v73, v74, v75
    ds_write_b64 v1, v[72:73] offset:128
    v_cvt_pk_bf16_f32 v76, v76, v77
    v_cvt_pk_bf16_f32 v77, v78, v79
    ds_write_b64 v1, v[76:77] offset:144
    v_cvt_pk_bf16_f32 v80, v80, v81
    v_cvt_pk_bf16_f32 v81, v82, v83
    ds_write_b64 v1, v[80:81] offset:160
    v_cvt_pk_bf16_f32 v84, v84, v85
    v_cvt_pk_bf16_f32 v85, v86, v87
    ds_write_b64 v1, v[84:85] offset:176
    s_mov_b32 s35, 6144
    s_lshl_b32 s39, s39, 1
    v_add_u32 v2, 0, v0
    v_mul_u32_u24 v3, 5462, v2
    v_lshrrev_b32 v3, 16, v3
    v_mul_u32_u24 v4, 12, v3
    v_sub_u32 v4, v2, v4
    v_lshlrev_b32 v4, 4, v4
    v_mul_u32_u24 v5, 208, v3
    v_add_u32 v5, v5, v4
    v_add_u32 v8, s32, v5
    v_add_u32 v3, s38, v3
    v_mul_lo_u32 v3, v3, s35
    v_add_u32 v3, v3, v4
    v_add_u32 v16, s39, v3
    v_add_u32 v2, 64, v0
    v_mul_u32_u24 v3, 5462, v2
    v_lshrrev_b32 v3, 16, v3
    v_mul_u32_u24 v4, 12, v3
    v_sub_u32 v4, v2, v4
    v_lshlrev_b32 v4, 4, v4
    v_mul_u32_u24 v5, 208, v3
    v_add_u32 v5, v5, v4
    v_add_u32 v9, s32, v5
    v_add_u32 v3, s38, v3
    v_mul_lo_u32 v3, v3, s35
    v_add_u32 v3, v3, v4
    v_add_u32 v17, s39, v3
    v_add_u32 v2, 128, v0
    v_mul_u32_u24 v3, 5462, v2
    v_lshrrev_b32 v3, 16, v3
    v_mul_u32_u24 v4, 12, v3
    v_sub_u32 v4, v2, v4
    v_lshlrev_b32 v4, 4, v4
    v_mul_u32_u24 v5, 208, v3
    v_add_u32 v5, v5, v4
    v_add_u32 v10, s32, v5
    v_add_u32 v3, s38, v3
    v_mul_lo_u32 v3, v3, s35
    v_add_u32 v3, v3, v4
    v_add_u32 v18, s39, v3
    v_add_u32 v2, 192, v0
    v_mul_u32_u24 v3, 5462, v2
    v_lshrrev_b32 v3, 16, v3
    v_mul_u32_u24 v4, 12, v3
    v_sub_u32 v4, v2, v4
    v_lshlrev_b32 v4, 4, v4
    v_mul_u32_u24 v5, 208, v3
    v_add_u32 v5, v5, v4
    v_add_u32 v11, s32, v5
    v_add_u32 v3, s38, v3
    v_mul_lo_u32 v3, v3, s35
    v_add_u32 v3, v3, v4
    v_add_u32 v19, s39, v3
    v_add_u32 v2, 256, v0
    v_mul_u32_u24 v3, 5462, v2
    v_lshrrev_b32 v3, 16, v3
    v_mul_u32_u24 v4, 12, v3
    v_sub_u32 v4, v2, v4
    v_lshlrev_b32 v4, 4, v4
    v_mul_u32_u24 v5, 208, v3
    v_add_u32 v5, v5, v4
    v_add_u32 v12, s32, v5
    v_add_u32 v3, s38, v3
    v_mul_lo_u32 v3, v3, s35
    v_add_u32 v3, v3, v4
    v_add_u32 v20, s39, v3
    v_add_u32 v2, 320, v0
    v_mul_u32_u24 v3, 5462, v2
    v_lshrrev_b32 v3, 16, v3
    v_mul_u32_u24 v4, 12, v3
    v_sub_u32 v4, v2, v4
    v_lshlrev_b32 v4, 4, v4
    v_mul_u32_u24 v5, 208, v3
    v_add_u32 v5, v5, v4
    v_add_u32 v13, s32, v5
    v_add_u32 v3, s38, v3
    v_mul_lo_u32 v3, v3, s35
    v_add_u32 v3, v3, v4
    v_add_u32 v21, s39, v3
    s_waitcnt lgkmcnt(0)
    ds_read_b128 v[40:43], v8
    ds_read_b128 v[44:47], v9
    ds_read_b128 v[48:51], v10
    ds_read_b128 v[52:55], v11
    ds_read_b128 v[56:59], v12
    ds_read_b128 v[60:63], v13
    s_waitcnt lgkmcnt(0)
    buffer_store_dwordx4 v[40:43], v16, s[16:19], 0 offen
    buffer_store_dwordx4 v[44:47], v17, s[16:19], 0 offen
    buffer_store_dwordx4 v[48:51], v18, s[16:19], 0 offen
    buffer_store_dwordx4 v[52:55], v19, s[16:19], 0 offen
    buffer_store_dwordx4 v[56:59], v20, s[16:19], 0 offen
    buffer_store_dwordx4 v[60:63], v21, s[16:19], 0 offen
L_done_gqkv_1_kernel:
    s_endpgm
.globl akv_1_kernel
.p2align 8
.type akv_1_kernel,@function
akv_1_kernel:
    s_cmp_ge_u32 s2, 256
    s_cbranch_scc1 L_done_akv_1_kernel
    s_load_dwordx2 s[40:41], s[0:1], 16
    s_load_dwordx2 s[42:43], s[0:1], 88
    s_waitcnt lgkmcnt(0)
    s_add_u32 s8, s42, 4194304
    s_addc_u32 s9, s43, 0
    s_mov_b32 s10, 12582912
    s_mov_b32 s11, 0x00020000
    s_mov_b32 s12, s40
    s_mov_b32 s13, s41
    s_mov_b32 s14, 65536
    s_mov_b32 s15, 0x00020000
    s_add_u32 s16, s42, 16777216
    s_addc_u32 s17, s43, 0
    s_mov_b32 s18, 2162688
    s_mov_b32 s19, 0x00020000
    s_and_b32 s28, s2, 31
    s_lshr_b32 s29, s2, 5
    v_lshrrev_b32 v1, 6, v0
    s_nop 0
    v_readfirstlane_b32 s30, v1
    v_mov_b32 v60, v0
    v_and_b32 v0, 63, v0
    v_and_b32 v2, 31, v0
    v_lshrrev_b32 v3, 5, v0
    v_xor_b32 v4, 32, v0
    v_lshlrev_b32 v4, 2, v4
    s_lshl_b32 s31, s28, 11
    v_lshlrev_b32 v5, 9, v3
    v_lshlrev_b32 v6, 1, v2
    v_add_u32 v5, v5, v6
    v_add_u32 v5, s31, v5
    buffer_load_ushort v16, v5, s[12:15], 0 offen offset:0
    buffer_load_ushort v17, v5, s[12:15], 0 offen offset:64
    buffer_load_ushort v18, v5, s[12:15], 0 offen offset:128
    buffer_load_ushort v19, v5, s[12:15], 0 offen offset:192
    buffer_load_ushort v20, v5, s[12:15], 0 offen offset:256
    buffer_load_ushort v21, v5, s[12:15], 0 offen offset:320
    buffer_load_ushort v22, v5, s[12:15], 0 offen offset:384
    buffer_load_ushort v23, v5, s[12:15], 0 offen offset:448
    buffer_load_ushort v24, v5, s[12:15], 0 offen offset:1024
    buffer_load_ushort v25, v5, s[12:15], 0 offen offset:1088
    buffer_load_ushort v26, v5, s[12:15], 0 offen offset:1152
    buffer_load_ushort v27, v5, s[12:15], 0 offen offset:1216
    buffer_load_ushort v28, v5, s[12:15], 0 offen offset:1280
    buffer_load_ushort v29, v5, s[12:15], 0 offen offset:1344
    buffer_load_ushort v30, v5, s[12:15], 0 offen offset:1408
    buffer_load_ushort v31, v5, s[12:15], 0 offen offset:1472
    s_waitcnt vmcnt(0)
    v_lshl_or_b32 v8, v17, 16, v16
    v_lshl_or_b32 v9, v19, 16, v18
    v_lshl_or_b32 v10, v21, 16, v20
    v_lshl_or_b32 v11, v23, 16, v22
    v_lshl_or_b32 v12, v25, 16, v24
    v_lshl_or_b32 v13, v27, 16, v26
    v_lshl_or_b32 v14, v29, 16, v28
    v_lshl_or_b32 v15, v31, 16, v30
    v_mov_b32 v64, 0
    v_mov_b32 v65, 0
    v_mov_b32 v66, 0
    v_mov_b32 v67, 0
    v_mov_b32 v68, 0
    v_mov_b32 v69, 0
    v_mov_b32 v70, 0
    v_mov_b32 v71, 0
    v_mov_b32 v72, 0
    v_mov_b32 v73, 0
    v_mov_b32 v74, 0
    v_mov_b32 v75, 0
    v_mov_b32 v76, 0
    v_mov_b32 v77, 0
    v_mov_b32 v78, 0
    v_mov_b32 v79, 0
    v_mov_b32 v80, 0
    v_mov_b32 v81, 0
    v_mov_b32 v82, 0
    v_mov_b32 v83, 0
    v_mov_b32 v84, 0
    v_mov_b32 v85, 0
    v_mov_b32 v86, 0
    v_mov_b32 v87, 0
    v_mov_b32 v88, 0
    v_mov_b32 v89, 0
    v_mov_b32 v90, 0
    v_mov_b32 v91, 0
    v_mov_b32 v92, 0
    v_mov_b32 v93, 0
    v_mov_b32 v94, 0
    v_mov_b32 v95, 0
    v_mov_b32 v96, 0
    v_mov_b32 v97, 0
    v_mov_b32 v98, 0
    v_mov_b32 v99, 0
    v_mov_b32 v100, 0
    v_mov_b32 v101, 0
    v_mov_b32 v102, 0
    v_mov_b32 v103, 0
    v_mov_b32 v104, 0
    v_mov_b32 v105, 0
    v_mov_b32 v106, 0
    v_mov_b32 v107, 0
    v_mov_b32 v108, 0
    v_mov_b32 v109, 0
    v_mov_b32 v110, 0
    v_mov_b32 v111, 0
    v_mov_b32 v112, 0
    v_mov_b32 v113, 0
    v_mov_b32 v114, 0
    v_mov_b32 v115, 0
    v_mov_b32 v116, 0
    v_mov_b32 v117, 0
    v_mov_b32 v118, 0
    v_mov_b32 v119, 0
    v_mov_b32 v120, 0
    v_mov_b32 v121, 0
    v_mov_b32 v122, 0
    v_mov_b32 v123, 0
    v_mov_b32 v124, 0
    v_mov_b32 v125, 0
    v_mov_b32 v126, 0
    v_mov_b32 v127, 0
    v_mov_b32 v128, 0x3f803f80
    v_mov_b32 v129, 0x3f803f80
    v_mov_b32 v130, 0x3f803f80
    v_mov_b32 v131, 0x3f803f80
    s_mul_i32 s32, s30, 6144
    s_add_u32 s32, s32, 33792
    s_lshl_b32 s31, s29, 8
    s_lshl_b32 s33, s30, 6
    s_add_u32 s31, s31, s33
    s_add_u32 s31, s31, 0
    s_mul_i32 s33, s31, 6144
    v_mul_u32_u24 v7, 6144, v2
    v_add_u32 v7, s33, v7
    s_lshl_b32 s34, s28, 6
    s_add_u32 s34, s34, 2048
    v_lshrrev_b32 v61, 2, v0
    v_mul_u32_u24 v61, 6144, v61
    v_and_b32 v62, 3, v0
    v_lshlrev_b32 v62, 4, v62
    v_add_u32 v61, v61, v62
    v_add_u32 v61, s33, v61
    s_lshl_b32 s35, s28, 6
    s_add_u32 s35, s35, 4096
    v_add_u32 v61, s35, v61
    buffer_load_dwordx4 v[132:135], v61, s[8:11], 0 offen
    v_add_u32 v61, 98304, v61
    buffer_load_dwordx4 v[136:139], v61, s[8:11], 0 offen
    v_lshlrev_b32 v6, 4, v3
    v_add_u32 v6, v7, v6
    v_add_u32 v6, s34, v6
    buffer_load_dwordx4 v[48:51], v6, s[8:11], 0 offen
    buffer_load_dwordx4 v[52:55], v6, s[8:11], 0 offen offset:32
    v_mov_b32 v16, 0
    v_mov_b32 v17, 0
    v_mov_b32 v18, 0
    v_mov_b32 v19, 0
    v_mov_b32 v20, 0
    v_mov_b32 v21, 0
    v_mov_b32 v22, 0
    v_mov_b32 v23, 0
    v_mov_b32 v24, 0
    v_mov_b32 v25, 0
    v_mov_b32 v26, 0
    v_mov_b32 v27, 0
    v_mov_b32 v28, 0
    v_mov_b32 v29, 0
    v_mov_b32 v30, 0
    v_mov_b32 v31, 0
    s_waitcnt vmcnt(0)
    v_mfma_f32_32x32x16_bf16 v[16:31], v[8:11], v[48:51], v[16:31]
    v_mfma_f32_32x32x16_bf16 v[16:31], v[12:15], v[52:55], v[16:31]
    s_nop 15
    s_nop 3
    v_cvt_pk_bf16_f32 v16, v16, v16
    v_lshlrev_b32 v16, 16, v16
    v_cvt_pk_bf16_f32 v17, v17, v17
    v_lshlrev_b32 v17, 16, v17
    v_cvt_pk_bf16_f32 v18, v18, v18
    v_lshlrev_b32 v18, 16, v18
    v_cvt_pk_bf16_f32 v19, v19, v19
    v_lshlrev_b32 v19, 16, v19
    v_cvt_pk_bf16_f32 v20, v20, v20
    v_lshlrev_b32 v20, 16, v20
    v_cvt_pk_bf16_f32 v21, v21, v21
    v_lshlrev_b32 v21, 16, v21
    v_cvt_pk_bf16_f32 v22, v22, v22
    v_lshlrev_b32 v22, 16, v22
    v_cvt_pk_bf16_f32 v23, v23, v23
    v_lshlrev_b32 v23, 16, v23
    v_cvt_pk_bf16_f32 v24, v24, v24
    v_lshlrev_b32 v24, 16, v24
    v_cvt_pk_bf16_f32 v25, v25, v25
    v_lshlrev_b32 v25, 16, v25
    v_cvt_pk_bf16_f32 v26, v26, v26
    v_lshlrev_b32 v26, 16, v26
    v_cvt_pk_bf16_f32 v27, v27, v27
    v_lshlrev_b32 v27, 16, v27
    v_cvt_pk_bf16_f32 v28, v28, v28
    v_lshlrev_b32 v28, 16, v28
    v_cvt_pk_bf16_f32 v29, v29, v29
    v_lshlrev_b32 v29, 16, v29
    v_cvt_pk_bf16_f32 v30, v30, v30
    v_lshlrev_b32 v30, 16, v30
    v_cvt_pk_bf16_f32 v31, v31, v31
    v_lshlrev_b32 v31, 16, v31
    v_mov_b32 v56, v16
    v_mov_b32 v57, v16
    v_max_f32 v56, v56, v17
    v_min_f32 v57, v57, v17
    v_max_f32 v56, v56, v18
    v_min_f32 v57, v57, v18
    v_max_f32 v56, v56, v19
    v_min_f32 v57, v57, v19
    v_max_f32 v56, v56, v20
    v_min_f32 v57, v57, v20
    v_max_f32 v56, v56, v21
    v_min_f32 v57, v57, v21
    v_max_f32 v56, v56, v22
    v_min_f32 v57, v57, v22
    v_max_f32 v56, v56, v23
    v_min_f32 v57, v57, v23
    v_max_f32 v56, v56, v24
    v_min_f32 v57, v57, v24
    v_max_f32 v56, v56, v25
    v_min_f32 v57, v57, v25
    v_max_f32 v56, v56, v26
    v_min_f32 v57, v57, v26
    v_max_f32 v56, v56, v27
    v_min_f32 v57, v57, v27
    v_max_f32 v56, v56, v28
    v_min_f32 v57, v57, v28
    v_max_f32 v56, v56, v29
    v_min_f32 v57, v57, v29
    v_max_f32 v56, v56, v30
    v_min_f32 v57, v57, v30
    v_max_f32 v56, v56, v31
    v_min_f32 v57, v57, v31
    ds_bpermute_b32 v58, v4, v56
    ds_bpermute_b32 v59, v4, v57
    s_waitcnt lgkmcnt(0)
    v_max_f32 v56, v56, v58
    v_min_f32 v57, v57, v59
    v_mov_b32 v58, 0
    v_mov_b32 v59, 0
    s_mov_b32 s35, 0x3fb8aa3b
    v_sub_f32 v32, v57, v16
    v_sub_f32 v16, v16, v56
    v_mul_f32 v32, s35, v32
    v_mul_f32 v16, s35, v16
    v_exp_f32 v32, v32
    v_exp_f32 v16, v16
    s_nop 0
    v_add_f32 v58, v58, v16
    v_add_f32 v59, v59, v32
    v_sub_f32 v33, v57, v17
    v_sub_f32 v17, v17, v56
    v_mul_f32 v33, s35, v33
    v_mul_f32 v17, s35, v17
    v_exp_f32 v33, v33
    v_exp_f32 v17, v17
    s_nop 0
    v_add_f32 v58, v58, v17
    v_add_f32 v59, v59, v33
    v_sub_f32 v34, v57, v18
    v_sub_f32 v18, v18, v56
    v_mul_f32 v34, s35, v34
    v_mul_f32 v18, s35, v18
    v_exp_f32 v34, v34
    v_exp_f32 v18, v18
    s_nop 0
    v_add_f32 v58, v58, v18
    v_add_f32 v59, v59, v34
    v_sub_f32 v35, v57, v19
    v_sub_f32 v19, v19, v56
    v_mul_f32 v35, s35, v35
    v_mul_f32 v19, s35, v19
    v_exp_f32 v35, v35
    v_exp_f32 v19, v19
    s_nop 0
    v_add_f32 v58, v58, v19
    v_add_f32 v59, v59, v35
    v_sub_f32 v36, v57, v20
    v_sub_f32 v20, v20, v56
    v_mul_f32 v36, s35, v36
    v_mul_f32 v20, s35, v20
    v_exp_f32 v36, v36
    v_exp_f32 v20, v20
    s_nop 0
    v_add_f32 v58, v58, v20
    v_add_f32 v59, v59, v36
    v_sub_f32 v37, v57, v21
    v_sub_f32 v21, v21, v56
    v_mul_f32 v37, s35, v37
    v_mul_f32 v21, s35, v21
    v_exp_f32 v37, v37
    v_exp_f32 v21, v21
    s_nop 0
    v_add_f32 v58, v58, v21
    v_add_f32 v59, v59, v37
    v_sub_f32 v38, v57, v22
    v_sub_f32 v22, v22, v56
    v_mul_f32 v38, s35, v38
    v_mul_f32 v22, s35, v22
    v_exp_f32 v38, v38
    v_exp_f32 v22, v22
    s_nop 0
    v_add_f32 v58, v58, v22
    v_add_f32 v59, v59, v38
    v_sub_f32 v39, v57, v23
    v_sub_f32 v23, v23, v56
    v_mul_f32 v39, s35, v39
    v_mul_f32 v23, s35, v23
    v_exp_f32 v39, v39
    v_exp_f32 v23, v23
    s_nop 0
    v_add_f32 v58, v58, v23
    v_add_f32 v59, v59, v39
    v_sub_f32 v40, v57, v24
    v_sub_f32 v24, v24, v56
    v_mul_f32 v40, s35, v40
    v_mul_f32 v24, s35, v24
    v_exp_f32 v40, v40
    v_exp_f32 v24, v24
    s_nop 0
    v_add_f32 v58, v58, v24
    v_add_f32 v59, v59, v40
    v_sub_f32 v41, v57, v25
    v_sub_f32 v25, v25, v56
    v_mul_f32 v41, s35, v41
    v_mul_f32 v25, s35, v25
    v_exp_f32 v41, v41
    v_exp_f32 v25, v25
    s_nop 0
    v_add_f32 v58, v58, v25
    v_add_f32 v59, v59, v41
    v_sub_f32 v42, v57, v26
    v_sub_f32 v26, v26, v56
    v_mul_f32 v42, s35, v42
    v_mul_f32 v26, s35, v26
    v_exp_f32 v42, v42
    v_exp_f32 v26, v26
    s_nop 0
    v_add_f32 v58, v58, v26
    v_add_f32 v59, v59, v42
    v_sub_f32 v43, v57, v27
    v_sub_f32 v27, v27, v56
    v_mul_f32 v43, s35, v43
    v_mul_f32 v27, s35, v27
    v_exp_f32 v43, v43
    v_exp_f32 v27, v27
    s_nop 0
    v_add_f32 v58, v58, v27
    v_add_f32 v59, v59, v43
    v_sub_f32 v44, v57, v28
    v_sub_f32 v28, v28, v56
    v_mul_f32 v44, s35, v44
    v_mul_f32 v28, s35, v28
    v_exp_f32 v44, v44
    v_exp_f32 v28, v28
    s_nop 0
    v_add_f32 v58, v58, v28
    v_add_f32 v59, v59, v44
    v_sub_f32 v45, v57, v29
    v_sub_f32 v29, v29, v56
    v_mul_f32 v45, s35, v45
    v_mul_f32 v29, s35, v29
    v_exp_f32 v45, v45
    v_exp_f32 v29, v29
    s_nop 0
    v_add_f32 v58, v58, v29
    v_add_f32 v59, v59, v45
    v_sub_f32 v46, v57, v30
    v_sub_f32 v30, v30, v56
    v_mul_f32 v46, s35, v46
    v_mul_f32 v30, s35, v30
    v_exp_f32 v46, v46
    v_exp_f32 v30, v30
    s_nop 0
    v_add_f32 v58, v58, v30
    v_add_f32 v59, v59, v46
    v_sub_f32 v47, v57, v31
    v_sub_f32 v31, v31, v56
    v_mul_f32 v47, s35, v47
    v_mul_f32 v31, s35, v31
    v_exp_f32 v47, v47
    v_exp_f32 v31, v31
    s_nop 0
    v_add_f32 v58, v58, v31
    v_add_f32 v59, v59, v47
    ds_bpermute_b32 v56, v4, v58
    ds_bpermute_b32 v57, v4, v59
    s_waitcnt lgkmcnt(0)
    v_add_f32 v58, v58, v56
    v_add_f32 v59, v59, v57
    v_rcp_f32 v58, v58
    v_rcp_f32 v59, v59
    s_nop 0
    v_mul_f32 v16, v16, v58
    v_mul_f32 v32, v32, v59
    v_cvt_pk_bf16_f32 v16, v16, v16
    v_lshlrev_b32 v16, 16, v16
    v_cvt_pk_bf16_f32 v32, v32, v32
    v_lshlrev_b32 v32, 16, v32
    v_mul_f32 v17, v17, v58
    v_mul_f32 v33, v33, v59
    v_cvt_pk_bf16_f32 v17, v17, v17
    v_lshlrev_b32 v17, 16, v17
    v_cvt_pk_bf16_f32 v33, v33, v33
    v_lshlrev_b32 v33, 16, v33
    v_mul_f32 v18, v18, v58
    v_mul_f32 v34, v34, v59
    v_cvt_pk_bf16_f32 v18, v18, v18
    v_lshlrev_b32 v18, 16, v18
    v_cvt_pk_bf16_f32 v34, v34, v34
    v_lshlrev_b32 v34, 16, v34
    v_mul_f32 v19, v19, v58
    v_mul_f32 v35, v35, v59
    v_cvt_pk_bf16_f32 v19, v19, v19
    v_lshlrev_b32 v19, 16, v19
    v_cvt_pk_bf16_f32 v35, v35, v35
    v_lshlrev_b32 v35, 16, v35
    v_mul_f32 v20, v20, v58
    v_mul_f32 v36, v36, v59
    v_cvt_pk_bf16_f32 v20, v20, v20
    v_lshlrev_b32 v20, 16, v20
    v_cvt_pk_bf16_f32 v36, v36, v36
    v_lshlrev_b32 v36, 16, v36
    v_mul_f32 v21, v21, v58
    v_mul_f32 v37, v37, v59
    v_cvt_pk_bf16_f32 v21, v21, v21
    v_lshlrev_b32 v21, 16, v21
    v_cvt_pk_bf16_f32 v37, v37, v37
    v_lshlrev_b32 v37, 16, v37
    v_mul_f32 v22, v22, v58
    v_mul_f32 v38, v38, v59
    v_cvt_pk_bf16_f32 v22, v22, v22
    v_lshlrev_b32 v22, 16, v22
    v_cvt_pk_bf16_f32 v38, v38, v38
    v_lshlrev_b32 v38, 16, v38
    v_mul_f32 v23, v23, v58
    v_mul_f32 v39, v39, v59
    v_cvt_pk_bf16_f32 v23, v23, v23
    v_lshlrev_b32 v23, 16, v23
    v_cvt_pk_bf16_f32 v39, v39, v39
    v_lshlrev_b32 v39, 16, v39
    v_mul_f32 v24, v24, v58
    v_mul_f32 v40, v40, v59
    v_cvt_pk_bf16_f32 v24, v24, v24
    v_lshlrev_b32 v24, 16, v24
    v_cvt_pk_bf16_f32 v40, v40, v40
    v_lshlrev_b32 v40, 16, v40
    v_mul_f32 v25, v25, v58
    v_mul_f32 v41, v41, v59
    v_cvt_pk_bf16_f32 v25, v25, v25
    v_lshlrev_b32 v25, 16, v25
    v_cvt_pk_bf16_f32 v41, v41, v41
    v_lshlrev_b32 v41, 16, v41
    v_mul_f32 v26, v26, v58
    v_mul_f32 v42, v42, v59
    v_cvt_pk_bf16_f32 v26, v26, v26
    v_lshlrev_b32 v26, 16, v26
    v_cvt_pk_bf16_f32 v42, v42, v42
    v_lshlrev_b32 v42, 16, v42
    v_mul_f32 v27, v27, v58
    v_mul_f32 v43, v43, v59
    v_cvt_pk_bf16_f32 v27, v27, v27
    v_lshlrev_b32 v27, 16, v27
    v_cvt_pk_bf16_f32 v43, v43, v43
    v_lshlrev_b32 v43, 16, v43
    v_mul_f32 v28, v28, v58
    v_mul_f32 v44, v44, v59
    v_cvt_pk_bf16_f32 v28, v28, v28
    v_lshlrev_b32 v28, 16, v28
    v_cvt_pk_bf16_f32 v44, v44, v44
    v_lshlrev_b32 v44, 16, v44
    v_mul_f32 v29, v29, v58
    v_mul_f32 v45, v45, v59
    v_cvt_pk_bf16_f32 v29, v29, v29
    v_lshlrev_b32 v29, 16, v29
    v_cvt_pk_bf16_f32 v45, v45, v45
    v_lshlrev_b32 v45, 16, v45
    v_mul_f32 v30, v30, v58
    v_mul_f32 v46, v46, v59
    v_cvt_pk_bf16_f32 v30, v30, v30
    v_lshlrev_b32 v30, 16, v30
    v_cvt_pk_bf16_f32 v46, v46, v46
    v_lshlrev_b32 v46, 16, v46
    v_mul_f32 v31, v31, v58
    v_mul_f32 v47, v47, v59
    v_cvt_pk_bf16_f32 v31, v31, v31
    v_lshlrev_b32 v31, 16, v31
    v_cvt_pk_bf16_f32 v47, v47, v47
    v_lshlrev_b32 v47, 16, v47
    v_lshlrev_b32 v6, 7, v2
    v_lshlrev_b32 v62, 3, v3
    v_add_u32 v6, v6, v62
    v_add_u32 v6, s32, v6
    v_cvt_pk_bf16_f32 v16, v16, v17
    v_cvt_pk_bf16_f32 v17, v18, v19
    ds_write_b64 v6, v[16:17] offset:0
    v_cvt_pk_bf16_f32 v20, v20, v21
    v_cvt_pk_bf16_f32 v21, v22, v23
    ds_write_b64 v6, v[20:21] offset:16
    v_cvt_pk_bf16_f32 v24, v24, v25
    v_cvt_pk_bf16_f32 v25, v26, v27
    ds_write_b64 v6, v[24:25] offset:32
    v_cvt_pk_bf16_f32 v28, v28, v29
    v_cvt_pk_bf16_f32 v29, v30, v31
    ds_write_b64 v6, v[28:29] offset:48
    v_cvt_pk_bf16_f32 v32, v32, v33
    v_cvt_pk_bf16_f32 v33, v34, v35
    ds_write_b64 v6, v[32:33] offset:64
    v_cvt_pk_bf16_f32 v36, v36, v37
    v_cvt_pk_bf16_f32 v37, v38, v39
    ds_write_b64 v6, v[36:37] offset:80
    v_cvt_pk_bf16_f32 v40, v40, v41
    v_cvt_pk_bf16_f32 v41, v42, v43
    ds_write_b64 v6, v[40:41] offset:96
    v_cvt_pk_bf16_f32 v44, v44, v45
    v_cvt_pk_bf16_f32 v45, v46, v47
    ds_write_b64 v6, v[44:45] offset:112
    v_lshlrev_b32 v6, 4, v0
    v_add_u32 v6, s32, v6
    s_waitcnt vmcnt(0)
    ds_write_b128 v6, v[132:135] offset:4096
    ds_write_b128 v6, v[136:139] offset:5120
    s_waitcnt lgkmcnt(0)
    v_lshlrev_b32 v6, 3, v3
    v_bfe_u32 v61, v0, 2, 2
    v_add_u32 v6, v6, v61
    v_bfe_u32 v61, v0, 4, 1
    v_lshlrev_b32 v61, 4, v61
    v_and_b32 v62, 3, v0
    v_lshlrev_b32 v62, 2, v62
    v_add_u32 v61, v61, v62
    v_lshlrev_b32 v61, 1, v61
    v_lshlrev_b32 v62, 7, v6
    v_add_u32 v62, v62, v61
    v_add_u32 v62, s32, v62
    v_lshlrev_b32 v63, 6, v6
    v_add_u32 v63, v63, v61
    v_add_u32 v63, s32, v63
    ds_read_b64_tr_b16 v[16:17], v62 offset:0
    ds_read_b64_tr_b16 v[18:19], v62 offset:512
    ds_read_b64_tr_b16 v[20:21], v62 offset:64
    ds_read_b64_tr_b16 v[22:23], v62 offset:576
    ds_read_b64_tr_b16 v[24:25], v63 offset:4096
    ds_read_b64_tr_b16 v[26:27], v63 offset:4352
    s_waitcnt lgkmcnt(0)
    v_mfma_f32_32x32x16_bf16 v[64:79], v[16:19], v[24:27], v[64:79]
    v_mfma_f32_32x32x16_bf16 v[96:111], v[16:19], v[128:131], v[96:111]
    v_mfma_f32_32x32x16_bf16 v[80:95], v[20:23], v[24:27], v[80:95]
    v_mfma_f32_32x32x16_bf16 v[112:127], v[20:23], v[128:131], v[112:127]
    s_nop 7
    s_nop 7
    ds_read_b64_tr_b16 v[16:17], v62 offset:2048
    ds_read_b64_tr_b16 v[18:19], v62 offset:2560
    ds_read_b64_tr_b16 v[20:21], v62 offset:2112
    ds_read_b64_tr_b16 v[22:23], v62 offset:2624
    ds_read_b64_tr_b16 v[24:25], v63 offset:5120
    ds_read_b64_tr_b16 v[26:27], v63 offset:5376
    s_waitcnt lgkmcnt(0)
    v_mfma_f32_32x32x16_bf16 v[64:79], v[16:19], v[24:27], v[64:79]
    v_mfma_f32_32x32x16_bf16 v[96:111], v[16:19], v[128:131], v[96:111]
    v_mfma_f32_32x32x16_bf16 v[80:95], v[20:23], v[24:27], v[80:95]
    v_mfma_f32_32x32x16_bf16 v[112:127], v[20:23], v[128:131], v[112:127]
    s_nop 7
    s_nop 7
    s_lshl_b32 s31, s29, 8
    s_lshl_b32 s33, s30, 6
    s_add_u32 s31, s31, s33
    s_add_u32 s31, s31, 32
    s_mul_i32 s33, s31, 6144
    v_mul_u32_u24 v7, 6144, v2
    v_add_u32 v7, s33, v7
    s_lshl_b32 s34, s28, 6
    s_add_u32 s34, s34, 2048
    v_lshrrev_b32 v61, 2, v0
    v_mul_u32_u24 v61, 6144, v61
    v_and_b32 v62, 3, v0
    v_lshlrev_b32 v62, 4, v62
    v_add_u32 v61, v61, v62
    v_add_u32 v61, s33, v61
    s_lshl_b32 s35, s28, 6
    s_add_u32 s35, s35, 4096
    v_add_u32 v61, s35, v61
    buffer_load_dwordx4 v[132:135], v61, s[8:11], 0 offen
    v_add_u32 v61, 98304, v61
    buffer_load_dwordx4 v[136:139], v61, s[8:11], 0 offen
    v_lshlrev_b32 v6, 4, v3
    v_add_u32 v6, v7, v6
    v_add_u32 v6, s34, v6
    buffer_load_dwordx4 v[48:51], v6, s[8:11], 0 offen
    buffer_load_dwordx4 v[52:55], v6, s[8:11], 0 offen offset:32
    v_mov_b32 v16, 0
    v_mov_b32 v17, 0
    v_mov_b32 v18, 0
    v_mov_b32 v19, 0
    v_mov_b32 v20, 0
    v_mov_b32 v21, 0
    v_mov_b32 v22, 0
    v_mov_b32 v23, 0
    v_mov_b32 v24, 0
    v_mov_b32 v25, 0
    v_mov_b32 v26, 0
    v_mov_b32 v27, 0
    v_mov_b32 v28, 0
    v_mov_b32 v29, 0
    v_mov_b32 v30, 0
    v_mov_b32 v31, 0
    s_waitcnt vmcnt(0)
    v_mfma_f32_32x32x16_bf16 v[16:31], v[8:11], v[48:51], v[16:31]
    v_mfma_f32_32x32x16_bf16 v[16:31], v[12:15], v[52:55], v[16:31]
    s_nop 15
    s_nop 3
    v_cvt_pk_bf16_f32 v16, v16, v16
    v_lshlrev_b32 v16, 16, v16
    v_cvt_pk_bf16_f32 v17, v17, v17
    v_lshlrev_b32 v17, 16, v17
    v_cvt_pk_bf16_f32 v18, v18, v18
    v_lshlrev_b32 v18, 16, v18
    v_cvt_pk_bf16_f32 v19, v19, v19
    v_lshlrev_b32 v19, 16, v19
    v_cvt_pk_bf16_f32 v20, v20, v20
    v_lshlrev_b32 v20, 16, v20
    v_cvt_pk_bf16_f32 v21, v21, v21
    v_lshlrev_b32 v21, 16, v21
    v_cvt_pk_bf16_f32 v22, v22, v22
    v_lshlrev_b32 v22, 16, v22
    v_cvt_pk_bf16_f32 v23, v23, v23
    v_lshlrev_b32 v23, 16, v23
    v_cvt_pk_bf16_f32 v24, v24, v24
    v_lshlrev_b32 v24, 16, v24
    v_cvt_pk_bf16_f32 v25, v25, v25
    v_lshlrev_b32 v25, 16, v25
    v_cvt_pk_bf16_f32 v26, v26, v26
    v_lshlrev_b32 v26, 16, v26
    v_cvt_pk_bf16_f32 v27, v27, v27
    v_lshlrev_b32 v27, 16, v27
    v_cvt_pk_bf16_f32 v28, v28, v28
    v_lshlrev_b32 v28, 16, v28
    v_cvt_pk_bf16_f32 v29, v29, v29
    v_lshlrev_b32 v29, 16, v29
    v_cvt_pk_bf16_f32 v30, v30, v30
    v_lshlrev_b32 v30, 16, v30
    v_cvt_pk_bf16_f32 v31, v31, v31
    v_lshlrev_b32 v31, 16, v31
    v_mov_b32 v56, v16
    v_mov_b32 v57, v16
    v_max_f32 v56, v56, v17
    v_min_f32 v57, v57, v17
    v_max_f32 v56, v56, v18
    v_min_f32 v57, v57, v18
    v_max_f32 v56, v56, v19
    v_min_f32 v57, v57, v19
    v_max_f32 v56, v56, v20
    v_min_f32 v57, v57, v20
    v_max_f32 v56, v56, v21
    v_min_f32 v57, v57, v21
    v_max_f32 v56, v56, v22
    v_min_f32 v57, v57, v22
    v_max_f32 v56, v56, v23
    v_min_f32 v57, v57, v23
    v_max_f32 v56, v56, v24
    v_min_f32 v57, v57, v24
    v_max_f32 v56, v56, v25
    v_min_f32 v57, v57, v25
    v_max_f32 v56, v56, v26
    v_min_f32 v57, v57, v26
    v_max_f32 v56, v56, v27
    v_min_f32 v57, v57, v27
    v_max_f32 v56, v56, v28
    v_min_f32 v57, v57, v28
    v_max_f32 v56, v56, v29
    v_min_f32 v57, v57, v29
    v_max_f32 v56, v56, v30
    v_min_f32 v57, v57, v30
    v_max_f32 v56, v56, v31
    v_min_f32 v57, v57, v31
    ds_bpermute_b32 v58, v4, v56
    ds_bpermute_b32 v59, v4, v57
    s_waitcnt lgkmcnt(0)
    v_max_f32 v56, v56, v58
    v_min_f32 v57, v57, v59
    v_mov_b32 v58, 0
    v_mov_b32 v59, 0
    s_mov_b32 s35, 0x3fb8aa3b
    v_sub_f32 v32, v57, v16
    v_sub_f32 v16, v16, v56
    v_mul_f32 v32, s35, v32
    v_mul_f32 v16, s35, v16
    v_exp_f32 v32, v32
    v_exp_f32 v16, v16
    s_nop 0
    v_add_f32 v58, v58, v16
    v_add_f32 v59, v59, v32
    v_sub_f32 v33, v57, v17
    v_sub_f32 v17, v17, v56
    v_mul_f32 v33, s35, v33
    v_mul_f32 v17, s35, v17
    v_exp_f32 v33, v33
    v_exp_f32 v17, v17
    s_nop 0
    v_add_f32 v58, v58, v17
    v_add_f32 v59, v59, v33
    v_sub_f32 v34, v57, v18
    v_sub_f32 v18, v18, v56
    v_mul_f32 v34, s35, v34
    v_mul_f32 v18, s35, v18
    v_exp_f32 v34, v34
    v_exp_f32 v18, v18
    s_nop 0
    v_add_f32 v58, v58, v18
    v_add_f32 v59, v59, v34
    v_sub_f32 v35, v57, v19
    v_sub_f32 v19, v19, v56
    v_mul_f32 v35, s35, v35
    v_mul_f32 v19, s35, v19
    v_exp_f32 v35, v35
    v_exp_f32 v19, v19
    s_nop 0
    v_add_f32 v58, v58, v19
    v_add_f32 v59, v59, v35
    v_sub_f32 v36, v57, v20
    v_sub_f32 v20, v20, v56
    v_mul_f32 v36, s35, v36
    v_mul_f32 v20, s35, v20
    v_exp_f32 v36, v36
    v_exp_f32 v20, v20
    s_nop 0
    v_add_f32 v58, v58, v20
    v_add_f32 v59, v59, v36
    v_sub_f32 v37, v57, v21
    v_sub_f32 v21, v21, v56
    v_mul_f32 v37, s35, v37
    v_mul_f32 v21, s35, v21
    v_exp_f32 v37, v37
    v_exp_f32 v21, v21
    s_nop 0
    v_add_f32 v58, v58, v21
    v_add_f32 v59, v59, v37
    v_sub_f32 v38, v57, v22
    v_sub_f32 v22, v22, v56
    v_mul_f32 v38, s35, v38
    v_mul_f32 v22, s35, v22
    v_exp_f32 v38, v38
    v_exp_f32 v22, v22
    s_nop 0
    v_add_f32 v58, v58, v22
    v_add_f32 v59, v59, v38
    v_sub_f32 v39, v57, v23
    v_sub_f32 v23, v23, v56
    v_mul_f32 v39, s35, v39
    v_mul_f32 v23, s35, v23
    v_exp_f32 v39, v39
    v_exp_f32 v23, v23
    s_nop 0
    v_add_f32 v58, v58, v23
    v_add_f32 v59, v59, v39
    v_sub_f32 v40, v57, v24
    v_sub_f32 v24, v24, v56
    v_mul_f32 v40, s35, v40
    v_mul_f32 v24, s35, v24
    v_exp_f32 v40, v40
    v_exp_f32 v24, v24
    s_nop 0
    v_add_f32 v58, v58, v24
    v_add_f32 v59, v59, v40
    v_sub_f32 v41, v57, v25
    v_sub_f32 v25, v25, v56
    v_mul_f32 v41, s35, v41
    v_mul_f32 v25, s35, v25
    v_exp_f32 v41, v41
    v_exp_f32 v25, v25
    s_nop 0
    v_add_f32 v58, v58, v25
    v_add_f32 v59, v59, v41
    v_sub_f32 v42, v57, v26
    v_sub_f32 v26, v26, v56
    v_mul_f32 v42, s35, v42
    v_mul_f32 v26, s35, v26
    v_exp_f32 v42, v42
    v_exp_f32 v26, v26
    s_nop 0
    v_add_f32 v58, v58, v26
    v_add_f32 v59, v59, v42
    v_sub_f32 v43, v57, v27
    v_sub_f32 v27, v27, v56
    v_mul_f32 v43, s35, v43
    v_mul_f32 v27, s35, v27
    v_exp_f32 v43, v43
    v_exp_f32 v27, v27
    s_nop 0
    v_add_f32 v58, v58, v27
    v_add_f32 v59, v59, v43
    v_sub_f32 v44, v57, v28
    v_sub_f32 v28, v28, v56
    v_mul_f32 v44, s35, v44
    v_mul_f32 v28, s35, v28
    v_exp_f32 v44, v44
    v_exp_f32 v28, v28
    s_nop 0
    v_add_f32 v58, v58, v28
    v_add_f32 v59, v59, v44
    v_sub_f32 v45, v57, v29
    v_sub_f32 v29, v29, v56
    v_mul_f32 v45, s35, v45
    v_mul_f32 v29, s35, v29
    v_exp_f32 v45, v45
    v_exp_f32 v29, v29
    s_nop 0
    v_add_f32 v58, v58, v29
    v_add_f32 v59, v59, v45
    v_sub_f32 v46, v57, v30
    v_sub_f32 v30, v30, v56
    v_mul_f32 v46, s35, v46
    v_mul_f32 v30, s35, v30
    v_exp_f32 v46, v46
    v_exp_f32 v30, v30
    s_nop 0
    v_add_f32 v58, v58, v30
    v_add_f32 v59, v59, v46
    v_sub_f32 v47, v57, v31
    v_sub_f32 v31, v31, v56
    v_mul_f32 v47, s35, v47
    v_mul_f32 v31, s35, v31
    v_exp_f32 v47, v47
    v_exp_f32 v31, v31
    s_nop 0
    v_add_f32 v58, v58, v31
    v_add_f32 v59, v59, v47
    ds_bpermute_b32 v56, v4, v58
    ds_bpermute_b32 v57, v4, v59
    s_waitcnt lgkmcnt(0)
    v_add_f32 v58, v58, v56
    v_add_f32 v59, v59, v57
    v_rcp_f32 v58, v58
    v_rcp_f32 v59, v59
    s_nop 0
    v_mul_f32 v16, v16, v58
    v_mul_f32 v32, v32, v59
    v_cvt_pk_bf16_f32 v16, v16, v16
    v_lshlrev_b32 v16, 16, v16
    v_cvt_pk_bf16_f32 v32, v32, v32
    v_lshlrev_b32 v32, 16, v32
    v_mul_f32 v17, v17, v58
    v_mul_f32 v33, v33, v59
    v_cvt_pk_bf16_f32 v17, v17, v17
    v_lshlrev_b32 v17, 16, v17
    v_cvt_pk_bf16_f32 v33, v33, v33
    v_lshlrev_b32 v33, 16, v33
    v_mul_f32 v18, v18, v58
    v_mul_f32 v34, v34, v59
    v_cvt_pk_bf16_f32 v18, v18, v18
    v_lshlrev_b32 v18, 16, v18
    v_cvt_pk_bf16_f32 v34, v34, v34
    v_lshlrev_b32 v34, 16, v34
    v_mul_f32 v19, v19, v58
    v_mul_f32 v35, v35, v59
    v_cvt_pk_bf16_f32 v19, v19, v19
    v_lshlrev_b32 v19, 16, v19
    v_cvt_pk_bf16_f32 v35, v35, v35
    v_lshlrev_b32 v35, 16, v35
    v_mul_f32 v20, v20, v58
    v_mul_f32 v36, v36, v59
    v_cvt_pk_bf16_f32 v20, v20, v20
    v_lshlrev_b32 v20, 16, v20
    v_cvt_pk_bf16_f32 v36, v36, v36
    v_lshlrev_b32 v36, 16, v36
    v_mul_f32 v21, v21, v58
    v_mul_f32 v37, v37, v59
    v_cvt_pk_bf16_f32 v21, v21, v21
    v_lshlrev_b32 v21, 16, v21
    v_cvt_pk_bf16_f32 v37, v37, v37
    v_lshlrev_b32 v37, 16, v37
    v_mul_f32 v22, v22, v58
    v_mul_f32 v38, v38, v59
    v_cvt_pk_bf16_f32 v22, v22, v22
    v_lshlrev_b32 v22, 16, v22
    v_cvt_pk_bf16_f32 v38, v38, v38
    v_lshlrev_b32 v38, 16, v38
    v_mul_f32 v23, v23, v58
    v_mul_f32 v39, v39, v59
    v_cvt_pk_bf16_f32 v23, v23, v23
    v_lshlrev_b32 v23, 16, v23
    v_cvt_pk_bf16_f32 v39, v39, v39
    v_lshlrev_b32 v39, 16, v39
    v_mul_f32 v24, v24, v58
    v_mul_f32 v40, v40, v59
    v_cvt_pk_bf16_f32 v24, v24, v24
    v_lshlrev_b32 v24, 16, v24
    v_cvt_pk_bf16_f32 v40, v40, v40
    v_lshlrev_b32 v40, 16, v40
    v_mul_f32 v25, v25, v58
    v_mul_f32 v41, v41, v59
    v_cvt_pk_bf16_f32 v25, v25, v25
    v_lshlrev_b32 v25, 16, v25
    v_cvt_pk_bf16_f32 v41, v41, v41
    v_lshlrev_b32 v41, 16, v41
    v_mul_f32 v26, v26, v58
    v_mul_f32 v42, v42, v59
    v_cvt_pk_bf16_f32 v26, v26, v26
    v_lshlrev_b32 v26, 16, v26
    v_cvt_pk_bf16_f32 v42, v42, v42
    v_lshlrev_b32 v42, 16, v42
    v_mul_f32 v27, v27, v58
    v_mul_f32 v43, v43, v59
    v_cvt_pk_bf16_f32 v27, v27, v27
    v_lshlrev_b32 v27, 16, v27
    v_cvt_pk_bf16_f32 v43, v43, v43
    v_lshlrev_b32 v43, 16, v43
    v_mul_f32 v28, v28, v58
    v_mul_f32 v44, v44, v59
    v_cvt_pk_bf16_f32 v28, v28, v28
    v_lshlrev_b32 v28, 16, v28
    v_cvt_pk_bf16_f32 v44, v44, v44
    v_lshlrev_b32 v44, 16, v44
    v_mul_f32 v29, v29, v58
    v_mul_f32 v45, v45, v59
    v_cvt_pk_bf16_f32 v29, v29, v29
    v_lshlrev_b32 v29, 16, v29
    v_cvt_pk_bf16_f32 v45, v45, v45
    v_lshlrev_b32 v45, 16, v45
    v_mul_f32 v30, v30, v58
    v_mul_f32 v46, v46, v59
    v_cvt_pk_bf16_f32 v30, v30, v30
    v_lshlrev_b32 v30, 16, v30
    v_cvt_pk_bf16_f32 v46, v46, v46
    v_lshlrev_b32 v46, 16, v46
    v_mul_f32 v31, v31, v58
    v_mul_f32 v47, v47, v59
    v_cvt_pk_bf16_f32 v31, v31, v31
    v_lshlrev_b32 v31, 16, v31
    v_cvt_pk_bf16_f32 v47, v47, v47
    v_lshlrev_b32 v47, 16, v47
    v_lshlrev_b32 v6, 7, v2
    v_lshlrev_b32 v62, 3, v3
    v_add_u32 v6, v6, v62
    v_add_u32 v6, s32, v6
    v_cvt_pk_bf16_f32 v16, v16, v17
    v_cvt_pk_bf16_f32 v17, v18, v19
    ds_write_b64 v6, v[16:17] offset:0
    v_cvt_pk_bf16_f32 v20, v20, v21
    v_cvt_pk_bf16_f32 v21, v22, v23
    ds_write_b64 v6, v[20:21] offset:16
    v_cvt_pk_bf16_f32 v24, v24, v25
    v_cvt_pk_bf16_f32 v25, v26, v27
    ds_write_b64 v6, v[24:25] offset:32
    v_cvt_pk_bf16_f32 v28, v28, v29
    v_cvt_pk_bf16_f32 v29, v30, v31
    ds_write_b64 v6, v[28:29] offset:48
    v_cvt_pk_bf16_f32 v32, v32, v33
    v_cvt_pk_bf16_f32 v33, v34, v35
    ds_write_b64 v6, v[32:33] offset:64
    v_cvt_pk_bf16_f32 v36, v36, v37
    v_cvt_pk_bf16_f32 v37, v38, v39
    ds_write_b64 v6, v[36:37] offset:80
    v_cvt_pk_bf16_f32 v40, v40, v41
    v_cvt_pk_bf16_f32 v41, v42, v43
    ds_write_b64 v6, v[40:41] offset:96
    v_cvt_pk_bf16_f32 v44, v44, v45
    v_cvt_pk_bf16_f32 v45, v46, v47
    ds_write_b64 v6, v[44:45] offset:112
    v_lshlrev_b32 v6, 4, v0
    v_add_u32 v6, s32, v6
    s_waitcnt vmcnt(0)
    ds_write_b128 v6, v[132:135] offset:4096
    ds_write_b128 v6, v[136:139] offset:5120
    s_waitcnt lgkmcnt(0)
    v_lshlrev_b32 v6, 3, v3
    v_bfe_u32 v61, v0, 2, 2
    v_add_u32 v6, v6, v61
    v_bfe_u32 v61, v0, 4, 1
    v_lshlrev_b32 v61, 4, v61
    v_and_b32 v62, 3, v0
    v_lshlrev_b32 v62, 2, v62
    v_add_u32 v61, v61, v62
    v_lshlrev_b32 v61, 1, v61
    v_lshlrev_b32 v62, 7, v6
    v_add_u32 v62, v62, v61
    v_add_u32 v62, s32, v62
    v_lshlrev_b32 v63, 6, v6
    v_add_u32 v63, v63, v61
    v_add_u32 v63, s32, v63
    ds_read_b64_tr_b16 v[16:17], v62 offset:0
    ds_read_b64_tr_b16 v[18:19], v62 offset:512
    ds_read_b64_tr_b16 v[20:21], v62 offset:64
    ds_read_b64_tr_b16 v[22:23], v62 offset:576
    ds_read_b64_tr_b16 v[24:25], v63 offset:4096
    ds_read_b64_tr_b16 v[26:27], v63 offset:4352
    s_waitcnt lgkmcnt(0)
    v_mfma_f32_32x32x16_bf16 v[64:79], v[16:19], v[24:27], v[64:79]
    v_mfma_f32_32x32x16_bf16 v[96:111], v[16:19], v[128:131], v[96:111]
    v_mfma_f32_32x32x16_bf16 v[80:95], v[20:23], v[24:27], v[80:95]
    v_mfma_f32_32x32x16_bf16 v[112:127], v[20:23], v[128:131], v[112:127]
    s_nop 7
    s_nop 7
    ds_read_b64_tr_b16 v[16:17], v62 offset:2048
    ds_read_b64_tr_b16 v[18:19], v62 offset:2560
    ds_read_b64_tr_b16 v[20:21], v62 offset:2112
    ds_read_b64_tr_b16 v[22:23], v62 offset:2624
    ds_read_b64_tr_b16 v[24:25], v63 offset:5120
    ds_read_b64_tr_b16 v[26:27], v63 offset:5376
    s_waitcnt lgkmcnt(0)
    v_mfma_f32_32x32x16_bf16 v[64:79], v[16:19], v[24:27], v[64:79]
    v_mfma_f32_32x32x16_bf16 v[96:111], v[16:19], v[128:131], v[96:111]
    v_mfma_f32_32x32x16_bf16 v[80:95], v[20:23], v[24:27], v[80:95]
    v_mfma_f32_32x32x16_bf16 v[112:127], v[20:23], v[128:131], v[112:127]
    s_nop 7
    s_nop 7
    s_nop 15
    s_mul_i32 s32, s30, 8448
    v_lshlrev_b32 v6, 2, v2
    v_lshlrev_b32 v7, 9, v3
    v_add_u32 v6, v6, v7
    v_add_u32 v6, s32, v6
    v_lshlrev_b32 v7, 4, v3
    v_add_u32 v7, s32, v7
    ds_write_b32 v6, v64 offset:0
    ds_write_b32 v7, v96 offset:8192
    ds_write_b32 v6, v65 offset:128
    ds_write_b32 v7, v97 offset:8196
    ds_write_b32 v6, v66 offset:256
    ds_write_b32 v7, v98 offset:8200
    ds_write_b32 v6, v67 offset:384
    ds_write_b32 v7, v99 offset:8204
    ds_write_b32 v6, v68 offset:1024
    ds_write_b32 v7, v100 offset:8224
    ds_write_b32 v6, v69 offset:1152
    ds_write_b32 v7, v101 offset:8228
    ds_write_b32 v6, v70 offset:1280
    ds_write_b32 v7, v102 offset:8232
    ds_write_b32 v6, v71 offset:1408
    ds_write_b32 v7, v103 offset:8236
    ds_write_b32 v6, v72 offset:2048
    ds_write_b32 v7, v104 offset:8256
    ds_write_b32 v6, v73 offset:2176
    ds_write_b32 v7, v105 offset:8260
    ds_write_b32 v6, v74 offset:2304
    ds_write_b32 v7, v106 offset:8264
    ds_write_b32 v6, v75 offset:2432
    ds_write_b32 v7, v107 offset:8268
    ds_write_b32 v6, v76 offset:3072
    ds_write_b32 v7, v108 offset:8288
    ds_write_b32 v6, v77 offset:3200
    ds_write_b32 v7, v109 offset:8292
    ds_write_b32 v6, v78 offset:3328
    ds_write_b32 v7, v110 offset:8296
    ds_write_b32 v6, v79 offset:3456
    ds_write_b32 v7, v111 offset:8300
    ds_write_b32 v6, v80 offset:4096
    ds_write_b32 v7, v112 offset:8320
    ds_write_b32 v6, v81 offset:4224
    ds_write_b32 v7, v113 offset:8324
    ds_write_b32 v6, v82 offset:4352
    ds_write_b32 v7, v114 offset:8328
    ds_write_b32 v6, v83 offset:4480
    ds_write_b32 v7, v115 offset:8332
    ds_write_b32 v6, v84 offset:5120
    ds_write_b32 v7, v116 offset:8352
    ds_write_b32 v6, v85 offset:5248
    ds_write_b32 v7, v117 offset:8356
    ds_write_b32 v6, v86 offset:5376
    ds_write_b32 v7, v118 offset:8360
    ds_write_b32 v6, v87 offset:5504
    ds_write_b32 v7, v119 offset:8364
    ds_write_b32 v6, v88 offset:6144
    ds_write_b32 v7, v120 offset:8384
    ds_write_b32 v6, v89 offset:6272
    ds_write_b32 v7, v121 offset:8388
    ds_write_b32 v6, v90 offset:6400
    ds_write_b32 v7, v122 offset:8392
    ds_write_b32 v6, v91 offset:6528
    ds_write_b32 v7, v123 offset:8396
    ds_write_b32 v6, v92 offset:7168
    ds_write_b32 v7, v124 offset:8416
    ds_write_b32 v6, v93 offset:7296
    ds_write_b32 v7, v125 offset:8420
    ds_write_b32 v6, v94 offset:7424
    ds_write_b32 v7, v126 offset:8424
    ds_write_b32 v6, v95 offset:7552
    ds_write_b32 v7, v127 offset:8428
    s_waitcnt lgkmcnt(0)
    s_barrier
    v_lshlrev_b32 v6, 2, v60
    s_lshl_b32 s31, s28, 3
    s_add_u32 s31, s31, s29
    s_mul_i32 s31, s31, 8448
    v_add_u32 v7, s31, v6
    ds_read_b32 v16, v6 offset:0
    ds_read_b32 v17, v6 offset:8448
    ds_read_b32 v18, v6 offset:16896
    ds_read_b32 v19, v6 offset:25344
    s_waitcnt lgkmcnt(0)
    v_add_f32 v16, v16, v17
    v_add_f32 v18, v18, v19
    v_add_f32 v16, v16, v18
    s_mov_b32 s33, 0
    buffer_store_dword v16, v7, s[16:19], s33 offen
    ds_read_b32 v16, v6 offset:1024
    ds_read_b32 v17, v6 offset:9472
    ds_read_b32 v18, v6 offset:17920
    ds_read_b32 v19, v6 offset:26368
    s_waitcnt lgkmcnt(0)
    v_add_f32 v16, v16, v17
    v_add_f32 v18, v18, v19
    v_add_f32 v16, v16, v18
    s_mov_b32 s33, 1024
    buffer_store_dword v16, v7, s[16:19], s33 offen
    ds_read_b32 v16, v6 offset:2048
    ds_read_b32 v17, v6 offset:10496
    ds_read_b32 v18, v6 offset:18944
    ds_read_b32 v19, v6 offset:27392
    s_waitcnt lgkmcnt(0)
    v_add_f32 v16, v16, v17
    v_add_f32 v18, v18, v19
    v_add_f32 v16, v16, v18
    s_mov_b32 s33, 2048
    buffer_store_dword v16, v7, s[16:19], s33 offen
    ds_read_b32 v16, v6 offset:3072
    ds_read_b32 v17, v6 offset:11520
    ds_read_b32 v18, v6 offset:19968
    ds_read_b32 v19, v6 offset:28416
    s_waitcnt lgkmcnt(0)
    v_add_f32 v16, v16, v17
    v_add_f32 v18, v18, v19
    v_add_f32 v16, v16, v18
    s_mov_b32 s33, 3072
    buffer_store_dword v16, v7, s[16:19], s33 offen
    ds_read_b32 v16, v6 offset:4096
    ds_read_b32 v17, v6 offset:12544
    ds_read_b32 v18, v6 offset:20992
    ds_read_b32 v19, v6 offset:29440
    s_waitcnt lgkmcnt(0)
    v_add_f32 v16, v16, v17
    v_add_f32 v18, v18, v19
    v_add_f32 v16, v16, v18
    s_mov_b32 s33, 4096
    buffer_store_dword v16, v7, s[16:19], s33 offen
    ds_read_b32 v16, v6 offset:5120
    ds_read_b32 v17, v6 offset:13568
    ds_read_b32 v18, v6 offset:22016
    ds_read_b32 v19, v6 offset:30464
    s_waitcnt lgkmcnt(0)
    v_add_f32 v16, v16, v17
    v_add_f32 v18, v18, v19
    v_add_f32 v16, v16, v18
    s_mov_b32 s33, 5120
    buffer_store_dword v16, v7, s[16:19], s33 offen
    ds_read_b32 v16, v6 offset:6144
    ds_read_b32 v17, v6 offset:14592
    ds_read_b32 v18, v6 offset:23040
    ds_read_b32 v19, v6 offset:31488
    s_waitcnt lgkmcnt(0)
    v_add_f32 v16, v16, v17
    v_add_f32 v18, v18, v19
    v_add_f32 v16, v16, v18
    s_mov_b32 s33, 6144
    buffer_store_dword v16, v7, s[16:19], s33 offen
    ds_read_b32 v16, v6 offset:7168
    ds_read_b32 v17, v6 offset:15616
    ds_read_b32 v18, v6 offset:24064
    ds_read_b32 v19, v6 offset:32512
    s_waitcnt lgkmcnt(0)
    v_add_f32 v16, v16, v17
    v_add_f32 v18, v18, v19
    v_add_f32 v16, v16, v18
    s_mov_b32 s33, 7168
    buffer_store_dword v16, v7, s[16:19], s33 offen
    v_cmp_gt_u32 vcc, 64, v60
    s_and_saveexec_b64 s[36:37], vcc
    ds_read_b32 v16, v6 offset:8192
    ds_read_b32 v17, v6 offset:16640
    ds_read_b32 v18, v6 offset:25088
    ds_read_b32 v19, v6 offset:33536
    s_waitcnt lgkmcnt(0)
    v_add_f32 v16, v16, v17
    v_add_f32 v18, v18, v19
    v_add_f32 v16, v16, v18
    s_mov_b32 s33, 8192
    buffer_store_dword v16, v7, s[16:19], s33 offen
L_done_akv_1_kernel:
    s_endpgm
.globl ao_1_kernel
.p2align 8
.type ao_1_kernel,@function
ao_1_kernel:
    s_cmp_ge_u32 s2, 256
    s_cbranch_scc1 L_done_ao_1_kernel
    s_load_dwordx2 s[40:41], s[0:1], 16
    s_load_dwordx2 s[42:43], s[0:1], 88
    s_waitcnt lgkmcnt(0)
    s_add_u32 s8, s42, 4194304
    s_addc_u32 s9, s43, 0
    s_mov_b32 s10, 12582912
    s_mov_b32 s11, 0x00020000
    s_mov_b32 s12, s40
    s_mov_b32 s13, s41
    s_mov_b32 s14, 65536
    s_mov_b32 s15, 0x00020000
    s_add_u32 s16, s42, 16777216
    s_addc_u32 s17, s43, 0
    s_mov_b32 s18, 2162688
    s_mov_b32 s19, 0x00020000
    s_add_u32 s20, s42, 20971520
    s_addc_u32 s21, s43, 0
    s_mov_b32 s22, 4194304
    s_mov_b32 s23, 0x00020000
    s_and_b32 s28, s2, 31
    s_lshr_b32 s29, s2, 5
    v_lshrrev_b32 v1, 6, v0
    s_nop 0
    v_readfirstlane_b32 s30, v1
    v_mov_b32 v60, v0
    v_and_b32 v0, 63, v0
    v_and_b32 v2, 31, v0
    v_lshrrev_b32 v3, 5, v0
    v_xor_b32 v4, 32, v0
    v_lshlrev_b32 v4, 2, v4
    s_lshl_b32 s31, s28, 11
    v_lshlrev_b32 v5, 9, v3
    v_lshlrev_b32 v6, 1, v2
    v_add_u32 v5, v5, v6
    v_add_u32 v5, s31, v5
    buffer_load_ushort v16, v5, s[12:15], 0 offen offset:0
    buffer_load_ushort v17, v5, s[12:15], 0 offen offset:64
    buffer_load_ushort v18, v5, s[12:15], 0 offen offset:128
    buffer_load_ushort v19, v5, s[12:15], 0 offen offset:192
    buffer_load_ushort v20, v5, s[12:15], 0 offen offset:256
    buffer_load_ushort v21, v5, s[12:15], 0 offen offset:320
    buffer_load_ushort v22, v5, s[12:15], 0 offen offset:384
    buffer_load_ushort v23, v5, s[12:15], 0 offen offset:448
    buffer_load_ushort v24, v5, s[12:15], 0 offen offset:1024
    buffer_load_ushort v25, v5, s[12:15], 0 offen offset:1088
    buffer_load_ushort v26, v5, s[12:15], 0 offen offset:1152
    buffer_load_ushort v27, v5, s[12:15], 0 offen offset:1216
    buffer_load_ushort v28, v5, s[12:15], 0 offen offset:1280
    buffer_load_ushort v29, v5, s[12:15], 0 offen offset:1344
    buffer_load_ushort v30, v5, s[12:15], 0 offen offset:1408
    buffer_load_ushort v31, v5, s[12:15], 0 offen offset:1472
    s_waitcnt vmcnt(0)
    v_lshl_or_b32 v8, v17, 16, v16
    v_lshl_or_b32 v9, v19, 16, v18
    v_lshl_or_b32 v10, v21, 16, v20
    v_lshl_or_b32 v11, v23, 16, v22
    v_lshl_or_b32 v12, v25, 16, v24
    v_lshl_or_b32 v13, v27, 16, v26
    v_lshl_or_b32 v14, v29, 16, v28
    v_lshl_or_b32 v15, v31, 16, v30
    v_lshlrev_b32 v6, 2, v60
    s_mul_i32 s31, s28, 67584
    v_add_u32 v7, s31, v6
    s_mov_b32 s33, 0
    buffer_load_dword v64, v7, s[16:19], s33 offen
    s_mov_b32 s33, 8448
    buffer_load_dword v65, v7, s[16:19], s33 offen
    s_mov_b32 s33, 16896
    buffer_load_dword v66, v7, s[16:19], s33 offen
    s_mov_b32 s33, 25344
    buffer_load_dword v67, v7, s[16:19], s33 offen
    s_mov_b32 s33, 33792
    buffer_load_dword v68, v7, s[16:19], s33 offen
    s_mov_b32 s33, 42240
    buffer_load_dword v69, v7, s[16:19], s33 offen
    s_mov_b32 s33, 50688
    buffer_load_dword v70, v7, s[16:19], s33 offen
    s_mov_b32 s33, 59136
    buffer_load_dword v71, v7, s[16:19], s33 offen
    s_mov_b32 s33, 1024
    buffer_load_dword v72, v7, s[16:19], s33 offen
    s_mov_b32 s33, 9472
    buffer_load_dword v73, v7, s[16:19], s33 offen
    s_mov_b32 s33, 17920
    buffer_load_dword v74, v7, s[16:19], s33 offen
    s_mov_b32 s33, 26368
    buffer_load_dword v75, v7, s[16:19], s33 offen
    s_mov_b32 s33, 34816
    buffer_load_dword v76, v7, s[16:19], s33 offen
    s_mov_b32 s33, 43264
    buffer_load_dword v77, v7, s[16:19], s33 offen
    s_mov_b32 s33, 51712
    buffer_load_dword v78, v7, s[16:19], s33 offen
    s_mov_b32 s33, 60160
    buffer_load_dword v79, v7, s[16:19], s33 offen
    s_mov_b32 s33, 2048
    buffer_load_dword v80, v7, s[16:19], s33 offen
    s_mov_b32 s33, 10496
    buffer_load_dword v81, v7, s[16:19], s33 offen
    s_mov_b32 s33, 18944
    buffer_load_dword v82, v7, s[16:19], s33 offen
    s_mov_b32 s33, 27392
    buffer_load_dword v83, v7, s[16:19], s33 offen
    s_mov_b32 s33, 35840
    buffer_load_dword v84, v7, s[16:19], s33 offen
    s_mov_b32 s33, 44288
    buffer_load_dword v85, v7, s[16:19], s33 offen
    s_mov_b32 s33, 52736
    buffer_load_dword v86, v7, s[16:19], s33 offen
    s_mov_b32 s33, 61184
    buffer_load_dword v87, v7, s[16:19], s33 offen
    s_mov_b32 s33, 3072
    buffer_load_dword v88, v7, s[16:19], s33 offen
    s_mov_b32 s33, 11520
    buffer_load_dword v89, v7, s[16:19], s33 offen
    s_mov_b32 s33, 19968
    buffer_load_dword v90, v7, s[16:19], s33 offen
    s_mov_b32 s33, 28416
    buffer_load_dword v91, v7, s[16:19], s33 offen
    s_mov_b32 s33, 36864
    buffer_load_dword v92, v7, s[16:19], s33 offen
    s_mov_b32 s33, 45312
    buffer_load_dword v93, v7, s[16:19], s33 offen
    s_mov_b32 s33, 53760
    buffer_load_dword v94, v7, s[16:19], s33 offen
    s_mov_b32 s33, 62208
    buffer_load_dword v95, v7, s[16:19], s33 offen
    s_mov_b32 s33, 4096
    buffer_load_dword v96, v7, s[16:19], s33 offen
    s_mov_b32 s33, 12544
    buffer_load_dword v97, v7, s[16:19], s33 offen
    s_mov_b32 s33, 20992
    buffer_load_dword v98, v7, s[16:19], s33 offen
    s_mov_b32 s33, 29440
    buffer_load_dword v99, v7, s[16:19], s33 offen
    s_mov_b32 s33, 37888
    buffer_load_dword v100, v7, s[16:19], s33 offen
    s_mov_b32 s33, 46336
    buffer_load_dword v101, v7, s[16:19], s33 offen
    s_mov_b32 s33, 54784
    buffer_load_dword v102, v7, s[16:19], s33 offen
    s_mov_b32 s33, 63232
    buffer_load_dword v103, v7, s[16:19], s33 offen
    s_mov_b32 s33, 5120
    buffer_load_dword v104, v7, s[16:19], s33 offen
    s_mov_b32 s33, 13568
    buffer_load_dword v105, v7, s[16:19], s33 offen
    s_mov_b32 s33, 22016
    buffer_load_dword v106, v7, s[16:19], s33 offen
    s_mov_b32 s33, 30464
    buffer_load_dword v107, v7, s[16:19], s33 offen
    s_mov_b32 s33, 38912
    buffer_load_dword v108, v7, s[16:19], s33 offen
    s_mov_b32 s33, 47360
    buffer_load_dword v109, v7, s[16:19], s33 offen
    s_mov_b32 s33, 55808
    buffer_load_dword v110, v7, s[16:19], s33 offen
    s_mov_b32 s33, 64256
    buffer_load_dword v111, v7, s[16:19], s33 offen
    s_mov_b32 s33, 6144
    buffer_load_dword v112, v7, s[16:19], s33 offen
    s_mov_b32 s33, 14592
    buffer_load_dword v113, v7, s[16:19], s33 offen
    s_mov_b32 s33, 23040
    buffer_load_dword v114, v7, s[16:19], s33 offen
    s_mov_b32 s33, 31488
    buffer_load_dword v115, v7, s[16:19], s33 offen
    s_mov_b32 s33, 39936
    buffer_load_dword v116, v7, s[16:19], s33 offen
    s_mov_b32 s33, 48384
    buffer_load_dword v117, v7, s[16:19], s33 offen
    s_mov_b32 s33, 56832
    buffer_load_dword v118, v7, s[16:19], s33 offen
    s_mov_b32 s33, 65280
    buffer_load_dword v119, v7, s[16:19], s33 offen
    s_mov_b32 s33, 7168
    buffer_load_dword v120, v7, s[16:19], s33 offen
    s_mov_b32 s33, 15616
    buffer_load_dword v121, v7, s[16:19], s33 offen
    s_mov_b32 s33, 24064
    buffer_load_dword v122, v7, s[16:19], s33 offen
    s_mov_b32 s33, 32512
    buffer_load_dword v123, v7, s[16:19], s33 offen
    s_mov_b32 s33, 40960
    buffer_load_dword v124, v7, s[16:19], s33 offen
    s_mov_b32 s33, 49408
    buffer_load_dword v125, v7, s[16:19], s33 offen
    s_mov_b32 s33, 57856
    buffer_load_dword v126, v7, s[16:19], s33 offen
    s_mov_b32 s33, 66304
    buffer_load_dword v127, v7, s[16:19], s33 offen
    v_cmp_gt_u32 vcc, 64, v60
    s_and_saveexec_b64 s[36:37], vcc
    s_mov_b32 s33, 8192
    buffer_load_dword v128, v7, s[16:19], s33 offen
    s_mov_b32 s33, 16640
    buffer_load_dword v129, v7, s[16:19], s33 offen
    s_mov_b32 s33, 25088
    buffer_load_dword v130, v7, s[16:19], s33 offen
    s_mov_b32 s33, 33536
    buffer_load_dword v131, v7, s[16:19], s33 offen
    s_mov_b32 s33, 41984
    buffer_load_dword v132, v7, s[16:19], s33 offen
    s_mov_b32 s33, 50432
    buffer_load_dword v133, v7, s[16:19], s33 offen
    s_mov_b32 s33, 58880
    buffer_load_dword v134, v7, s[16:19], s33 offen
    s_mov_b32 s33, 67328
    buffer_load_dword v135, v7, s[16:19], s33 offen
    s_mov_b64 exec, -1
    s_waitcnt vmcnt(0)
    v_add_f32 v64, v64, v65
    v_add_f32 v64, v64, v66
    v_add_f32 v64, v64, v67
    v_add_f32 v64, v64, v68
    v_add_f32 v64, v64, v69
    v_add_f32 v64, v64, v70
    v_add_f32 v64, v64, v71
    v_cvt_pk_bf16_f32 v64, v64, v64
    v_lshlrev_b32 v64, 16, v64
    ds_write_b32 v6, v64 offset:0
    v_add_f32 v72, v72, v73
    v_add_f32 v72, v72, v74
    v_add_f32 v72, v72, v75
    v_add_f32 v72, v72, v76
    v_add_f32 v72, v72, v77
    v_add_f32 v72, v72, v78
    v_add_f32 v72, v72, v79
    v_cvt_pk_bf16_f32 v72, v72, v72
    v_lshlrev_b32 v72, 16, v72
    ds_write_b32 v6, v72 offset:1024
    v_add_f32 v80, v80, v81
    v_add_f32 v80, v80, v82
    v_add_f32 v80, v80, v83
    v_add_f32 v80, v80, v84
    v_add_f32 v80, v80, v85
    v_add_f32 v80, v80, v86
    v_add_f32 v80, v80, v87
    v_cvt_pk_bf16_f32 v80, v80, v80
    v_lshlrev_b32 v80, 16, v80
    ds_write_b32 v6, v80 offset:2048
    v_add_f32 v88, v88, v89
    v_add_f32 v88, v88, v90
    v_add_f32 v88, v88, v91
    v_add_f32 v88, v88, v92
    v_add_f32 v88, v88, v93
    v_add_f32 v88, v88, v94
    v_add_f32 v88, v88, v95
    v_cvt_pk_bf16_f32 v88, v88, v88
    v_lshlrev_b32 v88, 16, v88
    ds_write_b32 v6, v88 offset:3072
    v_add_f32 v96, v96, v97
    v_add_f32 v96, v96, v98
    v_add_f32 v96, v96, v99
    v_add_f32 v96, v96, v100
    v_add_f32 v96, v96, v101
    v_add_f32 v96, v96, v102
    v_add_f32 v96, v96, v103
    v_cvt_pk_bf16_f32 v96, v96, v96
    v_lshlrev_b32 v96, 16, v96
    ds_write_b32 v6, v96 offset:4096
    v_add_f32 v104, v104, v105
    v_add_f32 v104, v104, v106
    v_add_f32 v104, v104, v107
    v_add_f32 v104, v104, v108
    v_add_f32 v104, v104, v109
    v_add_f32 v104, v104, v110
    v_add_f32 v104, v104, v111
    v_cvt_pk_bf16_f32 v104, v104, v104
    v_lshlrev_b32 v104, 16, v104
    ds_write_b32 v6, v104 offset:5120
    v_add_f32 v112, v112, v113
    v_add_f32 v112, v112, v114
    v_add_f32 v112, v112, v115
    v_add_f32 v112, v112, v116
    v_add_f32 v112, v112, v117
    v_add_f32 v112, v112, v118
    v_add_f32 v112, v112, v119
    v_cvt_pk_bf16_f32 v112, v112, v112
    v_lshlrev_b32 v112, 16, v112
    ds_write_b32 v6, v112 offset:6144
    v_add_f32 v120, v120, v121
    v_add_f32 v120, v120, v122
    v_add_f32 v120, v120, v123
    v_add_f32 v120, v120, v124
    v_add_f32 v120, v120, v125
    v_add_f32 v120, v120, v126
    v_add_f32 v120, v120, v127
    v_cvt_pk_bf16_f32 v120, v120, v120
    v_lshlrev_b32 v120, 16, v120
    ds_write_b32 v6, v120 offset:7168
    v_cmp_gt_u32 vcc, 64, v60
    s_and_saveexec_b64 s[36:37], vcc
    v_add_f32 v128, v128, v129
    v_add_f32 v128, v128, v130
    v_add_f32 v128, v128, v131
    v_add_f32 v128, v128, v132
    v_add_f32 v128, v128, v133
    v_add_f32 v128, v128, v134
    v_add_f32 v128, v128, v135
    v_cvt_pk_bf16_f32 v128, v128, v128
    v_lshlrev_b32 v128, 16, v128
    ds_write_b32 v6, v128 offset:8192
    s_mov_b64 exec, -1
    s_waitcnt lgkmcnt(0)
    s_barrier
    v_lshlrev_b32 v6, 2, v2
    v_lshlrev_b32 v7, 9, v3
    v_add_u32 v6, v6, v7
    ds_read_b32 v80, v6 offset:0
    ds_read_b32 v81, v6 offset:128
    ds_read_b32 v82, v6 offset:256
    ds_read_b32 v83, v6 offset:384
    ds_read_b32 v84, v6 offset:1024
    ds_read_b32 v85, v6 offset:1152
    ds_read_b32 v86, v6 offset:1280
    ds_read_b32 v87, v6 offset:1408
    ds_read_b32 v88, v6 offset:2048
    ds_read_b32 v89, v6 offset:2176
    ds_read_b32 v90, v6 offset:2304
    ds_read_b32 v91, v6 offset:2432
    ds_read_b32 v92, v6 offset:3072
    ds_read_b32 v93, v6 offset:3200
    ds_read_b32 v94, v6 offset:3328
    ds_read_b32 v95, v6 offset:3456
    ds_read_b32 v96, v6 offset:4096
    ds_read_b32 v97, v6 offset:4224
    ds_read_b32 v98, v6 offset:4352
    ds_read_b32 v99, v6 offset:4480
    ds_read_b32 v100, v6 offset:5120
    ds_read_b32 v101, v6 offset:5248
    ds_read_b32 v102, v6 offset:5376
    ds_read_b32 v103, v6 offset:5504
    ds_read_b32 v104, v6 offset:6144
    ds_read_b32 v105, v6 offset:6272
    ds_read_b32 v106, v6 offset:6400
    ds_read_b32 v107, v6 offset:6528
    ds_read_b32 v108, v6 offset:7168
    ds_read_b32 v109, v6 offset:7296
    ds_read_b32 v110, v6 offset:7424
    ds_read_b32 v111, v6 offset:7552
    v_lshlrev_b32 v7, 4, v3
    ds_read_b32 v112, v7 offset:8192
    ds_read_b32 v113, v7 offset:8196
    ds_read_b32 v114, v7 offset:8200
    ds_read_b32 v115, v7 offset:8204
    ds_read_b32 v116, v7 offset:8224
    ds_read_b32 v117, v7 offset:8228
    ds_read_b32 v118, v7 offset:8232
    ds_read_b32 v119, v7 offset:8236
    ds_read_b32 v120, v7 offset:8256
    ds_read_b32 v121, v7 offset:8260
    ds_read_b32 v122, v7 offset:8264
    ds_read_b32 v123, v7 offset:8268
    ds_read_b32 v124, v7 offset:8288
    ds_read_b32 v125, v7 offset:8292
    ds_read_b32 v126, v7 offset:8296
    ds_read_b32 v127, v7 offset:8300
    ds_read_b32 v128, v7 offset:8320
    ds_read_b32 v129, v7 offset:8324
    ds_read_b32 v130, v7 offset:8328
    ds_read_b32 v131, v7 offset:8332
    ds_read_b32 v132, v7 offset:8352
    ds_read_b32 v133, v7 offset:8356
    ds_read_b32 v134, v7 offset:8360
    ds_read_b32 v135, v7 offset:8364
    ds_read_b32 v136, v7 offset:8384
    ds_read_b32 v137, v7 offset:8388
    ds_read_b32 v138, v7 offset:8392
    ds_read_b32 v139, v7 offset:8396
    ds_read_b32 v140, v7 offset:8416
    ds_read_b32 v141, v7 offset:8420
    ds_read_b32 v142, v7 offset:8424
    ds_read_b32 v143, v7 offset:8428
    s_waitcnt lgkmcnt(0)
    v_cvt_pk_bf16_f32 v64, v80, v81
    v_cvt_pk_bf16_f32 v65, v82, v83
    v_cvt_pk_bf16_f32 v66, v84, v85
    v_cvt_pk_bf16_f32 v67, v86, v87
    v_cvt_pk_bf16_f32 v68, v88, v89
    v_cvt_pk_bf16_f32 v69, v90, v91
    v_cvt_pk_bf16_f32 v70, v92, v93
    v_cvt_pk_bf16_f32 v71, v94, v95
    v_cvt_pk_bf16_f32 v72, v96, v97
    v_cvt_pk_bf16_f32 v73, v98, v99
    v_cvt_pk_bf16_f32 v74, v100, v101
    v_cvt_pk_bf16_f32 v75, v102, v103
    v_cvt_pk_bf16_f32 v76, v104, v105
    v_cvt_pk_bf16_f32 v77, v106, v107
    v_cvt_pk_bf16_f32 v78, v108, v109
    v_cvt_pk_bf16_f32 v79, v110, v111
    s_lshl_b32 s31, s29, 8
    s_lshl_b32 s33, s30, 6
    s_add_u32 s31, s31, s33
    s_add_u32 s31, s31, 0
    s_mul_i32 s33, s31, 6144
    v_mul_u32_u24 v7, 6144, v2
    v_add_u32 v7, s33, v7
    s_lshl_b32 s34, s28, 6
    v_lshlrev_b32 v6, 4, v3
    v_add_u32 v6, v7, v6
    v_add_u32 v6, s34, v6
    buffer_load_dwordx4 v[48:51], v6, s[8:11], 0 offen
    buffer_load_dwordx4 v[52:55], v6, s[8:11], 0 offen offset:32
    v_mov_b32 v16, 0
    v_mov_b32 v17, 0
    v_mov_b32 v18, 0
    v_mov_b32 v19, 0
    v_mov_b32 v20, 0
    v_mov_b32 v21, 0
    v_mov_b32 v22, 0
    v_mov_b32 v23, 0
    v_mov_b32 v24, 0
    v_mov_b32 v25, 0
    v_mov_b32 v26, 0
    v_mov_b32 v27, 0
    v_mov_b32 v28, 0
    v_mov_b32 v29, 0
    v_mov_b32 v30, 0
    v_mov_b32 v31, 0
    s_waitcnt vmcnt(0)
    v_mfma_f32_32x32x16_bf16 v[16:31], v[8:11], v[48:51], v[16:31]
    v_mfma_f32_32x32x16_bf16 v[16:31], v[12:15], v[52:55], v[16:31]
    s_nop 15
    s_nop 3
    v_cvt_pk_bf16_f32 v16, v16, v16
    v_lshlrev_b32 v16, 16, v16
    v_cvt_pk_bf16_f32 v17, v17, v17
    v_lshlrev_b32 v17, 16, v17
    v_cvt_pk_bf16_f32 v18, v18, v18
    v_lshlrev_b32 v18, 16, v18
    v_cvt_pk_bf16_f32 v19, v19, v19
    v_lshlrev_b32 v19, 16, v19
    v_cvt_pk_bf16_f32 v20, v20, v20
    v_lshlrev_b32 v20, 16, v20
    v_cvt_pk_bf16_f32 v21, v21, v21
    v_lshlrev_b32 v21, 16, v21
    v_cvt_pk_bf16_f32 v22, v22, v22
    v_lshlrev_b32 v22, 16, v22
    v_cvt_pk_bf16_f32 v23, v23, v23
    v_lshlrev_b32 v23, 16, v23
    v_cvt_pk_bf16_f32 v24, v24, v24
    v_lshlrev_b32 v24, 16, v24
    v_cvt_pk_bf16_f32 v25, v25, v25
    v_lshlrev_b32 v25, 16, v25
    v_cvt_pk_bf16_f32 v26, v26, v26
    v_lshlrev_b32 v26, 16, v26
    v_cvt_pk_bf16_f32 v27, v27, v27
    v_lshlrev_b32 v27, 16, v27
    v_cvt_pk_bf16_f32 v28, v28, v28
    v_lshlrev_b32 v28, 16, v28
    v_cvt_pk_bf16_f32 v29, v29, v29
    v_lshlrev_b32 v29, 16, v29
    v_cvt_pk_bf16_f32 v30, v30, v30
    v_lshlrev_b32 v30, 16, v30
    v_cvt_pk_bf16_f32 v31, v31, v31
    v_lshlrev_b32 v31, 16, v31
    v_mov_b32 v56, v16
    v_mov_b32 v57, v16
    v_max_f32 v56, v56, v17
    v_min_f32 v57, v57, v17
    v_max_f32 v56, v56, v18
    v_min_f32 v57, v57, v18
    v_max_f32 v56, v56, v19
    v_min_f32 v57, v57, v19
    v_max_f32 v56, v56, v20
    v_min_f32 v57, v57, v20
    v_max_f32 v56, v56, v21
    v_min_f32 v57, v57, v21
    v_max_f32 v56, v56, v22
    v_min_f32 v57, v57, v22
    v_max_f32 v56, v56, v23
    v_min_f32 v57, v57, v23
    v_max_f32 v56, v56, v24
    v_min_f32 v57, v57, v24
    v_max_f32 v56, v56, v25
    v_min_f32 v57, v57, v25
    v_max_f32 v56, v56, v26
    v_min_f32 v57, v57, v26
    v_max_f32 v56, v56, v27
    v_min_f32 v57, v57, v27
    v_max_f32 v56, v56, v28
    v_min_f32 v57, v57, v28
    v_max_f32 v56, v56, v29
    v_min_f32 v57, v57, v29
    v_max_f32 v56, v56, v30
    v_min_f32 v57, v57, v30
    v_max_f32 v56, v56, v31
    v_min_f32 v57, v57, v31
    ds_bpermute_b32 v58, v4, v56
    ds_bpermute_b32 v59, v4, v57
    s_waitcnt lgkmcnt(0)
    v_max_f32 v56, v56, v58
    v_min_f32 v57, v57, v59
    v_mov_b32 v58, 0
    v_mov_b32 v59, 0
    s_mov_b32 s35, 0x3fb8aa3b
    v_sub_f32 v32, v57, v16
    v_sub_f32 v16, v16, v56
    v_mul_f32 v32, s35, v32
    v_mul_f32 v16, s35, v16
    v_exp_f32 v32, v32
    v_exp_f32 v16, v16
    s_nop 0
    v_add_f32 v58, v58, v16
    v_add_f32 v59, v59, v32
    v_sub_f32 v33, v57, v17
    v_sub_f32 v17, v17, v56
    v_mul_f32 v33, s35, v33
    v_mul_f32 v17, s35, v17
    v_exp_f32 v33, v33
    v_exp_f32 v17, v17
    s_nop 0
    v_add_f32 v58, v58, v17
    v_add_f32 v59, v59, v33
    v_sub_f32 v34, v57, v18
    v_sub_f32 v18, v18, v56
    v_mul_f32 v34, s35, v34
    v_mul_f32 v18, s35, v18
    v_exp_f32 v34, v34
    v_exp_f32 v18, v18
    s_nop 0
    v_add_f32 v58, v58, v18
    v_add_f32 v59, v59, v34
    v_sub_f32 v35, v57, v19
    v_sub_f32 v19, v19, v56
    v_mul_f32 v35, s35, v35
    v_mul_f32 v19, s35, v19
    v_exp_f32 v35, v35
    v_exp_f32 v19, v19
    s_nop 0
    v_add_f32 v58, v58, v19
    v_add_f32 v59, v59, v35
    v_sub_f32 v36, v57, v20
    v_sub_f32 v20, v20, v56
    v_mul_f32 v36, s35, v36
    v_mul_f32 v20, s35, v20
    v_exp_f32 v36, v36
    v_exp_f32 v20, v20
    s_nop 0
    v_add_f32 v58, v58, v20
    v_add_f32 v59, v59, v36
    v_sub_f32 v37, v57, v21
    v_sub_f32 v21, v21, v56
    v_mul_f32 v37, s35, v37
    v_mul_f32 v21, s35, v21
    v_exp_f32 v37, v37
    v_exp_f32 v21, v21
    s_nop 0
    v_add_f32 v58, v58, v21
    v_add_f32 v59, v59, v37
    v_sub_f32 v38, v57, v22
    v_sub_f32 v22, v22, v56
    v_mul_f32 v38, s35, v38
    v_mul_f32 v22, s35, v22
    v_exp_f32 v38, v38
    v_exp_f32 v22, v22
    s_nop 0
    v_add_f32 v58, v58, v22
    v_add_f32 v59, v59, v38
    v_sub_f32 v39, v57, v23
    v_sub_f32 v23, v23, v56
    v_mul_f32 v39, s35, v39
    v_mul_f32 v23, s35, v23
    v_exp_f32 v39, v39
    v_exp_f32 v23, v23
    s_nop 0
    v_add_f32 v58, v58, v23
    v_add_f32 v59, v59, v39
    v_sub_f32 v40, v57, v24
    v_sub_f32 v24, v24, v56
    v_mul_f32 v40, s35, v40
    v_mul_f32 v24, s35, v24
    v_exp_f32 v40, v40
    v_exp_f32 v24, v24
    s_nop 0
    v_add_f32 v58, v58, v24
    v_add_f32 v59, v59, v40
    v_sub_f32 v41, v57, v25
    v_sub_f32 v25, v25, v56
    v_mul_f32 v41, s35, v41
    v_mul_f32 v25, s35, v25
    v_exp_f32 v41, v41
    v_exp_f32 v25, v25
    s_nop 0
    v_add_f32 v58, v58, v25
    v_add_f32 v59, v59, v41
    v_sub_f32 v42, v57, v26
    v_sub_f32 v26, v26, v56
    v_mul_f32 v42, s35, v42
    v_mul_f32 v26, s35, v26
    v_exp_f32 v42, v42
    v_exp_f32 v26, v26
    s_nop 0
    v_add_f32 v58, v58, v26
    v_add_f32 v59, v59, v42
    v_sub_f32 v43, v57, v27
    v_sub_f32 v27, v27, v56
    v_mul_f32 v43, s35, v43
    v_mul_f32 v27, s35, v27
    v_exp_f32 v43, v43
    v_exp_f32 v27, v27
    s_nop 0
    v_add_f32 v58, v58, v27
    v_add_f32 v59, v59, v43
    v_sub_f32 v44, v57, v28
    v_sub_f32 v28, v28, v56
    v_mul_f32 v44, s35, v44
    v_mul_f32 v28, s35, v28
    v_exp_f32 v44, v44
    v_exp_f32 v28, v28
    s_nop 0
    v_add_f32 v58, v58, v28
    v_add_f32 v59, v59, v44
    v_sub_f32 v45, v57, v29
    v_sub_f32 v29, v29, v56
    v_mul_f32 v45, s35, v45
    v_mul_f32 v29, s35, v29
    v_exp_f32 v45, v45
    v_exp_f32 v29, v29
    s_nop 0
    v_add_f32 v58, v58, v29
    v_add_f32 v59, v59, v45
    v_sub_f32 v46, v57, v30
    v_sub_f32 v30, v30, v56
    v_mul_f32 v46, s35, v46
    v_mul_f32 v30, s35, v30
    v_exp_f32 v46, v46
    v_exp_f32 v30, v30
    s_nop 0
    v_add_f32 v58, v58, v30
    v_add_f32 v59, v59, v46
    v_sub_f32 v47, v57, v31
    v_sub_f32 v31, v31, v56
    v_mul_f32 v47, s35, v47
    v_mul_f32 v31, s35, v31
    v_exp_f32 v47, v47
    v_exp_f32 v31, v31
    s_nop 0
    v_add_f32 v58, v58, v31
    v_add_f32 v59, v59, v47
    ds_bpermute_b32 v56, v4, v58
    ds_bpermute_b32 v57, v4, v59
    s_waitcnt lgkmcnt(0)
    v_add_f32 v58, v58, v56
    v_add_f32 v59, v59, v57
    v_rcp_f32 v58, v58
    v_rcp_f32 v59, v59
    s_nop 0
    v_mul_f32 v16, v16, v58
    v_mul_f32 v32, v32, v59
    v_cvt_pk_bf16_f32 v16, v16, v16
    v_lshlrev_b32 v16, 16, v16
    v_cvt_pk_bf16_f32 v32, v32, v32
    v_lshlrev_b32 v32, 16, v32
    v_mul_f32 v17, v17, v58
    v_mul_f32 v33, v33, v59
    v_cvt_pk_bf16_f32 v17, v17, v17
    v_lshlrev_b32 v17, 16, v17
    v_cvt_pk_bf16_f32 v33, v33, v33
    v_lshlrev_b32 v33, 16, v33
    v_mul_f32 v18, v18, v58
    v_mul_f32 v34, v34, v59
    v_cvt_pk_bf16_f32 v18, v18, v18
    v_lshlrev_b32 v18, 16, v18
    v_cvt_pk_bf16_f32 v34, v34, v34
    v_lshlrev_b32 v34, 16, v34
    v_mul_f32 v19, v19, v58
    v_mul_f32 v35, v35, v59
    v_cvt_pk_bf16_f32 v19, v19, v19
    v_lshlrev_b32 v19, 16, v19
    v_cvt_pk_bf16_f32 v35, v35, v35
    v_lshlrev_b32 v35, 16, v35
    v_mul_f32 v20, v20, v58
    v_mul_f32 v36, v36, v59
    v_cvt_pk_bf16_f32 v20, v20, v20
    v_lshlrev_b32 v20, 16, v20
    v_cvt_pk_bf16_f32 v36, v36, v36
    v_lshlrev_b32 v36, 16, v36
    v_mul_f32 v21, v21, v58
    v_mul_f32 v37, v37, v59
    v_cvt_pk_bf16_f32 v21, v21, v21
    v_lshlrev_b32 v21, 16, v21
    v_cvt_pk_bf16_f32 v37, v37, v37
    v_lshlrev_b32 v37, 16, v37
    v_mul_f32 v22, v22, v58
    v_mul_f32 v38, v38, v59
    v_cvt_pk_bf16_f32 v22, v22, v22
    v_lshlrev_b32 v22, 16, v22
    v_cvt_pk_bf16_f32 v38, v38, v38
    v_lshlrev_b32 v38, 16, v38
    v_mul_f32 v23, v23, v58
    v_mul_f32 v39, v39, v59
    v_cvt_pk_bf16_f32 v23, v23, v23
    v_lshlrev_b32 v23, 16, v23
    v_cvt_pk_bf16_f32 v39, v39, v39
    v_lshlrev_b32 v39, 16, v39
    v_mul_f32 v24, v24, v58
    v_mul_f32 v40, v40, v59
    v_cvt_pk_bf16_f32 v24, v24, v24
    v_lshlrev_b32 v24, 16, v24
    v_cvt_pk_bf16_f32 v40, v40, v40
    v_lshlrev_b32 v40, 16, v40
    v_mul_f32 v25, v25, v58
    v_mul_f32 v41, v41, v59
    v_cvt_pk_bf16_f32 v25, v25, v25
    v_lshlrev_b32 v25, 16, v25
    v_cvt_pk_bf16_f32 v41, v41, v41
    v_lshlrev_b32 v41, 16, v41
    v_mul_f32 v26, v26, v58
    v_mul_f32 v42, v42, v59
    v_cvt_pk_bf16_f32 v26, v26, v26
    v_lshlrev_b32 v26, 16, v26
    v_cvt_pk_bf16_f32 v42, v42, v42
    v_lshlrev_b32 v42, 16, v42
    v_mul_f32 v27, v27, v58
    v_mul_f32 v43, v43, v59
    v_cvt_pk_bf16_f32 v27, v27, v27
    v_lshlrev_b32 v27, 16, v27
    v_cvt_pk_bf16_f32 v43, v43, v43
    v_lshlrev_b32 v43, 16, v43
    v_mul_f32 v28, v28, v58
    v_mul_f32 v44, v44, v59
    v_cvt_pk_bf16_f32 v28, v28, v28
    v_lshlrev_b32 v28, 16, v28
    v_cvt_pk_bf16_f32 v44, v44, v44
    v_lshlrev_b32 v44, 16, v44
    v_mul_f32 v29, v29, v58
    v_mul_f32 v45, v45, v59
    v_cvt_pk_bf16_f32 v29, v29, v29
    v_lshlrev_b32 v29, 16, v29
    v_cvt_pk_bf16_f32 v45, v45, v45
    v_lshlrev_b32 v45, 16, v45
    v_mul_f32 v30, v30, v58
    v_mul_f32 v46, v46, v59
    v_cvt_pk_bf16_f32 v30, v30, v30
    v_lshlrev_b32 v30, 16, v30
    v_cvt_pk_bf16_f32 v46, v46, v46
    v_lshlrev_b32 v46, 16, v46
    v_mul_f32 v31, v31, v58
    v_mul_f32 v47, v47, v59
    v_cvt_pk_bf16_f32 v31, v31, v31
    v_lshlrev_b32 v31, 16, v31
    v_cvt_pk_bf16_f32 v47, v47, v47
    v_lshlrev_b32 v47, 16, v47
    v_mov_b32 v56, 0
    v_fmac_f32 v56, v16, v112
    v_fmac_f32 v56, v17, v113
    v_fmac_f32 v56, v18, v114
    v_fmac_f32 v56, v19, v115
    v_fmac_f32 v56, v20, v116
    v_fmac_f32 v56, v21, v117
    v_fmac_f32 v56, v22, v118
    v_fmac_f32 v56, v23, v119
    v_fmac_f32 v56, v24, v120
    v_fmac_f32 v56, v25, v121
    v_fmac_f32 v56, v26, v122
    v_fmac_f32 v56, v27, v123
    v_fmac_f32 v56, v28, v124
    v_fmac_f32 v56, v29, v125
    v_fmac_f32 v56, v30, v126
    v_fmac_f32 v56, v31, v127
    v_fmac_f32 v56, v32, v128
    v_fmac_f32 v56, v33, v129
    v_fmac_f32 v56, v34, v130
    v_fmac_f32 v56, v35, v131
    v_fmac_f32 v56, v36, v132
    v_fmac_f32 v56, v37, v133
    v_fmac_f32 v56, v38, v134
    v_fmac_f32 v56, v39, v135
    v_fmac_f32 v56, v40, v136
    v_fmac_f32 v56, v41, v137
    v_fmac_f32 v56, v42, v138
    v_fmac_f32 v56, v43, v139
    v_fmac_f32 v56, v44, v140
    v_fmac_f32 v56, v45, v141
    v_fmac_f32 v56, v46, v142
    v_fmac_f32 v56, v47, v143
    ds_bpermute_b32 v57, v4, v56
    v_cvt_pk_bf16_f32 v80, v16, v17
    v_cvt_pk_bf16_f32 v81, v18, v19
    v_cvt_pk_bf16_f32 v82, v20, v21
    v_cvt_pk_bf16_f32 v83, v22, v23
    v_cvt_pk_bf16_f32 v84, v24, v25
    v_cvt_pk_bf16_f32 v85, v26, v27
    v_cvt_pk_bf16_f32 v86, v28, v29
    v_cvt_pk_bf16_f32 v87, v30, v31
    v_cvt_pk_bf16_f32 v88, v32, v33
    v_cvt_pk_bf16_f32 v89, v34, v35
    v_cvt_pk_bf16_f32 v90, v36, v37
    v_cvt_pk_bf16_f32 v91, v38, v39
    v_cvt_pk_bf16_f32 v92, v40, v41
    v_cvt_pk_bf16_f32 v93, v42, v43
    v_cvt_pk_bf16_f32 v94, v44, v45
    v_cvt_pk_bf16_f32 v95, v46, v47
    v_mov_b32 v16, 0
    v_mov_b32 v17, 0
    v_mov_b32 v18, 0
    v_mov_b32 v19, 0
    v_mov_b32 v20, 0
    v_mov_b32 v21, 0
    v_mov_b32 v22, 0
    v_mov_b32 v23, 0
    v_mov_b32 v24, 0
    v_mov_b32 v25, 0
    v_mov_b32 v26, 0
    v_mov_b32 v27, 0
    v_mov_b32 v28, 0
    v_mov_b32 v29, 0
    v_mov_b32 v30, 0
    v_mov_b32 v31, 0
    s_waitcnt lgkmcnt(0)
    v_add_f32 v56, v56, v57
    v_cvt_pk_bf16_f32 v56, v56, v56
    v_lshlrev_b32 v56, 16, v56
    v_add_f32 v56, 0x358637bd, v56
    v_cvt_pk_bf16_f32 v56, v56, v56
    v_lshlrev_b32 v56, 16, v56
    v_rcp_f32 v56, v56
    v_mfma_f32_32x32x16_bf16 v[16:31], v[64:67], v[80:83], v[16:31]
    v_mfma_f32_32x32x16_bf16 v[16:31], v[68:71], v[84:87], v[16:31]
    v_mfma_f32_32x32x16_bf16 v[16:31], v[72:75], v[88:91], v[16:31]
    v_mfma_f32_32x32x16_bf16 v[16:31], v[76:79], v[92:95], v[16:31]
    s_nop 15
    s_nop 3
    s_lshl_b32 s33, s31, 11
    v_lshlrev_b32 v6, 11, v2
    v_add_u32 v6, s33, v6
    v_lshlrev_b32 v7, 3, v3
    v_add_u32 v6, v6, v7
    v_add_u32 v6, s34, v6
    v_cvt_pk_bf16_f32 v16, v16, v16
    v_lshlrev_b32 v16, 16, v16
    v_mul_f32 v16, v16, v56
    v_cvt_pk_bf16_f32 v17, v17, v17
    v_lshlrev_b32 v17, 16, v17
    v_mul_f32 v17, v17, v56
    v_cvt_pk_bf16_f32 v18, v18, v18
    v_lshlrev_b32 v18, 16, v18
    v_mul_f32 v18, v18, v56
    v_cvt_pk_bf16_f32 v19, v19, v19
    v_lshlrev_b32 v19, 16, v19
    v_mul_f32 v19, v19, v56
    v_cvt_pk_bf16_f32 v16, v16, v17
    v_cvt_pk_bf16_f32 v17, v18, v19
    buffer_store_dwordx2 v[16:17], v6, s[20:23], 0 offen offset:0
    v_cvt_pk_bf16_f32 v20, v20, v20
    v_lshlrev_b32 v20, 16, v20
    v_mul_f32 v20, v20, v56
    v_cvt_pk_bf16_f32 v21, v21, v21
    v_lshlrev_b32 v21, 16, v21
    v_mul_f32 v21, v21, v56
    v_cvt_pk_bf16_f32 v22, v22, v22
    v_lshlrev_b32 v22, 16, v22
    v_mul_f32 v22, v22, v56
    v_cvt_pk_bf16_f32 v23, v23, v23
    v_lshlrev_b32 v23, 16, v23
    v_mul_f32 v23, v23, v56
    v_cvt_pk_bf16_f32 v20, v20, v21
    v_cvt_pk_bf16_f32 v21, v22, v23
    buffer_store_dwordx2 v[20:21], v6, s[20:23], 0 offen offset:16
    v_cvt_pk_bf16_f32 v24, v24, v24
    v_lshlrev_b32 v24, 16, v24
    v_mul_f32 v24, v24, v56
    v_cvt_pk_bf16_f32 v25, v25, v25
    v_lshlrev_b32 v25, 16, v25
    v_mul_f32 v25, v25, v56
    v_cvt_pk_bf16_f32 v26, v26, v26
    v_lshlrev_b32 v26, 16, v26
    v_mul_f32 v26, v26, v56
    v_cvt_pk_bf16_f32 v27, v27, v27
    v_lshlrev_b32 v27, 16, v27
    v_mul_f32 v27, v27, v56
    v_cvt_pk_bf16_f32 v24, v24, v25
    v_cvt_pk_bf16_f32 v25, v26, v27
    buffer_store_dwordx2 v[24:25], v6, s[20:23], 0 offen offset:32
    v_cvt_pk_bf16_f32 v28, v28, v28
    v_lshlrev_b32 v28, 16, v28
    v_mul_f32 v28, v28, v56
    v_cvt_pk_bf16_f32 v29, v29, v29
    v_lshlrev_b32 v29, 16, v29
    v_mul_f32 v29, v29, v56
    v_cvt_pk_bf16_f32 v30, v30, v30
    v_lshlrev_b32 v30, 16, v30
    v_mul_f32 v30, v30, v56
    v_cvt_pk_bf16_f32 v31, v31, v31
    v_lshlrev_b32 v31, 16, v31
    v_mul_f32 v31, v31, v56
    v_cvt_pk_bf16_f32 v28, v28, v29
    v_cvt_pk_bf16_f32 v29, v30, v31
    buffer_store_dwordx2 v[28:29], v6, s[20:23], 0 offen offset:48
    s_nop 3
    s_lshl_b32 s31, s29, 8
    s_lshl_b32 s33, s30, 6
    s_add_u32 s31, s31, s33
    s_add_u32 s31, s31, 32
    s_mul_i32 s33, s31, 6144
    v_mul_u32_u24 v7, 6144, v2
    v_add_u32 v7, s33, v7
    s_lshl_b32 s34, s28, 6
    v_lshlrev_b32 v6, 4, v3
    v_add_u32 v6, v7, v6
    v_add_u32 v6, s34, v6
    buffer_load_dwordx4 v[48:51], v6, s[8:11], 0 offen
    buffer_load_dwordx4 v[52:55], v6, s[8:11], 0 offen offset:32
    v_mov_b32 v16, 0
    v_mov_b32 v17, 0
    v_mov_b32 v18, 0
    v_mov_b32 v19, 0
    v_mov_b32 v20, 0
    v_mov_b32 v21, 0
    v_mov_b32 v22, 0
    v_mov_b32 v23, 0
    v_mov_b32 v24, 0
    v_mov_b32 v25, 0
    v_mov_b32 v26, 0
    v_mov_b32 v27, 0
    v_mov_b32 v28, 0
    v_mov_b32 v29, 0
    v_mov_b32 v30, 0
    v_mov_b32 v31, 0
    s_waitcnt vmcnt(0)
    v_mfma_f32_32x32x16_bf16 v[16:31], v[8:11], v[48:51], v[16:31]
    v_mfma_f32_32x32x16_bf16 v[16:31], v[12:15], v[52:55], v[16:31]
    s_nop 15
    s_nop 3
    v_cvt_pk_bf16_f32 v16, v16, v16
    v_lshlrev_b32 v16, 16, v16
    v_cvt_pk_bf16_f32 v17, v17, v17
    v_lshlrev_b32 v17, 16, v17
    v_cvt_pk_bf16_f32 v18, v18, v18
    v_lshlrev_b32 v18, 16, v18
    v_cvt_pk_bf16_f32 v19, v19, v19
    v_lshlrev_b32 v19, 16, v19
    v_cvt_pk_bf16_f32 v20, v20, v20
    v_lshlrev_b32 v20, 16, v20
    v_cvt_pk_bf16_f32 v21, v21, v21
    v_lshlrev_b32 v21, 16, v21
    v_cvt_pk_bf16_f32 v22, v22, v22
    v_lshlrev_b32 v22, 16, v22
    v_cvt_pk_bf16_f32 v23, v23, v23
    v_lshlrev_b32 v23, 16, v23
    v_cvt_pk_bf16_f32 v24, v24, v24
    v_lshlrev_b32 v24, 16, v24
    v_cvt_pk_bf16_f32 v25, v25, v25
    v_lshlrev_b32 v25, 16, v25
    v_cvt_pk_bf16_f32 v26, v26, v26
    v_lshlrev_b32 v26, 16, v26
    v_cvt_pk_bf16_f32 v27, v27, v27
    v_lshlrev_b32 v27, 16, v27
    v_cvt_pk_bf16_f32 v28, v28, v28
    v_lshlrev_b32 v28, 16, v28
    v_cvt_pk_bf16_f32 v29, v29, v29
    v_lshlrev_b32 v29, 16, v29
    v_cvt_pk_bf16_f32 v30, v30, v30
    v_lshlrev_b32 v30, 16, v30
    v_cvt_pk_bf16_f32 v31, v31, v31
    v_lshlrev_b32 v31, 16, v31
    v_mov_b32 v56, v16
    v_mov_b32 v57, v16
    v_max_f32 v56, v56, v17
    v_min_f32 v57, v57, v17
    v_max_f32 v56, v56, v18
    v_min_f32 v57, v57, v18
    v_max_f32 v56, v56, v19
    v_min_f32 v57, v57, v19
    v_max_f32 v56, v56, v20
    v_min_f32 v57, v57, v20
    v_max_f32 v56, v56, v21
    v_min_f32 v57, v57, v21
    v_max_f32 v56, v56, v22
    v_min_f32 v57, v57, v22
    v_max_f32 v56, v56, v23
    v_min_f32 v57, v57, v23
    v_max_f32 v56, v56, v24
    v_min_f32 v57, v57, v24
    v_max_f32 v56, v56, v25
    v_min_f32 v57, v57, v25
    v_max_f32 v56, v56, v26
    v_min_f32 v57, v57, v26
    v_max_f32 v56, v56, v27
    v_min_f32 v57, v57, v27
    v_max_f32 v56, v56, v28
    v_min_f32 v57, v57, v28
    v_max_f32 v56, v56, v29
    v_min_f32 v57, v57, v29
    v_max_f32 v56, v56, v30
    v_min_f32 v57, v57, v30
    v_max_f32 v56, v56, v31
    v_min_f32 v57, v57, v31
    ds_bpermute_b32 v58, v4, v56
    ds_bpermute_b32 v59, v4, v57
    s_waitcnt lgkmcnt(0)
    v_max_f32 v56, v56, v58
    v_min_f32 v57, v57, v59
    v_mov_b32 v58, 0
    v_mov_b32 v59, 0
    s_mov_b32 s35, 0x3fb8aa3b
    v_sub_f32 v32, v57, v16
    v_sub_f32 v16, v16, v56
    v_mul_f32 v32, s35, v32
    v_mul_f32 v16, s35, v16
    v_exp_f32 v32, v32
    v_exp_f32 v16, v16
    s_nop 0
    v_add_f32 v58, v58, v16
    v_add_f32 v59, v59, v32
    v_sub_f32 v33, v57, v17
    v_sub_f32 v17, v17, v56
    v_mul_f32 v33, s35, v33
    v_mul_f32 v17, s35, v17
    v_exp_f32 v33, v33
    v_exp_f32 v17, v17
    s_nop 0
    v_add_f32 v58, v58, v17
    v_add_f32 v59, v59, v33
    v_sub_f32 v34, v57, v18
    v_sub_f32 v18, v18, v56
    v_mul_f32 v34, s35, v34
    v_mul_f32 v18, s35, v18
    v_exp_f32 v34, v34
    v_exp_f32 v18, v18
    s_nop 0
    v_add_f32 v58, v58, v18
    v_add_f32 v59, v59, v34
    v_sub_f32 v35, v57, v19
    v_sub_f32 v19, v19, v56
    v_mul_f32 v35, s35, v35
    v_mul_f32 v19, s35, v19
    v_exp_f32 v35, v35
    v_exp_f32 v19, v19
    s_nop 0
    v_add_f32 v58, v58, v19
    v_add_f32 v59, v59, v35
    v_sub_f32 v36, v57, v20
    v_sub_f32 v20, v20, v56
    v_mul_f32 v36, s35, v36
    v_mul_f32 v20, s35, v20
    v_exp_f32 v36, v36
    v_exp_f32 v20, v20
    s_nop 0
    v_add_f32 v58, v58, v20
    v_add_f32 v59, v59, v36
    v_sub_f32 v37, v57, v21
    v_sub_f32 v21, v21, v56
    v_mul_f32 v37, s35, v37
    v_mul_f32 v21, s35, v21
    v_exp_f32 v37, v37
    v_exp_f32 v21, v21
    s_nop 0
    v_add_f32 v58, v58, v21
    v_add_f32 v59, v59, v37
    v_sub_f32 v38, v57, v22
    v_sub_f32 v22, v22, v56
    v_mul_f32 v38, s35, v38
    v_mul_f32 v22, s35, v22
    v_exp_f32 v38, v38
    v_exp_f32 v22, v22
    s_nop 0
    v_add_f32 v58, v58, v22
    v_add_f32 v59, v59, v38
    v_sub_f32 v39, v57, v23
    v_sub_f32 v23, v23, v56
    v_mul_f32 v39, s35, v39
    v_mul_f32 v23, s35, v23
    v_exp_f32 v39, v39
    v_exp_f32 v23, v23
    s_nop 0
    v_add_f32 v58, v58, v23
    v_add_f32 v59, v59, v39
    v_sub_f32 v40, v57, v24
    v_sub_f32 v24, v24, v56
    v_mul_f32 v40, s35, v40
    v_mul_f32 v24, s35, v24
    v_exp_f32 v40, v40
    v_exp_f32 v24, v24
    s_nop 0
    v_add_f32 v58, v58, v24
    v_add_f32 v59, v59, v40
    v_sub_f32 v41, v57, v25
    v_sub_f32 v25, v25, v56
    v_mul_f32 v41, s35, v41
    v_mul_f32 v25, s35, v25
    v_exp_f32 v41, v41
    v_exp_f32 v25, v25
    s_nop 0
    v_add_f32 v58, v58, v25
    v_add_f32 v59, v59, v41
    v_sub_f32 v42, v57, v26
    v_sub_f32 v26, v26, v56
    v_mul_f32 v42, s35, v42
    v_mul_f32 v26, s35, v26
    v_exp_f32 v42, v42
    v_exp_f32 v26, v26
    s_nop 0
    v_add_f32 v58, v58, v26
    v_add_f32 v59, v59, v42
    v_sub_f32 v43, v57, v27
    v_sub_f32 v27, v27, v56
    v_mul_f32 v43, s35, v43
    v_mul_f32 v27, s35, v27
    v_exp_f32 v43, v43
    v_exp_f32 v27, v27
    s_nop 0
    v_add_f32 v58, v58, v27
    v_add_f32 v59, v59, v43
    v_sub_f32 v44, v57, v28
    v_sub_f32 v28, v28, v56
    v_mul_f32 v44, s35, v44
    v_mul_f32 v28, s35, v28
    v_exp_f32 v44, v44
    v_exp_f32 v28, v28
    s_nop 0
    v_add_f32 v58, v58, v28
    v_add_f32 v59, v59, v44
    v_sub_f32 v45, v57, v29
    v_sub_f32 v29, v29, v56
    v_mul_f32 v45, s35, v45
    v_mul_f32 v29, s35, v29
    v_exp_f32 v45, v45
    v_exp_f32 v29, v29
    s_nop 0
    v_add_f32 v58, v58, v29
    v_add_f32 v59, v59, v45
    v_sub_f32 v46, v57, v30
    v_sub_f32 v30, v30, v56
    v_mul_f32 v46, s35, v46
    v_mul_f32 v30, s35, v30
    v_exp_f32 v46, v46
    v_exp_f32 v30, v30
    s_nop 0
    v_add_f32 v58, v58, v30
    v_add_f32 v59, v59, v46
    v_sub_f32 v47, v57, v31
    v_sub_f32 v31, v31, v56
    v_mul_f32 v47, s35, v47
    v_mul_f32 v31, s35, v31
    v_exp_f32 v47, v47
    v_exp_f32 v31, v31
    s_nop 0
    v_add_f32 v58, v58, v31
    v_add_f32 v59, v59, v47
    ds_bpermute_b32 v56, v4, v58
    ds_bpermute_b32 v57, v4, v59
    s_waitcnt lgkmcnt(0)
    v_add_f32 v58, v58, v56
    v_add_f32 v59, v59, v57
    v_rcp_f32 v58, v58
    v_rcp_f32 v59, v59
    s_nop 0
    v_mul_f32 v16, v16, v58
    v_mul_f32 v32, v32, v59
    v_cvt_pk_bf16_f32 v16, v16, v16
    v_lshlrev_b32 v16, 16, v16
    v_cvt_pk_bf16_f32 v32, v32, v32
    v_lshlrev_b32 v32, 16, v32
    v_mul_f32 v17, v17, v58
    v_mul_f32 v33, v33, v59
    v_cvt_pk_bf16_f32 v17, v17, v17
    v_lshlrev_b32 v17, 16, v17
    v_cvt_pk_bf16_f32 v33, v33, v33
    v_lshlrev_b32 v33, 16, v33
    v_mul_f32 v18, v18, v58
    v_mul_f32 v34, v34, v59
    v_cvt_pk_bf16_f32 v18, v18, v18
    v_lshlrev_b32 v18, 16, v18
    v_cvt_pk_bf16_f32 v34, v34, v34
    v_lshlrev_b32 v34, 16, v34
    v_mul_f32 v19, v19, v58
    v_mul_f32 v35, v35, v59
    v_cvt_pk_bf16_f32 v19, v19, v19
    v_lshlrev_b32 v19, 16, v19
    v_cvt_pk_bf16_f32 v35, v35, v35
    v_lshlrev_b32 v35, 16, v35
    v_mul_f32 v20, v20, v58
    v_mul_f32 v36, v36, v59
    v_cvt_pk_bf16_f32 v20, v20, v20
    v_lshlrev_b32 v20, 16, v20
    v_cvt_pk_bf16_f32 v36, v36, v36
    v_lshlrev_b32 v36, 16, v36
    v_mul_f32 v21, v21, v58
    v_mul_f32 v37, v37, v59
    v_cvt_pk_bf16_f32 v21, v21, v21
    v_lshlrev_b32 v21, 16, v21
    v_cvt_pk_bf16_f32 v37, v37, v37
    v_lshlrev_b32 v37, 16, v37
    v_mul_f32 v22, v22, v58
    v_mul_f32 v38, v38, v59
    v_cvt_pk_bf16_f32 v22, v22, v22
    v_lshlrev_b32 v22, 16, v22
    v_cvt_pk_bf16_f32 v38, v38, v38
    v_lshlrev_b32 v38, 16, v38
    v_mul_f32 v23, v23, v58
    v_mul_f32 v39, v39, v59
    v_cvt_pk_bf16_f32 v23, v23, v23
    v_lshlrev_b32 v23, 16, v23
    v_cvt_pk_bf16_f32 v39, v39, v39
    v_lshlrev_b32 v39, 16, v39
    v_mul_f32 v24, v24, v58
    v_mul_f32 v40, v40, v59
    v_cvt_pk_bf16_f32 v24, v24, v24
    v_lshlrev_b32 v24, 16, v24
    v_cvt_pk_bf16_f32 v40, v40, v40
    v_lshlrev_b32 v40, 16, v40
    v_mul_f32 v25, v25, v58
    v_mul_f32 v41, v41, v59
    v_cvt_pk_bf16_f32 v25, v25, v25
    v_lshlrev_b32 v25, 16, v25
    v_cvt_pk_bf16_f32 v41, v41, v41
    v_lshlrev_b32 v41, 16, v41
    v_mul_f32 v26, v26, v58
    v_mul_f32 v42, v42, v59
    v_cvt_pk_bf16_f32 v26, v26, v26
    v_lshlrev_b32 v26, 16, v26
    v_cvt_pk_bf16_f32 v42, v42, v42
    v_lshlrev_b32 v42, 16, v42
    v_mul_f32 v27, v27, v58
    v_mul_f32 v43, v43, v59
    v_cvt_pk_bf16_f32 v27, v27, v27
    v_lshlrev_b32 v27, 16, v27
    v_cvt_pk_bf16_f32 v43, v43, v43
    v_lshlrev_b32 v43, 16, v43
    v_mul_f32 v28, v28, v58
    v_mul_f32 v44, v44, v59
    v_cvt_pk_bf16_f32 v28, v28, v28
    v_lshlrev_b32 v28, 16, v28
    v_cvt_pk_bf16_f32 v44, v44, v44
    v_lshlrev_b32 v44, 16, v44
    v_mul_f32 v29, v29, v58
    v_mul_f32 v45, v45, v59
    v_cvt_pk_bf16_f32 v29, v29, v29
    v_lshlrev_b32 v29, 16, v29
    v_cvt_pk_bf16_f32 v45, v45, v45
    v_lshlrev_b32 v45, 16, v45
    v_mul_f32 v30, v30, v58
    v_mul_f32 v46, v46, v59
    v_cvt_pk_bf16_f32 v30, v30, v30
    v_lshlrev_b32 v30, 16, v30
    v_cvt_pk_bf16_f32 v46, v46, v46
    v_lshlrev_b32 v46, 16, v46
    v_mul_f32 v31, v31, v58
    v_mul_f32 v47, v47, v59
    v_cvt_pk_bf16_f32 v31, v31, v31
    v_lshlrev_b32 v31, 16, v31
    v_cvt_pk_bf16_f32 v47, v47, v47
    v_lshlrev_b32 v47, 16, v47
    v_mov_b32 v56, 0
    v_fmac_f32 v56, v16, v112
    v_fmac_f32 v56, v17, v113
    v_fmac_f32 v56, v18, v114
    v_fmac_f32 v56, v19, v115
    v_fmac_f32 v56, v20, v116
    v_fmac_f32 v56, v21, v117
    v_fmac_f32 v56, v22, v118
    v_fmac_f32 v56, v23, v119
    v_fmac_f32 v56, v24, v120
    v_fmac_f32 v56, v25, v121
    v_fmac_f32 v56, v26, v122
    v_fmac_f32 v56, v27, v123
    v_fmac_f32 v56, v28, v124
    v_fmac_f32 v56, v29, v125
    v_fmac_f32 v56, v30, v126
    v_fmac_f32 v56, v31, v127
    v_fmac_f32 v56, v32, v128
    v_fmac_f32 v56, v33, v129
    v_fmac_f32 v56, v34, v130
    v_fmac_f32 v56, v35, v131
    v_fmac_f32 v56, v36, v132
    v_fmac_f32 v56, v37, v133
    v_fmac_f32 v56, v38, v134
    v_fmac_f32 v56, v39, v135
    v_fmac_f32 v56, v40, v136
    v_fmac_f32 v56, v41, v137
    v_fmac_f32 v56, v42, v138
    v_fmac_f32 v56, v43, v139
    v_fmac_f32 v56, v44, v140
    v_fmac_f32 v56, v45, v141
    v_fmac_f32 v56, v46, v142
    v_fmac_f32 v56, v47, v143
    ds_bpermute_b32 v57, v4, v56
    v_cvt_pk_bf16_f32 v80, v16, v17
    v_cvt_pk_bf16_f32 v81, v18, v19
    v_cvt_pk_bf16_f32 v82, v20, v21
    v_cvt_pk_bf16_f32 v83, v22, v23
    v_cvt_pk_bf16_f32 v84, v24, v25
    v_cvt_pk_bf16_f32 v85, v26, v27
    v_cvt_pk_bf16_f32 v86, v28, v29
    v_cvt_pk_bf16_f32 v87, v30, v31
    v_cvt_pk_bf16_f32 v88, v32, v33
    v_cvt_pk_bf16_f32 v89, v34, v35
    v_cvt_pk_bf16_f32 v90, v36, v37
    v_cvt_pk_bf16_f32 v91, v38, v39
    v_cvt_pk_bf16_f32 v92, v40, v41
    v_cvt_pk_bf16_f32 v93, v42, v43
    v_cvt_pk_bf16_f32 v94, v44, v45
    v_cvt_pk_bf16_f32 v95, v46, v47
    v_mov_b32 v16, 0
    v_mov_b32 v17, 0
    v_mov_b32 v18, 0
    v_mov_b32 v19, 0
    v_mov_b32 v20, 0
    v_mov_b32 v21, 0
    v_mov_b32 v22, 0
    v_mov_b32 v23, 0
    v_mov_b32 v24, 0
    v_mov_b32 v25, 0
    v_mov_b32 v26, 0
    v_mov_b32 v27, 0
    v_mov_b32 v28, 0
    v_mov_b32 v29, 0
    v_mov_b32 v30, 0
    v_mov_b32 v31, 0
    s_waitcnt lgkmcnt(0)
    v_add_f32 v56, v56, v57
    v_cvt_pk_bf16_f32 v56, v56, v56
    v_lshlrev_b32 v56, 16, v56
    v_add_f32 v56, 0x358637bd, v56
    v_cvt_pk_bf16_f32 v56, v56, v56
    v_lshlrev_b32 v56, 16, v56
    v_rcp_f32 v56, v56
    v_mfma_f32_32x32x16_bf16 v[16:31], v[64:67], v[80:83], v[16:31]
    v_mfma_f32_32x32x16_bf16 v[16:31], v[68:71], v[84:87], v[16:31]
    v_mfma_f32_32x32x16_bf16 v[16:31], v[72:75], v[88:91], v[16:31]
    v_mfma_f32_32x32x16_bf16 v[16:31], v[76:79], v[92:95], v[16:31]
    s_nop 15
    s_nop 3
    s_lshl_b32 s33, s31, 11
    v_lshlrev_b32 v6, 11, v2
    v_add_u32 v6, s33, v6
    v_lshlrev_b32 v7, 3, v3
    v_add_u32 v6, v6, v7
    v_add_u32 v6, s34, v6
    v_cvt_pk_bf16_f32 v16, v16, v16
    v_lshlrev_b32 v16, 16, v16
    v_mul_f32 v16, v16, v56
    v_cvt_pk_bf16_f32 v17, v17, v17
    v_lshlrev_b32 v17, 16, v17
    v_mul_f32 v17, v17, v56
    v_cvt_pk_bf16_f32 v18, v18, v18
    v_lshlrev_b32 v18, 16, v18
    v_mul_f32 v18, v18, v56
    v_cvt_pk_bf16_f32 v19, v19, v19
    v_lshlrev_b32 v19, 16, v19
    v_mul_f32 v19, v19, v56
    v_cvt_pk_bf16_f32 v16, v16, v17
    v_cvt_pk_bf16_f32 v17, v18, v19
    buffer_store_dwordx2 v[16:17], v6, s[20:23], 0 offen offset:0
    v_cvt_pk_bf16_f32 v20, v20, v20
    v_lshlrev_b32 v20, 16, v20
    v_mul_f32 v20, v20, v56
    v_cvt_pk_bf16_f32 v21, v21, v21
    v_lshlrev_b32 v21, 16, v21
    v_mul_f32 v21, v21, v56
    v_cvt_pk_bf16_f32 v22, v22, v22
    v_lshlrev_b32 v22, 16, v22
    v_mul_f32 v22, v22, v56
    v_cvt_pk_bf16_f32 v23, v23, v23
    v_lshlrev_b32 v23, 16, v23
    v_mul_f32 v23, v23, v56
    v_cvt_pk_bf16_f32 v20, v20, v21
    v_cvt_pk_bf16_f32 v21, v22, v23
    buffer_store_dwordx2 v[20:21], v6, s[20:23], 0 offen offset:16
    v_cvt_pk_bf16_f32 v24, v24, v24
    v_lshlrev_b32 v24, 16, v24
    v_mul_f32 v24, v24, v56
    v_cvt_pk_bf16_f32 v25, v25, v25
    v_lshlrev_b32 v25, 16, v25
    v_mul_f32 v25, v25, v56
    v_cvt_pk_bf16_f32 v26, v26, v26
    v_lshlrev_b32 v26, 16, v26
    v_mul_f32 v26, v26, v56
    v_cvt_pk_bf16_f32 v27, v27, v27
    v_lshlrev_b32 v27, 16, v27
    v_mul_f32 v27, v27, v56
    v_cvt_pk_bf16_f32 v24, v24, v25
    v_cvt_pk_bf16_f32 v25, v26, v27
    buffer_store_dwordx2 v[24:25], v6, s[20:23], 0 offen offset:32
    v_cvt_pk_bf16_f32 v28, v28, v28
    v_lshlrev_b32 v28, 16, v28
    v_mul_f32 v28, v28, v56
    v_cvt_pk_bf16_f32 v29, v29, v29
    v_lshlrev_b32 v29, 16, v29
    v_mul_f32 v29, v29, v56
    v_cvt_pk_bf16_f32 v30, v30, v30
    v_lshlrev_b32 v30, 16, v30
    v_mul_f32 v30, v30, v56
    v_cvt_pk_bf16_f32 v31, v31, v31
    v_lshlrev_b32 v31, 16, v31
    v_mul_f32 v31, v31, v56
    v_cvt_pk_bf16_f32 v28, v28, v29
    v_cvt_pk_bf16_f32 v29, v30, v31
    buffer_store_dwordx2 v[28:29], v6, s[20:23], 0 offen offset:48
    s_nop 3
L_done_ao_1_kernel:
    s_endpgm
.globl gwo_1_kernel
.p2align 8
.type gwo_1_kernel,@function
gwo_1_kernel:
    s_cmp_ge_u32 s2, 256
    s_cbranch_scc1 L_done_gwo_1_kernel
    s_load_dwordx2 s[40:41], s[0:1], 24
    s_load_dwordx2 s[42:43], s[0:1], 88
    s_waitcnt lgkmcnt(0)
    s_add_u32 s8, s42, 20971520
    s_addc_u32 s9, s43, 0
    s_mov_b32 s10, 4194304
    s_mov_b32 s11, 0x00020000
    s_mov_b32 s12, s40
    s_mov_b32 s13, s41
    s_mov_b32 s14, 2097152
    s_mov_b32 s15, 0x00020000
    s_add_u32 s16, s42, 25165824
    s_addc_u32 s17, s43, 0
    s_mov_b32 s18, 4194304
    s_mov_b32 s19, 0x00020000
    s_add_u32 s20, s42, 69206016
    s_addc_u32 s21, s43, 0
    s_mov_b32 s22, 4194304
    s_mov_b32 s23, 0x00020000
    s_mov_b32 s36, 0x3d372713
    s_mov_b32 s37, 0xc0135761
    s_and_b32 s3, s2, 7
    s_lshr_b32 s4, s2, 3
    s_mul_i32 s5, s4, 8192
    s_lshr_b32 s5, s5, 16
    s_mul_i32 s6, s5, 8
    s_sub_u32 s6, s4, s6
    s_lshr_b32 s7, s3, 1
    s_mul_i32 s7, s7, 4
    s_add_u32 s28, s7, s5
    s_and_b32 s7, s3, 1
    s_mul_i32 s7, s7, 8
    s_add_u32 s29, s7, s6
    v_lshrrev_b32 v1, 6, v0
    s_nop 0
    v_readfirstlane_b32 s30, v1
    v_and_b32 v0, 63, v0
    v_lshrrev_b32 v1, 3, v0
    s_lshl_b32 s31, s30, 4
    s_lshl_b32 s34, s28, 7
    s_add_u32 s31, s31, s34
    v_add_u32 v1, s31, v1
    v_add_u32 v6, 0, v1
    v_lshrrev_b32 v7, 1, v6
    v_and_b32 v7, 7, v7
    v_and_b32 v8, 7, v0
    v_xor_b32 v7, v7, v8
    v_lshlrev_b32 v7, 4, v7
    s_mov_b32 s35, 2048
    v_mul_lo_u32 v6, v6, s35
    v_add_u32 v2, v6, v7
    v_add_u32 v6, 8, v1
    v_lshrrev_b32 v7, 1, v6
    v_and_b32 v7, 7, v7
    v_and_b32 v8, 7, v0
    v_xor_b32 v7, v7, v8
    v_lshlrev_b32 v7, 4, v7
    s_mov_b32 s35, 2048
    v_mul_lo_u32 v6, v6, s35
    v_add_u32 v3, v6, v7
    s_mul_i32 s31, s30, 64
    s_mul_i32 s34, s29, 128
    v_add_u32 v6, s31, v0
    v_add_u32 v6, 0, v6
    v_mul_u32_u24 v7, 8192, v6
    v_lshrrev_b32 v7, 16, v7
    v_mul_u32_u24 v8, 8, v7
    v_sub_u32 v8, v6, v8
    v_lshlrev_b32 v9, 1, v7
    v_and_b32 v9, 4, v9
    v_xor_b32 v8, v8, v9
    v_lshlrev_b32 v8, 4, v8
    s_mov_b32 s35, 2048
    v_mul_lo_u32 v7, v7, s35
    v_add_u32 v7, v7, v8
    v_add_u32 v10, s34, v7
    s_lshr_b32 s31, s30, 1
    s_and_b32 s34, s30, 1
    s_mul_i32 s38, s31, 32
    s_mul_i32 s39, s34, 32
    v_and_b32 v6, 31, v0
    v_add_u32 v6, s38, v6
    v_lshrrev_b32 v7, 1, v6
    v_and_b32 v7, 7, v7
    v_lshrrev_b32 v8, 5, v0
    v_xor_b32 v7, v7, v8
    v_lshlrev_b32 v7, 4, v7
    v_lshlrev_b32 v6, 7, v6
    v_add_u32 v6, v6, v7
    v_xor_b32 v20, 0, v6
    v_add_u32 v36, 65536, v20
    v_xor_b32 v21, 32, v6
    v_add_u32 v37, 65536, v21
    v_xor_b32 v22, 64, v6
    v_add_u32 v38, 65536, v22
    v_xor_b32 v23, 96, v6
    v_add_u32 v39, 65536, v23
    v_lshrrev_b32 v6, 5, v0
    v_lshlrev_b32 v6, 3, v6
    v_bfe_u32 v7, v0, 2, 2
    v_add_u32 v6, v6, v7
    v_bfe_u32 v8, v0, 4, 1
    v_lshlrev_b32 v8, 4, v8
    v_and_b32 v9, 3, v0
    v_lshlrev_b32 v9, 2, v9
    v_add_u32 v8, v8, v9
    v_add_u32 v8, s39, v8
    v_add_u32 v9, 0, v8
    v_lshlrev_b32 v9, 1, v9
    v_lshlrev_b32 v18, 5, v7
    v_and_b32 v18, 64, v18
    v_xor_b32 v9, v9, v18
    v_mul_u32_u24 v19, 128, v6
    v_add_u32 v24, v19, v9
    v_add_u32 v24, 98304, v24
    v_add_u32 v28, 16384, v24
    v_add_u32 v32, 32768, v24
    v_mov_b32 v40, 0
    v_mov_b32 v41, 0
    v_mov_b32 v42, 0
    v_mov_b32 v43, 0
    v_mov_b32 v44, 0
    v_mov_b32 v45, 0
    v_mov_b32 v46, 0
    v_mov_b32 v47, 0
    v_mov_b32 v48, 0
    v_mov_b32 v49, 0
    v_mov_b32 v50, 0
    v_mov_b32 v51, 0
    v_mov_b32 v52, 0
    v_mov_b32 v53, 0
    v_mov_b32 v54, 0
    v_mov_b32 v55, 0
    s_lshl_b32 s40, s30, 11
    s_mul_i32 s41, s30, 1024
    s_add_u32 s41, s41, 98304
    s_mov_b32 s32, 0
    s_mov_b32 s33, 0
    s_and_b32 s42, s4, 15
    s_mov_b32 s42, 0
    s_mov_b32 s35, 0
    s_add_u32 s35, s35, s42
    s_sub_u32 s34, s35, 16
    s_cmp_ge_u32 s35, 16
    s_cselect_b32 s35, s34, s35
    s_mul_i32 s33, s35, 131072
    s_lshl_b32 s32, s35, 7
    s_add_u32 m0, s40, 0
    s_nop 0
    buffer_load_dwordx4 v2, s[8:11], s32 offen lds
    s_add_u32 m0, s40, 1024
    s_nop 0
    buffer_load_dwordx4 v3, s[8:11], s32 offen lds
    s_add_u32 m0, s41, 0
    s_nop 0
    buffer_load_dwordx4 v10, s[12:15], s33 offen lds
    s_mov_b32 s35, 1
    s_add_u32 s35, s35, s42
    s_sub_u32 s34, s35, 16
    s_cmp_ge_u32 s35, 16
    s_cselect_b32 s35, s34, s35
    s_mul_i32 s33, s35, 131072
    s_lshl_b32 s32, s35, 7
    s_add_u32 m0, s40, 16384
    s_nop 0
    buffer_load_dwordx4 v2, s[8:11], s32 offen lds
    s_add_u32 m0, s40, 17408
    s_nop 0
    buffer_load_dwordx4 v3, s[8:11], s32 offen lds
    s_add_u32 m0, s41, 8192
    s_nop 0
    buffer_load_dwordx4 v10, s[12:15], s33 offen lds
    s_mov_b32 s35, 2
    s_add_u32 s35, s35, s42
    s_sub_u32 s34, s35, 16
    s_cmp_ge_u32 s35, 16
    s_cselect_b32 s35, s34, s35
    s_mul_i32 s33, s35, 131072
    s_lshl_b32 s32, s35, 7
    s_add_u32 m0, s40, 32768
    s_nop 0
    buffer_load_dwordx4 v2, s[8:11], s32 offen lds
    s_add_u32 m0, s40, 33792
    s_nop 0
    buffer_load_dwordx4 v3, s[8:11], s32 offen lds
    s_add_u32 m0, s41, 16384
    s_nop 0
    buffer_load_dwordx4 v10, s[12:15], s33 offen lds
    s_mov_b32 s35, 3
    s_add_u32 s35, s35, s42
    s_sub_u32 s34, s35, 16
    s_cmp_ge_u32 s35, 16
    s_cselect_b32 s35, s34, s35
    s_mul_i32 s33, s35, 131072
    s_lshl_b32 s32, s35, 7
    s_add_u32 m0, s40, 49152
    s_nop 0
    buffer_load_dwordx4 v2, s[8:11], s32 offen lds
    s_add_u32 m0, s40, 50176
    s_nop 0
    buffer_load_dwordx4 v3, s[8:11], s32 offen lds
    s_add_u32 m0, s41, 24576
    s_nop 0
    buffer_load_dwordx4 v10, s[12:15], s33 offen lds
    s_mov_b32 s35, 4
    s_add_u32 s35, s35, s42
    s_sub_u32 s34, s35, 16
    s_cmp_ge_u32 s35, 16
    s_cselect_b32 s35, s34, s35
    s_mul_i32 s33, s35, 131072
    s_lshl_b32 s32, s35, 7
    s_add_u32 m0, s40, 65536
    s_nop 0
    buffer_load_dwordx4 v2, s[8:11], s32 offen lds
    s_add_u32 m0, s40, 66560
    s_nop 0
    buffer_load_dwordx4 v3, s[8:11], s32 offen lds
    s_add_u32 m0, s41, 32768
    s_nop 0
    buffer_load_dwordx4 v10, s[12:15], s33 offen lds
    s_mov_b32 s31, 0
    s_waitcnt vmcnt(12)
    s_barrier
    ds_read_b128 v[56:59], v20 offset:0
    ds_read_b64_tr_b16 v[60:61], v24 offset:0
    ds_read_b64_tr_b16 v[62:63], v24 offset:512
L_loop_gwo_1_kernel:
    s_cmp_ge_u32 s31, 16
    s_cbranch_scc1 L_lend_gwo_1_kernel
    s_cmp_ge_u32 s31, 11
    s_cbranch_scc1 L_gwo_1_kernel_tail1
    s_waitcnt vmcnt(9)
    s_barrier
    s_add_u32 s35, s31, 5
    s_add_u32 s35, s35, s42
    s_sub_u32 s34, s35, 16
    s_cmp_ge_u32 s35, 16
    s_cselect_b32 s35, s34, s35
    s_mul_i32 s33, s35, 131072
    s_lshl_b32 s32, s35, 7
    s_add_u32 m0, s40, 81920
    s_nop 0
    buffer_load_dwordx4 v2, s[8:11], s32 offen lds
    s_add_u32 m0, s40, 82944
    s_nop 0
    buffer_load_dwordx4 v3, s[8:11], s32 offen lds
    s_add_u32 m0, s41, 40960
    s_nop 0
    buffer_load_dwordx4 v10, s[12:15], s33 offen lds
    s_branch L_gwo_1_kernel_join2
L_gwo_1_kernel_tail1:
    s_waitcnt vmcnt(0)
    s_barrier
L_gwo_1_kernel_join2:
    ds_read_b128 v[64:67], v21 offset:0
    ds_read_b64_tr_b16 v[68:69], v24 offset:2048
    ds_read_b64_tr_b16 v[70:71], v24 offset:2560
    s_waitcnt lgkmcnt(3)
    v_mfma_f32_32x32x16_bf16 v[40:55], v[60:63], v[56:59], v[40:55]
    ds_read_b128 v[56:59], v22 offset:0
    ds_read_b64_tr_b16 v[60:61], v24 offset:4096
    ds_read_b64_tr_b16 v[62:63], v24 offset:4608
    s_waitcnt lgkmcnt(3)
    v_mfma_f32_32x32x16_bf16 v[40:55], v[68:71], v[64:67], v[40:55]
    ds_read_b128 v[64:67], v23 offset:0
    ds_read_b64_tr_b16 v[68:69], v24 offset:6144
    ds_read_b64_tr_b16 v[70:71], v24 offset:6656
    s_waitcnt lgkmcnt(3)
    v_mfma_f32_32x32x16_bf16 v[40:55], v[60:63], v[56:59], v[40:55]
    ds_read_b128 v[56:59], v20 offset:16384
    ds_read_b64_tr_b16 v[60:61], v24 offset:8192
    ds_read_b64_tr_b16 v[62:63], v24 offset:8704
    s_waitcnt lgkmcnt(3)
    v_mfma_f32_32x32x16_bf16 v[40:55], v[68:71], v[64:67], v[40:55]
    s_cmp_ge_u32 s31, 15
    s_cbranch_scc1 L_lend_gwo_1_kernel
    s_cmp_ge_u32 s31, 10
    s_cbranch_scc1 L_gwo_1_kernel_tail3
    s_waitcnt vmcnt(9)
    s_barrier
    s_add_u32 s35, s31, 6
    s_add_u32 s35, s35, s42
    s_sub_u32 s34, s35, 16
    s_cmp_ge_u32 s35, 16
    s_cselect_b32 s35, s34, s35
    s_mul_i32 s33, s35, 131072
    s_lshl_b32 s32, s35, 7
    s_add_u32 m0, s40, 0
    s_nop 0
    buffer_load_dwordx4 v2, s[8:11], s32 offen lds
    s_add_u32 m0, s40, 1024
    s_nop 0
    buffer_load_dwordx4 v3, s[8:11], s32 offen lds
    s_add_u32 m0, s41, 0
    s_nop 0
    buffer_load_dwordx4 v10, s[12:15], s33 offen lds
    s_branch L_gwo_1_kernel_join4
L_gwo_1_kernel_tail3:
    s_waitcnt vmcnt(0)
    s_barrier
L_gwo_1_kernel_join4:
    ds_read_b128 v[64:67], v21 offset:16384
    ds_read_b64_tr_b16 v[68:69], v24 offset:10240
    ds_read_b64_tr_b16 v[70:71], v24 offset:10752
    s_waitcnt lgkmcnt(3)
    v_mfma_f32_32x32x16_bf16 v[40:55], v[60:63], v[56:59], v[40:55]
    ds_read_b128 v[56:59], v22 offset:16384
    ds_read_b64_tr_b16 v[60:61], v24 offset:12288
    ds_read_b64_tr_b16 v[62:63], v24 offset:12800
    s_waitcnt lgkmcnt(3)
    v_mfma_f32_32x32x16_bf16 v[40:55], v[68:71], v[64:67], v[40:55]
    ds_read_b128 v[64:67], v23 offset:16384
    ds_read_b64_tr_b16 v[68:69], v24 offset:14336
    ds_read_b64_tr_b16 v[70:71], v24 offset:14848
    s_waitcnt lgkmcnt(3)
    v_mfma_f32_32x32x16_bf16 v[40:55], v[60:63], v[56:59], v[40:55]
    ds_read_b128 v[56:59], v20 offset:32768
    ds_read_b64_tr_b16 v[60:61], v28 offset:0
    ds_read_b64_tr_b16 v[62:63], v28 offset:512
    s_waitcnt lgkmcnt(3)
    v_mfma_f32_32x32x16_bf16 v[40:55], v[68:71], v[64:67], v[40:55]
    s_cmp_ge_u32 s31, 14
    s_cbranch_scc1 L_lend_gwo_1_kernel
    s_cmp_ge_u32 s31, 9
    s_cbranch_scc1 L_gwo_1_kernel_tail5
    s_waitcnt vmcnt(9)
    s_barrier
    s_add_u32 s35, s31, 7
    s_add_u32 s35, s35, s42
    s_sub_u32 s34, s35, 16
    s_cmp_ge_u32 s35, 16
    s_cselect_b32 s35, s34, s35
    s_mul_i32 s33, s35, 131072
    s_lshl_b32 s32, s35, 7
    s_add_u32 m0, s40, 16384
    s_nop 0
    buffer_load_dwordx4 v2, s[8:11], s32 offen lds
    s_add_u32 m0, s40, 17408
    s_nop 0
    buffer_load_dwordx4 v3, s[8:11], s32 offen lds
    s_add_u32 m0, s41, 8192
    s_nop 0
    buffer_load_dwordx4 v10, s[12:15], s33 offen lds
    s_branch L_gwo_1_kernel_join6
L_gwo_1_kernel_tail5:
    s_waitcnt vmcnt(0)
    s_barrier
L_gwo_1_kernel_join6:
    ds_read_b128 v[64:67], v21 offset:32768
    ds_read_b64_tr_b16 v[68:69], v28 offset:2048
    ds_read_b64_tr_b16 v[70:71], v28 offset:2560
    s_waitcnt lgkmcnt(3)
    v_mfma_f32_32x32x16_bf16 v[40:55], v[60:63], v[56:59], v[40:55]
    ds_read_b128 v[56:59], v22 offset:32768
    ds_read_b64_tr_b16 v[60:61], v28 offset:4096
    ds_read_b64_tr_b16 v[62:63], v28 offset:4608
    s_waitcnt lgkmcnt(3)
    v_mfma_f32_32x32x16_bf16 v[40:55], v[68:71], v[64:67], v[40:55]
    ds_read_b128 v[64:67], v23 offset:32768
    ds_read_b64_tr_b16 v[68:69], v28 offset:6144
    ds_read_b64_tr_b16 v[70:71], v28 offset:6656
    s_waitcnt lgkmcnt(3)
    v_mfma_f32_32x32x16_bf16 v[40:55], v[60:63], v[56:59], v[40:55]
    ds_read_b128 v[56:59], v20 offset:49152
    ds_read_b64_tr_b16 v[60:61], v28 offset:8192
    ds_read_b64_tr_b16 v[62:63], v28 offset:8704
    s_waitcnt lgkmcnt(3)
    v_mfma_f32_32x32x16_bf16 v[40:55], v[68:71], v[64:67], v[40:55]
    s_cmp_ge_u32 s31, 13
    s_cbranch_scc1 L_lend_gwo_1_kernel
    s_cmp_ge_u32 s31, 8
    s_cbranch_scc1 L_gwo_1_kernel_tail7
    s_waitcnt vmcnt(9)
    s_barrier
    s_add_u32 s35, s31, 8
    s_add_u32 s35, s35, s42
    s_sub_u32 s34, s35, 16
    s_cmp_ge_u32 s35, 16
    s_cselect_b32 s35, s34, s35
    s_mul_i32 s33, s35, 131072
    s_lshl_b32 s32, s35, 7
    s_add_u32 m0, s40, 32768
    s_nop 0
    buffer_load_dwordx4 v2, s[8:11], s32 offen lds
    s_add_u32 m0, s40, 33792
    s_nop 0
    buffer_load_dwordx4 v3, s[8:11], s32 offen lds
    s_add_u32 m0, s41, 16384
    s_nop 0
    buffer_load_dwordx4 v10, s[12:15], s33 offen lds
    s_branch L_gwo_1_kernel_join8
L_gwo_1_kernel_tail7:
    s_waitcnt vmcnt(0)
    s_barrier
L_gwo_1_kernel_join8:
    ds_read_b128 v[64:67], v21 offset:49152
    ds_read_b64_tr_b16 v[68:69], v28 offset:10240
    ds_read_b64_tr_b16 v[70:71], v28 offset:10752
    s_waitcnt lgkmcnt(3)
    v_mfma_f32_32x32x16_bf16 v[40:55], v[60:63], v[56:59], v[40:55]
    ds_read_b128 v[56:59], v22 offset:49152
    ds_read_b64_tr_b16 v[60:61], v28 offset:12288
    ds_read_b64_tr_b16 v[62:63], v28 offset:12800
    s_waitcnt lgkmcnt(3)
    v_mfma_f32_32x32x16_bf16 v[40:55], v[68:71], v[64:67], v[40:55]
    ds_read_b128 v[64:67], v23 offset:49152
    ds_read_b64_tr_b16 v[68:69], v28 offset:14336
    ds_read_b64_tr_b16 v[70:71], v28 offset:14848
    s_waitcnt lgkmcnt(3)
    v_mfma_f32_32x32x16_bf16 v[40:55], v[60:63], v[56:59], v[40:55]
    ds_read_b128 v[56:59], v36 offset:0
    ds_read_b64_tr_b16 v[60:61], v32 offset:0
    ds_read_b64_tr_b16 v[62:63], v32 offset:512
    s_waitcnt lgkmcnt(3)
    v_mfma_f32_32x32x16_bf16 v[40:55], v[68:71], v[64:67], v[40:55]
    s_cmp_ge_u32 s31, 12
    s_cbranch_scc1 L_lend_gwo_1_kernel
    s_cmp_ge_u32 s31, 7
    s_cbranch_scc1 L_gwo_1_kernel_tail9
    s_waitcnt vmcnt(9)
    s_barrier
    s_add_u32 s35, s31, 9
    s_add_u32 s35, s35, s42
    s_sub_u32 s34, s35, 16
    s_cmp_ge_u32 s35, 16
    s_cselect_b32 s35, s34, s35
    s_mul_i32 s33, s35, 131072
    s_lshl_b32 s32, s35, 7
    s_add_u32 m0, s40, 49152
    s_nop 0
    buffer_load_dwordx4 v2, s[8:11], s32 offen lds
    s_add_u32 m0, s40, 50176
    s_nop 0
    buffer_load_dwordx4 v3, s[8:11], s32 offen lds
    s_add_u32 m0, s41, 24576
    s_nop 0
    buffer_load_dwordx4 v10, s[12:15], s33 offen lds
    s_branch L_gwo_1_kernel_join10
L_gwo_1_kernel_tail9:
    s_waitcnt vmcnt(0)
    s_barrier
L_gwo_1_kernel_join10:
    ds_read_b128 v[64:67], v37 offset:0
    ds_read_b64_tr_b16 v[68:69], v32 offset:2048
    ds_read_b64_tr_b16 v[70:71], v32 offset:2560
    s_waitcnt lgkmcnt(3)
    v_mfma_f32_32x32x16_bf16 v[40:55], v[60:63], v[56:59], v[40:55]
    ds_read_b128 v[56:59], v38 offset:0
    ds_read_b64_tr_b16 v[60:61], v32 offset:4096
    ds_read_b64_tr_b16 v[62:63], v32 offset:4608
    s_waitcnt lgkmcnt(3)
    v_mfma_f32_32x32x16_bf16 v[40:55], v[68:71], v[64:67], v[40:55]
    ds_read_b128 v[64:67], v39 offset:0
    ds_read_b64_tr_b16 v[68:69], v32 offset:6144
    ds_read_b64_tr_b16 v[70:71], v32 offset:6656
    s_waitcnt lgkmcnt(3)
    v_mfma_f32_32x32x16_bf16 v[40:55], v[60:63], v[56:59], v[40:55]
    ds_read_b128 v[56:59], v36 offset:16384
    ds_read_b64_tr_b16 v[60:61], v32 offset:8192
    ds_read_b64_tr_b16 v[62:63], v32 offset:8704
    s_waitcnt lgkmcnt(3)
    v_mfma_f32_32x32x16_bf16 v[40:55], v[68:71], v[64:67], v[40:55]
    s_cmp_ge_u32 s31, 11
    s_cbranch_scc1 L_lend_gwo_1_kernel
    s_cmp_ge_u32 s31, 6
    s_cbranch_scc1 L_gwo_1_kernel_tail11
    s_waitcnt vmcnt(9)
    s_barrier
    s_add_u32 s35, s31, 10
    s_add_u32 s35, s35, s42
    s_sub_u32 s34, s35, 16
    s_cmp_ge_u32 s35, 16
    s_cselect_b32 s35, s34, s35
    s_mul_i32 s33, s35, 131072
    s_lshl_b32 s32, s35, 7
    s_add_u32 m0, s40, 65536
    s_nop 0
    buffer_load_dwordx4 v2, s[8:11], s32 offen lds
    s_add_u32 m0, s40, 66560
    s_nop 0
    buffer_load_dwordx4 v3, s[8:11], s32 offen lds
    s_add_u32 m0, s41, 32768
    s_nop 0
    buffer_load_dwordx4 v10, s[12:15], s33 offen lds
    s_branch L_gwo_1_kernel_join12
L_gwo_1_kernel_tail11:
    s_waitcnt vmcnt(0)
    s_barrier
L_gwo_1_kernel_join12:
    ds_read_b128 v[64:67], v37 offset:16384
    ds_read_b64_tr_b16 v[68:69], v32 offset:10240
    ds_read_b64_tr_b16 v[70:71], v32 offset:10752
    s_waitcnt lgkmcnt(3)
    v_mfma_f32_32x32x16_bf16 v[40:55], v[60:63], v[56:59], v[40:55]
    ds_read_b128 v[56:59], v38 offset:16384
    ds_read_b64_tr_b16 v[60:61], v32 offset:12288
    ds_read_b64_tr_b16 v[62:63], v32 offset:12800
    s_waitcnt lgkmcnt(3)
    v_mfma_f32_32x32x16_bf16 v[40:55], v[68:71], v[64:67], v[40:55]
    ds_read_b128 v[64:67], v39 offset:16384
    ds_read_b64_tr_b16 v[68:69], v32 offset:14336
    ds_read_b64_tr_b16 v[70:71], v32 offset:14848
    s_waitcnt lgkmcnt(3)
    v_mfma_f32_32x32x16_bf16 v[40:55], v[60:63], v[56:59], v[40:55]
    ds_read_b128 v[56:59], v20 offset:0
    ds_read_b64_tr_b16 v[60:61], v24 offset:0
    ds_read_b64_tr_b16 v[62:63], v24 offset:512
    s_waitcnt lgkmcnt(3)
    v_mfma_f32_32x32x16_bf16 v[40:55], v[68:71], v[64:67], v[40:55]
    s_add_u32 s31, s31, 6
    s_cmp_lt_u32 s31, 16
    s_cbranch_scc1 L_loop_gwo_1_kernel
L_lend_gwo_1_kernel:
    s_nop 15
    s_nop 7
    s_lshr_b32 s31, s30, 1
    s_and_b32 s34, s30, 1
    s_mul_i32 s38, s31, 32
    s_mul_i32 s39, s34, 32
    s_lshl_b32 s31, s28, 7
    s_add_u32 s38, s38, s31
    s_mul_i32 s31, s29, 64
    s_add_u32 s39, s39, s31
    s_barrier
    s_mul_i32 s32, s30, 2560
    v_and_b32 v1, 31, v0
    v_mul_u32_u24 v1, 80, v1
    v_lshrrev_b32 v2, 5, v0
    v_lshlrev_b32 v2, 3, v2
    v_add_u32 v1, v1, v2
    v_add_u32 v1, s32, v1
    v_cvt_pk_bf16_f32 v40, v40, v41
    v_cvt_pk_bf16_f32 v41, v42, v43
    ds_write_b64 v1, v[40:41] offset:0
    v_cvt_pk_bf16_f32 v44, v44, v45
    v_cvt_pk_bf16_f32 v45, v46, v47
    ds_write_b64 v1, v[44:45] offset:16
    v_cvt_pk_bf16_f32 v48, v48, v49
    v_cvt_pk_bf16_f32 v49, v50, v51
    ds_write_b64 v1, v[48:49] offset:32
    v_cvt_pk_bf16_f32 v52, v52, v53
    v_cvt_pk_bf16_f32 v53, v54, v55
    ds_write_b64 v1, v[52:53] offset:48
    s_mov_b32 s35, 2048
    s_lshl_b32 s39, s39, 1
    v_add_u32 v2, 0, v0
    v_mul_u32_u24 v3, 16384, v2
    v_lshrrev_b32 v3, 16, v3
    v_mul_u32_u24 v4, 4, v3
    v_sub_u32 v4, v2, v4
    v_lshlrev_b32 v4, 4, v4
    v_mul_u32_u24 v5, 80, v3
    v_add_u32 v5, v5, v4
    v_add_u32 v8, s32, v5
    v_add_u32 v3, s38, v3
    v_mul_lo_u32 v3, v3, s35
    v_add_u32 v3, v3, v4
    v_add_u32 v16, s39, v3
    v_add_u32 v2, 64, v0
    v_mul_u32_u24 v3, 16384, v2
    v_lshrrev_b32 v3, 16, v3
    v_mul_u32_u24 v4, 4, v3
    v_sub_u32 v4, v2, v4
    v_lshlrev_b32 v4, 4, v4
    v_mul_u32_u24 v5, 80, v3
    v_add_u32 v5, v5, v4
    v_add_u32 v9, s32, v5
    v_add_u32 v3, s38, v3
    v_mul_lo_u32 v3, v3, s35
    v_add_u32 v3, v3, v4
    v_add_u32 v17, s39, v3
    s_waitcnt lgkmcnt(0)
    ds_read_b128 v[40:43], v8
    buffer_load_dwordx4 v[48:51], v16, s[20:23], 0 offen
    ds_read_b128 v[44:47], v9
    buffer_load_dwordx4 v[52:55], v17, s[20:23], 0 offen
    s_waitcnt lgkmcnt(0)
    s_waitcnt vmcnt(0)
    v_lshlrev_b32 v72, 16, v40
    v_and_b32 v73, 0xffff0000, v40
    v_lshlrev_b32 v74, 16, v48
    v_and_b32 v75, 0xffff0000, v48
    v_add_f32 v72, v72, v74
    v_add_f32 v73, v73, v75
    v_cvt_pk_bf16_f32 v40, v72, v73
    v_lshlrev_b32 v72, 16, v41
    v_and_b32 v73, 0xffff0000, v41
    v_lshlrev_b32 v74, 16, v49
    v_and_b32 v75, 0xffff0000, v49
    v_add_f32 v72, v72, v74
    v_add_f32 v73, v73, v75
    v_cvt_pk_bf16_f32 v41, v72, v73
    v_lshlrev_b32 v72, 16, v42
    v_and_b32 v73, 0xffff0000, v42
    v_lshlrev_b32 v74, 16, v50
    v_and_b32 v75, 0xffff0000, v50
    v_add_f32 v72, v72, v74
    v_add_f32 v73, v73, v75
    v_cvt_pk_bf16_f32 v42, v72, v73
    v_lshlrev_b32 v72, 16, v43
    v_and_b32 v73, 0xffff0000, v43
    v_lshlrev_b32 v74, 16, v51
    v_and_b32 v75, 0xffff0000, v51
    v_add_f32 v72, v72, v74
    v_add_f32 v73, v73, v75
    v_cvt_pk_bf16_f32 v43, v72, v73
    buffer_store_dwordx4 v[40:43], v16, s[16:19], 0 offen
    v_lshlrev_b32 v72, 16, v44
    v_and_b32 v73, 0xffff0000, v44
    v_lshlrev_b32 v74, 16, v52
    v_and_b32 v75, 0xffff0000, v52
    v_add_f32 v72, v72, v74
    v_add_f32 v73, v73, v75
    v_cvt_pk_bf16_f32 v44, v72, v73
    v_lshlrev_b32 v72, 16, v45
    v_and_b32 v73, 0xffff0000, v45
    v_lshlrev_b32 v74, 16, v53
    v_and_b32 v75, 0xffff0000, v53
    v_add_f32 v72, v72, v74
    v_add_f32 v73, v73, v75
    v_cvt_pk_bf16_f32 v45, v72, v73
    v_lshlrev_b32 v72, 16, v46
    v_and_b32 v73, 0xffff0000, v46
    v_lshlrev_b32 v74, 16, v54
    v_and_b32 v75, 0xffff0000, v54
    v_add_f32 v72, v72, v74
    v_add_f32 v73, v73, v75
    v_cvt_pk_bf16_f32 v46, v72, v73
    v_lshlrev_b32 v72, 16, v47
    v_and_b32 v73, 0xffff0000, v47
    v_lshlrev_b32 v74, 16, v55
    v_and_b32 v75, 0xffff0000, v55
    v_add_f32 v72, v72, v74
    v_add_f32 v73, v73, v75
    v_cvt_pk_bf16_f32 v47, v72, v73
    buffer_store_dwordx4 v[44:47], v17, s[16:19], 0 offen
L_done_gwo_1_kernel:
    s_endpgm
.globl lnb_1_kernel
.p2align 8
.type lnb_1_kernel,@function
lnb_1_kernel:
    s_cmp_ge_u32 s2, 512
    s_cbranch_scc1 L_done_lnb_1_kernel
    s_load_dwordx2 s[40:41], s[0:1], 88
    s_waitcnt lgkmcnt(0)
    s_add_u32 s8, s40, 25165824
    s_addc_u32 s9, s41, 0
    s_mov_b32 s10, 4194304
    s_mov_b32 s11, 0x00020000
    s_add_u32 s12, s40, 29360128
    s_addc_u32 s13, s41, 0
    s_mov_b32 s14, 4194304
    s_mov_b32 s15, 0x00020000
    s_add_u32 s16, s40, 33554432
    s_addc_u32 s17, s41, 0
    s_mov_b32 s18, 4194304
    s_mov_b32 s19, 0x00020000
    s_add_u32 s20, s40, 37748736
    s_addc_u32 s21, s41, 0
    s_mov_b32 s22, 4202496
    s_mov_b32 s23, 0x00020000
    s_lshl_b32 s3, s2, 2
    v_lshrrev_b32 v1, 6, v0
    v_add_u32 v1, s3, v1
    v_lshlrev_b32 v1, 11, v1
    v_and_b32 v2, 63, v0
    v_lshlrev_b32 v2, 4, v2
    v_add_u32 v1, v1, v2
    buffer_load_dwordx4 v[8:11], v1, s[8:11], 0 offen
    buffer_load_dwordx4 v[12:15], v1, s[8:11], 0 offen offset:1024
    s_cmp_lg_u32 s2, 0
    s_cbranch_scc1 L_lnb_1_kernel_nopad1
    v_lshrrev_b32 v3, 6, v0
    v_and_b32 v4, 2, v3
    v_mul_u32_u24 v4, 1024, v4
    v_add_u32 v3, v3, v4
    v_lshlrev_b32 v3, 11, v3
    v_add_u32 v3, v3, v2
    v_mov_b32 v48, 0
    v_mov_b32 v49, 0
    v_mov_b32 v50, 0
    v_mov_b32 v51, 0
    buffer_store_dwordx4 v[48:51], v3, s[20:23], 0 offen
    buffer_store_dwordx4 v[48:51], v3, s[20:23], 0 offen offset:1024
L_lnb_1_kernel_nopad1:
    s_waitcnt vmcnt(0)
    v_lshlrev_b32 v16, 16, v8
    v_and_b32 v17, 0xffff0000, v8
    v_lshlrev_b32 v18, 16, v9
    v_and_b32 v19, 0xffff0000, v9
    v_lshlrev_b32 v20, 16, v10
    v_and_b32 v21, 0xffff0000, v10
    v_lshlrev_b32 v22, 16, v11
    v_and_b32 v23, 0xffff0000, v11
    v_lshlrev_b32 v24, 16, v12
    v_and_b32 v25, 0xffff0000, v12
    v_lshlrev_b32 v26, 16, v13
    v_and_b32 v27, 0xffff0000, v13
    v_lshlrev_b32 v28, 16, v14
    v_and_b32 v29, 0xffff0000, v14
    v_lshlrev_b32 v30, 16, v15
    v_and_b32 v31, 0xffff0000, v15
    v_mov_b32 v4, 0
    v_add_f32 v4, v4, v16
    v_add_f32 v4, v4, v17
    v_add_f32 v4, v4, v18
    v_add_f32 v4, v4, v19
    v_add_f32 v4, v4, v20
    v_add_f32 v4, v4, v21
    v_add_f32 v4, v4, v22
    v_add_f32 v4, v4, v23
    v_add_f32 v4, v4, v24
    v_add_f32 v4, v4, v25
    v_add_f32 v4, v4, v26
    v_add_f32 v4, v4, v27
    v_add_f32 v4, v4, v28
    v_add_f32 v4, v4, v29
    v_add_f32 v4, v4, v30
    v_add_f32 v4, v4, v31
    ds_swizzle_b32 v5, v4 offset:0x041F
    s_waitcnt lgkmcnt(0)
    v_add_f32 v4, v4, v5
    ds_swizzle_b32 v5, v4 offset:0x081F
    s_waitcnt lgkmcnt(0)
    v_add_f32 v4, v4, v5
    ds_swizzle_b32 v5, v4 offset:0x101F
    s_waitcnt lgkmcnt(0)
    v_add_f32 v4, v4, v5
    ds_swizzle_b32 v5, v4 offset:0x201F
    s_waitcnt lgkmcnt(0)
    v_add_f32 v4, v4, v5
    ds_swizzle_b32 v5, v4 offset:0x401F
    s_waitcnt lgkmcnt(0)
    v_add_f32 v4, v4, v5
    s_nop 0
    v_readlane_b32 s30, v4, 32
    v_readlane_b32 s31, v4, 0
    s_nop 1
    v_mov_b32 v4, s30
    v_add_f32 v4, s31, v4
    v_mul_f32 v4, 0x3a800000, v4
    v_mov_b32 v6, 0
    v_sub_f32 v16, v16, v4
    v_fmac_f32 v6, v16, v16
    v_sub_f32 v17, v17, v4
    v_fmac_f32 v6, v17, v17
    v_sub_f32 v18, v18, v4
    v_fmac_f32 v6, v18, v18
    v_sub_f32 v19, v19, v4
    v_fmac_f32 v6, v19, v19
    v_sub_f32 v20, v20, v4
    v_fmac_f32 v6, v20, v20
    v_sub_f32 v21, v21, v4
    v_fmac_f32 v6, v21, v21
    v_sub_f32 v22, v22, v4
    v_fmac_f32 v6, v22, v22
    v_sub_f32 v23, v23, v4
    v_fmac_f32 v6, v23, v23
    v_sub_f32 v24, v24, v4
    v_fmac_f32 v6, v24, v24
    v_sub_f32 v25, v25, v4
    v_fmac_f32 v6, v25, v25
    v_sub_f32 v26, v26, v4
    v_fmac_f32 v6, v26, v26
    v_sub_f32 v27, v27, v4
    v_fmac_f32 v6, v27, v27
    v_sub_f32 v28, v28, v4
    v_fmac_f32 v6, v28, v28
    v_sub_f32 v29, v29, v4
    v_fmac_f32 v6, v29, v29
    v_sub_f32 v30, v30, v4
    v_fmac_f32 v6, v30, v30
    v_sub_f32 v31, v31, v4
    v_fmac_f32 v6, v31, v31
    ds_swizzle_b32 v5, v6 offset:0x041F
    s_waitcnt lgkmcnt(0)
    v_add_f32 v6, v6, v5
    ds_swizzle_b32 v5, v6 offset:0x081F
    s_waitcnt lgkmcnt(0)
    v_add_f32 v6, v6, v5
    ds_swizzle_b32 v5, v6 offset:0x101F
    s_waitcnt lgkmcnt(0)
    v_add_f32 v6, v6, v5
    ds_swizzle_b32 v5, v6 offset:0x201F
    s_waitcnt lgkmcnt(0)
    v_add_f32 v6, v6, v5
    ds_swizzle_b32 v5, v6 offset:0x401F
    s_waitcnt lgkmcnt(0)
    v_add_f32 v6, v6, v5
    s_nop 0
    v_readlane_b32 s30, v6, 32
    v_readlane_b32 s31, v6, 0
    s_nop 1
    v_mov_b32 v6, s30
    v_add_f32 v6, s31, v6
    v_mov_b32 v5, 0x3727c5ac
    v_fmac_f32 v5, 0x3a800000, v6
    v_rsq_f32 v5, v5
    s_nop 0
    v_mul_f32 v16, v16, v5
    v_mul_f32 v17, v17, v5
    v_mul_f32 v18, v18, v5
    v_mul_f32 v19, v19, v5
    v_mul_f32 v20, v20, v5
    v_mul_f32 v21, v21, v5
    v_mul_f32 v22, v22, v5
    v_mul_f32 v23, v23, v5
    v_mul_f32 v24, v24, v5
    v_mul_f32 v25, v25, v5
    v_mul_f32 v26, v26, v5
    v_mul_f32 v27, v27, v5
    v_mul_f32 v28, v28, v5
    v_mul_f32 v29, v29, v5
    v_mul_f32 v30, v30, v5
    v_mul_f32 v31, v31, v5
    v_cvt_pk_bf16_f32 v32, v16, v17
    v_cvt_pk_bf16_f32 v33, v18, v19
    v_cvt_pk_bf16_f32 v34, v20, v21
    v_cvt_pk_bf16_f32 v35, v22, v23
    v_cvt_pk_bf16_f32 v36, v24, v25
    v_cvt_pk_bf16_f32 v37, v26, v27
    v_cvt_pk_bf16_f32 v38, v28, v29
    v_cvt_pk_bf16_f32 v39, v30, v31
    buffer_store_dwordx4 v[32:35], v1, s[12:15], 0 offen
    buffer_store_dwordx4 v[36:39], v1, s[12:15], 0 offen offset:1024
    v_cvt_pk_bf16_f32 v16, v16, v16
    v_lshlrev_b32 v16, 16, v16
    v_cvt_pk_bf16_f32 v17, v17, v17
    v_lshlrev_b32 v17, 16, v17
    v_cvt_pk_bf16_f32 v18, v18, v18
    v_lshlrev_b32 v18, 16, v18
    v_cvt_pk_bf16_f32 v19, v19, v19
    v_lshlrev_b32 v19, 16, v19
    v_cvt_pk_bf16_f32 v20, v20, v20
    v_lshlrev_b32 v20, 16, v20
    v_cvt_pk_bf16_f32 v21, v21, v21
    v_lshlrev_b32 v21, 16, v21
    v_cvt_pk_bf16_f32 v22, v22, v22
    v_lshlrev_b32 v22, 16, v22
    v_cvt_pk_bf16_f32 v23, v23, v23
    v_lshlrev_b32 v23, 16, v23
    v_cvt_pk_bf16_f32 v24, v24, v24
    v_lshlrev_b32 v24, 16, v24
    v_cvt_pk_bf16_f32 v25, v25, v25
    v_lshlrev_b32 v25, 16, v25
    v_cvt_pk_bf16_f32 v26, v26, v26
    v_lshlrev_b32 v26, 16, v26
    v_cvt_pk_bf16_f32 v27, v27, v27
    v_lshlrev_b32 v27, 16, v27
    v_cvt_pk_bf16_f32 v28, v28, v28
    v_lshlrev_b32 v28, 16, v28
    v_cvt_pk_bf16_f32 v29, v29, v29
    v_lshlrev_b32 v29, 16, v29
    v_cvt_pk_bf16_f32 v30, v30, v30
    v_lshlrev_b32 v30, 16, v30
    v_cvt_pk_bf16_f32 v31, v31, v31
    v_lshlrev_b32 v31, 16, v31
    v_mov_b32 v4, 0
    v_add_f32 v4, v4, v16
    v_add_f32 v4, v4, v17
    v_add_f32 v4, v4, v18
    v_add_f32 v4, v4, v19
    v_add_f32 v4, v4, v20
    v_add_f32 v4, v4, v21
    v_add_f32 v4, v4, v22
    v_add_f32 v4, v4, v23
    v_add_f32 v4, v4, v24
    v_add_f32 v4, v4, v25
    v_add_f32 v4, v4, v26
    v_add_f32 v4, v4, v27
    v_add_f32 v4, v4, v28
    v_add_f32 v4, v4, v29
    v_add_f32 v4, v4, v30
    v_add_f32 v4, v4, v31
    ds_swizzle_b32 v5, v4 offset:0x041F
    s_waitcnt lgkmcnt(0)
    v_add_f32 v4, v4, v5
    ds_swizzle_b32 v5, v4 offset:0x081F
    s_waitcnt lgkmcnt(0)
    v_add_f32 v4, v4, v5
    ds_swizzle_b32 v5, v4 offset:0x101F
    s_waitcnt lgkmcnt(0)
    v_add_f32 v4, v4, v5
    ds_swizzle_b32 v5, v4 offset:0x201F
    s_waitcnt lgkmcnt(0)
    v_add_f32 v4, v4, v5
    ds_swizzle_b32 v5, v4 offset:0x401F
    s_waitcnt lgkmcnt(0)
    v_add_f32 v4, v4, v5
    s_nop 0
    v_readlane_b32 s30, v4, 32
    v_readlane_b32 s31, v4, 0
    s_nop 1
    v_mov_b32 v4, s30
    v_add_f32 v4, s31, v4
    v_mul_f32 v4, 0x3a800000, v4
    v_mov_b32 v6, 0
    v_sub_f32 v16, v16, v4
    v_fmac_f32 v6, v16, v16
    v_sub_f32 v17, v17, v4
    v_fmac_f32 v6, v17, v17
    v_sub_f32 v18, v18, v4
    v_fmac_f32 v6, v18, v18
    v_sub_f32 v19, v19, v4
    v_fmac_f32 v6, v19, v19
    v_sub_f32 v20, v20, v4
    v_fmac_f32 v6, v20, v20
    v_sub_f32 v21, v21, v4
    v_fmac_f32 v6, v21, v21
    v_sub_f32 v22, v22, v4
    v_fmac_f32 v6, v22, v22
    v_sub_f32 v23, v23, v4
    v_fmac_f32 v6, v23, v23
    v_sub_f32 v24, v24, v4
    v_fmac_f32 v6, v24, v24
    v_sub_f32 v25, v25, v4
    v_fmac_f32 v6, v25, v25
    v_sub_f32 v26, v26, v4
    v_fmac_f32 v6, v26, v26
    v_sub_f32 v27, v27, v4
    v_fmac_f32 v6, v27, v27
    v_sub_f32 v28, v28, v4
    v_fmac_f32 v6, v28, v28
    v_sub_f32 v29, v29, v4
    v_fmac_f32 v6, v29, v29
    v_sub_f32 v30, v30, v4
    v_fmac_f32 v6, v30, v30
    v_sub_f32 v31, v31, v4
    v_fmac_f32 v6, v31, v31
    ds_swizzle_b32 v5, v6 offset:0x041F
    s_waitcnt lgkmcnt(0)
    v_add_f32 v6, v6, v5
    ds_swizzle_b32 v5, v6 offset:0x081F
    s_waitcnt lgkmcnt(0)
    v_add_f32 v6, v6, v5
    ds_swizzle_b32 v5, v6 offset:0x101F
    s_waitcnt lgkmcnt(0)
    v_add_f32 v6, v6, v5
    ds_swizzle_b32 v5, v6 offset:0x201F
    s_waitcnt lgkmcnt(0)
    v_add_f32 v6, v6, v5
    ds_swizzle_b32 v5, v6 offset:0x401F
    s_waitcnt lgkmcnt(0)
    v_add_f32 v6, v6, v5
    s_nop 0
    v_readlane_b32 s30, v6, 32
    v_readlane_b32 s31, v6, 0
    s_nop 1
    v_mov_b32 v6, s30
    v_add_f32 v6, s31, v6
    v_mov_b32 v5, 0x3727c5ac
    v_fmac_f32 v5, 0x3a800000, v6
    v_rsq_f32 v5, v5
    s_nop 0
    v_mul_f32 v16, v16, v5
    v_mul_f32 v17, v17, v5
    v_mul_f32 v18, v18, v5
    v_mul_f32 v19, v19, v5
    v_mul_f32 v20, v20, v5
    v_mul_f32 v21, v21, v5
    v_mul_f32 v22, v22, v5
    v_mul_f32 v23, v23, v5
    v_mul_f32 v24, v24, v5
    v_mul_f32 v25, v25, v5
    v_mul_f32 v26, v26, v5
    v_mul_f32 v27, v27, v5
    v_mul_f32 v28, v28, v5
    v_mul_f32 v29, v29, v5
    v_mul_f32 v30, v30, v5
    v_mul_f32 v31, v31, v5
    s_nop 1
    v_cvt_pk_bf16_f32 v32, v16, v17
    v_cvt_pk_bf16_f32 v33, v18, v19
    v_cvt_pk_bf16_f32 v34, v20, v21
    v_cvt_pk_bf16_f32 v35, v22, v23
    v_cvt_pk_bf16_f32 v36, v24, v25
    v_cvt_pk_bf16_f32 v37, v26, v27
    v_cvt_pk_bf16_f32 v38, v28, v29
    v_cvt_pk_bf16_f32 v39, v30, v31
    buffer_store_dwordx4 v[32:35], v1, s[16:19], 0 offen
    buffer_store_dwordx4 v[36:39], v1, s[16:19], 0 offen offset:1024
L_done_lnb_1_kernel:
    s_endpgm
.globl gw1_1_kernel
.p2align 8
.type gw1_1_kernel,@function
gw1_1_kernel:
    s_cmp_ge_u32 s2, 256
    s_cbranch_scc1 L_done_gw1_1_kernel
    s_load_dwordx2 s[40:41], s[0:1], 40
    s_load_dwordx2 s[42:43], s[0:1], 88
    s_waitcnt lgkmcnt(0)
    s_add_u32 s8, s42, 33554432
    s_addc_u32 s9, s43, 0
    s_mov_b32 s10, 4194304
    s_mov_b32 s11, 0x00020000
    s_mov_b32 s12, s40
    s_mov_b32 s13, s41
    s_mov_b32 s14, 2097152
    s_mov_b32 s15, 0x00020000
    s_add_u32 s16, s42, 37752832
    s_addc_u32 s17, s43, 0
    s_mov_b32 s18, 4194304
    s_mov_b32 s19, 0x00020000
    s_mov_b32 s36, 0x3d372713
    s_mov_b32 s37, 0xc0135761
    s_and_b32 s3, s2, 7
    s_lshr_b32 s4, s2, 3
    s_mul_i32 s5, s4, 8192
    s_lshr_b32 s5, s5, 16
    s_mul_i32 s6, s5, 8
    s_sub_u32 s6, s4, s6
    s_lshr_b32 s7, s3, 1
    s_mul_i32 s7, s7, 4
    s_add_u32 s28, s7, s5
    s_and_b32 s7, s3, 1
    s_mul_i32 s7, s7, 8
    s_add_u32 s29, s7, s6
    v_lshrrev_b32 v1, 6, v0
    s_nop 0
    v_readfirstlane_b32 s30, v1
    v_and_b32 v0, 63, v0
    v_lshrrev_b32 v1, 3, v0
    s_lshl_b32 s31, s30, 4
    s_lshl_b32 s34, s28, 7
    s_add_u32 s31, s31, s34
    v_add_u32 v1, s31, v1
    v_add_u32 v6, 0, v1
    v_lshrrev_b32 v7, 1, v6
    v_and_b32 v7, 7, v7
    v_and_b32 v8, 7, v0
    v_xor_b32 v7, v7, v8
    v_lshlrev_b32 v7, 4, v7
    s_mov_b32 s35, 2048
    v_mul_lo_u32 v6, v6, s35
    v_add_u32 v2, v6, v7
    v_add_u32 v6, 8, v1
    v_lshrrev_b32 v7, 1, v6
    v_and_b32 v7, 7, v7
    v_and_b32 v8, 7, v0
    v_xor_b32 v7, v7, v8
    v_lshlrev_b32 v7, 4, v7
    s_mov_b32 s35, 2048
    v_mul_lo_u32 v6, v6, s35
    v_add_u32 v3, v6, v7
    s_mul_i32 s31, s30, 64
    s_mul_i32 s34, s29, 128
    v_add_u32 v6, s31, v0
    v_add_u32 v6, 0, v6
    v_mul_u32_u24 v7, 8192, v6
    v_lshrrev_b32 v7, 16, v7
    v_mul_u32_u24 v8, 8, v7
    v_sub_u32 v8, v6, v8
    v_lshlrev_b32 v9, 1, v7
    v_and_b32 v9, 4, v9
    v_xor_b32 v8, v8, v9
    v_lshlrev_b32 v8, 4, v8
    s_mov_b32 s35, 2048
    v_mul_lo_u32 v7, v7, s35
    v_add_u32 v7, v7, v8
    v_add_u32 v10, s34, v7
    s_lshr_b32 s31, s30, 1
    s_and_b32 s34, s30, 1
    s_mul_i32 s38, s31, 32
    s_mul_i32 s39, s34, 32
    v_and_b32 v6, 31, v0
    v_add_u32 v6, s38, v6
    v_lshrrev_b32 v7, 1, v6
    v_and_b32 v7, 7, v7
    v_lshrrev_b32 v8, 5, v0
    v_xor_b32 v7, v7, v8
    v_lshlrev_b32 v7, 4, v7
    v_lshlrev_b32 v6, 7, v6
    v_add_u32 v6, v6, v7
    v_xor_b32 v20, 0, v6
    v_add_u32 v36, 65536, v20
    v_xor_b32 v21, 32, v6
    v_add_u32 v37, 65536, v21
    v_xor_b32 v22, 64, v6
    v_add_u32 v38, 65536, v22
    v_xor_b32 v23, 96, v6
    v_add_u32 v39, 65536, v23
    v_lshrrev_b32 v6, 5, v0
    v_lshlrev_b32 v6, 3, v6
    v_bfe_u32 v7, v0, 2, 2
    v_add_u32 v6, v6, v7
    v_bfe_u32 v8, v0, 4, 1
    v_lshlrev_b32 v8, 4, v8
    v_and_b32 v9, 3, v0
    v_lshlrev_b32 v9, 2, v9
    v_add_u32 v8, v8, v9
    v_add_u32 v8, s39, v8
    v_add_u32 v9, 0, v8
    v_lshlrev_b32 v9, 1, v9
    v_lshlrev_b32 v18, 5, v7
    v_and_b32 v18, 64, v18
    v_xor_b32 v9, v9, v18
    v_mul_u32_u24 v19, 128, v6
    v_add_u32 v24, v19, v9
    v_add_u32 v24, 98304, v24
    v_add_u32 v28, 16384, v24
    v_add_u32 v32, 32768, v24
    v_mov_b32 v40, 0
    v_mov_b32 v41, 0
    v_mov_b32 v42, 0
    v_mov_b32 v43, 0
    v_mov_b32 v44, 0
    v_mov_b32 v45, 0
    v_mov_b32 v46, 0
    v_mov_b32 v47, 0
    v_mov_b32 v48, 0
    v_mov_b32 v49, 0
    v_mov_b32 v50, 0
    v_mov_b32 v51, 0
    v_mov_b32 v52, 0
    v_mov_b32 v53, 0
    v_mov_b32 v54, 0
    v_mov_b32 v55, 0
    s_lshl_b32 s40, s30, 11
    s_mul_i32 s41, s30, 1024
    s_add_u32 s41, s41, 98304
    s_mov_b32 s32, 0
    s_mov_b32 s33, 0
    s_and_b32 s42, s4, 15
    s_mov_b32 s42, 0
    s_mov_b32 s35, 0
    s_add_u32 s35, s35, s42
    s_sub_u32 s34, s35, 16
    s_cmp_ge_u32 s35, 16
    s_cselect_b32 s35, s34, s35
    s_mul_i32 s33, s35, 131072
    s_lshl_b32 s32, s35, 7
    s_add_u32 m0, s40, 0
    s_nop 0
    buffer_load_dwordx4 v2, s[8:11], s32 offen lds
    s_add_u32 m0, s40, 1024
    s_nop 0
    buffer_load_dwordx4 v3, s[8:11], s32 offen lds
    s_add_u32 m0, s41, 0
    s_nop 0
    buffer_load_dwordx4 v10, s[12:15], s33 offen lds
    s_mov_b32 s35, 1
    s_add_u32 s35, s35, s42
    s_sub_u32 s34, s35, 16
    s_cmp_ge_u32 s35, 16
    s_cselect_b32 s35, s34, s35
    s_mul_i32 s33, s35, 131072
    s_lshl_b32 s32, s35, 7
    s_add_u32 m0, s40, 16384
    s_nop 0
    buffer_load_dwordx4 v2, s[8:11], s32 offen lds
    s_add_u32 m0, s40, 17408
    s_nop 0
    buffer_load_dwordx4 v3, s[8:11], s32 offen lds
    s_add_u32 m0, s41, 8192
    s_nop 0
    buffer_load_dwordx4 v10, s[12:15], s33 offen lds
    s_mov_b32 s35, 2
    s_add_u32 s35, s35, s42
    s_sub_u32 s34, s35, 16
    s_cmp_ge_u32 s35, 16
    s_cselect_b32 s35, s34, s35
    s_mul_i32 s33, s35, 131072
    s_lshl_b32 s32, s35, 7
    s_add_u32 m0, s40, 32768
    s_nop 0
    buffer_load_dwordx4 v2, s[8:11], s32 offen lds
    s_add_u32 m0, s40, 33792
    s_nop 0
    buffer_load_dwordx4 v3, s[8:11], s32 offen lds
    s_add_u32 m0, s41, 16384
    s_nop 0
    buffer_load_dwordx4 v10, s[12:15], s33 offen lds
    s_mov_b32 s35, 3
    s_add_u32 s35, s35, s42
    s_sub_u32 s34, s35, 16
    s_cmp_ge_u32 s35, 16
    s_cselect_b32 s35, s34, s35
    s_mul_i32 s33, s35, 131072
    s_lshl_b32 s32, s35, 7
    s_add_u32 m0, s40, 49152
    s_nop 0
    buffer_load_dwordx4 v2, s[8:11], s32 offen lds
    s_add_u32 m0, s40, 50176
    s_nop 0
    buffer_load_dwordx4 v3, s[8:11], s32 offen lds
    s_add_u32 m0, s41, 24576
    s_nop 0
    buffer_load_dwordx4 v10, s[12:15], s33 offen lds
    s_mov_b32 s35, 4
    s_add_u32 s35, s35, s42
    s_sub_u32 s34, s35, 16
    s_cmp_ge_u32 s35, 16
    s_cselect_b32 s35, s34, s35
    s_mul_i32 s33, s35, 131072
    s_lshl_b32 s32, s35, 7
    s_add_u32 m0, s40, 65536
    s_nop 0
    buffer_load_dwordx4 v2, s[8:11], s32 offen lds
    s_add_u32 m0, s40, 66560
    s_nop 0
    buffer_load_dwordx4 v3, s[8:11], s32 offen lds
    s_add_u32 m0, s41, 32768
    s_nop 0
    buffer_load_dwordx4 v10, s[12:15], s33 offen lds
    s_mov_b32 s31, 0
    s_waitcnt vmcnt(12)
    s_barrier
    ds_read_b128 v[56:59], v20 offset:0
    ds_read_b64_tr_b16 v[60:61], v24 offset:0
    ds_read_b64_tr_b16 v[62:63], v24 offset:512
L_loop_gw1_1_kernel:
    s_cmp_ge_u32 s31, 16
    s_cbranch_scc1 L_lend_gw1_1_kernel
    s_cmp_ge_u32 s31, 11
    s_cbranch_scc1 L_gw1_1_kernel_tail1
    s_waitcnt vmcnt(9)
    s_barrier
    s_add_u32 s35, s31, 5
    s_add_u32 s35, s35, s42
    s_sub_u32 s34, s35, 16
    s_cmp_ge_u32 s35, 16
    s_cselect_b32 s35, s34, s35
    s_mul_i32 s33, s35, 131072
    s_lshl_b32 s32, s35, 7
    s_add_u32 m0, s40, 81920
    s_nop 0
    buffer_load_dwordx4 v2, s[8:11], s32 offen lds
    s_add_u32 m0, s40, 82944
    s_nop 0
    buffer_load_dwordx4 v3, s[8:11], s32 offen lds
    s_add_u32 m0, s41, 40960
    s_nop 0
    buffer_load_dwordx4 v10, s[12:15], s33 offen lds
    s_branch L_gw1_1_kernel_join2
L_gw1_1_kernel_tail1:
    s_waitcnt vmcnt(0)
    s_barrier
L_gw1_1_kernel_join2:
    ds_read_b128 v[64:67], v21 offset:0
    ds_read_b64_tr_b16 v[68:69], v24 offset:2048
    ds_read_b64_tr_b16 v[70:71], v24 offset:2560
    s_waitcnt lgkmcnt(3)
    v_mfma_f32_32x32x16_bf16 v[40:55], v[60:63], v[56:59], v[40:55]
    ds_read_b128 v[56:59], v22 offset:0
    ds_read_b64_tr_b16 v[60:61], v24 offset:4096
    ds_read_b64_tr_b16 v[62:63], v24 offset:4608
    s_waitcnt lgkmcnt(3)
    v_mfma_f32_32x32x16_bf16 v[40:55], v[68:71], v[64:67], v[40:55]
    ds_read_b128 v[64:67], v23 offset:0
    ds_read_b64_tr_b16 v[68:69], v24 offset:6144
    ds_read_b64_tr_b16 v[70:71], v24 offset:6656
    s_waitcnt lgkmcnt(3)
    v_mfma_f32_32x32x16_bf16 v[40:55], v[60:63], v[56:59], v[40:55]
    ds_read_b128 v[56:59], v20 offset:16384
    ds_read_b64_tr_b16 v[60:61], v24 offset:8192
    ds_read_b64_tr_b16 v[62:63], v24 offset:8704
    s_waitcnt lgkmcnt(3)
    v_mfma_f32_32x32x16_bf16 v[40:55], v[68:71], v[64:67], v[40:55]
    s_cmp_ge_u32 s31, 15
    s_cbranch_scc1 L_lend_gw1_1_kernel
    s_cmp_ge_u32 s31, 10
    s_cbranch_scc1 L_gw1_1_kernel_tail3
    s_waitcnt vmcnt(9)
    s_barrier
    s_add_u32 s35, s31, 6
    s_add_u32 s35, s35, s42
    s_sub_u32 s34, s35, 16
    s_cmp_ge_u32 s35, 16
    s_cselect_b32 s35, s34, s35
    s_mul_i32 s33, s35, 131072
    s_lshl_b32 s32, s35, 7
    s_add_u32 m0, s40, 0
    s_nop 0
    buffer_load_dwordx4 v2, s[8:11], s32 offen lds
    s_add_u32 m0, s40, 1024
    s_nop 0
    buffer_load_dwordx4 v3, s[8:11], s32 offen lds
    s_add_u32 m0, s41, 0
    s_nop 0
    buffer_load_dwordx4 v10, s[12:15], s33 offen lds
    s_branch L_gw1_1_kernel_join4
L_gw1_1_kernel_tail3:
    s_waitcnt vmcnt(0)
    s_barrier
L_gw1_1_kernel_join4:
    ds_read_b128 v[64:67], v21 offset:16384
    ds_read_b64_tr_b16 v[68:69], v24 offset:10240
    ds_read_b64_tr_b16 v[70:71], v24 offset:10752
    s_waitcnt lgkmcnt(3)
    v_mfma_f32_32x32x16_bf16 v[40:55], v[60:63], v[56:59], v[40:55]
    ds_read_b128 v[56:59], v22 offset:16384
    ds_read_b64_tr_b16 v[60:61], v24 offset:12288
    ds_read_b64_tr_b16 v[62:63], v24 offset:12800
    s_waitcnt lgkmcnt(3)
    v_mfma_f32_32x32x16_bf16 v[40:55], v[68:71], v[64:67], v[40:55]
    ds_read_b128 v[64:67], v23 offset:16384
    ds_read_b64_tr_b16 v[68:69], v24 offset:14336
    ds_read_b64_tr_b16 v[70:71], v24 offset:14848
    s_waitcnt lgkmcnt(3)
    v_mfma_f32_32x32x16_bf16 v[40:55], v[60:63], v[56:59], v[40:55]
    ds_read_b128 v[56:59], v20 offset:32768
    ds_read_b64_tr_b16 v[60:61], v28 offset:0
    ds_read_b64_tr_b16 v[62:63], v28 offset:512
    s_waitcnt lgkmcnt(3)
    v_mfma_f32_32x32x16_bf16 v[40:55], v[68:71], v[64:67], v[40:55]
    s_cmp_ge_u32 s31, 14
    s_cbranch_scc1 L_lend_gw1_1_kernel
    s_cmp_ge_u32 s31, 9
    s_cbranch_scc1 L_gw1_1_kernel_tail5
    s_waitcnt vmcnt(9)
    s_barrier
    s_add_u32 s35, s31, 7
    s_add_u32 s35, s35, s42
    s_sub_u32 s34, s35, 16
    s_cmp_ge_u32 s35, 16
    s_cselect_b32 s35, s34, s35
    s_mul_i32 s33, s35, 131072
    s_lshl_b32 s32, s35, 7
    s_add_u32 m0, s40, 16384
    s_nop 0
    buffer_load_dwordx4 v2, s[8:11], s32 offen lds
    s_add_u32 m0, s40, 17408
    s_nop 0
    buffer_load_dwordx4 v3, s[8:11], s32 offen lds
    s_add_u32 m0, s41, 8192
    s_nop 0
    buffer_load_dwordx4 v10, s[12:15], s33 offen lds
    s_branch L_gw1_1_kernel_join6
L_gw1_1_kernel_tail5:
    s_waitcnt vmcnt(0)
    s_barrier
L_gw1_1_kernel_join6:
    ds_read_b128 v[64:67], v21 offset:32768
    ds_read_b64_tr_b16 v[68:69], v28 offset:2048
    ds_read_b64_tr_b16 v[70:71], v28 offset:2560
    s_waitcnt lgkmcnt(3)
    v_mfma_f32_32x32x16_bf16 v[40:55], v[60:63], v[56:59], v[40:55]
    ds_read_b128 v[56:59], v22 offset:32768
    ds_read_b64_tr_b16 v[60:61], v28 offset:4096
    ds_read_b64_tr_b16 v[62:63], v28 offset:4608
    s_waitcnt lgkmcnt(3)
    v_mfma_f32_32x32x16_bf16 v[40:55], v[68:71], v[64:67], v[40:55]
    ds_read_b128 v[64:67], v23 offset:32768
    ds_read_b64_tr_b16 v[68:69], v28 offset:6144
    ds_read_b64_tr_b16 v[70:71], v28 offset:6656
    s_waitcnt lgkmcnt(3)
    v_mfma_f32_32x32x16_bf16 v[40:55], v[60:63], v[56:59], v[40:55]
    ds_read_b128 v[56:59], v20 offset:49152
    ds_read_b64_tr_b16 v[60:61], v28 offset:8192
    ds_read_b64_tr_b16 v[62:63], v28 offset:8704
    s_waitcnt lgkmcnt(3)
    v_mfma_f32_32x32x16_bf16 v[40:55], v[68:71], v[64:67], v[40:55]
    s_cmp_ge_u32 s31, 13
    s_cbranch_scc1 L_lend_gw1_1_kernel
    s_cmp_ge_u32 s31, 8
    s_cbranch_scc1 L_gw1_1_kernel_tail7
    s_waitcnt vmcnt(9)
    s_barrier
    s_add_u32 s35, s31, 8
    s_add_u32 s35, s35, s42
    s_sub_u32 s34, s35, 16
    s_cmp_ge_u32 s35, 16
    s_cselect_b32 s35, s34, s35
    s_mul_i32 s33, s35, 131072
    s_lshl_b32 s32, s35, 7
    s_add_u32 m0, s40, 32768
    s_nop 0
    buffer_load_dwordx4 v2, s[8:11], s32 offen lds
    s_add_u32 m0, s40, 33792
    s_nop 0
    buffer_load_dwordx4 v3, s[8:11], s32 offen lds
    s_add_u32 m0, s41, 16384
    s_nop 0
    buffer_load_dwordx4 v10, s[12:15], s33 offen lds
    s_branch L_gw1_1_kernel_join8
L_gw1_1_kernel_tail7:
    s_waitcnt vmcnt(0)
    s_barrier
L_gw1_1_kernel_join8:
    ds_read_b128 v[64:67], v21 offset:49152
    ds_read_b64_tr_b16 v[68:69], v28 offset:10240
    ds_read_b64_tr_b16 v[70:71], v28 offset:10752
    s_waitcnt lgkmcnt(3)
    v_mfma_f32_32x32x16_bf16 v[40:55], v[60:63], v[56:59], v[40:55]
    ds_read_b128 v[56:59], v22 offset:49152
    ds_read_b64_tr_b16 v[60:61], v28 offset:12288
    ds_read_b64_tr_b16 v[62:63], v28 offset:12800
    s_waitcnt lgkmcnt(3)
    v_mfma_f32_32x32x16_bf16 v[40:55], v[68:71], v[64:67], v[40:55]
    ds_read_b128 v[64:67], v23 offset:49152
    ds_read_b64_tr_b16 v[68:69], v28 offset:14336
    ds_read_b64_tr_b16 v[70:71], v28 offset:14848
    s_waitcnt lgkmcnt(3)
    v_mfma_f32_32x32x16_bf16 v[40:55], v[60:63], v[56:59], v[40:55]
    ds_read_b128 v[56:59], v36 offset:0
    ds_read_b64_tr_b16 v[60:61], v32 offset:0
    ds_read_b64_tr_b16 v[62:63], v32 offset:512
    s_waitcnt lgkmcnt(3)
    v_mfma_f32_32x32x16_bf16 v[40:55], v[68:71], v[64:67], v[40:55]
    s_cmp_ge_u32 s31, 12
    s_cbranch_scc1 L_lend_gw1_1_kernel
    s_cmp_ge_u32 s31, 7
    s_cbranch_scc1 L_gw1_1_kernel_tail9
    s_waitcnt vmcnt(9)
    s_barrier
    s_add_u32 s35, s31, 9
    s_add_u32 s35, s35, s42
    s_sub_u32 s34, s35, 16
    s_cmp_ge_u32 s35, 16
    s_cselect_b32 s35, s34, s35
    s_mul_i32 s33, s35, 131072
    s_lshl_b32 s32, s35, 7
    s_add_u32 m0, s40, 49152
    s_nop 0
    buffer_load_dwordx4 v2, s[8:11], s32 offen lds
    s_add_u32 m0, s40, 50176
    s_nop 0
    buffer_load_dwordx4 v3, s[8:11], s32 offen lds
    s_add_u32 m0, s41, 24576
    s_nop 0
    buffer_load_dwordx4 v10, s[12:15], s33 offen lds
    s_branch L_gw1_1_kernel_join10
L_gw1_1_kernel_tail9:
    s_waitcnt vmcnt(0)
    s_barrier
L_gw1_1_kernel_join10:
    ds_read_b128 v[64:67], v37 offset:0
    ds_read_b64_tr_b16 v[68:69], v32 offset:2048
    ds_read_b64_tr_b16 v[70:71], v32 offset:2560
    s_waitcnt lgkmcnt(3)
    v_mfma_f32_32x32x16_bf16 v[40:55], v[60:63], v[56:59], v[40:55]
    ds_read_b128 v[56:59], v38 offset:0
    ds_read_b64_tr_b16 v[60:61], v32 offset:4096
    ds_read_b64_tr_b16 v[62:63], v32 offset:4608
    s_waitcnt lgkmcnt(3)
    v_mfma_f32_32x32x16_bf16 v[40:55], v[68:71], v[64:67], v[40:55]
    ds_read_b128 v[64:67], v39 offset:0
    ds_read_b64_tr_b16 v[68:69], v32 offset:6144
    ds_read_b64_tr_b16 v[70:71], v32 offset:6656
    s_waitcnt lgkmcnt(3)
    v_mfma_f32_32x32x16_bf16 v[40:55], v[60:63], v[56:59], v[40:55]
    ds_read_b128 v[56:59], v36 offset:16384
    ds_read_b64_tr_b16 v[60:61], v32 offset:8192
    ds_read_b64_tr_b16 v[62:63], v32 offset:8704
    s_waitcnt lgkmcnt(3)
    v_mfma_f32_32x32x16_bf16 v[40:55], v[68:71], v[64:67], v[40:55]
    s_cmp_ge_u32 s31, 11
    s_cbranch_scc1 L_lend_gw1_1_kernel
    s_cmp_ge_u32 s31, 6
    s_cbranch_scc1 L_gw1_1_kernel_tail11
    s_waitcnt vmcnt(9)
    s_barrier
    s_add_u32 s35, s31, 10
    s_add_u32 s35, s35, s42
    s_sub_u32 s34, s35, 16
    s_cmp_ge_u32 s35, 16
    s_cselect_b32 s35, s34, s35
    s_mul_i32 s33, s35, 131072
    s_lshl_b32 s32, s35, 7
    s_add_u32 m0, s40, 65536
    s_nop 0
    buffer_load_dwordx4 v2, s[8:11], s32 offen lds
    s_add_u32 m0, s40, 66560
    s_nop 0
    buffer_load_dwordx4 v3, s[8:11], s32 offen lds
    s_add_u32 m0, s41, 32768
    s_nop 0
    buffer_load_dwordx4 v10, s[12:15], s33 offen lds
    s_branch L_gw1_1_kernel_join12
L_gw1_1_kernel_tail11:
    s_waitcnt vmcnt(0)
    s_barrier
L_gw1_1_kernel_join12:
    ds_read_b128 v[64:67], v37 offset:16384
    ds_read_b64_tr_b16 v[68:69], v32 offset:10240
    ds_read_b64_tr_b16 v[70:71], v32 offset:10752
    s_waitcnt lgkmcnt(3)
    v_mfma_f32_32x32x16_bf16 v[40:55], v[60:63], v[56:59], v[40:55]
    ds_read_b128 v[56:59], v38 offset:16384
    ds_read_b64_tr_b16 v[60:61], v32 offset:12288
    ds_read_b64_tr_b16 v[62:63], v32 offset:12800
    s_waitcnt lgkmcnt(3)
    v_mfma_f32_32x32x16_bf16 v[40:55], v[68:71], v[64:67], v[40:55]
    ds_read_b128 v[64:67], v39 offset:16384
    ds_read_b64_tr_b16 v[68:69], v32 offset:14336
    ds_read_b64_tr_b16 v[70:71], v32 offset:14848
    s_waitcnt lgkmcnt(3)
    v_mfma_f32_32x32x16_bf16 v[40:55], v[60:63], v[56:59], v[40:55]
    ds_read_b128 v[56:59], v20 offset:0
    ds_read_b64_tr_b16 v[60:61], v24 offset:0
    ds_read_b64_tr_b16 v[62:63], v24 offset:512
    s_waitcnt lgkmcnt(3)
    v_mfma_f32_32x32x16_bf16 v[40:55], v[68:71], v[64:67], v[40:55]
    s_add_u32 s31, s31, 6
    s_cmp_lt_u32 s31, 16
    s_cbranch_scc1 L_loop_gw1_1_kernel
L_lend_gw1_1_kernel:
    s_nop 15
    s_nop 7
    s_lshr_b32 s31, s30, 1
    s_and_b32 s34, s30, 1
    s_mul_i32 s38, s31, 32
    s_mul_i32 s39, s34, 32
    s_lshl_b32 s31, s28, 7
    s_add_u32 s38, s38, s31
    s_mul_i32 s31, s29, 64
    s_add_u32 s39, s39, s31
    s_barrier
    s_mul_i32 s32, s30, 2560
    v_and_b32 v1, 31, v0
    v_mul_u32_u24 v1, 80, v1
    v_lshrrev_b32 v2, 5, v0
    v_lshlrev_b32 v2, 3, v2
    v_add_u32 v1, v1, v2
    v_add_u32 v1, s32, v1
    v_cvt_pk_bf16_f32 v40, v40, v40
    v_lshlrev_b32 v40, 16, v40
    v_cvt_pk_bf16_f32 v41, v41, v41
    v_lshlrev_b32 v41, 16, v41
    v_cvt_pk_bf16_f32 v42, v42, v42
    v_lshlrev_b32 v42, 16, v42
    v_cvt_pk_bf16_f32 v43, v43, v43
    v_lshlrev_b32 v43, 16, v43
    v_mul_f32 v76, v40, v40
    v_fma_f32 v76, v76, s36, 1.0
    v_mul_f32 v76, v76, v40
    v_mul_f32 v76, s37, v76
    v_exp_f32 v76, v76
    s_nop 0
    v_add_f32 v76, 1.0, v76
    v_rcp_f32 v76, v76
    s_nop 0
    v_mul_f32 v40, v40, v76
    v_mul_f32 v76, v41, v41
    v_fma_f32 v76, v76, s36, 1.0
    v_mul_f32 v76, v76, v41
    v_mul_f32 v76, s37, v76
    v_exp_f32 v76, v76
    s_nop 0
    v_add_f32 v76, 1.0, v76
    v_rcp_f32 v76, v76
    s_nop 0
    v_mul_f32 v41, v41, v76
    v_mul_f32 v76, v42, v42
    v_fma_f32 v76, v76, s36, 1.0
    v_mul_f32 v76, v76, v42
    v_mul_f32 v76, s37, v76
    v_exp_f32 v76, v76
    s_nop 0
    v_add_f32 v76, 1.0, v76
    v_rcp_f32 v76, v76
    s_nop 0
    v_mul_f32 v42, v42, v76
    v_mul_f32 v76, v43, v43
    v_fma_f32 v76, v76, s36, 1.0
    v_mul_f32 v76, v76, v43
    v_mul_f32 v76, s37, v76
    v_exp_f32 v76, v76
    s_nop 0
    v_add_f32 v76, 1.0, v76
    v_rcp_f32 v76, v76
    s_nop 0
    v_mul_f32 v43, v43, v76
    v_cvt_pk_bf16_f32 v40, v40, v41
    v_cvt_pk_bf16_f32 v41, v42, v43
    ds_write_b64 v1, v[40:41] offset:0
    v_cvt_pk_bf16_f32 v44, v44, v44
    v_lshlrev_b32 v44, 16, v44
    v_cvt_pk_bf16_f32 v45, v45, v45
    v_lshlrev_b32 v45, 16, v45
    v_cvt_pk_bf16_f32 v46, v46, v46
    v_lshlrev_b32 v46, 16, v46
    v_cvt_pk_bf16_f32 v47, v47, v47
    v_lshlrev_b32 v47, 16, v47
    v_mul_f32 v76, v44, v44
    v_fma_f32 v76, v76, s36, 1.0
    v_mul_f32 v76, v76, v44
    v_mul_f32 v76, s37, v76
    v_exp_f32 v76, v76
    s_nop 0
    v_add_f32 v76, 1.0, v76
    v_rcp_f32 v76, v76
    s_nop 0
    v_mul_f32 v44, v44, v76
    v_mul_f32 v76, v45, v45
    v_fma_f32 v76, v76, s36, 1.0
    v_mul_f32 v76, v76, v45
    v_mul_f32 v76, s37, v76
    v_exp_f32 v76, v76
    s_nop 0
    v_add_f32 v76, 1.0, v76
    v_rcp_f32 v76, v76
    s_nop 0
    v_mul_f32 v45, v45, v76
    v_mul_f32 v76, v46, v46
    v_fma_f32 v76, v76, s36, 1.0
    v_mul_f32 v76, v76, v46
    v_mul_f32 v76, s37, v76
    v_exp_f32 v76, v76
    s_nop 0
    v_add_f32 v76, 1.0, v76
    v_rcp_f32 v76, v76
    s_nop 0
    v_mul_f32 v46, v46, v76
    v_mul_f32 v76, v47, v47
    v_fma_f32 v76, v76, s36, 1.0
    v_mul_f32 v76, v76, v47
    v_mul_f32 v76, s37, v76
    v_exp_f32 v76, v76
    s_nop 0
    v_add_f32 v76, 1.0, v76
    v_rcp_f32 v76, v76
    s_nop 0
    v_mul_f32 v47, v47, v76
    v_cvt_pk_bf16_f32 v44, v44, v45
    v_cvt_pk_bf16_f32 v45, v46, v47
    ds_write_b64 v1, v[44:45] offset:16
    v_cvt_pk_bf16_f32 v48, v48, v48
    v_lshlrev_b32 v48, 16, v48
    v_cvt_pk_bf16_f32 v49, v49, v49
    v_lshlrev_b32 v49, 16, v49
    v_cvt_pk_bf16_f32 v50, v50, v50
    v_lshlrev_b32 v50, 16, v50
    v_cvt_pk_bf16_f32 v51, v51, v51
    v_lshlrev_b32 v51, 16, v51
    v_mul_f32 v76, v48, v48
    v_fma_f32 v76, v76, s36, 1.0
    v_mul_f32 v76, v76, v48
    v_mul_f32 v76, s37, v76
    v_exp_f32 v76, v76
    s_nop 0
    v_add_f32 v76, 1.0, v76
    v_rcp_f32 v76, v76
    s_nop 0
    v_mul_f32 v48, v48, v76
    v_mul_f32 v76, v49, v49
    v_fma_f32 v76, v76, s36, 1.0
    v_mul_f32 v76, v76, v49
    v_mul_f32 v76, s37, v76
    v_exp_f32 v76, v76
    s_nop 0
    v_add_f32 v76, 1.0, v76
    v_rcp_f32 v76, v76
    s_nop 0
    v_mul_f32 v49, v49, v76
    v_mul_f32 v76, v50, v50
    v_fma_f32 v76, v76, s36, 1.0
    v_mul_f32 v76, v76, v50
    v_mul_f32 v76, s37, v76
    v_exp_f32 v76, v76
    s_nop 0
    v_add_f32 v76, 1.0, v76
    v_rcp_f32 v76, v76
    s_nop 0
    v_mul_f32 v50, v50, v76
    v_mul_f32 v76, v51, v51
    v_fma_f32 v76, v76, s36, 1.0
    v_mul_f32 v76, v76, v51
    v_mul_f32 v76, s37, v76
    v_exp_f32 v76, v76
    s_nop 0
    v_add_f32 v76, 1.0, v76
    v_rcp_f32 v76, v76
    s_nop 0
    v_mul_f32 v51, v51, v76
    v_cvt_pk_bf16_f32 v48, v48, v49
    v_cvt_pk_bf16_f32 v49, v50, v51
    ds_write_b64 v1, v[48:49] offset:32
    v_cvt_pk_bf16_f32 v52, v52, v52
    v_lshlrev_b32 v52, 16, v52
    v_cvt_pk_bf16_f32 v53, v53, v53
    v_lshlrev_b32 v53, 16, v53
    v_cvt_pk_bf16_f32 v54, v54, v54
    v_lshlrev_b32 v54, 16, v54
    v_cvt_pk_bf16_f32 v55, v55, v55
    v_lshlrev_b32 v55, 16, v55
    v_mul_f32 v76, v52, v52
    v_fma_f32 v76, v76, s36, 1.0
    v_mul_f32 v76, v76, v52
    v_mul_f32 v76, s37, v76
    v_exp_f32 v76, v76
    s_nop 0
    v_add_f32 v76, 1.0, v76
    v_rcp_f32 v76, v76
    s_nop 0
    v_mul_f32 v52, v52, v76
    v_mul_f32 v76, v53, v53
    v_fma_f32 v76, v76, s36, 1.0
    v_mul_f32 v76, v76, v53
    v_mul_f32 v76, s37, v76
    v_exp_f32 v76, v76
    s_nop 0
    v_add_f32 v76, 1.0, v76
    v_rcp_f32 v76, v76
    s_nop 0
    v_mul_f32 v53, v53, v76
    v_mul_f32 v76, v54, v54
    v_fma_f32 v76, v76, s36, 1.0
    v_mul_f32 v76, v76, v54
    v_mul_f32 v76, s37, v76
    v_exp_f32 v76, v76
    s_nop 0
    v_add_f32 v76, 1.0, v76
    v_rcp_f32 v76, v76
    s_nop 0
    v_mul_f32 v54, v54, v76
    v_mul_f32 v76, v55, v55
    v_fma_f32 v76, v76, s36, 1.0
    v_mul_f32 v76, v76, v55
    v_mul_f32 v76, s37, v76
    v_exp_f32 v76, v76
    s_nop 0
    v_add_f32 v76, 1.0, v76
    v_rcp_f32 v76, v76
    s_nop 0
    v_mul_f32 v55, v55, v76
    v_cvt_pk_bf16_f32 v52, v52, v53
    v_cvt_pk_bf16_f32 v53, v54, v55
    ds_write_b64 v1, v[52:53] offset:48
    s_mov_b32 s35, 2048
    s_lshl_b32 s39, s39, 1
    v_add_u32 v2, 0, v0
    v_mul_u32_u24 v3, 16384, v2
    v_lshrrev_b32 v3, 16, v3
    v_mul_u32_u24 v4, 4, v3
    v_sub_u32 v4, v2, v4
    v_lshlrev_b32 v4, 4, v4
    v_mul_u32_u24 v5, 80, v3
    v_add_u32 v5, v5, v4
    v_add_u32 v8, s32, v5
    v_add_u32 v3, s38, v3
    v_mul_lo_u32 v3, v3, s35
    v_add_u32 v3, v3, v4
    v_add_u32 v16, s39, v3
    v_add_u32 v2, 64, v0
    v_mul_u32_u24 v3, 16384, v2
    v_lshrrev_b32 v3, 16, v3
    v_mul_u32_u24 v4, 4, v3
    v_sub_u32 v4, v2, v4
    v_lshlrev_b32 v4, 4, v4
    v_mul_u32_u24 v5, 80, v3
    v_add_u32 v5, v5, v4
    v_add_u32 v9, s32, v5
    v_add_u32 v3, s38, v3
    v_mul_lo_u32 v3, v3, s35
    v_add_u32 v3, v3, v4
    v_add_u32 v17, s39, v3
    s_waitcnt lgkmcnt(0)
    ds_read_b128 v[40:43], v8
    ds_read_b128 v[44:47], v9
    s_waitcnt lgkmcnt(0)
    buffer_store_dwordx4 v[40:43], v16, s[16:19], 0 offen
    buffer_store_dwordx4 v[44:47], v17, s[16:19], 0 offen
L_done_gw1_1_kernel:
    s_endpgm
.globl gw2_1_kernel
.p2align 8
.type gw2_1_kernel,@function
gw2_1_kernel:
    s_cmp_ge_u32 s2, 256
    s_cbranch_scc1 L_done_gw2_1_kernel
    s_load_dwordx2 s[40:41], s[0:1], 48
    s_load_dwordx2 s[42:43], s[0:1], 88
    s_waitcnt lgkmcnt(0)
    s_add_u32 s8, s42, 37748736
    s_addc_u32 s9, s43, 0
    s_mov_b32 s10, 4202496
    s_mov_b32 s11, 0x00020000
    s_mov_b32 s12, s40
    s_mov_b32 s13, s41
    s_mov_b32 s14, 2097152
    s_mov_b32 s15, 0x00020000
    s_add_u32 s16, s42, 44040192
    s_addc_u32 s17, s43, 0
    s_mov_b32 s18, 4194304
    s_mov_b32 s19, 0x00020000
    s_add_u32 s20, s42, 29360128
    s_addc_u32 s21, s43, 0
    s_mov_b32 s22, 4194304
    s_mov_b32 s23, 0x00020000
    s_mov_b32 s36, 0x3d372713
    s_mov_b32 s37, 0xc0135761
    s_and_b32 s3, s2, 7
    s_lshr_b32 s4, s2, 3
    s_mul_i32 s5, s4, 8192
    s_lshr_b32 s5, s5, 16
    s_mul_i32 s6, s5, 8
    s_sub_u32 s6, s4, s6
    s_lshr_b32 s7, s3, 1
    s_mul_i32 s7, s7, 4
    s_add_u32 s28, s7, s5
    s_and_b32 s7, s3, 1
    s_mul_i32 s7, s7, 8
    s_add_u32 s29, s7, s6
    v_lshrrev_b32 v1, 6, v0
    s_nop 0
    v_readfirstlane_b32 s30, v1
    v_and_b32 v0, 63, v0
    v_lshrrev_b32 v1, 3, v0
    s_lshl_b32 s31, s30, 4
    s_lshl_b32 s34, s28, 7
    s_add_u32 s31, s31, s34
    v_add_u32 v1, s31, v1
    v_add_u32 v6, 0, v1
    v_lshrrev_b32 v7, 1, v6
    v_and_b32 v7, 7, v7
    v_and_b32 v8, 7, v0
    v_xor_b32 v7, v7, v8
    v_lshlrev_b32 v7, 4, v7
    s_mov_b32 s35, 2048
    v_mul_lo_u32 v6, v6, s35
    v_add_u32 v2, v6, v7
    v_add_u32 v6, 8, v1
    v_lshrrev_b32 v7, 1, v6
    v_and_b32 v7, 7, v7
    v_and_b32 v8, 7, v0
    v_xor_b32 v7, v7, v8
    v_lshlrev_b32 v7, 4, v7
    s_mov_b32 s35, 2048
    v_mul_lo_u32 v6, v6, s35
    v_add_u32 v3, v6, v7
    s_mul_i32 s31, s30, 64
    s_mul_i32 s34, s29, 128
    v_add_u32 v6, s31, v0
    v_add_u32 v6, 0, v6
    v_mul_u32_u24 v7, 8192, v6
    v_lshrrev_b32 v7, 16, v7
    v_mul_u32_u24 v8, 8, v7
    v_sub_u32 v8, v6, v8
    v_lshlrev_b32 v9, 1, v7
    v_and_b32 v9, 4, v9
    v_xor_b32 v8, v8, v9
    v_lshlrev_b32 v8, 4, v8
    s_mov_b32 s35, 2048
    v_mul_lo_u32 v7, v7, s35
    v_add_u32 v7, v7, v8
    v_add_u32 v10, s34, v7
    s_lshr_b32 s31, s30, 1
    s_and_b32 s34, s30, 1
    s_mul_i32 s38, s31, 32
    s_mul_i32 s39, s34, 32
    v_and_b32 v6, 31, v0
    v_add_u32 v6, s38, v6
    v_lshrrev_b32 v7, 1, v6
    v_and_b32 v7, 7, v7
    v_lshrrev_b32 v8, 5, v0
    v_xor_b32 v7, v7, v8
    v_lshlrev_b32 v7, 4, v7
    v_lshlrev_b32 v6, 7, v6
    v_add_u32 v6, v6, v7
    v_xor_b32 v20, 0, v6
    v_add_u32 v36, 65536, v20
    v_xor_b32 v21, 32, v6
    v_add_u32 v37, 65536, v21
    v_xor_b32 v22, 64, v6
    v_add_u32 v38, 65536, v22
    v_xor_b32 v23, 96, v6
    v_add_u32 v39, 65536, v23
    v_lshrrev_b32 v6, 5, v0
    v_lshlrev_b32 v6, 3, v6
    v_bfe_u32 v7, v0, 2, 2
    v_add_u32 v6, v6, v7
    v_bfe_u32 v8, v0, 4, 1
    v_lshlrev_b32 v8, 4, v8
    v_and_b32 v9, 3, v0
    v_lshlrev_b32 v9, 2, v9
    v_add_u32 v8, v8, v9
    v_add_u32 v8, s39, v8
    v_add_u32 v9, 0, v8
    v_lshlrev_b32 v9, 1, v9
    v_lshlrev_b32 v18, 5, v7
    v_and_b32 v18, 64, v18
    v_xor_b32 v9, v9, v18
    v_mul_u32_u24 v19, 128, v6
    v_add_u32 v24, v19, v9
    v_add_u32 v24, 98304, v24
    v_add_u32 v28, 16384, v24
    v_add_u32 v32, 32768, v24
    v_mov_b32 v40, 0
    v_mov_b32 v41, 0
    v_mov_b32 v42, 0
    v_mov_b32 v43, 0
    v_mov_b32 v44, 0
    v_mov_b32 v45, 0
    v_mov_b32 v46, 0
    v_mov_b32 v47, 0
    v_mov_b32 v48, 0
    v_mov_b32 v49, 0
    v_mov_b32 v50, 0
    v_mov_b32 v51, 0
    v_mov_b32 v52, 0
    v_mov_b32 v53, 0
    v_mov_b32 v54, 0
    v_mov_b32 v55, 0
    s_lshl_b32 s40, s30, 11
    s_mul_i32 s41, s30, 1024
    s_add_u32 s41, s41, 98304
    s_mov_b32 s32, 0
    s_mov_b32 s33, 0
    s_and_b32 s42, s4, 15
    s_mov_b32 s42, 0
    s_mov_b32 s35, 0
    s_add_u32 s35, s35, s42
    s_sub_u32 s34, s35, 16
    s_cmp_ge_u32 s35, 16
    s_cselect_b32 s35, s34, s35
    s_mul_i32 s33, s35, 131072
    s_lshl_b32 s32, s35, 7
    s_lshr_b32 s34, s35, 2
    s_mov_b32 s39, 0x04000301
    s_lshl_b32 s34, s34, 3
    s_lshr_b32 s39, s39, s34
    s_and_b32 s39, s39, 0xff
    s_mul_i32 s39, s39, 2048
    s_add_u32 s32, s32, s39
    s_add_u32 m0, s40, 0
    s_nop 0
    buffer_load_dwordx4 v2, s[8:11], s32 offen lds
    s_add_u32 m0, s40, 1024
    s_nop 0
    buffer_load_dwordx4 v3, s[8:11], s32 offen lds
    s_add_u32 m0, s41, 0
    s_nop 0
    buffer_load_dwordx4 v10, s[12:15], s33 offen lds
    s_mov_b32 s35, 1
    s_add_u32 s35, s35, s42
    s_sub_u32 s34, s35, 16
    s_cmp_ge_u32 s35, 16
    s_cselect_b32 s35, s34, s35
    s_mul_i32 s33, s35, 131072
    s_lshl_b32 s32, s35, 7
    s_lshr_b32 s34, s35, 2
    s_mov_b32 s39, 0x04000301
    s_lshl_b32 s34, s34, 3
    s_lshr_b32 s39, s39, s34
    s_and_b32 s39, s39, 0xff
    s_mul_i32 s39, s39, 2048
    s_add_u32 s32, s32, s39
    s_add_u32 m0, s40, 16384
    s_nop 0
    buffer_load_dwordx4 v2, s[8:11], s32 offen lds
    s_add_u32 m0, s40, 17408
    s_nop 0
    buffer_load_dwordx4 v3, s[8:11], s32 offen lds
    s_add_u32 m0, s41, 8192
    s_nop 0
    buffer_load_dwordx4 v10, s[12:15], s33 offen lds
    s_mov_b32 s35, 2
    s_add_u32 s35, s35, s42
    s_sub_u32 s34, s35, 16
    s_cmp_ge_u32 s35, 16
    s_cselect_b32 s35, s34, s35
    s_mul_i32 s33, s35, 131072
    s_lshl_b32 s32, s35, 7
    s_lshr_b32 s34, s35, 2
    s_mov_b32 s39, 0x04000301
    s_lshl_b32 s34, s34, 3
    s_lshr_b32 s39, s39, s34
    s_and_b32 s39, s39, 0xff
    s_mul_i32 s39, s39, 2048
    s_add_u32 s32, s32, s39
    s_add_u32 m0, s40, 32768
    s_nop 0
    buffer_load_dwordx4 v2, s[8:11], s32 offen lds
    s_add_u32 m0, s40, 33792
    s_nop 0
    buffer_load_dwordx4 v3, s[8:11], s32 offen lds
    s_add_u32 m0, s41, 16384
    s_nop 0
    buffer_load_dwordx4 v10, s[12:15], s33 offen lds
    s_mov_b32 s35, 3
    s_add_u32 s35, s35, s42
    s_sub_u32 s34, s35, 16
    s_cmp_ge_u32 s35, 16
    s_cselect_b32 s35, s34, s35
    s_mul_i32 s33, s35, 131072
    s_lshl_b32 s32, s35, 7
    s_lshr_b32 s34, s35, 2
    s_mov_b32 s39, 0x04000301
    s_lshl_b32 s34, s34, 3
    s_lshr_b32 s39, s39, s34
    s_and_b32 s39, s39, 0xff
    s_mul_i32 s39, s39, 2048
    s_add_u32 s32, s32, s39
    s_add_u32 m0, s40, 49152
    s_nop 0
    buffer_load_dwordx4 v2, s[8:11], s32 offen lds
    s_add_u32 m0, s40, 50176
    s_nop 0
    buffer_load_dwordx4 v3, s[8:11], s32 offen lds
    s_add_u32 m0, s41, 24576
    s_nop 0
    buffer_load_dwordx4 v10, s[12:15], s33 offen lds
    s_mov_b32 s35, 4
    s_add_u32 s35, s35, s42
    s_sub_u32 s34, s35, 16
    s_cmp_ge_u32 s35, 16
    s_cselect_b32 s35, s34, s35
    s_mul_i32 s33, s35, 131072
    s_lshl_b32 s32, s35, 7
    s_lshr_b32 s34, s35, 2
    s_mov_b32 s39, 0x04000301
    s_lshl_b32 s34, s34, 3
    s_lshr_b32 s39, s39, s34
    s_and_b32 s39, s39, 0xff
    s_mul_i32 s39, s39, 2048
    s_add_u32 s32, s32, s39
    s_add_u32 m0, s40, 65536
    s_nop 0
    buffer_load_dwordx4 v2, s[8:11], s32 offen lds
    s_add_u32 m0, s40, 66560
    s_nop 0
    buffer_load_dwordx4 v3, s[8:11], s32 offen lds
    s_add_u32 m0, s41, 32768
    s_nop 0
    buffer_load_dwordx4 v10, s[12:15], s33 offen lds
    s_mov_b32 s31, 0
    s_waitcnt vmcnt(12)
    s_barrier
    ds_read_b128 v[56:59], v20 offset:0
    ds_read_b64_tr_b16 v[60:61], v24 offset:0
    ds_read_b64_tr_b16 v[62:63], v24 offset:512
L_loop_gw2_1_kernel:
    s_cmp_ge_u32 s31, 16
    s_cbranch_scc1 L_lend_gw2_1_kernel
    s_cmp_ge_u32 s31, 11
    s_cbranch_scc1 L_gw2_1_kernel_tail1
    s_waitcnt vmcnt(9)
    s_barrier
    s_add_u32 s35, s31, 5
    s_add_u32 s35, s35, s42
    s_sub_u32 s34, s35, 16
    s_cmp_ge_u32 s35, 16
    s_cselect_b32 s35, s34, s35
    s_mul_i32 s33, s35, 131072
    s_lshl_b32 s32, s35, 7
    s_lshr_b32 s34, s35, 2
    s_mov_b32 s39, 0x04000301
    s_lshl_b32 s34, s34, 3
    s_lshr_b32 s39, s39, s34
    s_and_b32 s39, s39, 0xff
    s_mul_i32 s39, s39, 2048
    s_add_u32 s32, s32, s39
    s_add_u32 m0, s40, 81920
    s_nop 0
    buffer_load_dwordx4 v2, s[8:11], s32 offen lds
    s_add_u32 m0, s40, 82944
    s_nop 0
    buffer_load_dwordx4 v3, s[8:11], s32 offen lds
    s_add_u32 m0, s41, 40960
    s_nop 0
    buffer_load_dwordx4 v10, s[12:15], s33 offen lds
    s_branch L_gw2_1_kernel_join2
L_gw2_1_kernel_tail1:
    s_waitcnt vmcnt(0)
    s_barrier
L_gw2_1_kernel_join2:
    ds_read_b128 v[64:67], v21 offset:0
    ds_read_b64_tr_b16 v[68:69], v24 offset:2048
    ds_read_b64_tr_b16 v[70:71], v24 offset:2560
    s_waitcnt lgkmcnt(3)
    v_mfma_f32_32x32x16_bf16 v[40:55], v[60:63], v[56:59], v[40:55]
    ds_read_b128 v[56:59], v22 offset:0
    ds_read_b64_tr_b16 v[60:61], v24 offset:4096
    ds_read_b64_tr_b16 v[62:63], v24 offset:4608
    s_waitcnt lgkmcnt(3)
    v_mfma_f32_32x32x16_bf16 v[40:55], v[68:71], v[64:67], v[40:55]
    ds_read_b128 v[64:67], v23 offset:0
    ds_read_b64_tr_b16 v[68:69], v24 offset:6144
    ds_read_b64_tr_b16 v[70:71], v24 offset:6656
    s_waitcnt lgkmcnt(3)
    v_mfma_f32_32x32x16_bf16 v[40:55], v[60:63], v[56:59], v[40:55]
    ds_read_b128 v[56:59], v20 offset:16384
    ds_read_b64_tr_b16 v[60:61], v24 offset:8192
    ds_read_b64_tr_b16 v[62:63], v24 offset:8704
    s_waitcnt lgkmcnt(3)
    v_mfma_f32_32x32x16_bf16 v[40:55], v[68:71], v[64:67], v[40:55]
    s_cmp_ge_u32 s31, 15
    s_cbranch_scc1 L_lend_gw2_1_kernel
    s_cmp_ge_u32 s31, 10
    s_cbranch_scc1 L_gw2_1_kernel_tail3
    s_waitcnt vmcnt(9)
    s_barrier
    s_add_u32 s35, s31, 6
    s_add_u32 s35, s35, s42
    s_sub_u32 s34, s35, 16
    s_cmp_ge_u32 s35, 16
    s_cselect_b32 s35, s34, s35
    s_mul_i32 s33, s35, 131072
    s_lshl_b32 s32, s35, 7
    s_lshr_b32 s34, s35, 2
    s_mov_b32 s39, 0x04000301
    s_lshl_b32 s34, s34, 3
    s_lshr_b32 s39, s39, s34
    s_and_b32 s39, s39, 0xff
    s_mul_i32 s39, s39, 2048
    s_add_u32 s32, s32, s39
    s_add_u32 m0, s40, 0
    s_nop 0
    buffer_load_dwordx4 v2, s[8:11], s32 offen lds
    s_add_u32 m0, s40, 1024
    s_nop 0
    buffer_load_dwordx4 v3, s[8:11], s32 offen lds
    s_add_u32 m0, s41, 0
    s_nop 0
    buffer_load_dwordx4 v10, s[12:15], s33 offen lds
    s_branch L_gw2_1_kernel_join4
L_gw2_1_kernel_tail3:
    s_waitcnt vmcnt(0)
    s_barrier
L_gw2_1_kernel_join4:
    ds_read_b128 v[64:67], v21 offset:16384
    ds_read_b64_tr_b16 v[68:69], v24 offset:10240
    ds_read_b64_tr_b16 v[70:71], v24 offset:10752
    s_waitcnt lgkmcnt(3)
    v_mfma_f32_32x32x16_bf16 v[40:55], v[60:63], v[56:59], v[40:55]
    ds_read_b128 v[56:59], v22 offset:16384
    ds_read_b64_tr_b16 v[60:61], v24 offset:12288
    ds_read_b64_tr_b16 v[62:63], v24 offset:12800
    s_waitcnt lgkmcnt(3)
    v_mfma_f32_32x32x16_bf16 v[40:55], v[68:71], v[64:67], v[40:55]
    ds_read_b128 v[64:67], v23 offset:16384
    ds_read_b64_tr_b16 v[68:69], v24 offset:14336
    ds_read_b64_tr_b16 v[70:71], v24 offset:14848
    s_waitcnt lgkmcnt(3)
    v_mfma_f32_32x32x16_bf16 v[40:55], v[60:63], v[56:59], v[40:55]
    ds_read_b128 v[56:59], v20 offset:32768
    ds_read_b64_tr_b16 v[60:61], v28 offset:0
    ds_read_b64_tr_b16 v[62:63], v28 offset:512
    s_waitcnt lgkmcnt(3)
    v_mfma_f32_32x32x16_bf16 v[40:55], v[68:71], v[64:67], v[40:55]
    s_cmp_ge_u32 s31, 14
    s_cbranch_scc1 L_lend_gw2_1_kernel
    s_cmp_ge_u32 s31, 9
    s_cbranch_scc1 L_gw2_1_kernel_tail5
    s_waitcnt vmcnt(9)
    s_barrier
    s_add_u32 s35, s31, 7
    s_add_u32 s35, s35, s42
    s_sub_u32 s34, s35, 16
    s_cmp_ge_u32 s35, 16
    s_cselect_b32 s35, s34, s35
    s_mul_i32 s33, s35, 131072
    s_lshl_b32 s32, s35, 7
    s_lshr_b32 s34, s35, 2
    s_mov_b32 s39, 0x04000301
    s_lshl_b32 s34, s34, 3
    s_lshr_b32 s39, s39, s34
    s_and_b32 s39, s39, 0xff
    s_mul_i32 s39, s39, 2048
    s_add_u32 s32, s32, s39
    s_add_u32 m0, s40, 16384
    s_nop 0
    buffer_load_dwordx4 v2, s[8:11], s32 offen lds
    s_add_u32 m0, s40, 17408
    s_nop 0
    buffer_load_dwordx4 v3, s[8:11], s32 offen lds
    s_add_u32 m0, s41, 8192
    s_nop 0
    buffer_load_dwordx4 v10, s[12:15], s33 offen lds
    s_branch L_gw2_1_kernel_join6
L_gw2_1_kernel_tail5:
    s_waitcnt vmcnt(0)
    s_barrier
L_gw2_1_kernel_join6:
    ds_read_b128 v[64:67], v21 offset:32768
    ds_read_b64_tr_b16 v[68:69], v28 offset:2048
    ds_read_b64_tr_b16 v[70:71], v28 offset:2560
    s_waitcnt lgkmcnt(3)
    v_mfma_f32_32x32x16_bf16 v[40:55], v[60:63], v[56:59], v[40:55]
    ds_read_b128 v[56:59], v22 offset:32768
    ds_read_b64_tr_b16 v[60:61], v28 offset:4096
    ds_read_b64_tr_b16 v[62:63], v28 offset:4608
    s_waitcnt lgkmcnt(3)
    v_mfma_f32_32x32x16_bf16 v[40:55], v[68:71], v[64:67], v[40:55]
    ds_read_b128 v[64:67], v23 offset:32768
    ds_read_b64_tr_b16 v[68:69], v28 offset:6144
    ds_read_b64_tr_b16 v[70:71], v28 offset:6656
    s_waitcnt lgkmcnt(3)
    v_mfma_f32_32x32x16_bf16 v[40:55], v[60:63], v[56:59], v[40:55]
    ds_read_b128 v[56:59], v20 offset:49152
    ds_read_b64_tr_b16 v[60:61], v28 offset:8192
    ds_read_b64_tr_b16 v[62:63], v28 offset:8704
    s_waitcnt lgkmcnt(3)
    v_mfma_f32_32x32x16_bf16 v[40:55], v[68:71], v[64:67], v[40:55]
    s_cmp_ge_u32 s31, 13
    s_cbranch_scc1 L_lend_gw2_1_kernel
    s_cmp_ge_u32 s31, 8
    s_cbranch_scc1 L_gw2_1_kernel_tail7
    s_waitcnt vmcnt(9)
    s_barrier
    s_add_u32 s35, s31, 8
    s_add_u32 s35, s35, s42
    s_sub_u32 s34, s35, 16
    s_cmp_ge_u32 s35, 16
    s_cselect_b32 s35, s34, s35
    s_mul_i32 s33, s35, 131072
    s_lshl_b32 s32, s35, 7
    s_lshr_b32 s34, s35, 2
    s_mov_b32 s39, 0x04000301
    s_lshl_b32 s34, s34, 3
    s_lshr_b32 s39, s39, s34
    s_and_b32 s39, s39, 0xff
    s_mul_i32 s39, s39, 2048
    s_add_u32 s32, s32, s39
    s_add_u32 m0, s40, 32768
    s_nop 0
    buffer_load_dwordx4 v2, s[8:11], s32 offen lds
    s_add_u32 m0, s40, 33792
    s_nop 0
    buffer_load_dwordx4 v3, s[8:11], s32 offen lds
    s_add_u32 m0, s41, 16384
    s_nop 0
    buffer_load_dwordx4 v10, s[12:15], s33 offen lds
    s_branch L_gw2_1_kernel_join8
L_gw2_1_kernel_tail7:
    s_waitcnt vmcnt(0)
    s_barrier
L_gw2_1_kernel_join8:
    ds_read_b128 v[64:67], v21 offset:49152
    ds_read_b64_tr_b16 v[68:69], v28 offset:10240
    ds_read_b64_tr_b16 v[70:71], v28 offset:10752
    s_waitcnt lgkmcnt(3)
    v_mfma_f32_32x32x16_bf16 v[40:55], v[60:63], v[56:59], v[40:55]
    ds_read_b128 v[56:59], v22 offset:49152
    ds_read_b64_tr_b16 v[60:61], v28 offset:12288
    ds_read_b64_tr_b16 v[62:63], v28 offset:12800
    s_waitcnt lgkmcnt(3)
    v_mfma_f32_32x32x16_bf16 v[40:55], v[68:71], v[64:67], v[40:55]
    ds_read_b128 v[64:67], v23 offset:49152
    ds_read_b64_tr_b16 v[68:69], v28 offset:14336
    ds_read_b64_tr_b16 v[70:71], v28 offset:14848
    s_waitcnt lgkmcnt(3)
    v_mfma_f32_32x32x16_bf16 v[40:55], v[60:63], v[56:59], v[40:55]
    ds_read_b128 v[56:59], v36 offset:0
    ds_read_b64_tr_b16 v[60:61], v32 offset:0
    ds_read_b64_tr_b16 v[62:63], v32 offset:512
    s_waitcnt lgkmcnt(3)
    v_mfma_f32_32x32x16_bf16 v[40:55], v[68:71], v[64:67], v[40:55]
    s_cmp_ge_u32 s31, 12
    s_cbranch_scc1 L_lend_gw2_1_kernel
    s_cmp_ge_u32 s31, 7
    s_cbranch_scc1 L_gw2_1_kernel_tail9
    s_waitcnt vmcnt(9)
    s_barrier
    s_add_u32 s35, s31, 9
    s_add_u32 s35, s35, s42
    s_sub_u32 s34, s35, 16
    s_cmp_ge_u32 s35, 16
    s_cselect_b32 s35, s34, s35
    s_mul_i32 s33, s35, 131072
    s_lshl_b32 s32, s35, 7
    s_lshr_b32 s34, s35, 2
    s_mov_b32 s39, 0x04000301
    s_lshl_b32 s34, s34, 3
    s_lshr_b32 s39, s39, s34
    s_and_b32 s39, s39, 0xff
    s_mul_i32 s39, s39, 2048
    s_add_u32 s32, s32, s39
    s_add_u32 m0, s40, 49152
    s_nop 0
    buffer_load_dwordx4 v2, s[8:11], s32 offen lds
    s_add_u32 m0, s40, 50176
    s_nop 0
    buffer_load_dwordx4 v3, s[8:11], s32 offen lds
    s_add_u32 m0, s41, 24576
    s_nop 0
    buffer_load_dwordx4 v10, s[12:15], s33 offen lds
    s_branch L_gw2_1_kernel_join10
L_gw2_1_kernel_tail9:
    s_waitcnt vmcnt(0)
    s_barrier
L_gw2_1_kernel_join10:
    ds_read_b128 v[64:67], v37 offset:0
    ds_read_b64_tr_b16 v[68:69], v32 offset:2048
    ds_read_b64_tr_b16 v[70:71], v32 offset:2560
    s_waitcnt lgkmcnt(3)
    v_mfma_f32_32x32x16_bf16 v[40:55], v[60:63], v[56:59], v[40:55]
    ds_read_b128 v[56:59], v38 offset:0
    ds_read_b64_tr_b16 v[60:61], v32 offset:4096
    ds_read_b64_tr_b16 v[62:63], v32 offset:4608
    s_waitcnt lgkmcnt(3)
    v_mfma_f32_32x32x16_bf16 v[40:55], v[68:71], v[64:67], v[40:55]
    ds_read_b128 v[64:67], v39 offset:0
    ds_read_b64_tr_b16 v[68:69], v32 offset:6144
    ds_read_b64_tr_b16 v[70:71], v32 offset:6656
    s_waitcnt lgkmcnt(3)
    v_mfma_f32_32x32x16_bf16 v[40:55], v[60:63], v[56:59], v[40:55]
    ds_read_b128 v[56:59], v36 offset:16384
    ds_read_b64_tr_b16 v[60:61], v32 offset:8192
    ds_read_b64_tr_b16 v[62:63], v32 offset:8704
    s_waitcnt lgkmcnt(3)
    v_mfma_f32_32x32x16_bf16 v[40:55], v[68:71], v[64:67], v[40:55]
    s_cmp_ge_u32 s31, 11
    s_cbranch_scc1 L_lend_gw2_1_kernel
    s_cmp_ge_u32 s31, 6
    s_cbranch_scc1 L_gw2_1_kernel_tail11
    s_waitcnt vmcnt(9)
    s_barrier
    s_add_u32 s35, s31, 10
    s_add_u32 s35, s35, s42
    s_sub_u32 s34, s35, 16
    s_cmp_ge_u32 s35, 16
    s_cselect_b32 s35, s34, s35
    s_mul_i32 s33, s35, 131072
    s_lshl_b32 s32, s35, 7
    s_lshr_b32 s34, s35, 2
    s_mov_b32 s39, 0x04000301
    s_lshl_b32 s34, s34, 3
    s_lshr_b32 s39, s39, s34
    s_and_b32 s39, s39, 0xff
    s_mul_i32 s39, s39, 2048
    s_add_u32 s32, s32, s39
    s_add_u32 m0, s40, 65536
    s_nop 0
    buffer_load_dwordx4 v2, s[8:11], s32 offen lds
    s_add_u32 m0, s40, 66560
    s_nop 0
    buffer_load_dwordx4 v3, s[8:11], s32 offen lds
    s_add_u32 m0, s41, 32768
    s_nop 0
    buffer_load_dwordx4 v10, s[12:15], s33 offen lds
    s_branch L_gw2_1_kernel_join12
L_gw2_1_kernel_tail11:
    s_waitcnt vmcnt(0)
    s_barrier
L_gw2_1_kernel_join12:
    ds_read_b128 v[64:67], v37 offset:16384
    ds_read_b64_tr_b16 v[68:69], v32 offset:10240
    ds_read_b64_tr_b16 v[70:71], v32 offset:10752
    s_waitcnt lgkmcnt(3)
    v_mfma_f32_32x32x16_bf16 v[40:55], v[60:63], v[56:59], v[40:55]
    ds_read_b128 v[56:59], v38 offset:16384
    ds_read_b64_tr_b16 v[60:61], v32 offset:12288
    ds_read_b64_tr_b16 v[62:63], v32 offset:12800
    s_waitcnt lgkmcnt(3)
    v_mfma_f32_32x32x16_bf16 v[40:55], v[68:71], v[64:67], v[40:55]
    ds_read_b128 v[64:67], v39 offset:16384
    ds_read_b64_tr_b16 v[68:69], v32 offset:14336
    ds_read_b64_tr_b16 v[70:71], v32 offset:14848
    s_waitcnt lgkmcnt(3)
    v_mfma_f32_32x32x16_bf16 v[40:55], v[60:63], v[56:59], v[40:55]
    ds_read_b128 v[56:59], v20 offset:0
    ds_read_b64_tr_b16 v[60:61], v24 offset:0
    ds_read_b64_tr_b16 v[62:63], v24 offset:512
    s_waitcnt lgkmcnt(3)
    v_mfma_f32_32x32x16_bf16 v[40:55], v[68:71], v[64:67], v[40:55]
    s_add_u32 s31, s31, 6
    s_cmp_lt_u32 s31, 16
    s_cbranch_scc1 L_loop_gw2_1_kernel
L_lend_gw2_1_kernel:
    s_nop 15
    s_nop 7
    s_lshr_b32 s31, s30, 1
    s_and_b32 s34, s30, 1
    s_mul_i32 s38, s31, 32
    s_mul_i32 s39, s34, 32
    s_lshl_b32 s31, s28, 7
    s_add_u32 s38, s38, s31
    s_mul_i32 s31, s29, 64
    s_add_u32 s39, s39, s31
    s_barrier
    s_mul_i32 s32, s30, 2560
    v_and_b32 v1, 31, v0
    v_mul_u32_u24 v1, 80, v1
    v_lshrrev_b32 v2, 5, v0
    v_lshlrev_b32 v2, 3, v2
    v_add_u32 v1, v1, v2
    v_add_u32 v1, s32, v1
    v_cvt_pk_bf16_f32 v40, v40, v41
    v_cvt_pk_bf16_f32 v41, v42, v43
    ds_write_b64 v1, v[40:41] offset:0
    v_cvt_pk_bf16_f32 v44, v44, v45
    v_cvt_pk_bf16_f32 v45, v46, v47
    ds_write_b64 v1, v[44:45] offset:16
    v_cvt_pk_bf16_f32 v48, v48, v49
    v_cvt_pk_bf16_f32 v49, v50, v51
    ds_write_b64 v1, v[48:49] offset:32
    v_cvt_pk_bf16_f32 v52, v52, v53
    v_cvt_pk_bf16_f32 v53, v54, v55
    ds_write_b64 v1, v[52:53] offset:48
    s_mov_b32 s35, 2048
    s_lshl_b32 s39, s39, 1
    v_add_u32 v2, 0, v0
    v_mul_u32_u24 v3, 16384, v2
    v_lshrrev_b32 v3, 16, v3
    v_mul_u32_u24 v4, 4, v3
    v_sub_u32 v4, v2, v4
    v_lshlrev_b32 v4, 4, v4
    v_mul_u32_u24 v5, 80, v3
    v_add_u32 v5, v5, v4
    v_add_u32 v8, s32, v5
    v_add_u32 v3, s38, v3
    v_mul_lo_u32 v3, v3, s35
    v_add_u32 v3, v3, v4
    v_add_u32 v16, s39, v3
    v_add_u32 v2, 64, v0
    v_mul_u32_u24 v3, 16384, v2
    v_lshrrev_b32 v3, 16, v3
    v_mul_u32_u24 v4, 4, v3
    v_sub_u32 v4, v2, v4
    v_lshlrev_b32 v4, 4, v4
    v_mul_u32_u24 v5, 80, v3
    v_add_u32 v5, v5, v4
    v_add_u32 v9, s32, v5
    v_add_u32 v3, s38, v3
    v_mul_lo_u32 v3, v3, s35
    v_add_u32 v3, v3, v4
    v_add_u32 v17, s39, v3
    s_waitcnt lgkmcnt(0)
    ds_read_b128 v[40:43], v8
    buffer_load_dwordx4 v[48:51], v16, s[20:23], 0 offen
    ds_read_b128 v[44:47], v9
    buffer_load_dwordx4 v[52:55], v17, s[20:23], 0 offen
    s_waitcnt lgkmcnt(0)
    s_waitcnt vmcnt(0)
    v_lshlrev_b32 v72, 16, v40
    v_and_b32 v73, 0xffff0000, v40
    v_lshlrev_b32 v74, 16, v48
    v_and_b32 v75, 0xffff0000, v48
    v_add_f32 v72, v72, v74
    v_add_f32 v73, v73, v75
    v_cvt_pk_bf16_f32 v40, v72, v73
    v_lshlrev_b32 v72, 16, v41
    v_and_b32 v73, 0xffff0000, v41
    v_lshlrev_b32 v74, 16, v49
    v_and_b32 v75, 0xffff0000, v49
    v_add_f32 v72, v72, v74
    v_add_f32 v73, v73, v75
    v_cvt_pk_bf16_f32 v41, v72, v73
    v_lshlrev_b32 v72, 16, v42
    v_and_b32 v73, 0xffff0000, v42
    v_lshlrev_b32 v74, 16, v50
    v_and_b32 v75, 0xffff0000, v50
    v_add_f32 v72, v72, v74
    v_add_f32 v73, v73, v75
    v_cvt_pk_bf16_f32 v42, v72, v73
    v_lshlrev_b32 v72, 16, v43
    v_and_b32 v73, 0xffff0000, v43
    v_lshlrev_b32 v74, 16, v51
    v_and_b32 v75, 0xffff0000, v51
    v_add_f32 v72, v72, v74
    v_add_f32 v73, v73, v75
    v_cvt_pk_bf16_f32 v43, v72, v73
    buffer_store_dwordx4 v[40:43], v16, s[16:19], 0 offen
    v_lshlrev_b32 v72, 16, v44
    v_and_b32 v73, 0xffff0000, v44
    v_lshlrev_b32 v74, 16, v52
    v_and_b32 v75, 0xffff0000, v52
    v_add_f32 v72, v72, v74
    v_add_f32 v73, v73, v75
    v_cvt_pk_bf16_f32 v44, v72, v73
    v_lshlrev_b32 v72, 16, v45
    v_and_b32 v73, 0xffff0000, v45
    v_lshlrev_b32 v74, 16, v53
    v_and_b32 v75, 0xffff0000, v53
    v_add_f32 v72, v72, v74
    v_add_f32 v73, v73, v75
    v_cvt_pk_bf16_f32 v45, v72, v73
    v_lshlrev_b32 v72, 16, v46
    v_and_b32 v73, 0xffff0000, v46
    v_lshlrev_b32 v74, 16, v54
    v_and_b32 v75, 0xffff0000, v54
    v_add_f32 v72, v72, v74
    v_add_f32 v73, v73, v75
    v_cvt_pk_bf16_f32 v46, v72, v73
    v_lshlrev_b32 v72, 16, v47
    v_and_b32 v73, 0xffff0000, v47
    v_lshlrev_b32 v74, 16, v55
    v_and_b32 v75, 0xffff0000, v55
    v_add_f32 v72, v72, v74
    v_add_f32 v73, v73, v75
    v_cvt_pk_bf16_f32 v47, v72, v73
    buffer_store_dwordx4 v[44:47], v17, s[16:19], 0 offen
L_done_gw2_1_kernel:
    s_endpgm
.globl lnc_1_kernel
.p2align 8
.type lnc_1_kernel,@function
lnc_1_kernel:
    s_cmp_ge_u32 s2, 512
    s_cbranch_scc1 L_done_lnc_1_kernel
    s_load_dwordx2 s[40:41], s[0:1], 88
    s_waitcnt lgkmcnt(0)
    s_add_u32 s8, s40, 44040192
    s_addc_u32 s9, s41, 0
    s_mov_b32 s10, 4194304
    s_mov_b32 s11, 0x00020000
    s_add_u32 s12, s40, 48234496
    s_addc_u32 s13, s41, 0
    s_mov_b32 s14, 4194304
    s_mov_b32 s15, 0x00020000
    s_lshl_b32 s3, s2, 2
    v_lshrrev_b32 v1, 6, v0
    v_add_u32 v1, s3, v1
    v_lshlrev_b32 v1, 11, v1
    v_and_b32 v2, 63, v0
    v_lshlrev_b32 v2, 4, v2
    v_add_u32 v1, v1, v2
    buffer_load_dwordx4 v[8:11], v1, s[8:11], 0 offen
    buffer_load_dwordx4 v[12:15], v1, s[8:11], 0 offen offset:1024
    s_waitcnt vmcnt(0)
    v_lshlrev_b32 v16, 16, v8
    v_and_b32 v17, 0xffff0000, v8
    v_lshlrev_b32 v18, 16, v9
    v_and_b32 v19, 0xffff0000, v9
    v_lshlrev_b32 v20, 16, v10
    v_and_b32 v21, 0xffff0000, v10
    v_lshlrev_b32 v22, 16, v11
    v_and_b32 v23, 0xffff0000, v11
    v_lshlrev_b32 v24, 16, v12
    v_and_b32 v25, 0xffff0000, v12
    v_lshlrev_b32 v26, 16, v13
    v_and_b32 v27, 0xffff0000, v13
    v_lshlrev_b32 v28, 16, v14
    v_and_b32 v29, 0xffff0000, v14
    v_lshlrev_b32 v30, 16, v15
    v_and_b32 v31, 0xffff0000, v15
    v_mov_b32 v4, 0
    v_add_f32 v4, v4, v16
    v_add_f32 v4, v4, v17
    v_add_f32 v4, v4, v18
    v_add_f32 v4, v4, v19
    v_add_f32 v4, v4, v20
    v_add_f32 v4, v4, v21
    v_add_f32 v4, v4, v22
    v_add_f32 v4, v4, v23
    v_add_f32 v4, v4, v24
    v_add_f32 v4, v4, v25
    v_add_f32 v4, v4, v26
    v_add_f32 v4, v4, v27
    v_add_f32 v4, v4, v28
    v_add_f32 v4, v4, v29
    v_add_f32 v4, v4, v30
    v_add_f32 v4, v4, v31
    ds_swizzle_b32 v5, v4 offset:0x041F
    s_waitcnt lgkmcnt(0)
    v_add_f32 v4, v4, v5
    ds_swizzle_b32 v5, v4 offset:0x081F
    s_waitcnt lgkmcnt(0)
    v_add_f32 v4, v4, v5
    ds_swizzle_b32 v5, v4 offset:0x101F
    s_waitcnt lgkmcnt(0)
    v_add_f32 v4, v4, v5
    ds_swizzle_b32 v5, v4 offset:0x201F
    s_waitcnt lgkmcnt(0)
    v_add_f32 v4, v4, v5
    ds_swizzle_b32 v5, v4 offset:0x401F
    s_waitcnt lgkmcnt(0)
    v_add_f32 v4, v4, v5
    s_nop 0
    v_readlane_b32 s30, v4, 32
    v_readlane_b32 s31, v4, 0
    s_nop 1
    v_mov_b32 v4, s30
    v_add_f32 v4, s31, v4
    v_mul_f32 v4, 0x3a800000, v4
    v_mov_b32 v6, 0
    v_sub_f32 v16, v16, v4
    v_fmac_f32 v6, v16, v16
    v_sub_f32 v17, v17, v4
    v_fmac_f32 v6, v17, v17
    v_sub_f32 v18, v18, v4
    v_fmac_f32 v6, v18, v18
    v_sub_f32 v19, v19, v4
    v_fmac_f32 v6, v19, v19
    v_sub_f32 v20, v20, v4
    v_fmac_f32 v6, v20, v20
    v_sub_f32 v21, v21, v4
    v_fmac_f32 v6, v21, v21
    v_sub_f32 v22, v22, v4
    v_fmac_f32 v6, v22, v22
    v_sub_f32 v23, v23, v4
    v_fmac_f32 v6, v23, v23
    v_sub_f32 v24, v24, v4
    v_fmac_f32 v6, v24, v24
    v_sub_f32 v25, v25, v4
    v_fmac_f32 v6, v25, v25
    v_sub_f32 v26, v26, v4
    v_fmac_f32 v6, v26, v26
    v_sub_f32 v27, v27, v4
    v_fmac_f32 v6, v27, v27
    v_sub_f32 v28, v28, v4
    v_fmac_f32 v6, v28, v28
    v_sub_f32 v29, v29, v4
    v_fmac_f32 v6, v29, v29
    v_sub_f32 v30, v30, v4
    v_fmac_f32 v6, v30, v30
    v_sub_f32 v31, v31, v4
    v_fmac_f32 v6, v31, v31
    ds_swizzle_b32 v5, v6 offset:0x041F
    s_waitcnt lgkmcnt(0)
    v_add_f32 v6, v6, v5
    ds_swizzle_b32 v5, v6 offset:0x081F
    s_waitcnt lgkmcnt(0)
    v_add_f32 v6, v6, v5
    ds_swizzle_b32 v5, v6 offset:0x101F
    s_waitcnt lgkmcnt(0)
    v_add_f32 v6, v6, v5
    ds_swizzle_b32 v5, v6 offset:0x201F
    s_waitcnt lgkmcnt(0)
    v_add_f32 v6, v6, v5
    ds_swizzle_b32 v5, v6 offset:0x401F
    s_waitcnt lgkmcnt(0)
    v_add_f32 v6, v6, v5
    s_nop 0
    v_readlane_b32 s30, v6, 32
    v_readlane_b32 s31, v6, 0
    s_nop 1
    v_mov_b32 v6, s30
    v_add_f32 v6, s31, v6
    v_mov_b32 v5, 0x3727c5ac
    v_fmac_f32 v5, 0x3a800000, v6
    v_rsq_f32 v5, v5
    s_nop 0
    v_mul_f32 v16, v16, v5
    v_mul_f32 v17, v17, v5
    v_mul_f32 v18, v18, v5
    v_mul_f32 v19, v19, v5
    v_mul_f32 v20, v20, v5
    v_mul_f32 v21, v21, v5
    v_mul_f32 v22, v22, v5
    v_mul_f32 v23, v23, v5
    v_mul_f32 v24, v24, v5
    v_mul_f32 v25, v25, v5
    v_mul_f32 v26, v26, v5
    v_mul_f32 v27, v27, v5
    v_mul_f32 v28, v28, v5
    v_mul_f32 v29, v29, v5
    v_mul_f32 v30, v30, v5
    v_mul_f32 v31, v31, v5
    v_cvt_pk_bf16_f32 v32, v16, v17
    v_cvt_pk_bf16_f32 v33, v18, v19
    v_cvt_pk_bf16_f32 v34, v20, v21
    v_cvt_pk_bf16_f32 v35, v22, v23
    v_cvt_pk_bf16_f32 v36, v24, v25
    v_cvt_pk_bf16_f32 v37, v26, v27
    v_cvt_pk_bf16_f32 v38, v28, v29
    v_cvt_pk_bf16_f32 v39, v30, v31
    buffer_store_dwordx4 v[32:35], v1, s[12:15], 0 offen
    buffer_store_dwordx4 v[36:39], v1, s[12:15], 0 offen offset:1024
L_done_lnc_1_kernel:
    s_endpgm
.globl gw3_1_kernel
.p2align 8
.type gw3_1_kernel,@function
gw3_1_kernel:
    s_cmp_ge_u32 s2, 224
    s_cbranch_scc1 L_done_gw3_1_kernel
    s_load_dwordx2 s[40:41], s[0:1], 56
    s_load_dwordx2 s[42:43], s[0:1], 88
    s_waitcnt lgkmcnt(0)
    s_add_u32 s8, s42, 48234496
    s_addc_u32 s9, s43, 0
    s_mov_b32 s10, 4194304
    s_mov_b32 s11, 0x00020000
    s_mov_b32 s12, s40
    s_mov_b32 s13, s41
    s_mov_b32 s14, 7340032
    s_mov_b32 s15, 0x00020000
    s_add_u32 s16, s42, 52428800
    s_addc_u32 s17, s43, 0
    s_mov_b32 s18, 14680064
    s_mov_b32 s19, 0x00020000
    s_mov_b32 s36, 0x3d372713
    s_mov_b32 s37, 0xc0135761
    s_and_b32 s3, s2, 7
    s_lshr_b32 s4, s2, 3
    s_mul_i32 s5, s4, 9363
    s_lshr_b32 s5, s5, 16
    s_mul_i32 s6, s5, 7
    s_sub_u32 s6, s4, s6
    s_lshr_b32 s7, s3, 1
    s_mul_i32 s7, s7, 4
    s_add_u32 s28, s7, s5
    s_and_b32 s7, s3, 1
    s_mul_i32 s7, s7, 7
    s_add_u32 s29, s7, s6
    v_lshrrev_b32 v1, 6, v0
    s_nop 0
    v_readfirstlane_b32 s30, v1
    v_and_b32 v0, 63, v0
    v_lshrrev_b32 v1, 3, v0
    s_lshl_b32 s31, s30, 4
    s_lshl_b32 s34, s28, 7
    s_add_u32 s31, s31, s34
    v_add_u32 v1, s31, v1
    v_add_u32 v6, 0, v1
    v_lshrrev_b32 v7, 1, v6
    v_and_b32 v7, 7, v7
    v_and_b32 v8, 7, v0
    v_xor_b32 v7, v7, v8
    v_lshlrev_b32 v7, 4, v7
    s_mov_b32 s35, 2048
    v_mul_lo_u32 v6, v6, s35
    v_add_u32 v2, v6, v7
    v_add_u32 v6, 8, v1
    v_lshrrev_b32 v7, 1, v6
    v_and_b32 v7, 7, v7
    v_and_b32 v8, 7, v0
    v_xor_b32 v7, v7, v8
    v_lshlrev_b32 v7, 4, v7
    s_mov_b32 s35, 2048
    v_mul_lo_u32 v6, v6, s35
    v_add_u32 v3, v6, v7
    s_mul_i32 s31, s30, 256
    s_mul_i32 s34, s29, 512
    v_add_u32 v6, s31, v0
    v_add_u32 v6, 0, v6
    v_mul_u32_u24 v7, 2048, v6
    v_lshrrev_b32 v7, 16, v7
    v_mul_u32_u24 v8, 32, v7
    v_sub_u32 v8, v6, v8
    v_lshlrev_b32 v9, 1, v7
    v_and_b32 v9, 4, v9
    v_xor_b32 v8, v8, v9
    v_lshlrev_b32 v8, 4, v8
    s_mov_b32 s35, 7168
    v_mul_lo_u32 v7, v7, s35
    v_add_u32 v7, v7, v8
    v_add_u32 v10, s34, v7
    v_add_u32 v6, s31, v0
    v_add_u32 v6, 64, v6
    v_mul_u32_u24 v7, 2048, v6
    v_lshrrev_b32 v7, 16, v7
    v_mul_u32_u24 v8, 32, v7
    v_sub_u32 v8, v6, v8
    v_lshlrev_b32 v9, 1, v7
    v_and_b32 v9, 4, v9
    v_xor_b32 v8, v8, v9
    v_lshlrev_b32 v8, 4, v8
    s_mov_b32 s35, 7168
    v_mul_lo_u32 v7, v7, s35
    v_add_u32 v7, v7, v8
    v_add_u32 v11, s34, v7
    v_add_u32 v6, s31, v0
    v_add_u32 v6, 128, v6
    v_mul_u32_u24 v7, 2048, v6
    v_lshrrev_b32 v7, 16, v7
    v_mul_u32_u24 v8, 32, v7
    v_sub_u32 v8, v6, v8
    v_lshlrev_b32 v9, 1, v7
    v_and_b32 v9, 4, v9
    v_xor_b32 v8, v8, v9
    v_lshlrev_b32 v8, 4, v8
    s_mov_b32 s35, 7168
    v_mul_lo_u32 v7, v7, s35
    v_add_u32 v7, v7, v8
    v_add_u32 v12, s34, v7
    v_add_u32 v6, s31, v0
    v_add_u32 v6, 192, v6
    v_mul_u32_u24 v7, 2048, v6
    v_lshrrev_b32 v7, 16, v7
    v_mul_u32_u24 v8, 32, v7
    v_sub_u32 v8, v6, v8
    v_lshlrev_b32 v9, 1, v7
    v_and_b32 v9, 4, v9
    v_xor_b32 v8, v8, v9
    v_lshlrev_b32 v8, 4, v8
    s_mov_b32 s35, 7168
    v_mul_lo_u32 v7, v7, s35
    v_add_u32 v7, v7, v8
    v_add_u32 v13, s34, v7
    s_lshr_b32 s31, s30, 1
    s_and_b32 s34, s30, 1
    s_mul_i32 s38, s31, 32
    s_mul_i32 s39, s34, 128
    v_and_b32 v6, 31, v0
    v_add_u32 v6, s38, v6
    v_lshrrev_b32 v7, 1, v6
    v_and_b32 v7, 7, v7
    v_lshrrev_b32 v8, 5, v0
    v_xor_b32 v7, v7, v8
    v_lshlrev_b32 v7, 4, v7
    v_lshlrev_b32 v6, 7, v6
    v_add_u32 v6, v6, v7
    v_xor_b32 v20, 0, v6
    v_add_u32 v36, 65536, v20
    v_xor_b32 v21, 32, v6
    v_add_u32 v37, 65536, v21
    v_xor_b32 v22, 64, v6
    v_add_u32 v38, 65536, v22
    v_xor_b32 v23, 96, v6
    v_add_u32 v39, 65536, v23
    v_lshrrev_b32 v6, 5, v0
    v_lshlrev_b32 v6, 3, v6
    v_bfe_u32 v7, v0, 2, 2
    v_add_u32 v6, v6, v7
    v_bfe_u32 v8, v0, 4, 1
    v_lshlrev_b32 v8, 4, v8
    v_and_b32 v9, 3, v0
    v_lshlrev_b32 v9, 2, v9
    v_add_u32 v8, v8, v9
    v_add_u32 v8, s39, v8
    v_add_u32 v9, 0, v8
    v_lshlrev_b32 v9, 1, v9
    v_lshlrev_b32 v18, 5, v7
    v_and_b32 v18, 64, v18
    v_xor_b32 v9, v9, v18
    v_mul_u32_u24 v19, 512, v6
    v_add_u32 v24, v19, v9
    v_add_u32 v24, 49152, v24
    v_add_u32 v28, 65536, v24
    v_add_u32 v9, 32, v8
    v_lshlrev_b32 v9, 1, v9
    v_lshlrev_b32 v18, 5, v7
    v_and_b32 v18, 64, v18
    v_xor_b32 v9, v9, v18
    v_mul_u32_u24 v19, 512, v6
    v_add_u32 v25, v19, v9
    v_add_u32 v25, 49152, v25
    v_add_u32 v29, 65536, v25
    v_add_u32 v9, 64, v8
    v_lshlrev_b32 v9, 1, v9
    v_lshlrev_b32 v18, 5, v7
    v_and_b32 v18, 64, v18
    v_xor_b32 v9, v9, v18
    v_mul_u32_u24 v19, 512, v6
    v_add_u32 v26, v19, v9
    v_add_u32 v26, 49152, v26
    v_add_u32 v30, 65536, v26
    v_add_u32 v9, 96, v8
    v_lshlrev_b32 v9, 1, v9
    v_lshlrev_b32 v18, 5, v7
    v_and_b32 v18, 64, v18
    v_xor_b32 v9, v9, v18
    v_mul_u32_u24 v19, 512, v6
    v_add_u32 v27, v19, v9
    v_add_u32 v27, 49152, v27
    v_add_u32 v31, 65536, v27
    v_mov_b32 v40, 0
    v_mov_b32 v41, 0
    v_mov_b32 v42, 0
    v_mov_b32 v43, 0
    v_mov_b32 v44, 0
    v_mov_b32 v45, 0
    v_mov_b32 v46, 0
    v_mov_b32 v47, 0
    v_mov_b32 v48, 0
    v_mov_b32 v49, 0
    v_mov_b32 v50, 0
    v_mov_b32 v51, 0
    v_mov_b32 v52, 0
    v_mov_b32 v53, 0
    v_mov_b32 v54, 0
    v_mov_b32 v55, 0
    v_mov_b32 v56, 0
    v_mov_b32 v57, 0
    v_mov_b32 v58, 0
    v_mov_b32 v59, 0
    v_mov_b32 v60, 0
    v_mov_b32 v61, 0
    v_mov_b32 v62, 0
    v_mov_b32 v63, 0
    v_mov_b32 v64, 0
    v_mov_b32 v65, 0
    v_mov_b32 v66, 0
    v_mov_b32 v67, 0
    v_mov_b32 v68, 0
    v_mov_b32 v69, 0
    v_mov_b32 v70, 0
    v_mov_b32 v71, 0
    v_mov_b32 v72, 0
    v_mov_b32 v73, 0
    v_mov_b32 v74, 0
    v_mov_b32 v75, 0
    v_mov_b32 v76, 0
    v_mov_b32 v77, 0
    v_mov_b32 v78, 0
    v_mov_b32 v79, 0
    v_mov_b32 v80, 0
    v_mov_b32 v81, 0
    v_mov_b32 v82, 0
    v_mov_b32 v83, 0
    v_mov_b32 v84, 0
    v_mov_b32 v85, 0
    v_mov_b32 v86, 0
    v_mov_b32 v87, 0
    v_mov_b32 v88, 0
    v_mov_b32 v89, 0
    v_mov_b32 v90, 0
    v_mov_b32 v91, 0
    v_mov_b32 v92, 0
    v_mov_b32 v93, 0
    v_mov_b32 v94, 0
    v_mov_b32 v95, 0
    v_mov_b32 v96, 0
    v_mov_b32 v97, 0
    v_mov_b32 v98, 0
    v_mov_b32 v99, 0
    v_mov_b32 v100, 0
    v_mov_b32 v101, 0
    v_mov_b32 v102, 0
    v_mov_b32 v103, 0
    s_lshl_b32 s40, s30, 11
    s_mul_i32 s41, s30, 4096
    s_add_u32 s41, s41, 49152
    s_mov_b32 s32, 0
    s_mov_b32 s33, 0
    s_and_b32 s42, s4, 15
    s_mov_b32 s42, 0
    s_mov_b32 s35, 0
    s_add_u32 s35, s35, s42
    s_sub_u32 s34, s35, 16
    s_cmp_ge_u32 s35, 16
    s_cselect_b32 s35, s34, s35
    s_mul_i32 s33, s35, 458752
    s_lshl_b32 s32, s35, 7
    s_add_u32 m0, s40, 0
    s_nop 0
    buffer_load_dwordx4 v2, s[8:11], s32 offen lds
    s_add_u32 m0, s40, 1024
    s_nop 0
    buffer_load_dwordx4 v3, s[8:11], s32 offen lds
    s_add_u32 m0, s41, 0
    s_nop 0
    buffer_load_dwordx4 v10, s[12:15], s33 offen lds
    s_add_u32 m0, s41, 1024
    s_nop 0
    buffer_load_dwordx4 v11, s[12:15], s33 offen lds
    s_add_u32 m0, s41, 2048
    s_nop 0
    buffer_load_dwordx4 v12, s[12:15], s33 offen lds
    s_add_u32 m0, s41, 3072
    s_nop 0
    buffer_load_dwordx4 v13, s[12:15], s33 offen lds
    s_mov_b32 s35, 1
    s_add_u32 s35, s35, s42
    s_sub_u32 s34, s35, 16
    s_cmp_ge_u32 s35, 16
    s_cselect_b32 s35, s34, s35
    s_mul_i32 s33, s35, 458752
    s_lshl_b32 s32, s35, 7
    s_add_u32 m0, s40, 16384
    s_nop 0
    buffer_load_dwordx4 v2, s[8:11], s32 offen lds
    s_add_u32 m0, s40, 17408
    s_nop 0
    buffer_load_dwordx4 v3, s[8:11], s32 offen lds
    s_add_u32 m0, s41, 32768
    s_nop 0
    buffer_load_dwordx4 v10, s[12:15], s33 offen lds
    s_add_u32 m0, s41, 33792
    s_nop 0
    buffer_load_dwordx4 v11, s[12:15], s33 offen lds
    s_add_u32 m0, s41, 34816
    s_nop 0
    buffer_load_dwordx4 v12, s[12:15], s33 offen lds
    s_add_u32 m0, s41, 35840
    s_nop 0
    buffer_load_dwordx4 v13, s[12:15], s33 offen lds
    s_mov_b32 s31, 0
    s_waitcnt vmcnt(6)
    s_barrier
    ds_read_b128 v[104:107], v20 offset:0
    ds_read_b64_tr_b16 v[108:109], v24 offset:0
    ds_read_b64_tr_b16 v[110:111], v24 offset:2048
    ds_read_b64_tr_b16 v[112:113], v25 offset:0
    ds_read_b64_tr_b16 v[114:115], v25 offset:2048
    ds_read_b64_tr_b16 v[116:117], v26 offset:0
    ds_read_b64_tr_b16 v[118:119], v26 offset:2048
    ds_read_b64_tr_b16 v[120:121], v27 offset:0
    ds_read_b64_tr_b16 v[122:123], v27 offset:2048
L_loop_gw3_1_kernel:
    s_cmp_ge_u32 s31, 16
    s_cbranch_scc1 L_lend_gw3_1_kernel
    s_cmp_ge_u32 s31, 14
    s_cbranch_scc1 L_gw3_1_kernel_tail1
    s_waitcnt vmcnt(0)
    s_barrier
    s_add_u32 s35, s31, 2
    s_add_u32 s35, s35, s42
    s_sub_u32 s34, s35, 16
    s_cmp_ge_u32 s35, 16
    s_cselect_b32 s35, s34, s35
    s_mul_i32 s33, s35, 458752
    s_lshl_b32 s32, s35, 7
    s_add_u32 m0, s40, 32768
    s_nop 0
    buffer_load_dwordx4 v2, s[8:11], s32 offen lds
    s_add_u32 m0, s40, 33792
    s_nop 0
    buffer_load_dwordx4 v3, s[8:11], s32 offen lds
    s_add_u32 m0, s41, 65536
    s_nop 0
    buffer_load_dwordx4 v10, s[12:15], s33 offen lds
    s_add_u32 m0, s41, 66560
    s_nop 0
    buffer_load_dwordx4 v11, s[12:15], s33 offen lds
    s_add_u32 m0, s41, 67584
    s_nop 0
    buffer_load_dwordx4 v12, s[12:15], s33 offen lds
    s_add_u32 m0, s41, 68608
    s_nop 0
    buffer_load_dwordx4 v13, s[12:15], s33 offen lds
    s_branch L_gw3_1_kernel_join2
L_gw3_1_kernel_tail1:
    s_waitcnt vmcnt(0)
    s_barrier
L_gw3_1_kernel_join2:
    ds_read_b128 v[124:127], v21 offset:0
    ds_read_b64_tr_b16 v[128:129], v24 offset:8192
    ds_read_b64_tr_b16 v[130:131], v24 offset:10240
    ds_read_b64_tr_b16 v[132:133], v25 offset:8192
    ds_read_b64_tr_b16 v[134:135], v25 offset:10240
    ds_read_b64_tr_b16 v[136:137], v26 offset:8192
    ds_read_b64_tr_b16 v[138:139], v26 offset:10240
    ds_read_b64_tr_b16 v[140:141], v27 offset:8192
    ds_read_b64_tr_b16 v[142:143], v27 offset:10240
    s_waitcnt lgkmcnt(9)
    v_mfma_f32_32x32x16_bf16 v[40:55], v[108:111], v[104:107], v[40:55]
    v_mfma_f32_32x32x16_bf16 v[56:71], v[112:115], v[104:107], v[56:71]
    v_mfma_f32_32x32x16_bf16 v[72:87], v[116:119], v[104:107], v[72:87]
    v_mfma_f32_32x32x16_bf16 v[88:103], v[120:123], v[104:107], v[88:103]
    ds_read_b128 v[104:107], v22 offset:0
    ds_read_b64_tr_b16 v[108:109], v24 offset:16384
    ds_read_b64_tr_b16 v[110:111], v24 offset:18432
    ds_read_b64_tr_b16 v[112:113], v25 offset:16384
    ds_read_b64_tr_b16 v[114:115], v25 offset:18432
    ds_read_b64_tr_b16 v[116:117], v26 offset:16384
    ds_read_b64_tr_b16 v[118:119], v26 offset:18432
    ds_read_b64_tr_b16 v[120:121], v27 offset:16384
    ds_read_b64_tr_b16 v[122:123], v27 offset:18432
    s_waitcnt lgkmcnt(9)
    v_mfma_f32_32x32x16_bf16 v[40:55], v[128:131], v[124:127], v[40:55]
    v_mfma_f32_32x32x16_bf16 v[56:71], v[132:135], v[124:127], v[56:71]
    v_mfma_f32_32x32x16_bf16 v[72:87], v[136:139], v[124:127], v[72:87]
    v_mfma_f32_32x32x16_bf16 v[88:103], v[140:143], v[124:127], v[88:103]
    ds_read_b128 v[124:127], v23 offset:0
    ds_read_b64_tr_b16 v[128:129], v24 offset:24576
    ds_read_b64_tr_b16 v[130:131], v24 offset:26624
    ds_read_b64_tr_b16 v[132:133], v25 offset:24576
    ds_read_b64_tr_b16 v[134:135], v25 offset:26624
    ds_read_b64_tr_b16 v[136:137], v26 offset:24576
    ds_read_b64_tr_b16 v[138:139], v26 offset:26624
    ds_read_b64_tr_b16 v[140:141], v27 offset:24576
    ds_read_b64_tr_b16 v[142:143], v27 offset:26624
    s_waitcnt lgkmcnt(9)
    v_mfma_f32_32x32x16_bf16 v[40:55], v[108:111], v[104:107], v[40:55]
    v_mfma_f32_32x32x16_bf16 v[56:71], v[112:115], v[104:107], v[56:71]
    v_mfma_f32_32x32x16_bf16 v[72:87], v[116:119], v[104:107], v[72:87]
    v_mfma_f32_32x32x16_bf16 v[88:103], v[120:123], v[104:107], v[88:103]
    ds_read_b128 v[104:107], v20 offset:16384
    ds_read_b64_tr_b16 v[108:109], v24 offset:32768
    ds_read_b64_tr_b16 v[110:111], v24 offset:34816
    ds_read_b64_tr_b16 v[112:113], v25 offset:32768
    ds_read_b64_tr_b16 v[114:115], v25 offset:34816
    ds_read_b64_tr_b16 v[116:117], v26 offset:32768
    ds_read_b64_tr_b16 v[118:119], v26 offset:34816
    ds_read_b64_tr_b16 v[120:121], v27 offset:32768
    ds_read_b64_tr_b16 v[122:123], v27 offset:34816
    s_waitcnt lgkmcnt(9)
    v_mfma_f32_32x32x16_bf16 v[40:55], v[128:131], v[124:127], v[40:55]
    v_mfma_f32_32x32x16_bf16 v[56:71], v[132:135], v[124:127], v[56:71]
    v_mfma_f32_32x32x16_bf16 v[72:87], v[136:139], v[124:127], v[72:87]
    v_mfma_f32_32x32x16_bf16 v[88:103], v[140:143], v[124:127], v[88:103]
    s_cmp_ge_u32 s31, 15
    s_cbranch_scc1 L_lend_gw3_1_kernel
    s_cmp_ge_u32 s31, 13
    s_cbranch_scc1 L_gw3_1_kernel_tail3
    s_waitcnt vmcnt(0)
    s_barrier
    s_add_u32 s35, s31, 3
    s_add_u32 s35, s35, s42
    s_sub_u32 s34, s35, 16
    s_cmp_ge_u32 s35, 16
    s_cselect_b32 s35, s34, s35
    s_mul_i32 s33, s35, 458752
    s_lshl_b32 s32, s35, 7
    s_add_u32 m0, s40, 0
    s_nop 0
    buffer_load_dwordx4 v2, s[8:11], s32 offen lds
    s_add_u32 m0, s40, 1024
    s_nop 0
    buffer_load_dwordx4 v3, s[8:11], s32 offen lds
    s_add_u32 m0, s41, 0
    s_nop 0
    buffer_load_dwordx4 v10, s[12:15], s33 offen lds
    s_add_u32 m0, s41, 1024
    s_nop 0
    buffer_load_dwordx4 v11, s[12:15], s33 offen lds
    s_add_u32 m0, s41, 2048
    s_nop 0
    buffer_load_dwordx4 v12, s[12:15], s33 offen lds
    s_add_u32 m0, s41, 3072
    s_nop 0
    buffer_load_dwordx4 v13, s[12:15], s33 offen lds
    s_branch L_gw3_1_kernel_join4
L_gw3_1_kernel_tail3:
    s_waitcnt vmcnt(0)
    s_barrier
L_gw3_1_kernel_join4:
    ds_read_b128 v[124:127], v21 offset:16384
    ds_read_b64_tr_b16 v[128:129], v24 offset:40960
    ds_read_b64_tr_b16 v[130:131], v24 offset:43008
    ds_read_b64_tr_b16 v[132:133], v25 offset:40960
    ds_read_b64_tr_b16 v[134:135], v25 offset:43008
    ds_read_b64_tr_b16 v[136:137], v26 offset:40960
    ds_read_b64_tr_b16 v[138:139], v26 offset:43008
    ds_read_b64_tr_b16 v[140:141], v27 offset:40960
    ds_read_b64_tr_b16 v[142:143], v27 offset:43008
    s_waitcnt lgkmcnt(9)
    v_mfma_f32_32x32x16_bf16 v[40:55], v[108:111], v[104:107], v[40:55]
    v_mfma_f32_32x32x16_bf16 v[56:71], v[112:115], v[104:107], v[56:71]
    v_mfma_f32_32x32x16_bf16 v[72:87], v[116:119], v[104:107], v[72:87]
    v_mfma_f32_32x32x16_bf16 v[88:103], v[120:123], v[104:107], v[88:103]
    ds_read_b128 v[104:107], v22 offset:16384
    ds_read_b64_tr_b16 v[108:109], v24 offset:49152
    ds_read_b64_tr_b16 v[110:111], v24 offset:51200
    ds_read_b64_tr_b16 v[112:113], v25 offset:49152
    ds_read_b64_tr_b16 v[114:115], v25 offset:51200
    ds_read_b64_tr_b16 v[116:117], v26 offset:49152
    ds_read_b64_tr_b16 v[118:119], v26 offset:51200
    ds_read_b64_tr_b16 v[120:121], v27 offset:49152
    ds_read_b64_tr_b16 v[122:123], v27 offset:51200
    s_waitcnt lgkmcnt(9)
    v_mfma_f32_32x32x16_bf16 v[40:55], v[128:131], v[124:127], v[40:55]
    v_mfma_f32_32x32x16_bf16 v[56:71], v[132:135], v[124:127], v[56:71]
    v_mfma_f32_32x32x16_bf16 v[72:87], v[136:139], v[124:127], v[72:87]
    v_mfma_f32_32x32x16_bf16 v[88:103], v[140:143], v[124:127], v[88:103]
    ds_read_b128 v[124:127], v23 offset:16384
    ds_read_b64_tr_b16 v[128:129], v24 offset:57344
    ds_read_b64_tr_b16 v[130:131], v24 offset:59392
    ds_read_b64_tr_b16 v[132:133], v25 offset:57344
    ds_read_b64_tr_b16 v[134:135], v25 offset:59392
    ds_read_b64_tr_b16 v[136:137], v26 offset:57344
    ds_read_b64_tr_b16 v[138:139], v26 offset:59392
    ds_read_b64_tr_b16 v[140:141], v27 offset:57344
    ds_read_b64_tr_b16 v[142:143], v27 offset:59392
    s_waitcnt lgkmcnt(9)
    v_mfma_f32_32x32x16_bf16 v[40:55], v[108:111], v[104:107], v[40:55]
    v_mfma_f32_32x32x16_bf16 v[56:71], v[112:115], v[104:107], v[56:71]
    v_mfma_f32_32x32x16_bf16 v[72:87], v[116:119], v[104:107], v[72:87]
    v_mfma_f32_32x32x16_bf16 v[88:103], v[120:123], v[104:107], v[88:103]
    ds_read_b128 v[104:107], v20 offset:32768
    ds_read_b64_tr_b16 v[108:109], v28 offset:0
    ds_read_b64_tr_b16 v[110:111], v28 offset:2048
    ds_read_b64_tr_b16 v[112:113], v29 offset:0
    ds_read_b64_tr_b16 v[114:115], v29 offset:2048
    ds_read_b64_tr_b16 v[116:117], v30 offset:0
    ds_read_b64_tr_b16 v[118:119], v30 offset:2048
    ds_read_b64_tr_b16 v[120:121], v31 offset:0
    ds_read_b64_tr_b16 v[122:123], v31 offset:2048
    s_waitcnt lgkmcnt(9)
    v_mfma_f32_32x32x16_bf16 v[40:55], v[128:131], v[124:127], v[40:55]
    v_mfma_f32_32x32x16_bf16 v[56:71], v[132:135], v[124:127], v[56:71]
    v_mfma_f32_32x32x16_bf16 v[72:87], v[136:139], v[124:127], v[72:87]
    v_mfma_f32_32x32x16_bf16 v[88:103], v[140:143], v[124:127], v[88:103]
    s_cmp_ge_u32 s31, 14
    s_cbranch_scc1 L_lend_gw3_1_kernel
    s_cmp_ge_u32 s31, 12
    s_cbranch_scc1 L_gw3_1_kernel_tail5
    s_waitcnt vmcnt(0)
    s_barrier
    s_add_u32 s35, s31, 4
    s_add_u32 s35, s35, s42
    s_sub_u32 s34, s35, 16
    s_cmp_ge_u32 s35, 16
    s_cselect_b32 s35, s34, s35
    s_mul_i32 s33, s35, 458752
    s_lshl_b32 s32, s35, 7
    s_add_u32 m0, s40, 16384
    s_nop 0
    buffer_load_dwordx4 v2, s[8:11], s32 offen lds
    s_add_u32 m0, s40, 17408
    s_nop 0
    buffer_load_dwordx4 v3, s[8:11], s32 offen lds
    s_add_u32 m0, s41, 32768
    s_nop 0
    buffer_load_dwordx4 v10, s[12:15], s33 offen lds
    s_add_u32 m0, s41, 33792
    s_nop 0
    buffer_load_dwordx4 v11, s[12:15], s33 offen lds
    s_add_u32 m0, s41, 34816
    s_nop 0
    buffer_load_dwordx4 v12, s[12:15], s33 offen lds
    s_add_u32 m0, s41, 35840
    s_nop 0
    buffer_load_dwordx4 v13, s[12:15], s33 offen lds
    s_branch L_gw3_1_kernel_join6
L_gw3_1_kernel_tail5:
    s_waitcnt vmcnt(0)
    s_barrier
L_gw3_1_kernel_join6:
    ds_read_b128 v[124:127], v21 offset:32768
    ds_read_b64_tr_b16 v[128:129], v28 offset:8192
    ds_read_b64_tr_b16 v[130:131], v28 offset:10240
    ds_read_b64_tr_b16 v[132:133], v29 offset:8192
    ds_read_b64_tr_b16 v[134:135], v29 offset:10240
    ds_read_b64_tr_b16 v[136:137], v30 offset:8192
    ds_read_b64_tr_b16 v[138:139], v30 offset:10240
    ds_read_b64_tr_b16 v[140:141], v31 offset:8192
    ds_read_b64_tr_b16 v[142:143], v31 offset:10240
    s_waitcnt lgkmcnt(9)
    v_mfma_f32_32x32x16_bf16 v[40:55], v[108:111], v[104:107], v[40:55]
    v_mfma_f32_32x32x16_bf16 v[56:71], v[112:115], v[104:107], v[56:71]
    v_mfma_f32_32x32x16_bf16 v[72:87], v[116:119], v[104:107], v[72:87]
    v_mfma_f32_32x32x16_bf16 v[88:103], v[120:123], v[104:107], v[88:103]
    ds_read_b128 v[104:107], v22 offset:32768
    ds_read_b64_tr_b16 v[108:109], v28 offset:16384
    ds_read_b64_tr_b16 v[110:111], v28 offset:18432
    ds_read_b64_tr_b16 v[112:113], v29 offset:16384
    ds_read_b64_tr_b16 v[114:115], v29 offset:18432
    ds_read_b64_tr_b16 v[116:117], v30 offset:16384
    ds_read_b64_tr_b16 v[118:119], v30 offset:18432
    ds_read_b64_tr_b16 v[120:121], v31 offset:16384
    ds_read_b64_tr_b16 v[122:123], v31 offset:18432
    s_waitcnt lgkmcnt(9)
    v_mfma_f32_32x32x16_bf16 v[40:55], v[128:131], v[124:127], v[40:55]
    v_mfma_f32_32x32x16_bf16 v[56:71], v[132:135], v[124:127], v[56:71]
    v_mfma_f32_32x32x16_bf16 v[72:87], v[136:139], v[124:127], v[72:87]
    v_mfma_f32_32x32x16_bf16 v[88:103], v[140:143], v[124:127], v[88:103]
    ds_read_b128 v[124:127], v23 offset:32768
    ds_read_b64_tr_b16 v[128:129], v28 offset:24576
    ds_read_b64_tr_b16 v[130:131], v28 offset:26624
    ds_read_b64_tr_b16 v[132:133], v29 offset:24576
    ds_read_b64_tr_b16 v[134:135], v29 offset:26624
    ds_read_b64_tr_b16 v[136:137], v30 offset:24576
    ds_read_b64_tr_b16 v[138:139], v30 offset:26624
    ds_read_b64_tr_b16 v[140:141], v31 offset:24576
    ds_read_b64_tr_b16 v[142:143], v31 offset:26624
    s_waitcnt lgkmcnt(9)
    v_mfma_f32_32x32x16_bf16 v[40:55], v[108:111], v[104:107], v[40:55]
    v_mfma_f32_32x32x16_bf16 v[56:71], v[112:115], v[104:107], v[56:71]
    v_mfma_f32_32x32x16_bf16 v[72:87], v[116:119], v[104:107], v[72:87]
    v_mfma_f32_32x32x16_bf16 v[88:103], v[120:123], v[104:107], v[88:103]
    ds_read_b128 v[104:107], v20 offset:0
    ds_read_b64_tr_b16 v[108:109], v24 offset:0
    ds_read_b64_tr_b16 v[110:111], v24 offset:2048
    ds_read_b64_tr_b16 v[112:113], v25 offset:0
    ds_read_b64_tr_b16 v[114:115], v25 offset:2048
    ds_read_b64_tr_b16 v[116:117], v26 offset:0
    ds_read_b64_tr_b16 v[118:119], v26 offset:2048
    ds_read_b64_tr_b16 v[120:121], v27 offset:0
    ds_read_b64_tr_b16 v[122:123], v27 offset:2048
    s_waitcnt lgkmcnt(9)
    v_mfma_f32_32x32x16_bf16 v[40:55], v[128:131], v[124:127], v[40:55]
    v_mfma_f32_32x32x16_bf16 v[56:71], v[132:135], v[124:127], v[56:71]
    v_mfma_f32_32x32x16_bf16 v[72:87], v[136:139], v[124:127], v[72:87]
    v_mfma_f32_32x32x16_bf16 v[88:103], v[140:143], v[124:127], v[88:103]
    s_add_u32 s31, s31, 3
    s_cmp_lt_u32 s31, 16
    s_cbranch_scc1 L_loop_gw3_1_kernel
L_lend_gw3_1_kernel:
    s_nop 15
    s_nop 7
    s_lshr_b32 s31, s30, 1
    s_and_b32 s34, s30, 1
    s_mul_i32 s38, s31, 32
    s_mul_i32 s39, s34, 128
    s_lshl_b32 s31, s28, 7
    s_add_u32 s38, s38, s31
    s_mul_i32 s31, s29, 256
    s_add_u32 s39, s39, s31
    s_barrier
    s_mul_i32 s32, s30, 8704
    v_and_b32 v1, 31, v0
    v_mul_u32_u24 v1, 272, v1
    v_lshrrev_b32 v2, 5, v0
    v_lshlrev_b32 v2, 3, v2
    v_add_u32 v1, v1, v2
    v_add_u32 v1, s32, v1
    v_cvt_pk_bf16_f32 v40, v40, v40
    v_lshlrev_b32 v40, 16, v40
    v_cvt_pk_bf16_f32 v41, v41, v41
    v_lshlrev_b32 v41, 16, v41
    v_cvt_pk_bf16_f32 v42, v42, v42
    v_lshlrev_b32 v42, 16, v42
    v_cvt_pk_bf16_f32 v43, v43, v43
    v_lshlrev_b32 v43, 16, v43
    v_mul_f32 v148, v40, v40
    v_fma_f32 v148, v148, s36, 1.0
    v_mul_f32 v148, v148, v40
    v_mul_f32 v148, s37, v148
    v_exp_f32 v148, v148
    s_nop 0
    v_add_f32 v148, 1.0, v148
    v_rcp_f32 v148, v148
    s_nop 0
    v_mul_f32 v40, v40, v148
    v_mul_f32 v148, v41, v41
    v_fma_f32 v148, v148, s36, 1.0
    v_mul_f32 v148, v148, v41
    v_mul_f32 v148, s37, v148
    v_exp_f32 v148, v148
    s_nop 0
    v_add_f32 v148, 1.0, v148
    v_rcp_f32 v148, v148
    s_nop 0
    v_mul_f32 v41, v41, v148
    v_mul_f32 v148, v42, v42
    v_fma_f32 v148, v148, s36, 1.0
    v_mul_f32 v148, v148, v42
    v_mul_f32 v148, s37, v148
    v_exp_f32 v148, v148
    s_nop 0
    v_add_f32 v148, 1.0, v148
    v_rcp_f32 v148, v148
    s_nop 0
    v_mul_f32 v42, v42, v148
    v_mul_f32 v148, v43, v43
    v_fma_f32 v148, v148, s36, 1.0
    v_mul_f32 v148, v148, v43
    v_mul_f32 v148, s37, v148
    v_exp_f32 v148, v148
    s_nop 0
    v_add_f32 v148, 1.0, v148
    v_rcp_f32 v148, v148
    s_nop 0
    v_mul_f32 v43, v43, v148
    v_cvt_pk_bf16_f32 v40, v40, v41
    v_cvt_pk_bf16_f32 v41, v42, v43
    ds_write_b64 v1, v[40:41] offset:0
    v_cvt_pk_bf16_f32 v44, v44, v44
    v_lshlrev_b32 v44, 16, v44
    v_cvt_pk_bf16_f32 v45, v45, v45
    v_lshlrev_b32 v45, 16, v45
    v_cvt_pk_bf16_f32 v46, v46, v46
    v_lshlrev_b32 v46, 16, v46
    v_cvt_pk_bf16_f32 v47, v47, v47
    v_lshlrev_b32 v47, 16, v47
    v_mul_f32 v148, v44, v44
    v_fma_f32 v148, v148, s36, 1.0
    v_mul_f32 v148, v148, v44
    v_mul_f32 v148, s37, v148
    v_exp_f32 v148, v148
    s_nop 0
    v_add_f32 v148, 1.0, v148
    v_rcp_f32 v148, v148
    s_nop 0
    v_mul_f32 v44, v44, v148
    v_mul_f32 v148, v45, v45
    v_fma_f32 v148, v148, s36, 1.0
    v_mul_f32 v148, v148, v45
    v_mul_f32 v148, s37, v148
    v_exp_f32 v148, v148
    s_nop 0
    v_add_f32 v148, 1.0, v148
    v_rcp_f32 v148, v148
    s_nop 0
    v_mul_f32 v45, v45, v148
    v_mul_f32 v148, v46, v46
    v_fma_f32 v148, v148, s36, 1.0
    v_mul_f32 v148, v148, v46
    v_mul_f32 v148, s37, v148
    v_exp_f32 v148, v148
    s_nop 0
    v_add_f32 v148, 1.0, v148
    v_rcp_f32 v148, v148
    s_nop 0
    v_mul_f32 v46, v46, v148
    v_mul_f32 v148, v47, v47
    v_fma_f32 v148, v148, s36, 1.0
    v_mul_f32 v148, v148, v47
    v_mul_f32 v148, s37, v148
    v_exp_f32 v148, v148
    s_nop 0
    v_add_f32 v148, 1.0, v148
    v_rcp_f32 v148, v148
    s_nop 0
    v_mul_f32 v47, v47, v148
    v_cvt_pk_bf16_f32 v44, v44, v45
    v_cvt_pk_bf16_f32 v45, v46, v47
    ds_write_b64 v1, v[44:45] offset:16
    v_cvt_pk_bf16_f32 v48, v48, v48
    v_lshlrev_b32 v48, 16, v48
    v_cvt_pk_bf16_f32 v49, v49, v49
    v_lshlrev_b32 v49, 16, v49
    v_cvt_pk_bf16_f32 v50, v50, v50
    v_lshlrev_b32 v50, 16, v50
    v_cvt_pk_bf16_f32 v51, v51, v51
    v_lshlrev_b32 v51, 16, v51
    v_mul_f32 v148, v48, v48
    v_fma_f32 v148, v148, s36, 1.0
    v_mul_f32 v148, v148, v48
    v_mul_f32 v148, s37, v148
    v_exp_f32 v148, v148
    s_nop 0
    v_add_f32 v148, 1.0, v148
    v_rcp_f32 v148, v148
    s_nop 0
    v_mul_f32 v48, v48, v148
    v_mul_f32 v148, v49, v49
    v_fma_f32 v148, v148, s36, 1.0
    v_mul_f32 v148, v148, v49
    v_mul_f32 v148, s37, v148
    v_exp_f32 v148, v148
    s_nop 0
    v_add_f32 v148, 1.0, v148
    v_rcp_f32 v148, v148
    s_nop 0
    v_mul_f32 v49, v49, v148
    v_mul_f32 v148, v50, v50
    v_fma_f32 v148, v148, s36, 1.0
    v_mul_f32 v148, v148, v50
    v_mul_f32 v148, s37, v148
    v_exp_f32 v148, v148
    s_nop 0
    v_add_f32 v148, 1.0, v148
    v_rcp_f32 v148, v148
    s_nop 0
    v_mul_f32 v50, v50, v148
    v_mul_f32 v148, v51, v51
    v_fma_f32 v148, v148, s36, 1.0
    v_mul_f32 v148, v148, v51
    v_mul_f32 v148, s37, v148
    v_exp_f32 v148, v148
    s_nop 0
    v_add_f32 v148, 1.0, v148
    v_rcp_f32 v148, v148
    s_nop 0
    v_mul_f32 v51, v51, v148
    v_cvt_pk_bf16_f32 v48, v48, v49
    v_cvt_pk_bf16_f32 v49, v50, v51
    ds_write_b64 v1, v[48:49] offset:32
    v_cvt_pk_bf16_f32 v52, v52, v52
    v_lshlrev_b32 v52, 16, v52
    v_cvt_pk_bf16_f32 v53, v53, v53
    v_lshlrev_b32 v53, 16, v53
    v_cvt_pk_bf16_f32 v54, v54, v54
    v_lshlrev_b32 v54, 16, v54
    v_cvt_pk_bf16_f32 v55, v55, v55
    v_lshlrev_b32 v55, 16, v55
    v_mul_f32 v148, v52, v52
    v_fma_f32 v148, v148, s36, 1.0
    v_mul_f32 v148, v148, v52
    v_mul_f32 v148, s37, v148
    v_exp_f32 v148, v148
    s_nop 0
    v_add_f32 v148, 1.0, v148
    v_rcp_f32 v148, v148
    s_nop 0
    v_mul_f32 v52, v52, v148
    v_mul_f32 v148, v53, v53
    v_fma_f32 v148, v148, s36, 1.0
    v_mul_f32 v148, v148, v53
    v_mul_f32 v148, s37, v148
    v_exp_f32 v148, v148
    s_nop 0
    v_add_f32 v148, 1.0, v148
    v_rcp_f32 v148, v148
    s_nop 0
    v_mul_f32 v53, v53, v148
    v_mul_f32 v148, v54, v54
    v_fma_f32 v148, v148, s36, 1.0
    v_mul_f32 v148, v148, v54
    v_mul_f32 v148, s37, v148
    v_exp_f32 v148, v148
    s_nop 0
    v_add_f32 v148, 1.0, v148
    v_rcp_f32 v148, v148
    s_nop 0
    v_mul_f32 v54, v54, v148
    v_mul_f32 v148, v55, v55
    v_fma_f32 v148, v148, s36, 1.0
    v_mul_f32 v148, v148, v55
    v_mul_f32 v148, s37, v148
    v_exp_f32 v148, v148
    s_nop 0
    v_add_f32 v148, 1.0, v148
    v_rcp_f32 v148, v148
    s_nop 0
    v_mul_f32 v55, v55, v148
    v_cvt_pk_bf16_f32 v52, v52, v53
    v_cvt_pk_bf16_f32 v53, v54, v55
    ds_write_b64 v1, v[52:53] offset:48
    v_cvt_pk_bf16_f32 v56, v56, v56
    v_lshlrev_b32 v56, 16, v56
    v_cvt_pk_bf16_f32 v57, v57, v57
    v_lshlrev_b32 v57, 16, v57
    v_cvt_pk_bf16_f32 v58, v58, v58
    v_lshlrev_b32 v58, 16, v58
    v_cvt_pk_bf16_f32 v59, v59, v59
    v_lshlrev_b32 v59, 16, v59
    v_mul_f32 v148, v56, v56
    v_fma_f32 v148, v148, s36, 1.0
    v_mul_f32 v148, v148, v56
    v_mul_f32 v148, s37, v148
    v_exp_f32 v148, v148
    s_nop 0
    v_add_f32 v148, 1.0, v148
    v_rcp_f32 v148, v148
    s_nop 0
    v_mul_f32 v56, v56, v148
    v_mul_f32 v148, v57, v57
    v_fma_f32 v148, v148, s36, 1.0
    v_mul_f32 v148, v148, v57
    v_mul_f32 v148, s37, v148
    v_exp_f32 v148, v148
    s_nop 0
    v_add_f32 v148, 1.0, v148
    v_rcp_f32 v148, v148
    s_nop 0
    v_mul_f32 v57, v57, v148
    v_mul_f32 v148, v58, v58
    v_fma_f32 v148, v148, s36, 1.0
    v_mul_f32 v148, v148, v58
    v_mul_f32 v148, s37, v148
    v_exp_f32 v148, v148
    s_nop 0
    v_add_f32 v148, 1.0, v148
    v_rcp_f32 v148, v148
    s_nop 0
    v_mul_f32 v58, v58, v148
    v_mul_f32 v148, v59, v59
    v_fma_f32 v148, v148, s36, 1.0
    v_mul_f32 v148, v148, v59
    v_mul_f32 v148, s37, v148
    v_exp_f32 v148, v148
    s_nop 0
    v_add_f32 v148, 1.0, v148
    v_rcp_f32 v148, v148
    s_nop 0
    v_mul_f32 v59, v59, v148
    v_cvt_pk_bf16_f32 v56, v56, v57
    v_cvt_pk_bf16_f32 v57, v58, v59
    ds_write_b64 v1, v[56:57] offset:64
    v_cvt_pk_bf16_f32 v60, v60, v60
    v_lshlrev_b32 v60, 16, v60
    v_cvt_pk_bf16_f32 v61, v61, v61
    v_lshlrev_b32 v61, 16, v61
    v_cvt_pk_bf16_f32 v62, v62, v62
    v_lshlrev_b32 v62, 16, v62
    v_cvt_pk_bf16_f32 v63, v63, v63
    v_lshlrev_b32 v63, 16, v63
    v_mul_f32 v148, v60, v60
    v_fma_f32 v148, v148, s36, 1.0
    v_mul_f32 v148, v148, v60
    v_mul_f32 v148, s37, v148
    v_exp_f32 v148, v148
    s_nop 0
    v_add_f32 v148, 1.0, v148
    v_rcp_f32 v148, v148
    s_nop 0
    v_mul_f32 v60, v60, v148
    v_mul_f32 v148, v61, v61
    v_fma_f32 v148, v148, s36, 1.0
    v_mul_f32 v148, v148, v61
    v_mul_f32 v148, s37, v148
    v_exp_f32 v148, v148
    s_nop 0
    v_add_f32 v148, 1.0, v148
    v_rcp_f32 v148, v148
    s_nop 0
    v_mul_f32 v61, v61, v148
    v_mul_f32 v148, v62, v62
    v_fma_f32 v148, v148, s36, 1.0
    v_mul_f32 v148, v148, v62
    v_mul_f32 v148, s37, v148
    v_exp_f32 v148, v148
    s_nop 0
    v_add_f32 v148, 1.0, v148
    v_rcp_f32 v148, v148
    s_nop 0
    v_mul_f32 v62, v62, v148
    v_mul_f32 v148, v63, v63
    v_fma_f32 v148, v148, s36, 1.0
    v_mul_f32 v148, v148, v63
    v_mul_f32 v148, s37, v148
    v_exp_f32 v148, v148
    s_nop 0
    v_add_f32 v148, 1.0, v148
    v_rcp_f32 v148, v148
    s_nop 0
    v_mul_f32 v63, v63, v148
    v_cvt_pk_bf16_f32 v60, v60, v61
    v_cvt_pk_bf16_f32 v61, v62, v63
    ds_write_b64 v1, v[60:61] offset:80
    v_cvt_pk_bf16_f32 v64, v64, v64
    v_lshlrev_b32 v64, 16, v64
    v_cvt_pk_bf16_f32 v65, v65, v65
    v_lshlrev_b32 v65, 16, v65
    v_cvt_pk_bf16_f32 v66, v66, v66
    v_lshlrev_b32 v66, 16, v66
    v_cvt_pk_bf16_f32 v67, v67, v67
    v_lshlrev_b32 v67, 16, v67
    v_mul_f32 v148, v64, v64
    v_fma_f32 v148, v148, s36, 1.0
    v_mul_f32 v148, v148, v64
    v_mul_f32 v148, s37, v148
    v_exp_f32 v148, v148
    s_nop 0
    v_add_f32 v148, 1.0, v148
    v_rcp_f32 v148, v148
    s_nop 0
    v_mul_f32 v64, v64, v148
    v_mul_f32 v148, v65, v65
    v_fma_f32 v148, v148, s36, 1.0
    v_mul_f32 v148, v148, v65
    v_mul_f32 v148, s37, v148
    v_exp_f32 v148, v148
    s_nop 0
    v_add_f32 v148, 1.0, v148
    v_rcp_f32 v148, v148
    s_nop 0
    v_mul_f32 v65, v65, v148
    v_mul_f32 v148, v66, v66
    v_fma_f32 v148, v148, s36, 1.0
    v_mul_f32 v148, v148, v66
    v_mul_f32 v148, s37, v148
    v_exp_f32 v148, v148
    s_nop 0
    v_add_f32 v148, 1.0, v148
    v_rcp_f32 v148, v148
    s_nop 0
    v_mul_f32 v66, v66, v148
    v_mul_f32 v148, v67, v67
    v_fma_f32 v148, v148, s36, 1.0
    v_mul_f32 v148, v148, v67
    v_mul_f32 v148, s37, v148
    v_exp_f32 v148, v148
    s_nop 0
    v_add_f32 v148, 1.0, v148
    v_rcp_f32 v148, v148
    s_nop 0
    v_mul_f32 v67, v67, v148
    v_cvt_pk_bf16_f32 v64, v64, v65
    v_cvt_pk_bf16_f32 v65, v66, v67
    ds_write_b64 v1, v[64:65] offset:96
    v_cvt_pk_bf16_f32 v68, v68, v68
    v_lshlrev_b32 v68, 16, v68
    v_cvt_pk_bf16_f32 v69, v69, v69
    v_lshlrev_b32 v69, 16, v69
    v_cvt_pk_bf16_f32 v70, v70, v70
    v_lshlrev_b32 v70, 16, v70
    v_cvt_pk_bf16_f32 v71, v71, v71
    v_lshlrev_b32 v71, 16, v71
    v_mul_f32 v148, v68, v68
    v_fma_f32 v148, v148, s36, 1.0
    v_mul_f32 v148, v148, v68
    v_mul_f32 v148, s37, v148
    v_exp_f32 v148, v148
    s_nop 0
    v_add_f32 v148, 1.0, v148
    v_rcp_f32 v148, v148
    s_nop 0
    v_mul_f32 v68, v68, v148
    v_mul_f32 v148, v69, v69
    v_fma_f32 v148, v148, s36, 1.0
    v_mul_f32 v148, v148, v69
    v_mul_f32 v148, s37, v148
    v_exp_f32 v148, v148
    s_nop 0
    v_add_f32 v148, 1.0, v148
    v_rcp_f32 v148, v148
    s_nop 0
    v_mul_f32 v69, v69, v148
    v_mul_f32 v148, v70, v70
    v_fma_f32 v148, v148, s36, 1.0
    v_mul_f32 v148, v148, v70
    v_mul_f32 v148, s37, v148
    v_exp_f32 v148, v148
    s_nop 0
    v_add_f32 v148, 1.0, v148
    v_rcp_f32 v148, v148
    s_nop 0
    v_mul_f32 v70, v70, v148
    v_mul_f32 v148, v71, v71
    v_fma_f32 v148, v148, s36, 1.0
    v_mul_f32 v148, v148, v71
    v_mul_f32 v148, s37, v148
    v_exp_f32 v148, v148
    s_nop 0
    v_add_f32 v148, 1.0, v148
    v_rcp_f32 v148, v148
    s_nop 0
    v_mul_f32 v71, v71, v148
    v_cvt_pk_bf16_f32 v68, v68, v69
    v_cvt_pk_bf16_f32 v69, v70, v71
    ds_write_b64 v1, v[68:69] offset:112
    v_cvt_pk_bf16_f32 v72, v72, v72
    v_lshlrev_b32 v72, 16, v72
    v_cvt_pk_bf16_f32 v73, v73, v73
    v_lshlrev_b32 v73, 16, v73
    v_cvt_pk_bf16_f32 v74, v74, v74
    v_lshlrev_b32 v74, 16, v74
    v_cvt_pk_bf16_f32 v75, v75, v75
    v_lshlrev_b32 v75, 16, v75
    v_mul_f32 v148, v72, v72
    v_fma_f32 v148, v148, s36, 1.0
    v_mul_f32 v148, v148, v72
    v_mul_f32 v148, s37, v148
    v_exp_f32 v148, v148
    s_nop 0
    v_add_f32 v148, 1.0, v148
    v_rcp_f32 v148, v148
    s_nop 0
    v_mul_f32 v72, v72, v148
    v_mul_f32 v148, v73, v73
    v_fma_f32 v148, v148, s36, 1.0
    v_mul_f32 v148, v148, v73
    v_mul_f32 v148, s37, v148
    v_exp_f32 v148, v148
    s_nop 0
    v_add_f32 v148, 1.0, v148
    v_rcp_f32 v148, v148
    s_nop 0
    v_mul_f32 v73, v73, v148
    v_mul_f32 v148, v74, v74
    v_fma_f32 v148, v148, s36, 1.0
    v_mul_f32 v148, v148, v74
    v_mul_f32 v148, s37, v148
    v_exp_f32 v148, v148
    s_nop 0
    v_add_f32 v148, 1.0, v148
    v_rcp_f32 v148, v148
    s_nop 0
    v_mul_f32 v74, v74, v148
    v_mul_f32 v148, v75, v75
    v_fma_f32 v148, v148, s36, 1.0
    v_mul_f32 v148, v148, v75
    v_mul_f32 v148, s37, v148
    v_exp_f32 v148, v148
    s_nop 0
    v_add_f32 v148, 1.0, v148
    v_rcp_f32 v148, v148
    s_nop 0
    v_mul_f32 v75, v75, v148
    v_cvt_pk_bf16_f32 v72, v72, v73
    v_cvt_pk_bf16_f32 v73, v74, v75
    ds_write_b64 v1, v[72:73] offset:128
    v_cvt_pk_bf16_f32 v76, v76, v76
    v_lshlrev_b32 v76, 16, v76
    v_cvt_pk_bf16_f32 v77, v77, v77
    v_lshlrev_b32 v77, 16, v77
    v_cvt_pk_bf16_f32 v78, v78, v78
    v_lshlrev_b32 v78, 16, v78
    v_cvt_pk_bf16_f32 v79, v79, v79
    v_lshlrev_b32 v79, 16, v79
    v_mul_f32 v148, v76, v76
    v_fma_f32 v148, v148, s36, 1.0
    v_mul_f32 v148, v148, v76
    v_mul_f32 v148, s37, v148
    v_exp_f32 v148, v148
    s_nop 0
    v_add_f32 v148, 1.0, v148
    v_rcp_f32 v148, v148
    s_nop 0
    v_mul_f32 v76, v76, v148
    v_mul_f32 v148, v77, v77
    v_fma_f32 v148, v148, s36, 1.0
    v_mul_f32 v148, v148, v77
    v_mul_f32 v148, s37, v148
    v_exp_f32 v148, v148
    s_nop 0
    v_add_f32 v148, 1.0, v148
    v_rcp_f32 v148, v148
    s_nop 0
    v_mul_f32 v77, v77, v148
    v_mul_f32 v148, v78, v78
    v_fma_f32 v148, v148, s36, 1.0
    v_mul_f32 v148, v148, v78
    v_mul_f32 v148, s37, v148
    v_exp_f32 v148, v148
    s_nop 0
    v_add_f32 v148, 1.0, v148
    v_rcp_f32 v148, v148
    s_nop 0
    v_mul_f32 v78, v78, v148
    v_mul_f32 v148, v79, v79
    v_fma_f32 v148, v148, s36, 1.0
    v_mul_f32 v148, v148, v79
    v_mul_f32 v148, s37, v148
    v_exp_f32 v148, v148
    s_nop 0
    v_add_f32 v148, 1.0, v148
    v_rcp_f32 v148, v148
    s_nop 0
    v_mul_f32 v79, v79, v148
    v_cvt_pk_bf16_f32 v76, v76, v77
    v_cvt_pk_bf16_f32 v77, v78, v79
    ds_write_b64 v1, v[76:77] offset:144
    v_cvt_pk_bf16_f32 v80, v80, v80
    v_lshlrev_b32 v80, 16, v80
    v_cvt_pk_bf16_f32 v81, v81, v81
    v_lshlrev_b32 v81, 16, v81
    v_cvt_pk_bf16_f32 v82, v82, v82
    v_lshlrev_b32 v82, 16, v82
    v_cvt_pk_bf16_f32 v83, v83, v83
    v_lshlrev_b32 v83, 16, v83
    v_mul_f32 v148, v80, v80
    v_fma_f32 v148, v148, s36, 1.0
    v_mul_f32 v148, v148, v80
    v_mul_f32 v148, s37, v148
    v_exp_f32 v148, v148
    s_nop 0
    v_add_f32 v148, 1.0, v148
    v_rcp_f32 v148, v148
    s_nop 0
    v_mul_f32 v80, v80, v148
    v_mul_f32 v148, v81, v81
    v_fma_f32 v148, v148, s36, 1.0
    v_mul_f32 v148, v148, v81
    v_mul_f32 v148, s37, v148
    v_exp_f32 v148, v148
    s_nop 0
    v_add_f32 v148, 1.0, v148
    v_rcp_f32 v148, v148
    s_nop 0
    v_mul_f32 v81, v81, v148
    v_mul_f32 v148, v82, v82
    v_fma_f32 v148, v148, s36, 1.0
    v_mul_f32 v148, v148, v82
    v_mul_f32 v148, s37, v148
    v_exp_f32 v148, v148
    s_nop 0
    v_add_f32 v148, 1.0, v148
    v_rcp_f32 v148, v148
    s_nop 0
    v_mul_f32 v82, v82, v148
    v_mul_f32 v148, v83, v83
    v_fma_f32 v148, v148, s36, 1.0
    v_mul_f32 v148, v148, v83
    v_mul_f32 v148, s37, v148
    v_exp_f32 v148, v148
    s_nop 0
    v_add_f32 v148, 1.0, v148
    v_rcp_f32 v148, v148
    s_nop 0
    v_mul_f32 v83, v83, v148
    v_cvt_pk_bf16_f32 v80, v80, v81
    v_cvt_pk_bf16_f32 v81, v82, v83
    ds_write_b64 v1, v[80:81] offset:160
    v_cvt_pk_bf16_f32 v84, v84, v84
    v_lshlrev_b32 v84, 16, v84
    v_cvt_pk_bf16_f32 v85, v85, v85
    v_lshlrev_b32 v85, 16, v85
    v_cvt_pk_bf16_f32 v86, v86, v86
    v_lshlrev_b32 v86, 16, v86
    v_cvt_pk_bf16_f32 v87, v87, v87
    v_lshlrev_b32 v87, 16, v87
    v_mul_f32 v148, v84, v84
    v_fma_f32 v148, v148, s36, 1.0
    v_mul_f32 v148, v148, v84
    v_mul_f32 v148, s37, v148
    v_exp_f32 v148, v148
    s_nop 0
    v_add_f32 v148, 1.0, v148
    v_rcp_f32 v148, v148
    s_nop 0
    v_mul_f32 v84, v84, v148
    v_mul_f32 v148, v85, v85
    v_fma_f32 v148, v148, s36, 1.0
    v_mul_f32 v148, v148, v85
    v_mul_f32 v148, s37, v148
    v_exp_f32 v148, v148
    s_nop 0
    v_add_f32 v148, 1.0, v148
    v_rcp_f32 v148, v148
    s_nop 0
    v_mul_f32 v85, v85, v148
    v_mul_f32 v148, v86, v86
    v_fma_f32 v148, v148, s36, 1.0
    v_mul_f32 v148, v148, v86
    v_mul_f32 v148, s37, v148
    v_exp_f32 v148, v148
    s_nop 0
    v_add_f32 v148, 1.0, v148
    v_rcp_f32 v148, v148
    s_nop 0
    v_mul_f32 v86, v86, v148
    v_mul_f32 v148, v87, v87
    v_fma_f32 v148, v148, s36, 1.0
    v_mul_f32 v148, v148, v87
    v_mul_f32 v148, s37, v148
    v_exp_f32 v148, v148
    s_nop 0
    v_add_f32 v148, 1.0, v148
    v_rcp_f32 v148, v148
    s_nop 0
    v_mul_f32 v87, v87, v148
    v_cvt_pk_bf16_f32 v84, v84, v85
    v_cvt_pk_bf16_f32 v85, v86, v87
    ds_write_b64 v1, v[84:85] offset:176
    v_cvt_pk_bf16_f32 v88, v88, v88
    v_lshlrev_b32 v88, 16, v88
    v_cvt_pk_bf16_f32 v89, v89, v89
    v_lshlrev_b32 v89, 16, v89
    v_cvt_pk_bf16_f32 v90, v90, v90
    v_lshlrev_b32 v90, 16, v90
    v_cvt_pk_bf16_f32 v91, v91, v91
    v_lshlrev_b32 v91, 16, v91
    v_mul_f32 v148, v88, v88
    v_fma_f32 v148, v148, s36, 1.0
    v_mul_f32 v148, v148, v88
    v_mul_f32 v148, s37, v148
    v_exp_f32 v148, v148
    s_nop 0
    v_add_f32 v148, 1.0, v148
    v_rcp_f32 v148, v148
    s_nop 0
    v_mul_f32 v88, v88, v148
    v_mul_f32 v148, v89, v89
    v_fma_f32 v148, v148, s36, 1.0
    v_mul_f32 v148, v148, v89
    v_mul_f32 v148, s37, v148
    v_exp_f32 v148, v148
    s_nop 0
    v_add_f32 v148, 1.0, v148
    v_rcp_f32 v148, v148
    s_nop 0
    v_mul_f32 v89, v89, v148
    v_mul_f32 v148, v90, v90
    v_fma_f32 v148, v148, s36, 1.0
    v_mul_f32 v148, v148, v90
    v_mul_f32 v148, s37, v148
    v_exp_f32 v148, v148
    s_nop 0
    v_add_f32 v148, 1.0, v148
    v_rcp_f32 v148, v148
    s_nop 0
    v_mul_f32 v90, v90, v148
    v_mul_f32 v148, v91, v91
    v_fma_f32 v148, v148, s36, 1.0
    v_mul_f32 v148, v148, v91
    v_mul_f32 v148, s37, v148
    v_exp_f32 v148, v148
    s_nop 0
    v_add_f32 v148, 1.0, v148
    v_rcp_f32 v148, v148
    s_nop 0
    v_mul_f32 v91, v91, v148
    v_cvt_pk_bf16_f32 v88, v88, v89
    v_cvt_pk_bf16_f32 v89, v90, v91
    ds_write_b64 v1, v[88:89] offset:192
    v_cvt_pk_bf16_f32 v92, v92, v92
    v_lshlrev_b32 v92, 16, v92
    v_cvt_pk_bf16_f32 v93, v93, v93
    v_lshlrev_b32 v93, 16, v93
    v_cvt_pk_bf16_f32 v94, v94, v94
    v_lshlrev_b32 v94, 16, v94
    v_cvt_pk_bf16_f32 v95, v95, v95
    v_lshlrev_b32 v95, 16, v95
    v_mul_f32 v148, v92, v92
    v_fma_f32 v148, v148, s36, 1.0
    v_mul_f32 v148, v148, v92
    v_mul_f32 v148, s37, v148
    v_exp_f32 v148, v148
    s_nop 0
    v_add_f32 v148, 1.0, v148
    v_rcp_f32 v148, v148
    s_nop 0
    v_mul_f32 v92, v92, v148
    v_mul_f32 v148, v93, v93
    v_fma_f32 v148, v148, s36, 1.0
    v_mul_f32 v148, v148, v93
    v_mul_f32 v148, s37, v148
    v_exp_f32 v148, v148
    s_nop 0
    v_add_f32 v148, 1.0, v148
    v_rcp_f32 v148, v148
    s_nop 0
    v_mul_f32 v93, v93, v148
    v_mul_f32 v148, v94, v94
    v_fma_f32 v148, v148, s36, 1.0
    v_mul_f32 v148, v148, v94
    v_mul_f32 v148, s37, v148
    v_exp_f32 v148, v148
    s_nop 0
    v_add_f32 v148, 1.0, v148
    v_rcp_f32 v148, v148
    s_nop 0
    v_mul_f32 v94, v94, v148
    v_mul_f32 v148, v95, v95
    v_fma_f32 v148, v148, s36, 1.0
    v_mul_f32 v148, v148, v95
    v_mul_f32 v148, s37, v148
    v_exp_f32 v148, v148
    s_nop 0
    v_add_f32 v148, 1.0, v148
    v_rcp_f32 v148, v148
    s_nop 0
    v_mul_f32 v95, v95, v148
    v_cvt_pk_bf16_f32 v92, v92, v93
    v_cvt_pk_bf16_f32 v93, v94, v95
    ds_write_b64 v1, v[92:93] offset:208
    v_cvt_pk_bf16_f32 v96, v96, v96
    v_lshlrev_b32 v96, 16, v96
    v_cvt_pk_bf16_f32 v97, v97, v97
    v_lshlrev_b32 v97, 16, v97
    v_cvt_pk_bf16_f32 v98, v98, v98
    v_lshlrev_b32 v98, 16, v98
    v_cvt_pk_bf16_f32 v99, v99, v99
    v_lshlrev_b32 v99, 16, v99
    v_mul_f32 v148, v96, v96
    v_fma_f32 v148, v148, s36, 1.0
    v_mul_f32 v148, v148, v96
    v_mul_f32 v148, s37, v148
    v_exp_f32 v148, v148
    s_nop 0
    v_add_f32 v148, 1.0, v148
    v_rcp_f32 v148, v148
    s_nop 0
    v_mul_f32 v96, v96, v148
    v_mul_f32 v148, v97, v97
    v_fma_f32 v148, v148, s36, 1.0
    v_mul_f32 v148, v148, v97
    v_mul_f32 v148, s37, v148
    v_exp_f32 v148, v148
    s_nop 0
    v_add_f32 v148, 1.0, v148
    v_rcp_f32 v148, v148
    s_nop 0
    v_mul_f32 v97, v97, v148
    v_mul_f32 v148, v98, v98
    v_fma_f32 v148, v148, s36, 1.0
    v_mul_f32 v148, v148, v98
    v_mul_f32 v148, s37, v148
    v_exp_f32 v148, v148
    s_nop 0
    v_add_f32 v148, 1.0, v148
    v_rcp_f32 v148, v148
    s_nop 0
    v_mul_f32 v98, v98, v148
    v_mul_f32 v148, v99, v99
    v_fma_f32 v148, v148, s36, 1.0
    v_mul_f32 v148, v148, v99
    v_mul_f32 v148, s37, v148
    v_exp_f32 v148, v148
    s_nop 0
    v_add_f32 v148, 1.0, v148
    v_rcp_f32 v148, v148
    s_nop 0
    v_mul_f32 v99, v99, v148
    v_cvt_pk_bf16_f32 v96, v96, v97
    v_cvt_pk_bf16_f32 v97, v98, v99
    ds_write_b64 v1, v[96:97] offset:224
    v_cvt_pk_bf16_f32 v100, v100, v100
    v_lshlrev_b32 v100, 16, v100
    v_cvt_pk_bf16_f32 v101, v101, v101
    v_lshlrev_b32 v101, 16, v101
    v_cvt_pk_bf16_f32 v102, v102, v102
    v_lshlrev_b32 v102, 16, v102
    v_cvt_pk_bf16_f32 v103, v103, v103
    v_lshlrev_b32 v103, 16, v103
    v_mul_f32 v148, v100, v100
    v_fma_f32 v148, v148, s36, 1.0
    v_mul_f32 v148, v148, v100
    v_mul_f32 v148, s37, v148
    v_exp_f32 v148, v148
    s_nop 0
    v_add_f32 v148, 1.0, v148
    v_rcp_f32 v148, v148
    s_nop 0
    v_mul_f32 v100, v100, v148
    v_mul_f32 v148, v101, v101
    v_fma_f32 v148, v148, s36, 1.0
    v_mul_f32 v148, v148, v101
    v_mul_f32 v148, s37, v148
    v_exp_f32 v148, v148
    s_nop 0
    v_add_f32 v148, 1.0, v148
    v_rcp_f32 v148, v148
    s_nop 0
    v_mul_f32 v101, v101, v148
    v_mul_f32 v148, v102, v102
    v_fma_f32 v148, v148, s36, 1.0
    v_mul_f32 v148, v148, v102
    v_mul_f32 v148, s37, v148
    v_exp_f32 v148, v148
    s_nop 0
    v_add_f32 v148, 1.0, v148
    v_rcp_f32 v148, v148
    s_nop 0
    v_mul_f32 v102, v102, v148
    v_mul_f32 v148, v103, v103
    v_fma_f32 v148, v148, s36, 1.0
    v_mul_f32 v148, v148, v103
    v_mul_f32 v148, s37, v148
    v_exp_f32 v148, v148
    s_nop 0
    v_add_f32 v148, 1.0, v148
    v_rcp_f32 v148, v148
    s_nop 0
    v_mul_f32 v103, v103, v148
    v_cvt_pk_bf16_f32 v100, v100, v101
    v_cvt_pk_bf16_f32 v101, v102, v103
    ds_write_b64 v1, v[100:101] offset:240
    s_mov_b32 s35, 7168
    s_lshl_b32 s39, s39, 1
    v_add_u32 v2, 0, v0
    v_mul_u32_u24 v3, 4096, v2
    v_lshrrev_b32 v3, 16, v3
    v_mul_u32_u24 v4, 16, v3
    v_sub_u32 v4, v2, v4
    v_lshlrev_b32 v4, 4, v4
    v_mul_u32_u24 v5, 272, v3
    v_add_u32 v5, v5, v4
    v_add_u32 v8, s32, v5
    v_add_u32 v3, s38, v3
    v_mul_lo_u32 v3, v3, s35
    v_add_u32 v3, v3, v4
    v_add_u32 v16, s39, v3
    v_add_u32 v2, 64, v0
    v_mul_u32_u24 v3, 4096, v2
    v_lshrrev_b32 v3, 16, v3
    v_mul_u32_u24 v4, 16, v3
    v_sub_u32 v4, v2, v4
    v_lshlrev_b32 v4, 4, v4
    v_mul_u32_u24 v5, 272, v3
    v_add_u32 v5, v5, v4
    v_add_u32 v9, s32, v5
    v_add_u32 v3, s38, v3
    v_mul_lo_u32 v3, v3, s35
    v_add_u32 v3, v3, v4
    v_add_u32 v17, s39, v3
    v_add_u32 v2, 128, v0
    v_mul_u32_u24 v3, 4096, v2
    v_lshrrev_b32 v3, 16, v3
    v_mul_u32_u24 v4, 16, v3
    v_sub_u32 v4, v2, v4
    v_lshlrev_b32 v4, 4, v4
    v_mul_u32_u24 v5, 272, v3
    v_add_u32 v5, v5, v4
    v_add_u32 v10, s32, v5
    v_add_u32 v3, s38, v3
    v_mul_lo_u32 v3, v3, s35
    v_add_u32 v3, v3, v4
    v_add_u32 v18, s39, v3
    v_add_u32 v2, 192, v0
    v_mul_u32_u24 v3, 4096, v2
    v_lshrrev_b32 v3, 16, v3
    v_mul_u32_u24 v4, 16, v3
    v_sub_u32 v4, v2, v4
    v_lshlrev_b32 v4, 4, v4
    v_mul_u32_u24 v5, 272, v3
    v_add_u32 v5, v5, v4
    v_add_u32 v11, s32, v5
    v_add_u32 v3, s38, v3
    v_mul_lo_u32 v3, v3, s35
    v_add_u32 v3, v3, v4
    v_add_u32 v19, s39, v3
    v_add_u32 v2, 256, v0
    v_mul_u32_u24 v3, 4096, v2
    v_lshrrev_b32 v3, 16, v3
    v_mul_u32_u24 v4, 16, v3
    v_sub_u32 v4, v2, v4
    v_lshlrev_b32 v4, 4, v4
    v_mul_u32_u24 v5, 272, v3
    v_add_u32 v5, v5, v4
    v_add_u32 v12, s32, v5
    v_add_u32 v3, s38, v3
    v_mul_lo_u32 v3, v3, s35
    v_add_u32 v3, v3, v4
    v_add_u32 v20, s39, v3
    v_add_u32 v2, 320, v0
    v_mul_u32_u24 v3, 4096, v2
    v_lshrrev_b32 v3, 16, v3
    v_mul_u32_u24 v4, 16, v3
    v_sub_u32 v4, v2, v4
    v_lshlrev_b32 v4, 4, v4
    v_mul_u32_u24 v5, 272, v3
    v_add_u32 v5, v5, v4
    v_add_u32 v13, s32, v5
    v_add_u32 v3, s38, v3
    v_mul_lo_u32 v3, v3, s35
    v_add_u32 v3, v3, v4
    v_add_u32 v21, s39, v3
    v_add_u32 v2, 384, v0
    v_mul_u32_u24 v3, 4096, v2
    v_lshrrev_b32 v3, 16, v3
    v_mul_u32_u24 v4, 16, v3
    v_sub_u32 v4, v2, v4
    v_lshlrev_b32 v4, 4, v4
    v_mul_u32_u24 v5, 272, v3
    v_add_u32 v5, v5, v4
    v_add_u32 v14, s32, v5
    v_add_u32 v3, s38, v3
    v_mul_lo_u32 v3, v3, s35
    v_add_u32 v3, v3, v4
    v_add_u32 v22, s39, v3
    v_add_u32 v2, 448, v0
    v_mul_u32_u24 v3, 4096, v2
    v_lshrrev_b32 v3, 16, v3
    v_mul_u32_u24 v4, 16, v3
    v_sub_u32 v4, v2, v4
    v_lshlrev_b32 v4, 4, v4
    v_mul_u32_u24 v5, 272, v3
    v_add_u32 v5, v5, v4
    v_add_u32 v15, s32, v5
    v_add_u32 v3, s38, v3
    v_mul_lo_u32 v3, v3, s35
    v_add_u32 v3, v3, v4
    v_add_u32 v23, s39, v3
    s_waitcnt lgkmcnt(0)
    ds_read_b128 v[40:43], v8
    ds_read_b128 v[44:47], v9
    ds_read_b128 v[48:51], v10
    ds_read_b128 v[52:55], v11
    ds_read_b128 v[56:59], v12
    ds_read_b128 v[60:63], v13
    ds_read_b128 v[64:67], v14
    ds_read_b128 v[68:71], v15
    s_waitcnt lgkmcnt(0)
    buffer_store_dwordx4 v[40:43], v16, s[16:19], 0 offen
    buffer_store_dwordx4 v[44:47], v17, s[16:19], 0 offen
    buffer_store_dwordx4 v[48:51], v18, s[16:19], 0 offen
    buffer_store_dwordx4 v[52:55], v19, s[16:19], 0 offen
    buffer_store_dwordx4 v[56:59], v20, s[16:19], 0 offen
    buffer_store_dwordx4 v[60:63], v21, s[16:19], 0 offen
    buffer_store_dwordx4 v[64:67], v22, s[16:19], 0 offen
    buffer_store_dwordx4 v[68:71], v23, s[16:19], 0 offen
L_done_gw3_1_kernel:
    s_endpgm
.globl gw4_1_kernel
.p2align 8
.type gw4_1_kernel,@function
gw4_1_kernel:
    s_cmp_ge_u32 s2, 256
    s_cbranch_scc1 L_done_gw4_1_kernel
    s_load_dwordx2 s[40:41], s[0:1], 64
    s_load_dwordx2 s[42:43], s[0:1], 72
    s_load_dwordx2 s[44:45], s[0:1], 88
    s_waitcnt lgkmcnt(0)
    s_add_u32 s8, s44, 52428800
    s_addc_u32 s9, s45, 0
    s_mov_b32 s10, 14680064
    s_mov_b32 s11, 0x00020000
    s_mov_b32 s12, s40
    s_mov_b32 s13, s41
    s_mov_b32 s14, 7340032
    s_mov_b32 s15, 0x00020000
    s_mov_b32 s16, s42
    s_mov_b32 s17, s43
    s_mov_b32 s18, 4194304
    s_mov_b32 s19, 0x00020000
    s_add_u32 s20, s44, 44040192
    s_addc_u32 s21, s45, 0
    s_mov_b32 s22, 4194304
    s_mov_b32 s23, 0x00020000
    s_add_u32 s24, s44, 25165824
    s_addc_u32 s25, s45, 0
    s_mov_b32 s26, 4194304
    s_mov_b32 s27, 0x00020000
    s_mov_b32 s36, 0x3d372713
    s_mov_b32 s37, 0xc0135761
    s_and_b32 s3, s2, 7
    s_lshr_b32 s4, s2, 3
    s_mul_i32 s5, s4, 8192
    s_lshr_b32 s5, s5, 16
    s_mul_i32 s6, s5, 8
    s_sub_u32 s6, s4, s6
    s_lshr_b32 s7, s3, 1
    s_mul_i32 s7, s7, 4
    s_add_u32 s28, s7, s5
    s_and_b32 s7, s3, 1
    s_mul_i32 s7, s7, 8
    s_add_u32 s29, s7, s6
    v_lshrrev_b32 v1, 6, v0
    s_nop 0
    v_readfirstlane_b32 s30, v1
    v_and_b32 v0, 63, v0
    v_lshrrev_b32 v1, 3, v0
    s_lshl_b32 s31, s30, 4
    s_lshl_b32 s34, s28, 7
    s_add_u32 s31, s31, s34
    v_add_u32 v1, s31, v1
    v_add_u32 v6, 0, v1
    v_lshrrev_b32 v7, 1, v6
    v_and_b32 v7, 7, v7
    v_and_b32 v8, 7, v0
    v_xor_b32 v7, v7, v8
    v_lshlrev_b32 v7, 4, v7
    s_mov_b32 s35, 7168
    v_mul_lo_u32 v6, v6, s35
    v_add_u32 v2, v6, v7
    v_add_u32 v6, 8, v1
    v_lshrrev_b32 v7, 1, v6
    v_and_b32 v7, 7, v7
    v_and_b32 v8, 7, v0
    v_xor_b32 v7, v7, v8
    v_lshlrev_b32 v7, 4, v7
    s_mov_b32 s35, 7168
    v_mul_lo_u32 v6, v6, s35
    v_add_u32 v3, v6, v7
    s_mul_i32 s31, s30, 64
    s_mul_i32 s34, s29, 128
    v_add_u32 v6, s31, v0
    v_add_u32 v6, 0, v6
    v_mul_u32_u24 v7, 8192, v6
    v_lshrrev_b32 v7, 16, v7
    v_mul_u32_u24 v8, 8, v7
    v_sub_u32 v8, v6, v8
    v_lshlrev_b32 v9, 1, v7
    v_and_b32 v9, 4, v9
    v_xor_b32 v8, v8, v9
    v_lshlrev_b32 v8, 4, v8
    s_mov_b32 s35, 2048
    v_mul_lo_u32 v7, v7, s35
    v_add_u32 v7, v7, v8
    v_add_u32 v10, s34, v7
    s_lshr_b32 s31, s30, 1
    s_and_b32 s34, s30, 1
    s_mul_i32 s38, s31, 32
    s_mul_i32 s39, s34, 32
    v_and_b32 v6, 31, v0
    v_add_u32 v6, s38, v6
    v_lshrrev_b32 v7, 1, v6
    v_and_b32 v7, 7, v7
    v_lshrrev_b32 v8, 5, v0
    v_xor_b32 v7, v7, v8
    v_lshlrev_b32 v7, 4, v7
    v_lshlrev_b32 v6, 7, v6
    v_add_u32 v6, v6, v7
    v_xor_b32 v20, 0, v6
    v_add_u32 v36, 65536, v20
    v_xor_b32 v21, 32, v6
    v_add_u32 v37, 65536, v21
    v_xor_b32 v22, 64, v6
    v_add_u32 v38, 65536, v22
    v_xor_b32 v23, 96, v6
    v_add_u32 v39, 65536, v23
    v_lshrrev_b32 v6, 5, v0
    v_lshlrev_b32 v6, 3, v6
    v_bfe_u32 v7, v0, 2, 2
    v_add_u32 v6, v6, v7
    v_bfe_u32 v8, v0, 4, 1
    v_lshlrev_b32 v8, 4, v8
    v_and_b32 v9, 3, v0
    v_lshlrev_b32 v9, 2, v9
    v_add_u32 v8, v8, v9
    v_add_u32 v8, s39, v8
    v_add_u32 v9, 0, v8
    v_lshlrev_b32 v9, 1, v9
    v_lshlrev_b32 v18, 5, v7
    v_and_b32 v18, 64, v18
    v_xor_b32 v9, v9, v18
    v_mul_u32_u24 v19, 128, v6
    v_add_u32 v24, v19, v9
    v_add_u32 v24, 98304, v24
    v_add_u32 v28, 16384, v24
    v_add_u32 v32, 32768, v24
    v_mov_b32 v40, 0
    v_mov_b32 v41, 0
    v_mov_b32 v42, 0
    v_mov_b32 v43, 0
    v_mov_b32 v44, 0
    v_mov_b32 v45, 0
    v_mov_b32 v46, 0
    v_mov_b32 v47, 0
    v_mov_b32 v48, 0
    v_mov_b32 v49, 0
    v_mov_b32 v50, 0
    v_mov_b32 v51, 0
    v_mov_b32 v52, 0
    v_mov_b32 v53, 0
    v_mov_b32 v54, 0
    v_mov_b32 v55, 0
    s_lshl_b32 s40, s30, 11
    s_mul_i32 s41, s30, 1024
    s_add_u32 s41, s41, 98304
    s_mov_b32 s32, 0
    s_mov_b32 s33, 0
    s_and_b32 s42, s4, 7
    s_mul_i32 s42, s42, 7
    s_mov_b32 s42, 0
    s_mov_b32 s35, 0
    s_add_u32 s35, s35, s42
    s_sub_u32 s34, s35, 56
    s_cmp_ge_u32 s35, 56
    s_cselect_b32 s35, s34, s35
    s_mul_i32 s33, s35, 131072
    s_lshl_b32 s32, s35, 7
    s_add_u32 m0, s40, 0
    s_nop 0
    buffer_load_dwordx4 v2, s[8:11], s32 offen lds
    s_add_u32 m0, s40, 1024
    s_nop 0
    buffer_load_dwordx4 v3, s[8:11], s32 offen lds
    s_add_u32 m0, s41, 0
    s_nop 0
    buffer_load_dwordx4 v10, s[12:15], s33 offen lds
    s_mov_b32 s35, 1
    s_add_u32 s35, s35, s42
    s_sub_u32 s34, s35, 56
    s_cmp_ge_u32 s35, 56
    s_cselect_b32 s35, s34, s35
    s_mul_i32 s33, s35, 131072
    s_lshl_b32 s32, s35, 7
    s_add_u32 m0, s40, 16384
    s_nop 0
    buffer_load_dwordx4 v2, s[8:11], s32 offen lds
    s_add_u32 m0, s40, 17408
    s_nop 0
    buffer_load_dwordx4 v3, s[8:11], s32 offen lds
    s_add_u32 m0, s41, 8192
    s_nop 0
    buffer_load_dwordx4 v10, s[12:15], s33 offen lds
    s_mov_b32 s35, 2
    s_add_u32 s35, s35, s42
    s_sub_u32 s34, s35, 56
    s_cmp_ge_u32 s35, 56
    s_cselect_b32 s35, s34, s35
    s_mul_i32 s33, s35, 131072
    s_lshl_b32 s32, s35, 7
    s_add_u32 m0, s40, 32768
    s_nop 0
    buffer_load_dwordx4 v2, s[8:11], s32 offen lds
    s_add_u32 m0, s40, 33792
    s_nop 0
    buffer_load_dwordx4 v3, s[8:11], s32 offen lds
    s_add_u32 m0, s41, 16384
    s_nop 0
    buffer_load_dwordx4 v10, s[12:15], s33 offen lds
    s_mov_b32 s35, 3
    s_add_u32 s35, s35, s42
    s_sub_u32 s34, s35, 56
    s_cmp_ge_u32 s35, 56
    s_cselect_b32 s35, s34, s35
    s_mul_i32 s33, s35, 131072
    s_lshl_b32 s32, s35, 7
    s_add_u32 m0, s40, 49152
    s_nop 0
    buffer_load_dwordx4 v2, s[8:11], s32 offen lds
    s_add_u32 m0, s40, 50176
    s_nop 0
    buffer_load_dwordx4 v3, s[8:11], s32 offen lds
    s_add_u32 m0, s41, 24576
    s_nop 0
    buffer_load_dwordx4 v10, s[12:15], s33 offen lds
    s_mov_b32 s35, 4
    s_add_u32 s35, s35, s42
    s_sub_u32 s34, s35, 56
    s_cmp_ge_u32 s35, 56
    s_cselect_b32 s35, s34, s35
    s_mul_i32 s33, s35, 131072
    s_lshl_b32 s32, s35, 7
    s_add_u32 m0, s40, 65536
    s_nop 0
    buffer_load_dwordx4 v2, s[8:11], s32 offen lds
    s_add_u32 m0, s40, 66560
    s_nop 0
    buffer_load_dwordx4 v3, s[8:11], s32 offen lds
    s_add_u32 m0, s41, 32768
    s_nop 0
    buffer_load_dwordx4 v10, s[12:15], s33 offen lds
    s_mov_b32 s31, 0
    s_waitcnt vmcnt(12)
    s_barrier
    ds_read_b128 v[56:59], v20 offset:0
    ds_read_b64_tr_b16 v[60:61], v24 offset:0
    ds_read_b64_tr_b16 v[62:63], v24 offset:512
L_loop_gw4_1_kernel:
    s_cmp_ge_u32 s31, 56
    s_cbranch_scc1 L_lend_gw4_1_kernel
    s_cmp_ge_u32 s31, 51
    s_cbranch_scc1 L_gw4_1_kernel_tail1
    s_waitcnt vmcnt(9)
    s_barrier
    s_add_u32 s35, s31, 5
    s_add_u32 s35, s35, s42
    s_sub_u32 s34, s35, 56
    s_cmp_ge_u32 s35, 56
    s_cselect_b32 s35, s34, s35
    s_mul_i32 s33, s35, 131072
    s_lshl_b32 s32, s35, 7
    s_add_u32 m0, s40, 81920
    s_nop 0
    buffer_load_dwordx4 v2, s[8:11], s32 offen lds
    s_add_u32 m0, s40, 82944
    s_nop 0
    buffer_load_dwordx4 v3, s[8:11], s32 offen lds
    s_add_u32 m0, s41, 40960
    s_nop 0
    buffer_load_dwordx4 v10, s[12:15], s33 offen lds
    s_branch L_gw4_1_kernel_join2
L_gw4_1_kernel_tail1:
    s_waitcnt vmcnt(0)
    s_barrier
L_gw4_1_kernel_join2:
    ds_read_b128 v[64:67], v21 offset:0
    ds_read_b64_tr_b16 v[68:69], v24 offset:2048
    ds_read_b64_tr_b16 v[70:71], v24 offset:2560
    s_waitcnt lgkmcnt(3)
    v_mfma_f32_32x32x16_bf16 v[40:55], v[60:63], v[56:59], v[40:55]
    ds_read_b128 v[56:59], v22 offset:0
    ds_read_b64_tr_b16 v[60:61], v24 offset:4096
    ds_read_b64_tr_b16 v[62:63], v24 offset:4608
    s_waitcnt lgkmcnt(3)
    v_mfma_f32_32x32x16_bf16 v[40:55], v[68:71], v[64:67], v[40:55]
    ds_read_b128 v[64:67], v23 offset:0
    ds_read_b64_tr_b16 v[68:69], v24 offset:6144
    ds_read_b64_tr_b16 v[70:71], v24 offset:6656
    s_waitcnt lgkmcnt(3)
    v_mfma_f32_32x32x16_bf16 v[40:55], v[60:63], v[56:59], v[40:55]
    ds_read_b128 v[56:59], v20 offset:16384
    ds_read_b64_tr_b16 v[60:61], v24 offset:8192
    ds_read_b64_tr_b16 v[62:63], v24 offset:8704
    s_waitcnt lgkmcnt(3)
    v_mfma_f32_32x32x16_bf16 v[40:55], v[68:71], v[64:67], v[40:55]
    s_cmp_ge_u32 s31, 55
    s_cbranch_scc1 L_lend_gw4_1_kernel
    s_cmp_ge_u32 s31, 50
    s_cbranch_scc1 L_gw4_1_kernel_tail3
    s_waitcnt vmcnt(9)
    s_barrier
    s_add_u32 s35, s31, 6
    s_add_u32 s35, s35, s42
    s_sub_u32 s34, s35, 56
    s_cmp_ge_u32 s35, 56
    s_cselect_b32 s35, s34, s35
    s_mul_i32 s33, s35, 131072
    s_lshl_b32 s32, s35, 7
    s_add_u32 m0, s40, 0
    s_nop 0
    buffer_load_dwordx4 v2, s[8:11], s32 offen lds
    s_add_u32 m0, s40, 1024
    s_nop 0
    buffer_load_dwordx4 v3, s[8:11], s32 offen lds
    s_add_u32 m0, s41, 0
    s_nop 0
    buffer_load_dwordx4 v10, s[12:15], s33 offen lds
    s_branch L_gw4_1_kernel_join4
L_gw4_1_kernel_tail3:
    s_waitcnt vmcnt(0)
    s_barrier
L_gw4_1_kernel_join4:
    ds_read_b128 v[64:67], v21 offset:16384
    ds_read_b64_tr_b16 v[68:69], v24 offset:10240
    ds_read_b64_tr_b16 v[70:71], v24 offset:10752
    s_waitcnt lgkmcnt(3)
    v_mfma_f32_32x32x16_bf16 v[40:55], v[60:63], v[56:59], v[40:55]
    ds_read_b128 v[56:59], v22 offset:16384
    ds_read_b64_tr_b16 v[60:61], v24 offset:12288
    ds_read_b64_tr_b16 v[62:63], v24 offset:12800
    s_waitcnt lgkmcnt(3)
    v_mfma_f32_32x32x16_bf16 v[40:55], v[68:71], v[64:67], v[40:55]
    ds_read_b128 v[64:67], v23 offset:16384
    ds_read_b64_tr_b16 v[68:69], v24 offset:14336
    ds_read_b64_tr_b16 v[70:71], v24 offset:14848
    s_waitcnt lgkmcnt(3)
    v_mfma_f32_32x32x16_bf16 v[40:55], v[60:63], v[56:59], v[40:55]
    ds_read_b128 v[56:59], v20 offset:32768
    ds_read_b64_tr_b16 v[60:61], v28 offset:0
    ds_read_b64_tr_b16 v[62:63], v28 offset:512
    s_waitcnt lgkmcnt(3)
    v_mfma_f32_32x32x16_bf16 v[40:55], v[68:71], v[64:67], v[40:55]
    s_cmp_ge_u32 s31, 54
    s_cbranch_scc1 L_lend_gw4_1_kernel
    s_cmp_ge_u32 s31, 49
    s_cbranch_scc1 L_gw4_1_kernel_tail5
    s_waitcnt vmcnt(9)
    s_barrier
    s_add_u32 s35, s31, 7
    s_add_u32 s35, s35, s42
    s_sub_u32 s34, s35, 56
    s_cmp_ge_u32 s35, 56
    s_cselect_b32 s35, s34, s35
    s_mul_i32 s33, s35, 131072
    s_lshl_b32 s32, s35, 7
    s_add_u32 m0, s40, 16384
    s_nop 0
    buffer_load_dwordx4 v2, s[8:11], s32 offen lds
    s_add_u32 m0, s40, 17408
    s_nop 0
    buffer_load_dwordx4 v3, s[8:11], s32 offen lds
    s_add_u32 m0, s41, 8192
    s_nop 0
    buffer_load_dwordx4 v10, s[12:15], s33 offen lds
    s_branch L_gw4_1_kernel_join6
L_gw4_1_kernel_tail5:
    s_waitcnt vmcnt(0)
    s_barrier
L_gw4_1_kernel_join6:
    ds_read_b128 v[64:67], v21 offset:32768
    ds_read_b64_tr_b16 v[68:69], v28 offset:2048
    ds_read_b64_tr_b16 v[70:71], v28 offset:2560
    s_waitcnt lgkmcnt(3)
    v_mfma_f32_32x32x16_bf16 v[40:55], v[60:63], v[56:59], v[40:55]
    ds_read_b128 v[56:59], v22 offset:32768
    ds_read_b64_tr_b16 v[60:61], v28 offset:4096
    ds_read_b64_tr_b16 v[62:63], v28 offset:4608
    s_waitcnt lgkmcnt(3)
    v_mfma_f32_32x32x16_bf16 v[40:55], v[68:71], v[64:67], v[40:55]
    ds_read_b128 v[64:67], v23 offset:32768
    ds_read_b64_tr_b16 v[68:69], v28 offset:6144
    ds_read_b64_tr_b16 v[70:71], v28 offset:6656
    s_waitcnt lgkmcnt(3)
    v_mfma_f32_32x32x16_bf16 v[40:55], v[60:63], v[56:59], v[40:55]
    ds_read_b128 v[56:59], v20 offset:49152
    ds_read_b64_tr_b16 v[60:61], v28 offset:8192
    ds_read_b64_tr_b16 v[62:63], v28 offset:8704
    s_waitcnt lgkmcnt(3)
    v_mfma_f32_32x32x16_bf16 v[40:55], v[68:71], v[64:67], v[40:55]
    s_cmp_ge_u32 s31, 53
    s_cbranch_scc1 L_lend_gw4_1_kernel
    s_cmp_ge_u32 s31, 48
    s_cbranch_scc1 L_gw4_1_kernel_tail7
    s_waitcnt vmcnt(9)
    s_barrier
    s_add_u32 s35, s31, 8
    s_add_u32 s35, s35, s42
    s_sub_u32 s34, s35, 56
    s_cmp_ge_u32 s35, 56
    s_cselect_b32 s35, s34, s35
    s_mul_i32 s33, s35, 131072
    s_lshl_b32 s32, s35, 7
    s_add_u32 m0, s40, 32768
    s_nop 0
    buffer_load_dwordx4 v2, s[8:11], s32 offen lds
    s_add_u32 m0, s40, 33792
    s_nop 0
    buffer_load_dwordx4 v3, s[8:11], s32 offen lds
    s_add_u32 m0, s41, 16384
    s_nop 0
    buffer_load_dwordx4 v10, s[12:15], s33 offen lds
    s_branch L_gw4_1_kernel_join8
L_gw4_1_kernel_tail7:
    s_waitcnt vmcnt(0)
    s_barrier
L_gw4_1_kernel_join8:
    ds_read_b128 v[64:67], v21 offset:49152
    ds_read_b64_tr_b16 v[68:69], v28 offset:10240
    ds_read_b64_tr_b16 v[70:71], v28 offset:10752
    s_waitcnt lgkmcnt(3)
    v_mfma_f32_32x32x16_bf16 v[40:55], v[60:63], v[56:59], v[40:55]
    ds_read_b128 v[56:59], v22 offset:49152
    ds_read_b64_tr_b16 v[60:61], v28 offset:12288
    ds_read_b64_tr_b16 v[62:63], v28 offset:12800
    s_waitcnt lgkmcnt(3)
    v_mfma_f32_32x32x16_bf16 v[40:55], v[68:71], v[64:67], v[40:55]
    ds_read_b128 v[64:67], v23 offset:49152
    ds_read_b64_tr_b16 v[68:69], v28 offset:14336
    ds_read_b64_tr_b16 v[70:71], v28 offset:14848
    s_waitcnt lgkmcnt(3)
    v_mfma_f32_32x32x16_bf16 v[40:55], v[60:63], v[56:59], v[40:55]
    ds_read_b128 v[56:59], v36 offset:0
    ds_read_b64_tr_b16 v[60:61], v32 offset:0
    ds_read_b64_tr_b16 v[62:63], v32 offset:512
    s_waitcnt lgkmcnt(3)
    v_mfma_f32_32x32x16_bf16 v[40:55], v[68:71], v[64:67], v[40:55]
    s_cmp_ge_u32 s31, 52
    s_cbranch_scc1 L_lend_gw4_1_kernel
    s_cmp_ge_u32 s31, 47
    s_cbranch_scc1 L_gw4_1_kernel_tail9
    s_waitcnt vmcnt(9)
    s_barrier
    s_add_u32 s35, s31, 9
    s_add_u32 s35, s35, s42
    s_sub_u32 s34, s35, 56
    s_cmp_ge_u32 s35, 56
    s_cselect_b32 s35, s34, s35
    s_mul_i32 s33, s35, 131072
    s_lshl_b32 s32, s35, 7
    s_add_u32 m0, s40, 49152
    s_nop 0
    buffer_load_dwordx4 v2, s[8:11], s32 offen lds
    s_add_u32 m0, s40, 50176
    s_nop 0
    buffer_load_dwordx4 v3, s[8:11], s32 offen lds
    s_add_u32 m0, s41, 24576
    s_nop 0
    buffer_load_dwordx4 v10, s[12:15], s33 offen lds
    s_branch L_gw4_1_kernel_join10
L_gw4_1_kernel_tail9:
    s_waitcnt vmcnt(0)
    s_barrier
L_gw4_1_kernel_join10:
    ds_read_b128 v[64:67], v37 offset:0
    ds_read_b64_tr_b16 v[68:69], v32 offset:2048
    ds_read_b64_tr_b16 v[70:71], v32 offset:2560
    s_waitcnt lgkmcnt(3)
    v_mfma_f32_32x32x16_bf16 v[40:55], v[60:63], v[56:59], v[40:55]
    ds_read_b128 v[56:59], v38 offset:0
    ds_read_b64_tr_b16 v[60:61], v32 offset:4096
    ds_read_b64_tr_b16 v[62:63], v32 offset:4608
    s_waitcnt lgkmcnt(3)
    v_mfma_f32_32x32x16_bf16 v[40:55], v[68:71], v[64:67], v[40:55]
    ds_read_b128 v[64:67], v39 offset:0
    ds_read_b64_tr_b16 v[68:69], v32 offset:6144
    ds_read_b64_tr_b16 v[70:71], v32 offset:6656
    s_waitcnt lgkmcnt(3)
    v_mfma_f32_32x32x16_bf16 v[40:55], v[60:63], v[56:59], v[40:55]
    ds_read_b128 v[56:59], v36 offset:16384
    ds_read_b64_tr_b16 v[60:61], v32 offset:8192
    ds_read_b64_tr_b16 v[62:63], v32 offset:8704
    s_waitcnt lgkmcnt(3)
    v_mfma_f32_32x32x16_bf16 v[40:55], v[68:71], v[64:67], v[40:55]
    s_cmp_ge_u32 s31, 51
    s_cbranch_scc1 L_lend_gw4_1_kernel
    s_cmp_ge_u32 s31, 46
    s_cbranch_scc1 L_gw4_1_kernel_tail11
    s_waitcnt vmcnt(9)
    s_barrier
    s_add_u32 s35, s31, 10
    s_add_u32 s35, s35, s42
    s_sub_u32 s34, s35, 56
    s_cmp_ge_u32 s35, 56
    s_cselect_b32 s35, s34, s35
    s_mul_i32 s33, s35, 131072
    s_lshl_b32 s32, s35, 7
    s_add_u32 m0, s40, 65536
    s_nop 0
    buffer_load_dwordx4 v2, s[8:11], s32 offen lds
    s_add_u32 m0, s40, 66560
    s_nop 0
    buffer_load_dwordx4 v3, s[8:11], s32 offen lds
    s_add_u32 m0, s41, 32768
    s_nop 0
    buffer_load_dwordx4 v10, s[12:15], s33 offen lds
    s_branch L_gw4_1_kernel_join12
L_gw4_1_kernel_tail11:
    s_waitcnt vmcnt(0)
    s_barrier
L_gw4_1_kernel_join12:
    ds_read_b128 v[64:67], v37 offset:16384
    ds_read_b64_tr_b16 v[68:69], v32 offset:10240
    ds_read_b64_tr_b16 v[70:71], v32 offset:10752
    s_waitcnt lgkmcnt(3)
    v_mfma_f32_32x32x16_bf16 v[40:55], v[60:63], v[56:59], v[40:55]
    ds_read_b128 v[56:59], v38 offset:16384
    ds_read_b64_tr_b16 v[60:61], v32 offset:12288
    ds_read_b64_tr_b16 v[62:63], v32 offset:12800
    s_waitcnt lgkmcnt(3)
    v_mfma_f32_32x32x16_bf16 v[40:55], v[68:71], v[64:67], v[40:55]
    ds_read_b128 v[64:67], v39 offset:16384
    ds_read_b64_tr_b16 v[68:69], v32 offset:14336
    ds_read_b64_tr_b16 v[70:71], v32 offset:14848
    s_waitcnt lgkmcnt(3)
    v_mfma_f32_32x32x16_bf16 v[40:55], v[60:63], v[56:59], v[40:55]
    ds_read_b128 v[56:59], v20 offset:0
    ds_read_b64_tr_b16 v[60:61], v24 offset:0
    ds_read_b64_tr_b16 v[62:63], v24 offset:512
    s_waitcnt lgkmcnt(3)
    v_mfma_f32_32x32x16_bf16 v[40:55], v[68:71], v[64:67], v[40:55]
    s_add_u32 s31, s31, 6
    s_cmp_lt_u32 s31, 56
    s_cbranch_scc1 L_loop_gw4_1_kernel
L_lend_gw4_1_kernel:
    s_nop 15
    s_nop 7
    s_lshr_b32 s31, s30, 1
    s_and_b32 s34, s30, 1
    s_mul_i32 s38, s31, 32
    s_mul_i32 s39, s34, 32
    s_lshl_b32 s31, s28, 7
    s_add_u32 s38, s38, s31
    s_mul_i32 s31, s29, 64
    s_add_u32 s39, s39, s31
    s_barrier
    s_mul_i32 s32, s30, 2560
    v_and_b32 v1, 31, v0
    v_mul_u32_u24 v1, 80, v1
    v_lshrrev_b32 v2, 5, v0
    v_lshlrev_b32 v2, 3, v2
    v_add_u32 v1, v1, v2
    v_add_u32 v1, s32, v1
    v_cvt_pk_bf16_f32 v40, v40, v41
    v_cvt_pk_bf16_f32 v41, v42, v43
    ds_write_b64 v1, v[40:41] offset:0
    v_cvt_pk_bf16_f32 v44, v44, v45
    v_cvt_pk_bf16_f32 v45, v46, v47
    ds_write_b64 v1, v[44:45] offset:16
    v_cvt_pk_bf16_f32 v48, v48, v49
    v_cvt_pk_bf16_f32 v49, v50, v51
    ds_write_b64 v1, v[48:49] offset:32
    v_cvt_pk_bf16_f32 v52, v52, v53
    v_cvt_pk_bf16_f32 v53, v54, v55
    ds_write_b64 v1, v[52:53] offset:48
    s_mov_b32 s35, 2048
    s_lshl_b32 s39, s39, 1
    v_add_u32 v2, 0, v0
    v_mul_u32_u24 v3, 16384, v2
    v_lshrrev_b32 v3, 16, v3
    v_mul_u32_u24 v4, 4, v3
    v_sub_u32 v4, v2, v4
    v_lshlrev_b32 v4, 4, v4
    v_mul_u32_u24 v5, 80, v3
    v_add_u32 v5, v5, v4
    v_add_u32 v8, s32, v5
    v_add_u32 v3, s38, v3
    v_mul_lo_u32 v3, v3, s35
    v_add_u32 v3, v3, v4
    v_add_u32 v16, s39, v3
    v_add_u32 v2, 64, v0
    v_mul_u32_u24 v3, 16384, v2
    v_lshrrev_b32 v3, 16, v3
    v_mul_u32_u24 v4, 4, v3
    v_sub_u32 v4, v2, v4
    v_lshlrev_b32 v4, 4, v4
    v_mul_u32_u24 v5, 80, v3
    v_add_u32 v5, v5, v4
    v_add_u32 v9, s32, v5
    v_add_u32 v3, s38, v3
    v_mul_lo_u32 v3, v3, s35
    v_add_u32 v3, v3, v4
    v_add_u32 v17, s39, v3
    s_waitcnt lgkmcnt(0)
    ds_read_b128 v[40:43], v8
    buffer_load_dwordx4 v[48:51], v16, s[20:23], 0 offen
    buffer_load_dwordx4 v[56:59], v16, s[24:27], 0 offen
    ds_read_b128 v[44:47], v9
    buffer_load_dwordx4 v[52:55], v17, s[20:23], 0 offen
    buffer_load_dwordx4 v[60:63], v17, s[24:27], 0 offen
    s_waitcnt lgkmcnt(0)
    s_waitcnt vmcnt(0)
    v_lshlrev_b32 v72, 16, v40
    v_and_b32 v73, 0xffff0000, v40
    v_lshlrev_b32 v74, 16, v48
    v_and_b32 v75, 0xffff0000, v48
    v_add_f32 v72, v72, v74
    v_add_f32 v73, v73, v75
    v_cvt_pk_bf16_f32 v40, v72, v73
    v_lshlrev_b32 v72, 16, v40
    v_and_b32 v73, 0xffff0000, v40
    v_lshlrev_b32 v74, 16, v56
    v_and_b32 v75, 0xffff0000, v56
    v_add_f32 v72, v72, v74
    v_add_f32 v73, v73, v75
    v_cvt_pk_bf16_f32 v40, v72, v73
    v_lshlrev_b32 v72, 16, v41
    v_and_b32 v73, 0xffff0000, v41
    v_lshlrev_b32 v74, 16, v49
    v_and_b32 v75, 0xffff0000, v49
    v_add_f32 v72, v72, v74
    v_add_f32 v73, v73, v75
    v_cvt_pk_bf16_f32 v41, v72, v73
    v_lshlrev_b32 v72, 16, v41
    v_and_b32 v73, 0xffff0000, v41
    v_lshlrev_b32 v74, 16, v57
    v_and_b32 v75, 0xffff0000, v57
    v_add_f32 v72, v72, v74
    v_add_f32 v73, v73, v75
    v_cvt_pk_bf16_f32 v41, v72, v73
    v_lshlrev_b32 v72, 16, v42
    v_and_b32 v73, 0xffff0000, v42
    v_lshlrev_b32 v74, 16, v50
    v_and_b32 v75, 0xffff0000, v50
    v_add_f32 v72, v72, v74
    v_add_f32 v73, v73, v75
    v_cvt_pk_bf16_f32 v42, v72, v73
    v_lshlrev_b32 v72, 16, v42
    v_and_b32 v73, 0xffff0000, v42
    v_lshlrev_b32 v74, 16, v58
    v_and_b32 v75, 0xffff0000, v58
    v_add_f32 v72, v72, v74
    v_add_f32 v73, v73, v75
    v_cvt_pk_bf16_f32 v42, v72, v73
    v_lshlrev_b32 v72, 16, v43
    v_and_b32 v73, 0xffff0000, v43
    v_lshlrev_b32 v74, 16, v51
    v_and_b32 v75, 0xffff0000, v51
    v_add_f32 v72, v72, v74
    v_add_f32 v73, v73, v75
    v_cvt_pk_bf16_f32 v43, v72, v73
    v_lshlrev_b32 v72, 16, v43
    v_and_b32 v73, 0xffff0000, v43
    v_lshlrev_b32 v74, 16, v59
    v_and_b32 v75, 0xffff0000, v59
    v_add_f32 v72, v72, v74
    v_add_f32 v73, v73, v75
    v_cvt_pk_bf16_f32 v43, v72, v73
    buffer_store_dwordx4 v[40:43], v16, s[16:19], 0 offen
    v_lshlrev_b32 v72, 16, v44
    v_and_b32 v73, 0xffff0000, v44
    v_lshlrev_b32 v74, 16, v52
    v_and_b32 v75, 0xffff0000, v52
    v_add_f32 v72, v72, v74
    v_add_f32 v73, v73, v75
    v_cvt_pk_bf16_f32 v44, v72, v73
    v_lshlrev_b32 v72, 16, v44
    v_and_b32 v73, 0xffff0000, v44
    v_lshlrev_b32 v74, 16, v60
    v_and_b32 v75, 0xffff0000, v60
    v_add_f32 v72, v72, v74
    v_add_f32 v73, v73, v75
    v_cvt_pk_bf16_f32 v44, v72, v73
    v_lshlrev_b32 v72, 16, v45
    v_and_b32 v73, 0xffff0000, v45
    v_lshlrev_b32 v74, 16, v53
    v_and_b32 v75, 0xffff0000, v53
    v_add_f32 v72, v72, v74
    v_add_f32 v73, v73, v75
    v_cvt_pk_bf16_f32 v45, v72, v73
    v_lshlrev_b32 v72, 16, v45
    v_and_b32 v73, 0xffff0000, v45
    v_lshlrev_b32 v74, 16, v61
    v_and_b32 v75, 0xffff0000, v61
    v_add_f32 v72, v72, v74
    v_add_f32 v73, v73, v75
    v_cvt_pk_bf16_f32 v45, v72, v73
    v_lshlrev_b32 v72, 16, v46
    v_and_b32 v73, 0xffff0000, v46
    v_lshlrev_b32 v74, 16, v54
    v_and_b32 v75, 0xffff0000, v54
    v_add_f32 v72, v72, v74
    v_add_f32 v73, v73, v75
    v_cvt_pk_bf16_f32 v46, v72, v73
    v_lshlrev_b32 v72, 16, v46
    v_and_b32 v73, 0xffff0000, v46
    v_lshlrev_b32 v74, 16, v62
    v_and_b32 v75, 0xffff0000, v62
    v_add_f32 v72, v72, v74
    v_add_f32 v73, v73, v75
    v_cvt_pk_bf16_f32 v46, v72, v73
    v_lshlrev_b32 v72, 16, v47
    v_and_b32 v73, 0xffff0000, v47
    v_lshlrev_b32 v74, 16, v55
    v_and_b32 v75, 0xffff0000, v55
    v_add_f32 v72, v72, v74
    v_add_f32 v73, v73, v75
    v_cvt_pk_bf16_f32 v47, v72, v73
    v_lshlrev_b32 v72, 16, v47
    v_and_b32 v73, 0xffff0000, v47
    v_lshlrev_b32 v74, 16, v63
    v_and_b32 v75, 0xffff0000, v63
    v_add_f32 v72, v72, v74
    v_add_f32 v73, v73, v75
    v_cvt_pk_bf16_f32 v47, v72, v73
    buffer_store_dwordx4 v[44:47], v17, s[16:19], 0 offen
L_done_gw4_1_kernel:
    s_endpgm
.section .rodata,"a"
.p2align 6
.amdhsa_kernel lna_0_kernel
  .amdhsa_next_free_vgpr 56
  .amdhsa_next_free_sgpr 102
  .amdhsa_accum_offset 56
  .amdhsa_group_segment_fixed_size 0
  .amdhsa_kernarg_size 96
  .amdhsa_user_sgpr_count 2
  .amdhsa_user_sgpr_kernarg_segment_ptr 1
  .amdhsa_system_sgpr_workgroup_id_x 1
.end_amdhsa_kernel
.p2align 6
.amdhsa_kernel gqkv_0_kernel
  .amdhsa_next_free_vgpr 128
  .amdhsa_next_free_sgpr 102
  .amdhsa_accum_offset 128
  .amdhsa_group_segment_fixed_size 0
  .amdhsa_kernarg_size 96
  .amdhsa_user_sgpr_count 2
  .amdhsa_user_sgpr_kernarg_segment_ptr 1
  .amdhsa_system_sgpr_workgroup_id_x 1
.end_amdhsa_kernel
.p2align 6
.amdhsa_kernel akv_0_kernel
  .amdhsa_next_free_vgpr 144
  .amdhsa_next_free_sgpr 102
  .amdhsa_accum_offset 144
  .amdhsa_group_segment_fixed_size 0
  .amdhsa_kernarg_size 96
  .amdhsa_user_sgpr_count 2
  .amdhsa_user_sgpr_kernarg_segment_ptr 1
  .amdhsa_system_sgpr_workgroup_id_x 1
.end_amdhsa_kernel
.p2align 6
.amdhsa_kernel ao_0_kernel
  .amdhsa_next_free_vgpr 144
  .amdhsa_next_free_sgpr 102
  .amdhsa_accum_offset 144
  .amdhsa_group_segment_fixed_size 0
  .amdhsa_kernarg_size 96
  .amdhsa_user_sgpr_count 2
  .amdhsa_user_sgpr_kernarg_segment_ptr 1
  .amdhsa_system_sgpr_workgroup_id_x 1
.end_amdhsa_kernel
.p2align 6
.amdhsa_kernel gwo_0_kernel
  .amdhsa_next_free_vgpr 80
  .amdhsa_next_free_sgpr 102
  .amdhsa_accum_offset 80
  .amdhsa_group_segment_fixed_size 0
  .amdhsa_kernarg_size 96
  .amdhsa_user_sgpr_count 2
  .amdhsa_user_sgpr_kernarg_segment_ptr 1
  .amdhsa_system_sgpr_workgroup_id_x 1
.end_amdhsa_kernel
.p2align 6
.amdhsa_kernel lnb_0_kernel
  .amdhsa_next_free_vgpr 56
  .amdhsa_next_free_sgpr 102
  .amdhsa_accum_offset 56
  .amdhsa_group_segment_fixed_size 0
  .amdhsa_kernarg_size 96
  .amdhsa_user_sgpr_count 2
  .amdhsa_user_sgpr_kernarg_segment_ptr 1
  .amdhsa_system_sgpr_workgroup_id_x 1
.end_amdhsa_kernel
.p2align 6
.amdhsa_kernel gw1_0_kernel
  .amdhsa_next_free_vgpr 80
  .amdhsa_next_free_sgpr 102
  .amdhsa_accum_offset 80
  .amdhsa_group_segment_fixed_size 0
  .amdhsa_kernarg_size 96
  .amdhsa_user_sgpr_count 2
  .amdhsa_user_sgpr_kernarg_segment_ptr 1
  .amdhsa_system_sgpr_workgroup_id_x 1
.end_amdhsa_kernel
.p2align 6
.amdhsa_kernel gw2_0_kernel
  .amdhsa_next_free_vgpr 80
  .amdhsa_next_free_sgpr 102
  .amdhsa_accum_offset 80
  .amdhsa_group_segment_fixed_size 0
  .amdhsa_kernarg_size 96
  .amdhsa_user_sgpr_count 2
  .amdhsa_user_sgpr_kernarg_segment_ptr 1
  .amdhsa_system_sgpr_workgroup_id_x 1
.end_amdhsa_kernel
.p2align 6
.amdhsa_kernel lnc_0_kernel
  .amdhsa_next_free_vgpr 56
  .amdhsa_next_free_sgpr 102
  .amdhsa_accum_offset 56
  .amdhsa_group_segment_fixed_size 0
  .amdhsa_kernarg_size 96
  .amdhsa_user_sgpr_count 2
  .amdhsa_user_sgpr_kernarg_segment_ptr 1
  .amdhsa_system_sgpr_workgroup_id_x 1
.end_amdhsa_kernel
.p2align 6
.amdhsa_kernel gw3_0_kernel
  .amdhsa_next_free_vgpr 152
  .amdhsa_next_free_sgpr 102
  .amdhsa_accum_offset 152
  .amdhsa_group_segment_fixed_size 0
  .amdhsa_kernarg_size 96
  .amdhsa_user_sgpr_count 2
  .amdhsa_user_sgpr_kernarg_segment_ptr 1
  .amdhsa_system_sgpr_workgroup_id_x 1
.end_amdhsa_kernel
.p2align 6
.amdhsa_kernel gw4_0_kernel
  .amdhsa_next_free_vgpr 80
  .amdhsa_next_free_sgpr 102
  .amdhsa_accum_offset 80
  .amdhsa_group_segment_fixed_size 0
  .amdhsa_kernarg_size 96
  .amdhsa_user_sgpr_count 2
  .amdhsa_user_sgpr_kernarg_segment_ptr 1
  .amdhsa_system_sgpr_workgroup_id_x 1
.end_amdhsa_kernel
.p2align 6
.amdhsa_kernel lna_1_kernel
  .amdhsa_next_free_vgpr 56
  .amdhsa_next_free_sgpr 102
  .amdhsa_accum_offset 56
  .amdhsa_group_segment_fixed_size 0
  .amdhsa_kernarg_size 96
  .amdhsa_user_sgpr_count 2
  .amdhsa_user_sgpr_kernarg_segment_ptr 1
  .amdhsa_system_sgpr_workgroup_id_x 1
.end_amdhsa_kernel
.p2align 6
.amdhsa_kernel gqkv_1_kernel
  .amdhsa_next_free_vgpr 128
  .amdhsa_next_free_sgpr 102
  .amdhsa_accum_offset 128
  .amdhsa_group_segment_fixed_size 0
  .amdhsa_kernarg_size 96
  .amdhsa_user_sgpr_count 2
  .amdhsa_user_sgpr_kernarg_segment_ptr 1
  .amdhsa_system_sgpr_workgroup_id_x 1
.end_amdhsa_kernel
.p2align 6
.amdhsa_kernel akv_1_kernel
  .amdhsa_next_free_vgpr 144
  .amdhsa_next_free_sgpr 102
  .amdhsa_accum_offset 144
  .amdhsa_group_segment_fixed_size 0
  .amdhsa_kernarg_size 96
  .amdhsa_user_sgpr_count 2
  .amdhsa_user_sgpr_kernarg_segment_ptr 1
  .amdhsa_system_sgpr_workgroup_id_x 1
.end_amdhsa_kernel
.p2align 6
.amdhsa_kernel ao_1_kernel
  .amdhsa_next_free_vgpr 144
  .amdhsa_next_free_sgpr 102
  .amdhsa_accum_offset 144
  .amdhsa_group_segment_fixed_size 0
  .amdhsa_kernarg_size 96
  .amdhsa_user_sgpr_count 2
  .amdhsa_user_sgpr_kernarg_segment_ptr 1
  .amdhsa_system_sgpr_workgroup_id_x 1
.end_amdhsa_kernel
.p2align 6
.amdhsa_kernel gwo_1_kernel
  .amdhsa_next_free_vgpr 80
  .amdhsa_next_free_sgpr 102
  .amdhsa_accum_offset 80
  .amdhsa_group_segment_fixed_size 0
  .amdhsa_kernarg_size 96
  .amdhsa_user_sgpr_count 2
  .amdhsa_user_sgpr_kernarg_segment_ptr 1
  .amdhsa_system_sgpr_workgroup_id_x 1
.end_amdhsa_kernel
.p2align 6
.amdhsa_kernel lnb_1_kernel
  .amdhsa_next_free_vgpr 56
  .amdhsa_next_free_sgpr 102
  .amdhsa_accum_offset 56
  .amdhsa_group_segment_fixed_size 0
  .amdhsa_kernarg_size 96
  .amdhsa_user_sgpr_count 2
  .amdhsa_user_sgpr_kernarg_segment_ptr 1
  .amdhsa_system_sgpr_workgroup_id_x 1
.end_amdhsa_kernel
.p2align 6
.amdhsa_kernel gw1_1_kernel
  .amdhsa_next_free_vgpr 80
  .amdhsa_next_free_sgpr 102
  .amdhsa_accum_offset 80
  .amdhsa_group_segment_fixed_size 0
  .amdhsa_kernarg_size 96
  .amdhsa_user_sgpr_count 2
  .amdhsa_user_sgpr_kernarg_segment_ptr 1
  .amdhsa_system_sgpr_workgroup_id_x 1
.end_amdhsa_kernel
.p2align 6
.amdhsa_kernel gw2_1_kernel
  .amdhsa_next_free_vgpr 80
  .amdhsa_next_free_sgpr 102
  .amdhsa_accum_offset 80
  .amdhsa_group_segment_fixed_size 0
  .amdhsa_kernarg_size 96
  .amdhsa_user_sgpr_count 2
  .amdhsa_user_sgpr_kernarg_segment_ptr 1
  .amdhsa_system_sgpr_workgroup_id_x 1
.end_amdhsa_kernel
.p2align 6
.amdhsa_kernel lnc_1_kernel
  .amdhsa_next_free_vgpr 56
  .amdhsa_next_free_sgpr 102
  .amdhsa_accum_offset 56
  .amdhsa_group_segment_fixed_size 0
  .amdhsa_kernarg_size 96
  .amdhsa_user_sgpr_count 2
  .amdhsa_user_sgpr_kernarg_segment_ptr 1
  .amdhsa_system_sgpr_workgroup_id_x 1
.end_amdhsa_kernel
.p2align 6
.amdhsa_kernel gw3_1_kernel
  .amdhsa_next_free_vgpr 152
  .amdhsa_next_free_sgpr 102
  .amdhsa_accum_offset 152
  .amdhsa_group_segment_fixed_size 0
  .amdhsa_kernarg_size 96
  .amdhsa_user_sgpr_count 2
  .amdhsa_user_sgpr_kernarg_segment_ptr 1
  .amdhsa_system_sgpr_workgroup_id_x 1
.end_amdhsa_kernel
.p2align 6
.amdhsa_kernel gw4_1_kernel
  .amdhsa_next_free_vgpr 80
  .amdhsa_next_free_sgpr 102
  .amdhsa_accum_offset 80
  .amdhsa_group_segment_fixed_size 0
  .amdhsa_kernarg_size 96
  .amdhsa_user_sgpr_count 2
  .amdhsa_user_sgpr_kernarg_segment_ptr 1
  .amdhsa_system_sgpr_workgroup_id_x 1
.end_amdhsa_kernel
```
